```python
import torch

def _softmax(x, axis=-1):
    return torch.softmax(x, dim=axis)

def _gelu(x):
    return torch.nn.functional.gelu(x, approximate='tanh')

def _silu(x):
    return torch.nn.functional.silu(x)

def _sigmoid(x):
    return torch.sigmoid(x)

def _layernorm(x, axis=-1, eps=1e-05):
    m = x.mean(dim=axis, keepdim=True)
    v = x.var(dim=axis, keepdim=True, unbiased=False)
    return (x - m) / torch.sqrt(v + eps)

def _scatter_add(tgt, idx, src, axis=0):
    return tgt.clone().index_add_(axis, idx, src)

def _segment_sum(src, seg, n):
    out = torch.zeros((n,) + src.shape[1:], dtype=src.dtype)
    return out.index_add_(0, seg, src)

def _pad(x, pw):
    flat = tuple((v for pair in reversed(pw) for v in pair))
    return torch.nn.functional.pad(x, flat)
kernel_name = 'standalone__conformer_family_e_branchformer__speech'

def setup_inputs():

    _w = lambda a: (lambda t: t.to(torch.bfloat16) if t.is_floating_point() else t)(torch.as_tensor(a))
    B, T, D, K = (2, 4000, 512, 31)
    return {'x': _w((lambda *s: torch.randn(*s, dtype=torch.bfloat16) * 0.05)(B, T, D)), 'w_qkv': _w((lambda *s: torch.randn(*s, dtype=torch.bfloat16) * 0.05)(D, 3 * D)), 'w_att_out': _w((lambda *s: torch.randn(*s, dtype=torch.bfloat16) * 0.05)(D, D)), 'w_mlp_in': _w((lambda *s: torch.randn(*s, dtype=torch.bfloat16) * 0.05)(D, 2 * D)), 'dw_csgu': _w((lambda *s: torch.randn(*s, dtype=torch.bfloat16) * 0.05)(K, D)), 'w_mlp_out': _w((lambda *s: torch.randn(*s, dtype=torch.bfloat16) * 0.05)(D, D)), 'dw_merge': _w((lambda *s: torch.randn(*s, dtype=torch.bfloat16) * 0.05)(K, 2 * D)), 'w_merge': _w((lambda *s: torch.randn(*s, dtype=torch.bfloat16) * 0.05)(2 * D, D))}

def reference(x, w_qkv, w_att_out, w_mlp_in, dw_csgu, w_mlp_out, dw_merge, w_merge):
    B, T, D = x.shape
    K = dw_csgu.shape[0]
    pad = K // 2
    xa = _layernorm(x, axis=-1)
    qkv = torch.einsum('btd,de->bte', xa, w_qkv)
    q, k, v = (qkv[..., :D].clone(), qkv[..., D:2 * D].clone(), qkv[..., 2 * D:].clone())
    scores = torch.einsum('btd,bsd->bts', q, k) * D ** (-0.5)
    p = _softmax(scores, axis=-1)
    attn = torch.einsum('bts,bsd->btd', p, v)
    glob = torch.einsum('btd,de->bte', attn, w_att_out)
    xc = _layernorm(x, axis=-1)
    h = _gelu(torch.einsum('btd,de->bte', xc, w_mlp_in))
    u, g = (h[..., :D].clone(), h[..., D:].clone())
    g = _layernorm(g, axis=-1)
    gp = _pad(g, ((0, 0), (pad, pad), (0, 0)))
    gc = torch.zeros_like(g)
    for i in range(K):
        gc = gc + gp[:, i:i + T, :] * dw_csgu[i][None, None, :]
    loc = torch.einsum('btd,de->bte', u * gc, w_mlp_out)
    m = torch.concatenate([glob, loc], axis=-1)
    mp = _pad(m, ((0, 0), (pad, pad), (0, 0)))
    mc = torch.zeros_like(m)
    for i in range(K):
        mc = mc + mp[:, i:i + T, :] * dw_merge[i][None, None, :]
    m = m + mc
    return x + torch.einsum('btc,cd->btd', m, w_merge)
```

```asm
; @launch kernel=prep_kernel grid=(256,1,1) block=(512,1,1) lds=132096
; @launch kernel=in_kernel grid=(256,1,1) block=(256,1,1) lds=163840
.amdgcn_target "amdgcn-amd-amdhsa--gfx950"
.text
.macro MM p0, p1, p2, p3
 v_mfma_f32_16x16x32_bf16 \p0, \p1, \p2, \p3
.endm
.macro M4 p0, p1, p2, p3
 v_mfma_f32_4x4x4_16b_bf16 \p0, \p1, \p2, \p3
.endm
.macro CB p0, p1, p2
 v_cvt_pk_bf16_f32 \p0, \p1, \p2
.endm
.macro RA p0, p1
 v_accvgpr_read_b32 \p0, \p1
.endm
.macro WA p0, p1
 v_accvgpr_write_b32 \p0, \p1
.endm
.globl prep_kernel
.p2align 8
.type prep_kernel,@function
prep_kernel:
 s_cmp_ge_u32 s2, 256
 s_cbranch_scc1 prep_kernel_end
 s_load_dwordx16 s[16:31], s[0:1], 0
 s_load_dwordx2 s[4:5], s[0:1], 80
 s_lshr_b32 s62, s2, 3
 s_min_u32 s62, s62, 5
 s_lshl_b32 s62, s62, 15
 s_getpc_b64 s[60:61]
prep_kernel_pf12:
 s_add_u32 s60, s60, prep_kernel-prep_kernel_pf12
 s_addc_u32 s61, s61, -1
 v_lshlrev_b32 v120, 7, v0
 v_add_u32 v120, s62, v120
 v_min_u32 v121, tail_kernel_end-prep_kernel, v120
 global_load_dword v121, v121, s[60:61]
 v_lshrrev_b32 v1, 6, v0
 v_and_b32 v2, 63, v0
 v_readfirstlane_b32 s3, v1
 v_lshlrev_b32 v3, 4, v2
 v_lshrrev_b32 v4, 4, v2
 v_and_b32 v5, 15, v2
 s_waitcnt lgkmcnt(0)
 s_mov_b32 s8, s4
 s_and_b32 s9, s5, 0xffff
 s_mov_b32 s10, 268435456
 s_mov_b32 s11, 0x00020000
 s_mov_b32 s85, s2
 s_cmp_lt_u32 s3, 4
 s_cbranch_scc1 prep_kernel_role
 s_mov_b32 s52, s16
 s_and_b32 s53, s17, 0xffff
 s_mov_b32 s54, 8192000
 s_mov_b32 s55, 0x00020000
 s_lshl_b32 s58, s2, 16
 s_and_b32 s59, s3, 3
 s_lshl_b32 s57, s59, 13
 s_add_u32 s56, s58, s57
 s_add_u32 s65, s56, 0x8000
 v_and_b32 v193, 7, v2
 v_lshrrev_b32 v194, 3, v2
 v_lshlrev_b32_e64 v122, 10, v193
 v_lshl_add_u32 v122, v194, 4, v122
 s_lshl_b32 s57, s59, 3
 v_add_u32 v193, s57, v193
 v_and_b32 v192, 1, v194
 v_mul_u32_u24 v192, 12, v192
 v_xor_b32 v192, v192, v193
 v_lshlrev_b32 v192, 4, v192
 v_lshl_add_u32 v192, v194, 9, v192
 s_cmp_ge_u32 s2, 125
 s_cbranch_scc1 prep_kernel_end
 buffer_load_dwordx4 v[128:131], v122, s[52:55], s56 offen offset:0
 buffer_load_dwordx4 v[132:135], v122, s[52:55], s56 offen offset:128
 buffer_load_dwordx4 v[136:139], v122, s[52:55], s56 offen offset:256
 buffer_load_dwordx4 v[140:143], v122, s[52:55], s56 offen offset:384
 buffer_load_dwordx4 v[144:147], v122, s[52:55], s56 offen offset:512
 buffer_load_dwordx4 v[148:151], v122, s[52:55], s56 offen offset:640
 buffer_load_dwordx4 v[152:155], v122, s[52:55], s56 offen offset:768
 buffer_load_dwordx4 v[156:159], v122, s[52:55], s56 offen offset:896
 buffer_load_dwordx4 v[160:163], v122, s[52:55], s65 offen offset:0
 buffer_load_dwordx4 v[164:167], v122, s[52:55], s65 offen offset:128
 buffer_load_dwordx4 v[168:171], v122, s[52:55], s65 offen offset:256
 buffer_load_dwordx4 v[172:175], v122, s[52:55], s65 offen offset:384
 buffer_load_dwordx4 v[176:179], v122, s[52:55], s65 offen offset:512
 buffer_load_dwordx4 v[180:183], v122, s[52:55], s65 offen offset:640
 buffer_load_dwordx4 v[184:187], v122, s[52:55], s65 offen offset:768
 buffer_load_dwordx4 v[188:191], v122, s[52:55], s65 offen offset:896
 s_cmp_ge_u32 s2, 192
 s_cbranch_scc1 prep_kernel_nb
 s_barrier
prep_kernel_nb:
 s_mov_b32 s90, 0xffff0000
 s_waitcnt vmcnt(15)
 v_lshlrev_b32 v0, 16, v128
 v_and_b32 v1, s90, v128
 v_lshlrev_b32 v2, 16, v129
 v_and_b32 v3, s90, v129
 v_lshlrev_b32 v4, 16, v130
 v_and_b32 v5, s90, v130
 v_lshlrev_b32 v6, 16, v131
 v_and_b32 v7, s90, v131
 v_pk_add_f32 v[196:197], v[0:1], v[2:3]
 v_pk_add_f32 v[198:199], v[4:5], v[6:7]
 s_waitcnt vmcnt(14)
 v_lshlrev_b32 v8, 16, v132
 v_and_b32 v9, s90, v132
 v_lshlrev_b32 v10, 16, v133
 v_and_b32 v11, s90, v133
 v_lshlrev_b32 v12, 16, v134
 v_and_b32 v13, s90, v134
 v_lshlrev_b32 v14, 16, v135
 v_and_b32_e64 v15, s90, v135
 v_pk_add_f32 v[196:197], v[196:197], v[8:9]
 v_pk_add_f32 v[198:199], v[198:199], v[10:11]
 v_pk_add_f32 v[196:197], v[196:197], v[12:13]
 v_pk_add_f32 v[198:199], v[198:199], v[14:15]
 s_waitcnt vmcnt(13)
 v_lshlrev_b32 v16, 16, v136
 v_and_b32 v17, s90, v136
 v_lshlrev_b32 v18, 16, v137
 v_and_b32 v19, s90, v137
 v_lshlrev_b32 v20, 16, v138
 v_and_b32 v21, s90, v138
 v_lshlrev_b32 v22, 16, v139
 v_and_b32_e64 v23, s90, v139
 v_pk_add_f32 v[196:197], v[196:197], v[16:17]
 v_pk_add_f32 v[198:199], v[198:199], v[18:19]
 v_pk_add_f32 v[196:197], v[196:197], v[20:21]
 v_pk_add_f32 v[198:199], v[198:199], v[22:23]
 s_waitcnt vmcnt(12)
 v_lshlrev_b32 v24, 16, v140
 v_and_b32 v25, s90, v140
 v_lshlrev_b32 v26, 16, v141
 v_and_b32 v27, s90, v141
 v_lshlrev_b32 v28, 16, v142
 v_and_b32 v29, s90, v142
 v_lshlrev_b32 v30, 16, v143
 v_and_b32_e64 v31, s90, v143
 v_pk_add_f32 v[196:197], v[196:197], v[24:25]
 v_pk_add_f32 v[198:199], v[198:199], v[26:27]
 v_pk_add_f32 v[196:197], v[196:197], v[28:29]
 v_pk_add_f32 v[198:199], v[198:199], v[30:31]
 s_waitcnt vmcnt(11)
 v_lshlrev_b32 v32, 16, v144
 v_and_b32 v33, s90, v144
 v_lshlrev_b32 v34, 16, v145
 v_and_b32 v35, s90, v145
 v_lshlrev_b32 v36, 16, v146
 v_and_b32 v37, s90, v146
 v_lshlrev_b32 v38, 16, v147
 v_and_b32_e64 v39, s90, v147
 v_pk_add_f32 v[196:197], v[196:197], v[32:33]
 v_pk_add_f32 v[198:199], v[198:199], v[34:35]
 v_pk_add_f32 v[196:197], v[196:197], v[36:37]
 v_pk_add_f32 v[198:199], v[198:199], v[38:39]
 s_waitcnt vmcnt(10)
 v_lshlrev_b32 v40, 16, v148
 v_and_b32 v41, s90, v148
 v_lshlrev_b32 v42, 16, v149
 v_and_b32 v43, s90, v149
 v_lshlrev_b32 v44, 16, v150
 v_and_b32 v45, s90, v150
 v_lshlrev_b32 v46, 16, v151
 v_and_b32_e64 v47, s90, v151
 v_pk_add_f32 v[196:197], v[196:197], v[40:41]
 v_pk_add_f32 v[198:199], v[198:199], v[42:43]
 v_pk_add_f32 v[196:197], v[196:197], v[44:45]
 v_pk_add_f32 v[198:199], v[198:199], v[46:47]
 s_waitcnt vmcnt(9)
 v_lshlrev_b32 v48, 16, v152
 v_and_b32 v49, s90, v152
 v_lshlrev_b32 v50, 16, v153
 v_and_b32 v51, s90, v153
 v_lshlrev_b32 v52, 16, v154
 v_and_b32 v53, s90, v154
 v_lshlrev_b32 v54, 16, v155
 v_and_b32_e64 v55, s90, v155
 v_pk_add_f32 v[196:197], v[196:197], v[48:49]
 v_pk_add_f32 v[198:199], v[198:199], v[50:51]
 v_pk_add_f32 v[196:197], v[196:197], v[52:53]
 v_pk_add_f32 v[198:199], v[198:199], v[54:55]
 s_waitcnt vmcnt(8)
 v_lshlrev_b32 v56, 16, v156
 v_and_b32 v57, s90, v156
 v_lshlrev_b32 v58, 16, v157
 v_and_b32 v59, s90, v157
 v_lshlrev_b32 v60, 16, v158
 v_and_b32 v61, s90, v158
 v_lshlrev_b32 v62, 16, v159
 v_and_b32_e64 v63, s90, v159
 v_pk_add_f32 v[196:197], v[196:197], v[56:57]
 v_pk_add_f32 v[198:199], v[198:199], v[58:59]
 v_pk_add_f32 v[196:197], v[196:197], v[60:61]
 v_pk_add_f32 v[198:199], v[198:199], v[62:63]
 v_pk_add_f32 v[196:197], v[196:197], v[198:199]
 v_add_f32 v196, v196, v197
 s_nop 1
 v_add_f32_dpp v196, v196, v196 row_ror:8 row_mask:0xf bank_mask:0xf
 v_mov_b32 v197, v196
 s_nop 1
 v_permlane16_swap_b32 v197, v196
 v_add_f32 v196, v196, v197
 v_mov_b32 v197, v196
 s_nop 1
 v_permlane32_swap_b32 v197, v196
 v_add_f32 v196, v196, v197
 v_mul_f32 v200, 0xbb000000, v196
 v_pk_add_f32 v[0:1], v[0:1], v[200:201] op_sel_hi:[1,0]
 v_pk_mul_f32 v[196:197], v[0:1], v[0:1]
 v_pk_add_f32 v[2:3], v[2:3], v[200:201] op_sel_hi:[1,0]
 v_pk_mul_f32 v[198:199], v[2:3], v[2:3]
 v_pk_add_f32 v[4:5], v[4:5], v[200:201] op_sel_hi:[1,0]
 v_pk_fma_f32 v[196:197], v[4:5], v[4:5], v[196:197]
 v_pk_add_f32 v[6:7], v[6:7], v[200:201] op_sel_hi:[1,0]
 v_pk_fma_f32 v[198:199], v[6:7], v[6:7], v[198:199]
 v_pk_add_f32 v[8:9], v[8:9], v[200:201] op_sel_hi:[1,0]
 v_pk_fma_f32 v[196:197], v[8:9], v[8:9], v[196:197]
 v_pk_add_f32 v[10:11], v[10:11], v[200:201] op_sel_hi:[1,0]
 v_pk_fma_f32 v[198:199], v[10:11], v[10:11], v[198:199]
 v_pk_add_f32 v[12:13], v[12:13], v[200:201] op_sel_hi:[1,0]
 v_pk_fma_f32 v[196:197], v[12:13], v[12:13], v[196:197]
 v_pk_add_f32 v[14:15], v[14:15], v[200:201] op_sel_hi:[1,0]
 v_pk_fma_f32 v[198:199], v[14:15], v[14:15], v[198:199]
 v_pk_add_f32 v[16:17], v[16:17], v[200:201] op_sel_hi:[1,0]
 v_pk_fma_f32 v[196:197], v[16:17], v[16:17], v[196:197]
 v_pk_add_f32 v[18:19], v[18:19], v[200:201] op_sel_hi:[1,0]
 v_pk_fma_f32 v[198:199], v[18:19], v[18:19], v[198:199]
 v_pk_add_f32 v[20:21], v[20:21], v[200:201] op_sel_hi:[1,0]
 v_pk_fma_f32 v[196:197], v[20:21], v[20:21], v[196:197]
 v_pk_add_f32 v[22:23], v[22:23], v[200:201] op_sel_hi:[1,0]
 v_pk_fma_f32 v[198:199], v[22:23], v[22:23], v[198:199]
 v_pk_add_f32 v[24:25], v[24:25], v[200:201] op_sel_hi:[1,0]
 v_pk_fma_f32 v[196:197], v[24:25], v[24:25], v[196:197]
 v_pk_add_f32 v[26:27], v[26:27], v[200:201] op_sel_hi:[1,0]
 v_pk_fma_f32 v[198:199], v[26:27], v[26:27], v[198:199]
 v_pk_add_f32 v[28:29], v[28:29], v[200:201] op_sel_hi:[1,0]
 v_pk_fma_f32 v[196:197], v[28:29], v[28:29], v[196:197]
 v_pk_add_f32 v[30:31], v[30:31], v[200:201] op_sel_hi:[1,0]
 v_pk_fma_f32 v[198:199], v[30:31], v[30:31], v[198:199]
 v_pk_add_f32 v[32:33], v[32:33], v[200:201] op_sel_hi:[1,0]
 v_pk_fma_f32 v[196:197], v[32:33], v[32:33], v[196:197]
 v_pk_add_f32 v[34:35], v[34:35], v[200:201] op_sel_hi:[1,0]
 v_pk_fma_f32 v[198:199], v[34:35], v[34:35], v[198:199]
 v_pk_add_f32 v[36:37], v[36:37], v[200:201] op_sel_hi:[1,0]
 v_pk_fma_f32 v[196:197], v[36:37], v[36:37], v[196:197]
 v_pk_add_f32 v[38:39], v[38:39], v[200:201] op_sel_hi:[1,0]
 v_pk_fma_f32 v[198:199], v[38:39], v[38:39], v[198:199]
 v_pk_add_f32 v[40:41], v[40:41], v[200:201] op_sel_hi:[1,0]
 v_pk_fma_f32 v[196:197], v[40:41], v[40:41], v[196:197]
 v_pk_add_f32 v[42:43], v[42:43], v[200:201] op_sel_hi:[1,0]
 v_pk_fma_f32 v[198:199], v[42:43], v[42:43], v[198:199]
 v_pk_add_f32 v[44:45], v[44:45], v[200:201] op_sel_hi:[1,0]
 v_pk_fma_f32 v[196:197], v[44:45], v[44:45], v[196:197]
 v_pk_add_f32 v[46:47], v[46:47], v[200:201] op_sel_hi:[1,0]
 v_pk_fma_f32 v[198:199], v[46:47], v[46:47], v[198:199]
 v_pk_add_f32 v[48:49], v[48:49], v[200:201] op_sel_hi:[1,0]
 v_pk_fma_f32 v[196:197], v[48:49], v[48:49], v[196:197]
 v_pk_add_f32 v[50:51], v[50:51], v[200:201] op_sel_hi:[1,0]
 v_pk_fma_f32 v[198:199], v[50:51], v[50:51], v[198:199]
 v_pk_add_f32 v[52:53], v[52:53], v[200:201] op_sel_hi:[1,0]
 v_pk_fma_f32 v[196:197], v[52:53], v[52:53], v[196:197]
 v_pk_add_f32 v[54:55], v[54:55], v[200:201] op_sel_hi:[1,0]
 v_pk_fma_f32 v[198:199], v[54:55], v[54:55], v[198:199]
 v_pk_add_f32 v[56:57], v[56:57], v[200:201] op_sel_hi:[1,0]
 v_pk_fma_f32 v[196:197], v[56:57], v[56:57], v[196:197]
 v_pk_add_f32 v[58:59], v[58:59], v[200:201] op_sel_hi:[1,0]
 v_pk_fma_f32 v[198:199], v[58:59], v[58:59], v[198:199]
 v_pk_add_f32 v[60:61], v[60:61], v[200:201] op_sel_hi:[1,0]
 v_pk_fma_f32 v[196:197], v[60:61], v[60:61], v[196:197]
 v_pk_add_f32 v[62:63], v[62:63], v[200:201] op_sel_hi:[1,0]
 v_pk_fma_f32 v[198:199], v[62:63], v[62:63], v[198:199]
 v_pk_add_f32 v[196:197], v[196:197], v[198:199]
 v_add_f32 v196, v196, v197
 s_nop 1
 v_add_f32_dpp v196, v196, v196 row_ror:8 row_mask:0xf bank_mask:0xf
 v_mov_b32 v197, v196
 s_nop 1
 v_permlane16_swap_b32 v197, v196
 v_add_f32 v196, v196, v197
 v_mov_b32 v197, v196
 s_nop 1
 v_permlane32_swap_b32 v197, v196
 v_add_f32 v196, v196, v197
 v_mul_f32 v196, 0x3b000000, v196
 v_add_f32 v196, 0x3727c5ac, v196
 v_rsq_f32 v200, v196
 s_nop 0
 v_pk_mul_f32 v[0:1], v[0:1], v[200:201] op_sel_hi:[1,0]
 v_pk_mul_f32 v[2:3], v[2:3], v[200:201] op_sel_hi:[1,0]
 v_pk_mul_f32 v[4:5], v[4:5], v[200:201] op_sel_hi:[1,0]
 v_pk_mul_f32 v[6:7], v[6:7], v[200:201] op_sel_hi:[1,0]
 CB v128, v0, v1
 CB v129, v2, v3
 CB v130, v4, v5
 CB v131, v6, v7
 buffer_store_dwordx4 v[128:131], v192, s[8:11], s58 offen sc1
 s_add_u32 s58, s58, 0x1000
 v_pk_mul_f32 v[8:9], v[8:9], v[200:201] op_sel_hi:[1,0]
 v_pk_mul_f32 v[10:11], v[10:11], v[200:201] op_sel_hi:[1,0]
 v_pk_mul_f32 v[12:13], v[12:13], v[200:201] op_sel_hi:[1,0]
 v_pk_mul_f32 v[14:15], v[14:15], v[200:201] op_sel_hi:[1,0]
 CB v132, v8, v9
 CB v133, v10, v11
 CB v134, v12, v13
 CB v135, v14, v15
 buffer_store_dwordx4 v[132:135], v192, s[8:11], s58 offen sc1
 s_add_u32 s58, s58, 0x1000
 v_pk_mul_f32 v[16:17], v[16:17], v[200:201] op_sel_hi:[1,0]
 v_pk_mul_f32 v[18:19], v[18:19], v[200:201] op_sel_hi:[1,0]
 v_pk_mul_f32 v[20:21], v[20:21], v[200:201] op_sel_hi:[1,0]
 v_pk_mul_f32 v[22:23], v[22:23], v[200:201] op_sel_hi:[1,0]
 CB v136, v16, v17
 CB v137, v18, v19
 CB v138, v20, v21
 CB v139, v22, v23
 buffer_store_dwordx4 v[136:139], v192, s[8:11], s58 offen sc1
 s_add_u32 s58, s58, 0x1000
 v_pk_mul_f32 v[24:25], v[24:25], v[200:201] op_sel_hi:[1,0]
 v_pk_mul_f32 v[26:27], v[26:27], v[200:201] op_sel_hi:[1,0]
 v_pk_mul_f32 v[28:29], v[28:29], v[200:201] op_sel_hi:[1,0]
 v_pk_mul_f32 v[30:31], v[30:31], v[200:201] op_sel_hi:[1,0]
 CB v140, v24, v25
 CB v141, v26, v27
 CB v142, v28, v29
 CB v143, v30, v31
 buffer_store_dwordx4 v[140:143], v192, s[8:11], s58 offen sc1
 s_add_u32 s58, s58, 0x1000
 v_pk_mul_f32 v[32:33], v[32:33], v[200:201] op_sel_hi:[1,0]
 v_pk_mul_f32 v[34:35], v[34:35], v[200:201] op_sel_hi:[1,0]
 v_pk_mul_f32 v[36:37], v[36:37], v[200:201] op_sel_hi:[1,0]
 v_pk_mul_f32 v[38:39], v[38:39], v[200:201] op_sel_hi:[1,0]
 CB v144, v32, v33
 CB v145, v34, v35
 CB v146, v36, v37
 CB v147, v38, v39
 buffer_store_dwordx4 v[144:147], v192, s[8:11], s58 offen sc1
 s_add_u32 s58, s58, 0x1000
 v_pk_mul_f32 v[40:41], v[40:41], v[200:201] op_sel_hi:[1,0]
 v_pk_mul_f32 v[42:43], v[42:43], v[200:201] op_sel_hi:[1,0]
 v_pk_mul_f32 v[44:45], v[44:45], v[200:201] op_sel_hi:[1,0]
 v_pk_mul_f32 v[46:47], v[46:47], v[200:201] op_sel_hi:[1,0]
 CB v148, v40, v41
 CB v149, v42, v43
 CB v150, v44, v45
 CB v151, v46, v47
 buffer_store_dwordx4 v[148:151], v192, s[8:11], s58 offen sc1
 s_add_u32 s58, s58, 0x1000
 v_pk_mul_f32 v[48:49], v[48:49], v[200:201] op_sel_hi:[1,0]
 v_pk_mul_f32 v[50:51], v[50:51], v[200:201] op_sel_hi:[1,0]
 v_pk_mul_f32 v[52:53], v[52:53], v[200:201] op_sel_hi:[1,0]
 v_pk_mul_f32 v[54:55], v[54:55], v[200:201] op_sel_hi:[1,0]
 CB v152, v48, v49
 CB v153, v50, v51
 CB v154, v52, v53
 CB v155, v54, v55
 buffer_store_dwordx4 v[152:155], v192, s[8:11], s58 offen sc1
 s_add_u32 s58, s58, 0x1000
 v_pk_mul_f32 v[56:57], v[56:57], v[200:201] op_sel_hi:[1,0]
 v_pk_mul_f32 v[58:59], v[58:59], v[200:201] op_sel_hi:[1,0]
 v_pk_mul_f32 v[60:61], v[60:61], v[200:201] op_sel_hi:[1,0]
 v_pk_mul_f32 v[62:63], v[62:63], v[200:201] op_sel_hi:[1,0]
 CB v156, v56, v57
 CB v157, v58, v59
 CB v158, v60, v61
 CB v159, v62, v63
 buffer_store_dwordx4 v[156:159], v192, s[8:11], s58 offen sc1
 s_add_u32 s58, s58, 0x1000
 s_waitcnt vmcnt(15)
 v_lshlrev_b32 v0, 16, v160
 v_and_b32 v1, s90, v160
 v_lshlrev_b32 v2, 16, v161
 v_and_b32 v3, s90, v161
 v_lshlrev_b32 v4, 16, v162
 v_and_b32 v5, s90, v162
 v_lshlrev_b32 v6, 16, v163
 v_and_b32_e64 v7, s90, v163
 v_pk_add_f32 v[196:197], v[0:1], v[2:3]
 v_pk_add_f32 v[198:199], v[4:5], v[6:7]
 s_waitcnt vmcnt(14)
 v_lshlrev_b32 v8, 16, v164
 v_and_b32 v9, s90, v164
 v_lshlrev_b32 v10, 16, v165
 v_and_b32 v11, s90, v165
 v_lshlrev_b32 v12, 16, v166
 v_and_b32 v13, s90, v166
 v_lshlrev_b32 v14, 16, v167
 v_and_b32_e64 v15, s90, v167
 v_pk_add_f32 v[196:197], v[196:197], v[8:9]
 v_pk_add_f32 v[198:199], v[198:199], v[10:11]
 v_pk_add_f32 v[196:197], v[196:197], v[12:13]
 v_pk_add_f32 v[198:199], v[198:199], v[14:15]
 s_waitcnt vmcnt(13)
 v_lshlrev_b32 v16, 16, v168
 v_and_b32 v17, s90, v168
 v_lshlrev_b32 v18, 16, v169
 v_and_b32 v19, s90, v169
 v_lshlrev_b32 v20, 16, v170
 v_and_b32 v21, s90, v170
 v_lshlrev_b32 v22, 16, v171
 v_and_b32_e64 v23, s90, v171
 v_pk_add_f32 v[196:197], v[196:197], v[16:17]
 v_pk_add_f32 v[198:199], v[198:199], v[18:19]
 v_pk_add_f32 v[196:197], v[196:197], v[20:21]
 v_pk_add_f32 v[198:199], v[198:199], v[22:23]
 s_waitcnt vmcnt(12)
 v_lshlrev_b32 v24, 16, v172
 v_and_b32 v25, s90, v172
 v_lshlrev_b32 v26, 16, v173
 v_and_b32 v27, s90, v173
 v_lshlrev_b32 v28, 16, v174
 v_and_b32 v29, s90, v174
 v_lshlrev_b32 v30, 16, v175
 v_and_b32_e64 v31, s90, v175
 v_pk_add_f32 v[196:197], v[196:197], v[24:25]
 v_pk_add_f32 v[198:199], v[198:199], v[26:27]
 v_pk_add_f32 v[196:197], v[196:197], v[28:29]
 v_pk_add_f32 v[198:199], v[198:199], v[30:31]
 s_waitcnt vmcnt(11)
 v_lshlrev_b32 v32, 16, v176
 v_and_b32 v33, s90, v176
 v_lshlrev_b32 v34, 16, v177
 v_and_b32 v35, s90, v177
 v_lshlrev_b32 v36, 16, v178
 v_and_b32 v37, s90, v178
 v_lshlrev_b32 v38, 16, v179
 v_and_b32_e64 v39, s90, v179
 v_pk_add_f32 v[196:197], v[196:197], v[32:33]
 v_pk_add_f32 v[198:199], v[198:199], v[34:35]
 v_pk_add_f32 v[196:197], v[196:197], v[36:37]
 v_pk_add_f32 v[198:199], v[198:199], v[38:39]
 s_waitcnt vmcnt(10)
 v_lshlrev_b32 v40, 16, v180
 v_and_b32 v41, s90, v180
 v_lshlrev_b32 v42, 16, v181
 v_and_b32 v43, s90, v181
 v_lshlrev_b32 v44, 16, v182
 v_and_b32 v45, s90, v182
 v_lshlrev_b32 v46, 16, v183
 v_and_b32_e64 v47, s90, v183
 v_pk_add_f32 v[196:197], v[196:197], v[40:41]
 v_pk_add_f32 v[198:199], v[198:199], v[42:43]
 v_pk_add_f32 v[196:197], v[196:197], v[44:45]
 v_pk_add_f32 v[198:199], v[198:199], v[46:47]
 s_waitcnt vmcnt(9)
 v_lshlrev_b32 v48, 16, v184
 v_and_b32 v49, s90, v184
 v_lshlrev_b32 v50, 16, v185
 v_and_b32 v51, s90, v185
 v_lshlrev_b32 v52, 16, v186
 v_and_b32 v53, s90, v186
 v_lshlrev_b32 v54, 16, v187
 v_and_b32_e64 v55, s90, v187
 v_pk_add_f32 v[196:197], v[196:197], v[48:49]
 v_pk_add_f32 v[198:199], v[198:199], v[50:51]
 v_pk_add_f32 v[196:197], v[196:197], v[52:53]
 v_pk_add_f32 v[198:199], v[198:199], v[54:55]
 s_waitcnt vmcnt(8)
 v_lshlrev_b32 v56, 16, v188
 v_and_b32 v57, s90, v188
 v_lshlrev_b32 v58, 16, v189
 v_and_b32 v59, s90, v189
 v_lshlrev_b32 v60, 16, v190
 v_and_b32 v61, s90, v190
 v_lshlrev_b32 v62, 16, v191
 v_and_b32_e64 v63, s90, v191
 v_pk_add_f32 v[196:197], v[196:197], v[56:57]
 v_pk_add_f32 v[198:199], v[198:199], v[58:59]
 v_pk_add_f32 v[196:197], v[196:197], v[60:61]
 v_pk_add_f32 v[198:199], v[198:199], v[62:63]
 v_pk_add_f32 v[196:197], v[196:197], v[198:199]
 v_add_f32 v196, v196, v197
 s_nop 1
 v_add_f32_dpp v196, v196, v196 row_ror:8 row_mask:0xf bank_mask:0xf
 v_mov_b32 v197, v196
 s_nop 1
 v_permlane16_swap_b32 v197, v196
 v_add_f32 v196, v196, v197
 v_mov_b32 v197, v196
 s_nop 1
 v_permlane32_swap_b32 v197, v196
 v_add_f32 v196, v196, v197
 v_mul_f32 v200, 0xbb000000, v196
 v_pk_add_f32 v[0:1], v[0:1], v[200:201] op_sel_hi:[1,0]
 v_pk_mul_f32 v[196:197], v[0:1], v[0:1]
 v_pk_add_f32 v[2:3], v[2:3], v[200:201] op_sel_hi:[1,0]
 v_pk_mul_f32 v[198:199], v[2:3], v[2:3]
 v_pk_add_f32 v[4:5], v[4:5], v[200:201] op_sel_hi:[1,0]
 v_pk_fma_f32 v[196:197], v[4:5], v[4:5], v[196:197]
 v_pk_add_f32 v[6:7], v[6:7], v[200:201] op_sel_hi:[1,0]
 v_pk_fma_f32 v[198:199], v[6:7], v[6:7], v[198:199]
 v_pk_add_f32 v[8:9], v[8:9], v[200:201] op_sel_hi:[1,0]
 v_pk_fma_f32 v[196:197], v[8:9], v[8:9], v[196:197]
 v_pk_add_f32 v[10:11], v[10:11], v[200:201] op_sel_hi:[1,0]
 v_pk_fma_f32 v[198:199], v[10:11], v[10:11], v[198:199]
 v_pk_add_f32 v[12:13], v[12:13], v[200:201] op_sel_hi:[1,0]
 v_pk_fma_f32 v[196:197], v[12:13], v[12:13], v[196:197]
 v_pk_add_f32 v[14:15], v[14:15], v[200:201] op_sel_hi:[1,0]
 v_pk_fma_f32 v[198:199], v[14:15], v[14:15], v[198:199]
 v_pk_add_f32 v[16:17], v[16:17], v[200:201] op_sel_hi:[1,0]
 v_pk_fma_f32 v[196:197], v[16:17], v[16:17], v[196:197]
 v_pk_add_f32 v[18:19], v[18:19], v[200:201] op_sel_hi:[1,0]
 v_pk_fma_f32 v[198:199], v[18:19], v[18:19], v[198:199]
 v_pk_add_f32 v[20:21], v[20:21], v[200:201] op_sel_hi:[1,0]
 v_pk_fma_f32 v[196:197], v[20:21], v[20:21], v[196:197]
 v_pk_add_f32 v[22:23], v[22:23], v[200:201] op_sel_hi:[1,0]
 v_pk_fma_f32 v[198:199], v[22:23], v[22:23], v[198:199]
 v_pk_add_f32 v[24:25], v[24:25], v[200:201] op_sel_hi:[1,0]
 v_pk_fma_f32 v[196:197], v[24:25], v[24:25], v[196:197]
 v_pk_add_f32 v[26:27], v[26:27], v[200:201] op_sel_hi:[1,0]
 v_pk_fma_f32 v[198:199], v[26:27], v[26:27], v[198:199]
 v_pk_add_f32 v[28:29], v[28:29], v[200:201] op_sel_hi:[1,0]
 v_pk_fma_f32 v[196:197], v[28:29], v[28:29], v[196:197]
 v_pk_add_f32 v[30:31], v[30:31], v[200:201] op_sel_hi:[1,0]
 v_pk_fma_f32 v[198:199], v[30:31], v[30:31], v[198:199]
 v_pk_add_f32 v[32:33], v[32:33], v[200:201] op_sel_hi:[1,0]
 v_pk_fma_f32 v[196:197], v[32:33], v[32:33], v[196:197]
 v_pk_add_f32 v[34:35], v[34:35], v[200:201] op_sel_hi:[1,0]
 v_pk_fma_f32 v[198:199], v[34:35], v[34:35], v[198:199]
 v_pk_add_f32 v[36:37], v[36:37], v[200:201] op_sel_hi:[1,0]
 v_pk_fma_f32 v[196:197], v[36:37], v[36:37], v[196:197]
 v_pk_add_f32 v[38:39], v[38:39], v[200:201] op_sel_hi:[1,0]
 v_pk_fma_f32 v[198:199], v[38:39], v[38:39], v[198:199]
 v_pk_add_f32 v[40:41], v[40:41], v[200:201] op_sel_hi:[1,0]
 v_pk_fma_f32 v[196:197], v[40:41], v[40:41], v[196:197]
 v_pk_add_f32 v[42:43], v[42:43], v[200:201] op_sel_hi:[1,0]
 v_pk_fma_f32 v[198:199], v[42:43], v[42:43], v[198:199]
 v_pk_add_f32 v[44:45], v[44:45], v[200:201] op_sel_hi:[1,0]
 v_pk_fma_f32 v[196:197], v[44:45], v[44:45], v[196:197]
 v_pk_add_f32 v[46:47], v[46:47], v[200:201] op_sel_hi:[1,0]
 v_pk_fma_f32 v[198:199], v[46:47], v[46:47], v[198:199]
 v_pk_add_f32 v[48:49], v[48:49], v[200:201] op_sel_hi:[1,0]
 v_pk_fma_f32 v[196:197], v[48:49], v[48:49], v[196:197]
 v_pk_add_f32 v[50:51], v[50:51], v[200:201] op_sel_hi:[1,0]
 v_pk_fma_f32 v[198:199], v[50:51], v[50:51], v[198:199]
 v_pk_add_f32 v[52:53], v[52:53], v[200:201] op_sel_hi:[1,0]
 v_pk_fma_f32 v[196:197], v[52:53], v[52:53], v[196:197]
 v_pk_add_f32 v[54:55], v[54:55], v[200:201] op_sel_hi:[1,0]
 v_pk_fma_f32 v[198:199], v[54:55], v[54:55], v[198:199]
 v_pk_add_f32 v[56:57], v[56:57], v[200:201] op_sel_hi:[1,0]
 v_pk_fma_f32 v[196:197], v[56:57], v[56:57], v[196:197]
 v_pk_add_f32 v[58:59], v[58:59], v[200:201] op_sel_hi:[1,0]
 v_pk_fma_f32 v[198:199], v[58:59], v[58:59], v[198:199]
 v_pk_add_f32 v[60:61], v[60:61], v[200:201] op_sel_hi:[1,0]
 v_pk_fma_f32 v[196:197], v[60:61], v[60:61], v[196:197]
 v_pk_add_f32 v[62:63], v[62:63], v[200:201] op_sel_hi:[1,0]
 v_pk_fma_f32 v[198:199], v[62:63], v[62:63], v[198:199]
 v_pk_add_f32 v[196:197], v[196:197], v[198:199]
 v_add_f32 v196, v196, v197
 s_nop 1
 v_add_f32_dpp v196, v196, v196 row_ror:8 row_mask:0xf bank_mask:0xf
 v_mov_b32 v197, v196
 s_nop 1
 v_permlane16_swap_b32 v197, v196
 v_add_f32 v196, v196, v197
 v_mov_b32 v197, v196
 s_nop 1
 v_permlane32_swap_b32 v197, v196
 v_add_f32 v196, v196, v197
 v_mul_f32 v196, 0x3b000000, v196
 v_add_f32 v196, 0x3727c5ac, v196
 v_rsq_f32 v200, v196
 s_nop 0
 v_pk_mul_f32 v[0:1], v[0:1], v[200:201] op_sel_hi:[1,0]
 v_pk_mul_f32 v[2:3], v[2:3], v[200:201] op_sel_hi:[1,0]
 v_pk_mul_f32 v[4:5], v[4:5], v[200:201] op_sel_hi:[1,0]
 v_pk_mul_f32 v[6:7], v[6:7], v[200:201] op_sel_hi:[1,0]
 CB v160, v0, v1
 CB v161, v2, v3
 CB v162, v4, v5
 CB v163, v6, v7
 buffer_store_dwordx4 v[160:163], v192, s[8:11], s58 offen sc1
 s_add_u32 s58, s58, 0x1000
 v_pk_mul_f32 v[8:9], v[8:9], v[200:201] op_sel_hi:[1,0]
 v_pk_mul_f32 v[10:11], v[10:11], v[200:201] op_sel_hi:[1,0]
 v_pk_mul_f32 v[12:13], v[12:13], v[200:201] op_sel_hi:[1,0]
 v_pk_mul_f32 v[14:15], v[14:15], v[200:201] op_sel_hi:[1,0]
 CB v164, v8, v9
 CB v165, v10, v11
 CB v166, v12, v13
 CB v167, v14, v15
 buffer_store_dwordx4 v[164:167], v192, s[8:11], s58 offen sc1
 s_add_u32 s58, s58, 0x1000
 v_pk_mul_f32 v[16:17], v[16:17], v[200:201] op_sel_hi:[1,0]
 v_pk_mul_f32 v[18:19], v[18:19], v[200:201] op_sel_hi:[1,0]
 v_pk_mul_f32 v[20:21], v[20:21], v[200:201] op_sel_hi:[1,0]
 v_pk_mul_f32 v[22:23], v[22:23], v[200:201] op_sel_hi:[1,0]
 CB v168, v16, v17
 CB v169, v18, v19
 CB v170, v20, v21
 CB v171, v22, v23
 buffer_store_dwordx4 v[168:171], v192, s[8:11], s58 offen sc1
 s_add_u32 s58, s58, 0x1000
 v_pk_mul_f32 v[24:25], v[24:25], v[200:201] op_sel_hi:[1,0]
 v_pk_mul_f32 v[26:27], v[26:27], v[200:201] op_sel_hi:[1,0]
 v_pk_mul_f32 v[28:29], v[28:29], v[200:201] op_sel_hi:[1,0]
 v_pk_mul_f32 v[30:31], v[30:31], v[200:201] op_sel_hi:[1,0]
 CB v172, v24, v25
 CB v173, v26, v27
 CB v174, v28, v29
 CB v175, v30, v31
 buffer_store_dwordx4 v[172:175], v192, s[8:11], s58 offen sc1
 s_add_u32 s58, s58, 0x1000
 v_pk_mul_f32 v[32:33], v[32:33], v[200:201] op_sel_hi:[1,0]
 v_pk_mul_f32 v[34:35], v[34:35], v[200:201] op_sel_hi:[1,0]
 v_pk_mul_f32 v[36:37], v[36:37], v[200:201] op_sel_hi:[1,0]
 v_pk_mul_f32 v[38:39], v[38:39], v[200:201] op_sel_hi:[1,0]
 CB v176, v32, v33
 CB v177, v34, v35
 CB v178, v36, v37
 CB v179, v38, v39
 buffer_store_dwordx4 v[176:179], v192, s[8:11], s58 offen sc1
 s_add_u32 s58, s58, 0x1000
 v_pk_mul_f32 v[40:41], v[40:41], v[200:201] op_sel_hi:[1,0]
 v_pk_mul_f32 v[42:43], v[42:43], v[200:201] op_sel_hi:[1,0]
 v_pk_mul_f32 v[44:45], v[44:45], v[200:201] op_sel_hi:[1,0]
 v_pk_mul_f32 v[46:47], v[46:47], v[200:201] op_sel_hi:[1,0]
 CB v180, v40, v41
 CB v181, v42, v43
 CB v182, v44, v45
 CB v183, v46, v47
 buffer_store_dwordx4 v[180:183], v192, s[8:11], s58 offen sc1
 s_add_u32 s58, s58, 0x1000
 v_pk_mul_f32 v[48:49], v[48:49], v[200:201] op_sel_hi:[1,0]
 v_pk_mul_f32 v[50:51], v[50:51], v[200:201] op_sel_hi:[1,0]
 v_pk_mul_f32 v[52:53], v[52:53], v[200:201] op_sel_hi:[1,0]
 v_pk_mul_f32 v[54:55], v[54:55], v[200:201] op_sel_hi:[1,0]
 CB v184, v48, v49
 CB v185, v50, v51
 CB v186, v52, v53
 CB v187, v54, v55
 buffer_store_dwordx4 v[184:187], v192, s[8:11], s58 offen sc1
 s_add_u32 s58, s58, 0x1000
 v_pk_mul_f32 v[56:57], v[56:57], v[200:201] op_sel_hi:[1,0]
 v_pk_mul_f32 v[58:59], v[58:59], v[200:201] op_sel_hi:[1,0]
 v_pk_mul_f32 v[60:61], v[60:61], v[200:201] op_sel_hi:[1,0]
 v_pk_mul_f32 v[62:63], v[62:63], v[200:201] op_sel_hi:[1,0]
 CB v188, v56, v57
 CB v189, v58, v59
 CB v190, v60, v61
 CB v191, v62, v63
 buffer_store_dwordx4 v[188:191], v192, s[8:11], s58 offen sc1
 s_add_u32 s58, s58, 0x1000
prep_kernel_lnxw:
 s_endpgm
prep_kernel_role:
 s_cmp_lt_u32 s85, 128
 s_cbranch_scc1 prep_kernel_m
 s_cmp_lt_u32 s85, 192
 s_cbranch_scc1 prep_kernel_vo
 s_cmp_lt_u32 s85, 232
 s_cbranch_scc1 prep_kernel_rl
 s_cmp_lt_u32 s85, 244
 s_cbranch_scc1 prep_kernel_tp
 s_mov_b32 s87, 0x40000000
 s_sub_u32 s6, s85, 244
 s_cmp_gt_u32 s6, 8
 s_cbranch_scc1 prep_kernel_xt
 s_cmp_eq_u32 s6, 0
 s_cselect_b32 s7, 0, -1
 s_cselect_b32 s32, 0, 1
 s_add_u32 s6, s6, s32
 s_lshl_b32 s6, s6, 15
 s_add_u32 s6, s6, 92291072
 v_mov_b32 v8, s7
 v_mov_b32 v9, s7
 v_mov_b32 v10, s7
 v_mov_b32 v11, s7
 v_lshlrev_b32 v6, 4, v0
 buffer_store_dwordx4 v[8:11], v6, s[8:11], s6 offen sc1
 s_add_u32 s6, s6, 0x1000
 buffer_store_dwordx4 v[8:11], v6, s[8:11], s6 offen sc1
 s_add_u32 s6, s6, 0x1000
 buffer_store_dwordx4 v[8:11], v6, s[8:11], s6 offen sc1
 s_add_u32 s6, s6, 0x1000
 buffer_store_dwordx4 v[8:11], v6, s[8:11], s6 offen sc1
 s_add_u32 s6, s6, 0x1000
 buffer_store_dwordx4 v[8:11], v6, s[8:11], s6 offen sc1
 s_add_u32 s6, s6, 0x1000
 buffer_store_dwordx4 v[8:11], v6, s[8:11], s6 offen sc1
 s_add_u32 s6, s6, 0x1000
 buffer_store_dwordx4 v[8:11], v6, s[8:11], s6 offen sc1
 s_add_u32 s6, s6, 0x1000
 buffer_store_dwordx4 v[8:11], v6, s[8:11], s6 offen sc1
 s_add_u32 s6, s6, 0x1000
 s_branch prep_kernel_xt
prep_kernel_tp:
 s_sub_u32 s6, s85, 232
 s_cmp_lt_u32 s6, 4
 s_cselect_b32 s32, s24, s28
 s_cselect_b32 s33, s25, s29
 s_cselect_b32 s34, 1, 2
 s_cselect_b32 s39, 0, 16
 s_lshl_b32 s34, s34, 10
 s_mul_i32 s35, s34, 31
 s_mov_b32 s12, s32
 s_and_b32 s13, s33, 0xffff
 s_mov_b32 s14, 0
 s_mov_b32 s15, 0x00020000
 s_mov_b32 s14, s35
 s_lshl_b32 s36, s6, 2
 s_add_u32 s36, s36, s3
 s_mul_i32 s37, s36, 9216
 s_add_u32 s37, s37, 91848704
 s_sub_u32 s36, s36, s39
 s_lshl_b32 s36, s36, 6
 v_and_b32 v6, 3, v2
 v_add_u32_e64 v6, 1, v6
 v_mul_lo_u32 v6, v6, s34
 v_lshrrev_b32 v7, 2, v2
 v_lshlrev_b32 v7, 1, v7
 v_add_u32 v7, s36, v7
 v_sub_u32 v6, v7, v6
 buffer_load_ushort v16, v6, s[12:15], 0 offen offset:0
 buffer_load_ushort v34, v6, s[12:15], 0 offen offset:32
 v_add_u32_e64 v6, s34, v6
 buffer_load_ushort v52, v6, s[12:15], 0 offen offset:0
 buffer_load_ushort v70, v6, s[12:15], 0 offen offset:32
 v_add_u32_e64 v6, s34, v6
 buffer_load_ushort v17, v6, s[12:15], 0 offen offset:0
 buffer_load_ushort v35, v6, s[12:15], 0 offen offset:32
 v_add_u32_e64 v6, s34, v6
 buffer_load_ushort v53, v6, s[12:15], 0 offen offset:0
 buffer_load_ushort v71, v6, s[12:15], 0 offen offset:32
 v_add_u32_e64 v6, s34, v6
 buffer_load_ushort v18, v6, s[12:15], 0 offen offset:0
 buffer_load_ushort v36, v6, s[12:15], 0 offen offset:32
 v_add_u32_e64 v6, s34, v6
 buffer_load_ushort v54, v6, s[12:15], 0 offen offset:0
 buffer_load_ushort v72, v6, s[12:15], 0 offen offset:32
 v_add_u32_e64 v6, s34, v6
 buffer_load_ushort v19, v6, s[12:15], 0 offen offset:0
 buffer_load_ushort v37, v6, s[12:15], 0 offen offset:32
 v_add_u32_e64 v6, s34, v6
 buffer_load_ushort v55, v6, s[12:15], 0 offen offset:0
 buffer_load_ushort v73, v6, s[12:15], 0 offen offset:32
 v_add_u32_e64 v6, s34, v6
 buffer_load_ushort v20, v6, s[12:15], 0 offen offset:0
 buffer_load_ushort v38, v6, s[12:15], 0 offen offset:32
 v_add_u32_e64 v6, s34, v6
 buffer_load_ushort v56, v6, s[12:15], 0 offen offset:0
 buffer_load_ushort v74, v6, s[12:15], 0 offen offset:32
 v_add_u32_e64 v6, s34, v6
 buffer_load_ushort v21, v6, s[12:15], 0 offen offset:0
 buffer_load_ushort v39, v6, s[12:15], 0 offen offset:32
 v_add_u32_e64 v6, s34, v6
 buffer_load_ushort v57, v6, s[12:15], 0 offen offset:0
 buffer_load_ushort v75, v6, s[12:15], 0 offen offset:32
 v_add_u32_e64 v6, s34, v6
 buffer_load_ushort v22, v6, s[12:15], 0 offen offset:0
 buffer_load_ushort v40, v6, s[12:15], 0 offen offset:32
 v_add_u32_e64 v6, s34, v6
 buffer_load_ushort v58, v6, s[12:15], 0 offen offset:0
 buffer_load_ushort v76, v6, s[12:15], 0 offen offset:32
 v_add_u32_e64 v6, s34, v6
 buffer_load_ushort v23, v6, s[12:15], 0 offen offset:0
 buffer_load_ushort v41, v6, s[12:15], 0 offen offset:32
 v_add_u32_e64 v6, s34, v6
 buffer_load_ushort v59, v6, s[12:15], 0 offen offset:0
 buffer_load_ushort v77, v6, s[12:15], 0 offen offset:32
 v_add_u32_e64 v6, s34, v6
 buffer_load_ushort v24, v6, s[12:15], 0 offen offset:0
 buffer_load_ushort v42, v6, s[12:15], 0 offen offset:32
 v_add_u32_e64 v6, s34, v6
 buffer_load_ushort v60, v6, s[12:15], 0 offen offset:0
 buffer_load_ushort v78, v6, s[12:15], 0 offen offset:32
 v_add_u32_e64 v6, s34, v6
 buffer_load_ushort v25, v6, s[12:15], 0 offen offset:0
 buffer_load_ushort v43, v6, s[12:15], 0 offen offset:32
 v_add_u32_e64 v6, s34, v6
 buffer_load_ushort v61, v6, s[12:15], 0 offen offset:0
 buffer_load_ushort v79, v6, s[12:15], 0 offen offset:32
 v_add_u32_e64 v6, s34, v6
 buffer_load_ushort v26, v6, s[12:15], 0 offen offset:0
 buffer_load_ushort v44, v6, s[12:15], 0 offen offset:32
 v_add_u32_e64 v6, s34, v6
 buffer_load_ushort v62, v6, s[12:15], 0 offen offset:0
 buffer_load_ushort v80, v6, s[12:15], 0 offen offset:32
 v_add_u32_e64 v6, s34, v6
 buffer_load_ushort v27, v6, s[12:15], 0 offen offset:0
 buffer_load_ushort v45, v6, s[12:15], 0 offen offset:32
 v_add_u32_e64 v6, s34, v6
 buffer_load_ushort v63, v6, s[12:15], 0 offen offset:0
 buffer_load_ushort v81, v6, s[12:15], 0 offen offset:32
 v_add_u32_e64 v6, s34, v6
 buffer_load_ushort v28, v6, s[12:15], 0 offen offset:0
 buffer_load_ushort v46, v6, s[12:15], 0 offen offset:32
 v_add_u32_e64 v6, s34, v6
 buffer_load_ushort v64, v6, s[12:15], 0 offen offset:0
 buffer_load_ushort v82, v6, s[12:15], 0 offen offset:32
 v_add_u32_e64 v6, s34, v6
 buffer_load_ushort v29, v6, s[12:15], 0 offen offset:0
 buffer_load_ushort v47, v6, s[12:15], 0 offen offset:32
 v_add_u32_e64 v6, s34, v6
 buffer_load_ushort v65, v6, s[12:15], 0 offen offset:0
 buffer_load_ushort v83, v6, s[12:15], 0 offen offset:32
 v_add_u32_e64 v6, s34, v6
 buffer_load_ushort v30, v6, s[12:15], 0 offen offset:0
 buffer_load_ushort v48, v6, s[12:15], 0 offen offset:32
 v_add_u32_e64 v6, s34, v6
 buffer_load_ushort v66, v6, s[12:15], 0 offen offset:0
 buffer_load_ushort v84, v6, s[12:15], 0 offen offset:32
 v_add_u32_e64 v6, s34, v6
 buffer_load_ushort v31, v6, s[12:15], 0 offen offset:0
 buffer_load_ushort v49, v6, s[12:15], 0 offen offset:32
 v_add_u32_e64 v6, s34, v6
 buffer_load_ushort v67, v6, s[12:15], 0 offen offset:0
 buffer_load_ushort v85, v6, s[12:15], 0 offen offset:32
 v_add_u32_e64 v6, s34, v6
 buffer_load_ushort v32, v6, s[12:15], 0 offen offset:0
 buffer_load_ushort v50, v6, s[12:15], 0 offen offset:32
 v_add_u32_e64 v6, s34, v6
 buffer_load_ushort v68, v6, s[12:15], 0 offen offset:0
 buffer_load_ushort v86, v6, s[12:15], 0 offen offset:32
 v_add_u32_e64 v6, s34, v6
 buffer_load_ushort v33, v6, s[12:15], 0 offen offset:0
 buffer_load_ushort v51, v6, s[12:15], 0 offen offset:32
 v_add_u32_e64 v6, s34, v6
 buffer_load_ushort v69, v6, s[12:15], 0 offen offset:0
 buffer_load_ushort v87, v6, s[12:15], 0 offen offset:32
 s_waitcnt vmcnt(0)
 v_lshl_or_b32 v16, v52, 16, v16
 v_lshl_or_b32 v17, v53, 16, v17
 v_lshl_or_b32 v18, v54, 16, v18
 v_lshl_or_b32 v19, v55, 16, v19
 v_lshl_or_b32 v20, v56, 16, v20
 v_lshl_or_b32 v21, v57, 16, v21
 v_lshl_or_b32 v22, v58, 16, v22
 v_lshl_or_b32 v23, v59, 16, v23
 v_lshl_or_b32 v24, v60, 16, v24
 v_lshl_or_b32 v25, v61, 16, v25
 v_lshl_or_b32 v26, v62, 16, v26
 v_lshl_or_b32 v27, v63, 16, v27
 v_lshl_or_b32 v28, v64, 16, v28
 v_lshl_or_b32 v29, v65, 16, v29
 v_lshl_or_b32 v30, v66, 16, v30
 v_lshl_or_b32 v31, v67, 16, v31
 v_lshl_or_b32 v32, v68, 16, v32
 v_lshl_or_b32 v33, v69, 16, v33
 v_lshl_or_b32 v34, v70, 16, v34
 v_lshl_or_b32 v35, v71, 16, v35
 v_lshl_or_b32 v36, v72, 16, v36
 v_lshl_or_b32 v37, v73, 16, v37
 v_lshl_or_b32 v38, v74, 16, v38
 v_lshl_or_b32 v39, v75, 16, v39
 v_lshl_or_b32 v40, v76, 16, v40
 v_lshl_or_b32 v41, v77, 16, v41
 v_lshl_or_b32 v42, v78, 16, v42
 v_lshl_or_b32 v43, v79, 16, v43
 v_lshl_or_b32 v44, v80, 16, v44
 v_lshl_or_b32 v45, v81, 16, v45
 v_lshl_or_b32 v46, v82, 16, v46
 v_lshl_or_b32 v47, v83, 16, v47
 v_lshl_or_b32 v48, v84, 16, v48
 v_lshl_or_b32 v49, v85, 16, v49
 v_lshl_or_b32 v50, v86, 16, v50
 v_lshl_or_b32 v51, v87, 16, v51
 buffer_store_dwordx4 v[16:19], v3, s[8:11], s37 offen offset:0 sc1
 buffer_store_dwordx4 v[20:23], v3, s[8:11], s37 offen offset:1024 sc1
 buffer_store_dwordx4 v[24:27], v3, s[8:11], s37 offen offset:2048 sc1
 buffer_store_dwordx4 v[28:31], v3, s[8:11], s37 offen offset:3072 sc1
 s_add_u32 s37, s37, 0x1000
 buffer_store_dwordx4 v[32:35], v3, s[8:11], s37 offen offset:0 sc1
 buffer_store_dwordx4 v[36:39], v3, s[8:11], s37 offen offset:1024 sc1
 buffer_store_dwordx4 v[40:43], v3, s[8:11], s37 offen offset:2048 sc1
 buffer_store_dwordx4 v[44:47], v3, s[8:11], s37 offen offset:3072 sc1
 s_add_u32 s37, s37, 0x1000
 buffer_store_dwordx4 v[48:51], v3, s[8:11], s37 offen offset:0 sc1
 s_endpgm
prep_kernel_m:
 s_mov_b32 s12, s18
 s_and_b32 s13, s19, 0xffff
 s_mov_b32 s14, 1572864
 s_mov_b32 s15, 0x00020000
 s_lshr_b32 s32, s85, 3
 s_and_b32 s33, s85, 7
 s_lshl_b32 s87, s33, 7
 s_add_u32 s87, s87, 92315648
 s_lshl_b32 s34, s32, 5
 s_lshl_b32 s35, s3, 3
 s_add_u32 s34, s34, s35
 s_mul_i32 s34, s34, 3072
 s_mul_i32 s36, s3, 8320
 s_add_u32 m0, s36, 0
 s_add_u32 s45, s34, 0
 buffer_load_dwordx4 v3, s[12:15], s45 offen lds
 s_add_u32 m0, s36, 1040
 s_add_u32 s45, s34, 3072
 buffer_load_dwordx4 v3, s[12:15], s45 offen lds
 s_add_u32 m0, s36, 2080
 s_add_u32 s45, s34, 6144
 buffer_load_dwordx4 v3, s[12:15], s45 offen lds
 s_add_u32 m0, s36, 3120
 s_add_u32 s45, s34, 9216
 buffer_load_dwordx4 v3, s[12:15], s45 offen lds
 s_add_u32 m0, s36, 4160
 s_add_u32 s45, s34, 12288
 buffer_load_dwordx4 v3, s[12:15], s45 offen lds
 s_add_u32 m0, s36, 5200
 s_add_u32 s45, s34, 15360
 buffer_load_dwordx4 v3, s[12:15], s45 offen lds
 s_add_u32 m0, s36, 6240
 s_add_u32 s45, s34, 18432
 buffer_load_dwordx4 v3, s[12:15], s45 offen lds
 s_add_u32 m0, s36, 7280
 s_add_u32 s45, s34, 21504
 buffer_load_dwordx4 v3, s[12:15], s45 offen lds
 s_lshl_b32 s34, s33, 6
 s_lshl_b32 s35, s3, 4
 s_add_u32 s34, s34, s35
 s_mul_i32 s34, s34, 3072
 s_add_u32 s34, s34, 1024
 s_mul_i32 s36, s3, 16640
 s_add_u32 s36, s36, 33280
 s_add_u32 m0, s36, 0
 s_add_u32 s45, s34, 0
 buffer_load_dwordx4 v3, s[12:15], s45 offen lds
 s_add_u32 m0, s36, 1040
 s_add_u32 s45, s34, 3072
 buffer_load_dwordx4 v3, s[12:15], s45 offen lds
 s_add_u32 m0, s36, 2080
 s_add_u32 s45, s34, 6144
 buffer_load_dwordx4 v3, s[12:15], s45 offen lds
 s_add_u32 m0, s36, 3120
 s_add_u32 s45, s34, 9216
 buffer_load_dwordx4 v3, s[12:15], s45 offen lds
 s_add_u32 m0, s36, 4160
 s_add_u32 s45, s34, 12288
 buffer_load_dwordx4 v3, s[12:15], s45 offen lds
 s_add_u32 m0, s36, 5200
 s_add_u32 s45, s34, 15360
 buffer_load_dwordx4 v3, s[12:15], s45 offen lds
 s_add_u32 m0, s36, 6240
 s_add_u32 s45, s34, 18432
 buffer_load_dwordx4 v3, s[12:15], s45 offen lds
 s_add_u32 m0, s36, 7280
 s_add_u32 s45, s34, 21504
 buffer_load_dwordx4 v3, s[12:15], s45 offen lds
 s_add_u32 m0, s36, 8320
 s_add_u32 s45, s34, 24576
 buffer_load_dwordx4 v3, s[12:15], s45 offen lds
 s_add_u32 m0, s36, 9360
 s_add_u32 s45, s34, 27648
 buffer_load_dwordx4 v3, s[12:15], s45 offen lds
 s_add_u32 m0, s36, 10400
 s_add_u32 s45, s34, 30720
 buffer_load_dwordx4 v3, s[12:15], s45 offen lds
 s_add_u32 m0, s36, 11440
 s_add_u32 s45, s34, 33792
 buffer_load_dwordx4 v3, s[12:15], s45 offen lds
 s_add_u32 m0, s36, 12480
 s_add_u32 s45, s34, 36864
 buffer_load_dwordx4 v3, s[12:15], s45 offen lds
 s_add_u32 m0, s36, 13520
 s_add_u32 s45, s34, 39936
 buffer_load_dwordx4 v3, s[12:15], s45 offen lds
 s_add_u32 m0, s36, 14560
 s_add_u32 s45, s34, 43008
 buffer_load_dwordx4 v3, s[12:15], s45 offen lds
 s_add_u32 m0, s36, 15600
 s_add_u32 s45, s34, 46080
 buffer_load_dwordx4 v3, s[12:15], s45 offen lds
 v_lshrrev_b32 v6, 2, v5
 v_lshlrev_b32 v6, 3, v6
 v_and_b32 v7, 3, v5
 v_add_u32 v6, v6, v7
 v_mul_u32_u24 v6, 1040, v6
 v_lshl_add_u32 v6, v4, 4, v6
 s_lshr_b32 s36, s3, 1
 s_lshl_b32 s36, s36, 3
 s_and_b32 s37, s3, 1
 s_add_u32 s36, s36, s37
 s_mul_i32 s36, s36, 4160
 s_add_u32 s36, s36, 33280
 v_add_u32 v7, s36, v6
 s_lshl_b32 s34, s33, 1
 s_lshr_b32 s35, s3, 1
 s_add_u32 s34, s34, s35
 s_mul_i32 s34, s34, 96
 s_lshl_b32 s35, s32, 2
 s_add_u32 s34, s34, s35
 s_and_b32 s35, s3, 1
 s_add_u32 s34, s34, s35
 s_lshl_b32 s34, s34, 10
 s_add_u32 s34, s34, 88080384
 s_mov_b32 s38, 0x3d8293ee
 s_waitcnt vmcnt(0)
 s_barrier
 ds_read_b128 v[32:35], v6 offset:0
 ds_read_b128 v[36:39], v6 offset:4160
 ds_read_b128 v[40:43], v7 offset:0
 ds_read_b128 v[44:47], v6 offset:64
 ds_read_b128 v[48:51], v6 offset:4224
 ds_read_b128 v[52:55], v7 offset:64
 ds_read_b128 v[56:59], v6 offset:128
 ds_read_b128 v[60:63], v6 offset:4288
 ds_read_b128 v[64:67], v7 offset:128
 ds_read_b128 v[68:71], v6 offset:192
 ds_read_b128 v[72:75], v6 offset:4352
 ds_read_b128 v[76:79], v7 offset:192
 ds_read_b128 v[80:83], v6 offset:256
 ds_read_b128 v[84:87], v6 offset:4416
 ds_read_b128 v[88:91], v7 offset:256
 s_waitcnt lgkmcnt(12)
 MM v[16:19], v[32:35], v[40:43], 0
 MM v[20:23], v[36:39], v[40:43], 0
 ds_read_b128 v[32:35], v6 offset:320
 ds_read_b128 v[36:39], v6 offset:4480
 ds_read_b128 v[40:43], v7 offset:320
 s_waitcnt lgkmcnt(12)
 MM v[16:19], v[44:47], v[52:55], v[16:19]
 MM v[20:23], v[48:51], v[52:55], v[20:23]
 ds_read_b128 v[44:47], v6 offset:384
 ds_read_b128 v[48:51], v6 offset:4544
 ds_read_b128 v[52:55], v7 offset:384
 s_waitcnt lgkmcnt(12)
 MM v[16:19], v[56:59], v[64:67], v[16:19]
 MM v[20:23], v[60:63], v[64:67], v[20:23]
 ds_read_b128 v[56:59], v6 offset:448
 ds_read_b128 v[60:63], v6 offset:4608
 ds_read_b128 v[64:67], v7 offset:448
 s_waitcnt lgkmcnt(12)
 MM v[16:19], v[68:71], v[76:79], v[16:19]
 MM v[20:23], v[72:75], v[76:79], v[20:23]
 ds_read_b128 v[68:71], v6 offset:512
 ds_read_b128 v[72:75], v6 offset:4672
 ds_read_b128 v[76:79], v7 offset:512
 s_waitcnt lgkmcnt(12)
 MM v[16:19], v[80:83], v[88:91], v[16:19]
 MM v[20:23], v[84:87], v[88:91], v[20:23]
 ds_read_b128 v[80:83], v6 offset:576
 ds_read_b128 v[84:87], v6 offset:4736
 ds_read_b128 v[88:91], v7 offset:576
 s_waitcnt lgkmcnt(12)
 MM v[16:19], v[32:35], v[40:43], v[16:19]
 MM v[20:23], v[36:39], v[40:43], v[20:23]
 ds_read_b128 v[32:35], v6 offset:640
 ds_read_b128 v[36:39], v6 offset:4800
 ds_read_b128 v[40:43], v7 offset:640
 s_waitcnt lgkmcnt(12)
 MM v[16:19], v[44:47], v[52:55], v[16:19]
 MM v[20:23], v[48:51], v[52:55], v[20:23]
 ds_read_b128 v[44:47], v6 offset:704
 ds_read_b128 v[48:51], v6 offset:4864
 ds_read_b128 v[52:55], v7 offset:704
 s_waitcnt lgkmcnt(12)
 MM v[16:19], v[56:59], v[64:67], v[16:19]
 MM v[20:23], v[60:63], v[64:67], v[20:23]
 ds_read_b128 v[56:59], v6 offset:768
 ds_read_b128 v[60:63], v6 offset:4928
 ds_read_b128 v[64:67], v7 offset:768
 s_waitcnt lgkmcnt(12)
 MM v[16:19], v[68:71], v[76:79], v[16:19]
 MM v[20:23], v[72:75], v[76:79], v[20:23]
 ds_read_b128 v[68:71], v6 offset:832
 ds_read_b128 v[72:75], v6 offset:4992
 ds_read_b128 v[76:79], v7 offset:832
 s_waitcnt lgkmcnt(12)
 MM v[16:19], v[80:83], v[88:91], v[16:19]
 MM v[20:23], v[84:87], v[88:91], v[20:23]
 ds_read_b128 v[80:83], v6 offset:896
 ds_read_b128 v[84:87], v6 offset:5056
 ds_read_b128 v[88:91], v7 offset:896
 s_waitcnt lgkmcnt(12)
 MM v[16:19], v[32:35], v[40:43], v[16:19]
 MM v[20:23], v[36:39], v[40:43], v[20:23]
 ds_read_b128 v[32:35], v6 offset:960
 ds_read_b128 v[36:39], v6 offset:5120
 ds_read_b128 v[40:43], v7 offset:960
 s_waitcnt lgkmcnt(12)
 MM v[16:19], v[44:47], v[52:55], v[16:19]
 MM v[20:23], v[48:51], v[52:55], v[20:23]
 s_waitcnt lgkmcnt(9)
 MM v[16:19], v[56:59], v[64:67], v[16:19]
 MM v[20:23], v[60:63], v[64:67], v[20:23]
 s_waitcnt lgkmcnt(6)
 MM v[16:19], v[68:71], v[76:79], v[16:19]
 MM v[20:23], v[72:75], v[76:79], v[20:23]
 s_waitcnt lgkmcnt(3)
 MM v[16:19], v[80:83], v[88:91], v[16:19]
 MM v[20:23], v[84:87], v[88:91], v[20:23]
 s_waitcnt lgkmcnt(0)
 MM v[16:19], v[32:35], v[40:43], v[16:19]
 MM v[20:23], v[36:39], v[40:43], v[20:23]
 s_nop 6
 v_mul_f32 v16, s38, v16
 v_mul_f32 v17, s38, v17
 v_mul_f32 v18, s38, v18
 v_mul_f32 v19, s38, v19
 v_mul_f32 v20, s38, v20
 v_mul_f32 v21, s38, v21
 v_mul_f32 v22, s38, v22
 v_mul_f32 v23, s38, v23
 CB v24, v16, v17
 CB v25, v18, v19
 CB v26, v20, v21
 CB v27, v22, v23
 buffer_store_dwordx4 v[24:27], v3, s[8:11], s34 offen sc1
 s_endpgm
prep_kernel_vo:
 s_sub_u32 s6, s85, 128
 s_lshr_b32 s33, s6, 3
 s_and_b32 s32, s6, 7
 s_mov_b32 s12, s20
 s_and_b32 s13, s21, 0xffff
 s_mov_b32 s14, 524288
 s_mov_b32 s15, 0x00020000
 s_mov_b32 s48, s18
 s_and_b32 s49, s19, 0xffff
 s_mov_b32 s50, 1572864
 s_mov_b32 s51, 0x00020000
 s_lshl_b32 s40, s33, 7
 s_mov_b32 s42, 1024
 s_mov_b32 s63, 3
 s_mov_b32 s59, 32
 v_lshrrev_b32_e64 v7, 3, v2
 v_bfe_u32 v8, v2, 4, 1
 v_lshlrev_b32 v8, 2, v8
 v_and_b32 v9, 7, v2
 v_xor_b32_e64 v8, v8, v9
 v_mul_lo_u32 v7, v7, s42
 v_lshl_add_u32 v7, v8, 4, v7
 s_lshl_b32 s41, s42, 3
 s_lshl_b32 s43, s3, 4
 s_mul_i32 s43, s43, s41
 s_add_u32 s40, s40, s43
 s_lshl_b32 s44, s3, 14
 s_add_u32 m0, s44, 0
 s_nop 0
 buffer_load_dwordx4 v7, s[12:15], s40 offen lds
 s_add_u32 m0, s44, 1024
 s_add_u32 s40, s40, s41
 buffer_load_dwordx4 v7, s[12:15], s40 offen lds
 s_add_u32 m0, s44, 2048
 s_add_u32 s40, s40, s41
 buffer_load_dwordx4 v7, s[12:15], s40 offen lds
 s_add_u32 m0, s44, 3072
 s_add_u32 s40, s40, s41
 buffer_load_dwordx4 v7, s[12:15], s40 offen lds
 s_add_u32 m0, s44, 4096
 s_add_u32 s40, s40, s41
 buffer_load_dwordx4 v7, s[12:15], s40 offen lds
 s_add_u32 m0, s44, 5120
 s_add_u32 s40, s40, s41
 buffer_load_dwordx4 v7, s[12:15], s40 offen lds
 s_add_u32 m0, s44, 6144
 s_add_u32 s40, s40, s41
 buffer_load_dwordx4 v7, s[12:15], s40 offen lds
 s_add_u32 m0, s44, 7168
 s_add_u32 s40, s40, s41
 buffer_load_dwordx4 v7, s[12:15], s40 offen lds
 s_add_u32 m0, s44, 8192
 s_add_u32 s40, s40, s41
 buffer_load_dwordx4 v7, s[12:15], s40 offen lds
 s_add_u32 m0, s44, 9216
 s_add_u32 s40, s40, s41
 buffer_load_dwordx4 v7, s[12:15], s40 offen lds
 s_add_u32 m0, s44, 10240
 s_add_u32 s40, s40, s41
 buffer_load_dwordx4 v7, s[12:15], s40 offen lds
 s_add_u32 m0, s44, 11264
 s_add_u32 s40, s40, s41
 buffer_load_dwordx4 v7, s[12:15], s40 offen lds
 s_add_u32 m0, s44, 12288
 s_add_u32 s40, s40, s41
 buffer_load_dwordx4 v7, s[12:15], s40 offen lds
 s_add_u32 m0, s44, 13312
 s_add_u32 s40, s40, s41
 buffer_load_dwordx4 v7, s[12:15], s40 offen lds
 s_add_u32 m0, s44, 14336
 s_add_u32 s40, s40, s41
 buffer_load_dwordx4 v7, s[12:15], s40 offen lds
 s_add_u32 m0, s44, 15360
 s_add_u32 s40, s40, s41
 buffer_load_dwordx4 v7, s[12:15], s40 offen lds
 v_bfe_u32 v8, v2, 2, 2
 v_lshl_add_u32 v9, v4, 3, v8
 v_lshlrev_b32 v9, 7, v9
 v_lshrrev_b32 v8, 1, v8
 v_lshl_add_u32 v9, v8, 6, v9
 v_and_b32 v8, 3, v2
 v_lshlrev_b32 v8, s63, v8
 v_add_u32 v8, v8, v9
 v_xor_b32 v9, 64, v8
 v_add_u32 v10, s59, v8
 v_xor_b32_e64 v11, 64, v10
 s_lshl_b32 s34, s32, 6
 s_lshl_b32 s35, s3, 4
 s_add_u32 s34, s34, s35
 s_mul_i32 s34, s34, 3072
 s_add_u32 s34, s34, 2048
 s_mul_i32 s36, s3, 16640
 s_add_u32 s36, s36, 65536
 s_add_u32 m0, s36, 0
 s_add_u32 s45, s34, 0
 buffer_load_dwordx4 v3, s[48:51], s45 offen lds
 s_add_u32 m0, s36, 1040
 s_add_u32 s45, s34, 3072
 buffer_load_dwordx4 v3, s[48:51], s45 offen lds
 s_add_u32 m0, s36, 2080
 s_add_u32 s45, s34, 6144
 buffer_load_dwordx4 v3, s[48:51], s45 offen lds
 s_add_u32 m0, s36, 3120
 s_add_u32 s45, s34, 9216
 buffer_load_dwordx4 v3, s[48:51], s45 offen lds
 s_add_u32 m0, s36, 4160
 s_add_u32 s45, s34, 12288
 buffer_load_dwordx4 v3, s[48:51], s45 offen lds
 s_add_u32 m0, s36, 5200
 s_add_u32 s45, s34, 15360
 buffer_load_dwordx4 v3, s[48:51], s45 offen lds
 s_add_u32 m0, s36, 6240
 s_add_u32 s45, s34, 18432
 buffer_load_dwordx4 v3, s[48:51], s45 offen lds
 s_add_u32 m0, s36, 7280
 s_add_u32 s45, s34, 21504
 buffer_load_dwordx4 v3, s[48:51], s45 offen lds
 s_add_u32 m0, s36, 8320
 s_add_u32 s45, s34, 24576
 buffer_load_dwordx4 v3, s[48:51], s45 offen lds
 s_add_u32 m0, s36, 9360
 s_add_u32 s45, s34, 27648
 buffer_load_dwordx4 v3, s[48:51], s45 offen lds
 s_add_u32 m0, s36, 10400
 s_add_u32 s45, s34, 30720
 buffer_load_dwordx4 v3, s[48:51], s45 offen lds
 s_add_u32 m0, s36, 11440
 s_add_u32 s45, s34, 33792
 buffer_load_dwordx4 v3, s[48:51], s45 offen lds
 s_add_u32 m0, s36, 12480
 s_add_u32 s45, s34, 36864
 buffer_load_dwordx4 v3, s[48:51], s45 offen lds
 s_add_u32 m0, s36, 13520
 s_add_u32 s45, s34, 39936
 buffer_load_dwordx4 v3, s[48:51], s45 offen lds
 s_add_u32 m0, s36, 14560
 s_add_u32 s45, s34, 43008
 buffer_load_dwordx4 v3, s[48:51], s45 offen lds
 s_add_u32 m0, s36, 15600
 s_add_u32 s45, s34, 46080
 buffer_load_dwordx4 v3, s[48:51], s45 offen lds
 s_bitcmp1_b32 s3, 0
 s_cselect_b64 vcc, -1, 0
 v_cndmask_b32 v8, v8, v9, vcc
 v_cndmask_b32 v9, v10, v11, vcc
 v_mul_u32_u24 v6, 1040, v5
 v_lshl_add_u32 v6, v4, 4, v6
 s_lshr_b32 s36, s3, 1
 s_mul_i32 s37, s36, 33280
 s_add_u32 s37, s37, 65536
 v_add_u32_e64 v6, s37, v6
 s_lshr_b32 s34, s33, 1
 s_lshl_b32 s34, s34, 4
 s_lshl_b32 s35, s32, 1
 s_add_u32 s35, s35, s36
 s_add_u32 s34, s34, s35
 s_lshl_b32 s34, s34, 3
 s_and_b32 s35, s3, 1
 s_lshl_b32 s35, s35, 1
 s_add_u32 s34, s34, s35
 s_and_b32 s35, s33, 1
 s_lshl_b32 s35, s35, 2
 s_add_u32 s34, s34, s35
 s_lshl_b32 s34, s34, 10
 s_add_u32 s34, s34, 89653248
 s_waitcnt vmcnt(0)
 s_barrier
 ds_read_b128 v[32:35], v6 offset:0
 ds_read_b128 v[36:39], v6 offset:16640
 ds_read_b64_tr_b16 v[40:41], v8 offset:0
 ds_read_b64_tr_b16 v[42:43], v8 offset:512
 ds_read_b64_tr_b16 v[44:45], v9 offset:0
 ds_read_b64_tr_b16 v[46:47], v9 offset:512
 ds_read_b128 v[48:51], v6 offset:64
 ds_read_b128 v[52:55], v6 offset:16704
 ds_read_b64_tr_b16 v[56:57], v8 offset:4096
 ds_read_b64_tr_b16 v[58:59], v8 offset:4608
 ds_read_b64_tr_b16 v[60:61], v9 offset:4096
 ds_read_b64_tr_b16 v[62:63], v9 offset:4608
 ds_read_b128 v[64:67], v6 offset:128
 ds_read_b128 v[68:71], v6 offset:16768
 ds_read_b64_tr_b16 v[72:73], v8 offset:8192
 ds_read_b64_tr_b16 v[74:75], v8 offset:8704
 ds_read_b64_tr_b16 v[76:77], v9 offset:8192
 ds_read_b64_tr_b16 v[78:79], v9 offset:8704
 s_waitcnt lgkmcnt(12)
 MM v[16:19], v[32:35], v[40:43], 0
 MM v[20:23], v[36:39], v[40:43], 0
 MM v[24:27], v[32:35], v[44:47], 0
 MM v[28:31], v[36:39], v[44:47], 0
 ds_read_b128 v[32:35], v6 offset:192
 ds_read_b128 v[36:39], v6 offset:16832
 ds_read_b64_tr_b16 v[40:41], v8 offset:12288
 ds_read_b64_tr_b16 v[42:43], v8 offset:12800
 ds_read_b64_tr_b16 v[44:45], v9 offset:12288
 ds_read_b64_tr_b16 v[46:47], v9 offset:12800
 s_waitcnt lgkmcnt(12)
 MM v[16:19], v[48:51], v[56:59], v[16:19]
 MM v[20:23], v[52:55], v[56:59], v[20:23]
 MM v[24:27], v[48:51], v[60:63], v[24:27]
 MM v[28:31], v[52:55], v[60:63], v[28:31]
 ds_read_b128 v[48:51], v6 offset:256
 ds_read_b128 v[52:55], v6 offset:16896
 ds_read_b64_tr_b16 v[56:57], v8 offset:16384
 ds_read_b64_tr_b16 v[58:59], v8 offset:16896
 ds_read_b64_tr_b16 v[60:61], v9 offset:16384
 ds_read_b64_tr_b16 v[62:63], v9 offset:16896
 s_waitcnt lgkmcnt(12)
 MM v[16:19], v[64:67], v[72:75], v[16:19]
 MM v[20:23], v[68:71], v[72:75], v[20:23]
 MM v[24:27], v[64:67], v[76:79], v[24:27]
 MM v[28:31], v[68:71], v[76:79], v[28:31]
 ds_read_b128 v[64:67], v6 offset:320
 ds_read_b128 v[68:71], v6 offset:16960
 ds_read_b64_tr_b16 v[72:73], v8 offset:20480
 ds_read_b64_tr_b16 v[74:75], v8 offset:20992
 ds_read_b64_tr_b16 v[76:77], v9 offset:20480
 ds_read_b64_tr_b16 v[78:79], v9 offset:20992
 s_waitcnt lgkmcnt(12)
 MM v[16:19], v[32:35], v[40:43], v[16:19]
 MM v[20:23], v[36:39], v[40:43], v[20:23]
 MM v[24:27], v[32:35], v[44:47], v[24:27]
 MM v[28:31], v[36:39], v[44:47], v[28:31]
 ds_read_b128 v[32:35], v6 offset:384
 ds_read_b128 v[36:39], v6 offset:17024
 ds_read_b64_tr_b16 v[40:41], v8 offset:24576
 ds_read_b64_tr_b16 v[42:43], v8 offset:25088
 ds_read_b64_tr_b16 v[44:45], v9 offset:24576
 ds_read_b64_tr_b16 v[46:47], v9 offset:25088
 s_waitcnt lgkmcnt(12)
 MM v[16:19], v[48:51], v[56:59], v[16:19]
 MM v[20:23], v[52:55], v[56:59], v[20:23]
 MM v[24:27], v[48:51], v[60:63], v[24:27]
 MM v[28:31], v[52:55], v[60:63], v[28:31]
 ds_read_b128 v[48:51], v6 offset:448
 ds_read_b128 v[52:55], v6 offset:17088
 ds_read_b64_tr_b16 v[56:57], v8 offset:28672
 ds_read_b64_tr_b16 v[58:59], v8 offset:29184
 ds_read_b64_tr_b16 v[60:61], v9 offset:28672
 ds_read_b64_tr_b16 v[62:63], v9 offset:29184
 s_waitcnt lgkmcnt(12)
 MM v[16:19], v[64:67], v[72:75], v[16:19]
 MM v[20:23], v[68:71], v[72:75], v[20:23]
 MM v[24:27], v[64:67], v[76:79], v[24:27]
 MM v[28:31], v[68:71], v[76:79], v[28:31]
 ds_read_b128 v[64:67], v6 offset:512
 ds_read_b128 v[68:71], v6 offset:17152
 ds_read_b64_tr_b16 v[72:73], v8 offset:32768
 ds_read_b64_tr_b16 v[74:75], v8 offset:33280
 ds_read_b64_tr_b16 v[76:77], v9 offset:32768
 ds_read_b64_tr_b16 v[78:79], v9 offset:33280
 s_waitcnt lgkmcnt(12)
 MM v[16:19], v[32:35], v[40:43], v[16:19]
 MM v[20:23], v[36:39], v[40:43], v[20:23]
 MM v[24:27], v[32:35], v[44:47], v[24:27]
 MM v[28:31], v[36:39], v[44:47], v[28:31]
 ds_read_b128 v[32:35], v6 offset:576
 ds_read_b128 v[36:39], v6 offset:17216
 ds_read_b64_tr_b16 v[40:41], v8 offset:36864
 ds_read_b64_tr_b16 v[42:43], v8 offset:37376
 ds_read_b64_tr_b16 v[44:45], v9 offset:36864
 ds_read_b64_tr_b16 v[46:47], v9 offset:37376
 s_waitcnt lgkmcnt(12)
 MM v[16:19], v[48:51], v[56:59], v[16:19]
 MM v[20:23], v[52:55], v[56:59], v[20:23]
 MM v[24:27], v[48:51], v[60:63], v[24:27]
 MM v[28:31], v[52:55], v[60:63], v[28:31]
 ds_read_b128 v[48:51], v6 offset:640
 ds_read_b128 v[52:55], v6 offset:17280
 ds_read_b64_tr_b16 v[56:57], v8 offset:40960
 ds_read_b64_tr_b16 v[58:59], v8 offset:41472
 ds_read_b64_tr_b16 v[60:61], v9 offset:40960
 ds_read_b64_tr_b16 v[62:63], v9 offset:41472
 s_waitcnt lgkmcnt(12)
 MM v[16:19], v[64:67], v[72:75], v[16:19]
 MM v[20:23], v[68:71], v[72:75], v[20:23]
 MM v[24:27], v[64:67], v[76:79], v[24:27]
 MM v[28:31], v[68:71], v[76:79], v[28:31]
 ds_read_b128 v[64:67], v6 offset:704
 ds_read_b128 v[68:71], v6 offset:17344
 ds_read_b64_tr_b16 v[72:73], v8 offset:45056
 ds_read_b64_tr_b16 v[74:75], v8 offset:45568
 ds_read_b64_tr_b16 v[76:77], v9 offset:45056
 ds_read_b64_tr_b16 v[78:79], v9 offset:45568
 s_waitcnt lgkmcnt(12)
 MM v[16:19], v[32:35], v[40:43], v[16:19]
 MM v[20:23], v[36:39], v[40:43], v[20:23]
 MM v[24:27], v[32:35], v[44:47], v[24:27]
 MM v[28:31], v[36:39], v[44:47], v[28:31]
 ds_read_b128 v[32:35], v6 offset:768
 ds_read_b128 v[36:39], v6 offset:17408
 ds_read_b64_tr_b16 v[40:41], v8 offset:49152
 ds_read_b64_tr_b16 v[42:43], v8 offset:49664
 ds_read_b64_tr_b16 v[44:45], v9 offset:49152
 ds_read_b64_tr_b16 v[46:47], v9 offset:49664
 s_waitcnt lgkmcnt(12)
 MM v[16:19], v[48:51], v[56:59], v[16:19]
 MM v[20:23], v[52:55], v[56:59], v[20:23]
 MM v[24:27], v[48:51], v[60:63], v[24:27]
 MM v[28:31], v[52:55], v[60:63], v[28:31]
 ds_read_b128 v[48:51], v6 offset:832
 ds_read_b128 v[52:55], v6 offset:17472
 ds_read_b64_tr_b16 v[56:57], v8 offset:53248
 ds_read_b64_tr_b16 v[58:59], v8 offset:53760
 ds_read_b64_tr_b16 v[60:61], v9 offset:53248
 ds_read_b64_tr_b16 v[62:63], v9 offset:53760
 s_waitcnt lgkmcnt(12)
 MM v[16:19], v[64:67], v[72:75], v[16:19]
 MM v[20:23], v[68:71], v[72:75], v[20:23]
 MM v[24:27], v[64:67], v[76:79], v[24:27]
 MM v[28:31], v[68:71], v[76:79], v[28:31]
 ds_read_b128 v[64:67], v6 offset:896
 ds_read_b128 v[68:71], v6 offset:17536
 ds_read_b64_tr_b16 v[72:73], v8 offset:57344
 ds_read_b64_tr_b16 v[74:75], v8 offset:57856
 ds_read_b64_tr_b16 v[76:77], v9 offset:57344
 ds_read_b64_tr_b16 v[78:79], v9 offset:57856
 s_waitcnt lgkmcnt(12)
 MM v[16:19], v[32:35], v[40:43], v[16:19]
 MM v[20:23], v[36:39], v[40:43], v[20:23]
 MM v[24:27], v[32:35], v[44:47], v[24:27]
 MM v[28:31], v[36:39], v[44:47], v[28:31]
 ds_read_b128 v[32:35], v6 offset:960
 ds_read_b128 v[36:39], v6 offset:17600
 ds_read_b64_tr_b16 v[40:41], v8 offset:61440
 ds_read_b64_tr_b16 v[42:43], v8 offset:61952
 ds_read_b64_tr_b16 v[44:45], v9 offset:61440
 ds_read_b64_tr_b16 v[46:47], v9 offset:61952
 s_waitcnt lgkmcnt(12)
 MM v[16:19], v[48:51], v[56:59], v[16:19]
 MM v[20:23], v[52:55], v[56:59], v[20:23]
 MM v[24:27], v[48:51], v[60:63], v[24:27]
 MM v[28:31], v[52:55], v[60:63], v[28:31]
 s_waitcnt lgkmcnt(6)
 MM v[16:19], v[64:67], v[72:75], v[16:19]
 MM v[20:23], v[68:71], v[72:75], v[20:23]
 MM v[24:27], v[64:67], v[76:79], v[24:27]
 MM v[28:31], v[68:71], v[76:79], v[28:31]
 s_waitcnt lgkmcnt(0)
 MM v[16:19], v[32:35], v[40:43], v[16:19]
 MM v[20:23], v[36:39], v[40:43], v[20:23]
 MM v[24:27], v[32:35], v[44:47], v[24:27]
 MM v[28:31], v[36:39], v[44:47], v[28:31]
 s_nop 4
 CB v80, v16, v17
 CB v81, v18, v19
 CB v82, v20, v21
 CB v83, v22, v23
 buffer_store_dwordx4 v[80:83], v3, s[8:11], s34 offen offset:0 sc1
 CB v84, v24, v25
 CB v85, v26, v27
 CB v86, v28, v29
 CB v87, v30, v31
 buffer_store_dwordx4 v[84:87], v3, s[8:11], s34 offen offset:1024 sc1
 s_endpgm
prep_kernel_rl:
 s_sub_u32 s6, s85, 192
 s_mov_b32 s63, 4
 s_mov_b32 s59, 8
 s_mov_b32 s38, 2048
 s_cmp_lt_u32 s6, 16
 s_cbranch_scc1 prep_kernel_rl_mi
 s_cmp_lt_u32 s6, 24
 s_cbranch_scc1 prep_kernel_rl_mo
 s_sub_u32 s6, s6, 24
 s_lshr_b32 s36, s6, 3
 s_and_b32 s33, s6, 7
 s_mov_b32 s12, s30
 s_and_b32 s13, s31, 0xffff
 s_mov_b32 s14, 1048576
 s_mov_b32 s15, 0x00020000
 s_lshl_b32 s40, s33, 7
 s_lshl_b32 s37, s36, 19
 s_add_u32 s40, s40, s37
 s_mov_b32 s42, 1024
 s_lshr_b32 s34, s6, 1
 s_lshl_b32 s34, s34, 17
 s_xor_b32 s37, s6, s36
 s_xor_b32 s37, s37, 1
 s_and_b32 s37, s37, 1
 s_lshl_b32 s37, s37, 16
 s_add_u32 s34, s34, s37
 s_add_u32 s34, s34, 90701824
 s_mov_b32 s35, 4096
 s_branch prep_kernel_rl_go
prep_kernel_rl_mo:
 s_sub_u32 s33, s6, 16
 s_mov_b32 s63, 3
 s_mov_b32 s59, 32
 s_mov_b32 s12, s26
 s_and_b32 s13, s27, 0xffff
 s_mov_b32 s14, 524288
 s_mov_b32 s15, 0x00020000
 s_lshl_b32 s40, s33, 7
 s_mov_b32 s42, 1024
 s_lshr_b32 s34, s33, 1
 s_lshl_b32 s34, s34, 17
 s_and_b32 s37, s33, 1
 s_lshl_b32 s37, s37, 12
 s_add_u32 s34, s34, s37
 s_add_u32 s34, s34, 90177536
 s_mov_b32 s35, 8192
 s_branch prep_kernel_rl_go
prep_kernel_rl_mi:
 s_mov_b32 s12, s22
 s_and_b32 s13, s23, 0xffff
 s_mov_b32 s14, 1048576
 s_mov_b32 s15, 0x00020000
 s_lshl_b32 s40, s6, 7
 s_mov_b32 s42, 2048
 s_mov_b32 s63, 3
 s_mov_b32 s59, 32
 s_and_b32 s33, s6, 7
 s_mul_i32 s34, s33, 192
 s_cmp_lt_u32 s6, 8
 s_cselect_b32 s37, 64, 2
 s_cselect_b32 s35, 2, 4
 s_add_u32 s34, s34, s37
 s_lshl_b32 s34, s34, 10
 s_add_u32 s34, s34, 88080384
 s_lshl_b32 s35, s35, 10
 s_mov_b32 s38, 98304
prep_kernel_rl_go:
 v_lshrrev_b32 v7, 3, v2
 v_bfe_u32 v8, v2, 4, 1
 v_lshlrev_b32 v8, 2, v8
 v_and_b32 v9, 7, v2
 v_xor_b32_e64 v8, v8, v9
 v_mul_lo_u32 v7, v7, s42
 v_lshl_add_u32 v7, v8, 4, v7
 s_lshl_b32 s41, s42, 3
 s_lshl_b32 s43, s3, 4
 s_mul_i32 s43, s43, s41
 s_add_u32 s40, s40, s43
 s_lshl_b32 s44, s3, 14
 s_add_u32 m0, s44, 0
 s_nop 0
 buffer_load_dwordx4 v7, s[12:15], s40 offen lds
 s_add_u32 m0, s44, 1024
 s_add_u32 s40, s40, s41
 buffer_load_dwordx4 v7, s[12:15], s40 offen lds
 s_add_u32 m0, s44, 2048
 s_add_u32 s40, s40, s41
 buffer_load_dwordx4 v7, s[12:15], s40 offen lds
 s_add_u32 m0, s44, 3072
 s_add_u32 s40, s40, s41
 buffer_load_dwordx4 v7, s[12:15], s40 offen lds
 s_add_u32 m0, s44, 4096
 s_add_u32 s40, s40, s41
 buffer_load_dwordx4 v7, s[12:15], s40 offen lds
 s_add_u32 m0, s44, 5120
 s_add_u32 s40, s40, s41
 buffer_load_dwordx4 v7, s[12:15], s40 offen lds
 s_add_u32 m0, s44, 6144
 s_add_u32 s40, s40, s41
 buffer_load_dwordx4 v7, s[12:15], s40 offen lds
 s_add_u32 m0, s44, 7168
 s_add_u32 s40, s40, s41
 buffer_load_dwordx4 v7, s[12:15], s40 offen lds
 s_add_u32 m0, s44, 8192
 s_add_u32 s40, s40, s41
 buffer_load_dwordx4 v7, s[12:15], s40 offen lds
 s_add_u32 m0, s44, 9216
 s_add_u32 s40, s40, s41
 buffer_load_dwordx4 v7, s[12:15], s40 offen lds
 s_add_u32 m0, s44, 10240
 s_add_u32 s40, s40, s41
 buffer_load_dwordx4 v7, s[12:15], s40 offen lds
 s_add_u32 m0, s44, 11264
 s_add_u32 s40, s40, s41
 buffer_load_dwordx4 v7, s[12:15], s40 offen lds
 s_add_u32 m0, s44, 12288
 s_add_u32 s40, s40, s41
 buffer_load_dwordx4 v7, s[12:15], s40 offen lds
 s_add_u32 m0, s44, 13312
 s_add_u32 s40, s40, s41
 buffer_load_dwordx4 v7, s[12:15], s40 offen lds
 s_add_u32 m0, s44, 14336
 s_add_u32 s40, s40, s41
 buffer_load_dwordx4 v7, s[12:15], s40 offen lds
 s_add_u32 m0, s44, 15360
 s_add_u32 s40, s40, s41
 buffer_load_dwordx4 v7, s[12:15], s40 offen lds
 v_bfe_u32 v8, v2, 2, 2
 v_lshl_add_u32 v9, v4, 3, v8
 v_lshlrev_b32 v9, 7, v9
 v_lshrrev_b32 v8, 1, v8
 v_lshl_add_u32 v9, v8, 6, v9
 v_and_b32 v8, 3, v2
 v_lshlrev_b32 v8, s63, v8
 v_add_u32 v8, v8, v9
 v_xor_b32 v9, 64, v8
 v_add_u32 v10, s59, v8
 v_xor_b32 v11, 64, v10
 v_add_u32 v8, s44, v8
 v_add_u32 v9, s44, v9
 v_add_u32 v10, s44, v10
 v_add_u32 v11, s44, v11
 s_lshl_b32 s37, s3, 2
 s_mul_i32 s37, s37, s35
 s_add_u32 s34, s34, s37
 s_waitcnt vmcnt(12)
 ds_read_b64_tr_b16 v[16:17], v8 offset:0
 ds_read_b64_tr_b16 v[18:19], v8 offset:512
 ds_read_b64_tr_b16 v[20:21], v10 offset:0
 ds_read_b64_tr_b16 v[22:23], v10 offset:512
 ds_read_b64_tr_b16 v[24:25], v9 offset:0
 ds_read_b64_tr_b16 v[26:27], v9 offset:512
 ds_read_b64_tr_b16 v[28:29], v11 offset:0
 ds_read_b64_tr_b16 v[30:31], v11 offset:512
 s_waitcnt lgkmcnt(0)
 s_add_u32 s39, s34, s38
 buffer_store_dwordx4 v[16:19], v3, s[8:11], s34 offen offset:0 sc1
 buffer_store_dwordx4 v[20:23], v3, s[8:11], s34 offen offset:1024 sc1
 buffer_store_dwordx4 v[24:27], v3, s[8:11], s39 offen offset:0 sc1
 buffer_store_dwordx4 v[28:31], v3, s[8:11], s39 offen offset:1024 sc1
 s_add_u32 s34, s34, s35
 s_waitcnt vmcnt(12)
 ds_read_b64_tr_b16 v[32:33], v8 offset:4096
 ds_read_b64_tr_b16 v[34:35], v8 offset:4608
 ds_read_b64_tr_b16 v[36:37], v10 offset:4096
 ds_read_b64_tr_b16 v[38:39], v10 offset:4608
 ds_read_b64_tr_b16 v[40:41], v9 offset:4096
 ds_read_b64_tr_b16 v[42:43], v9 offset:4608
 ds_read_b64_tr_b16 v[44:45], v11 offset:4096
 ds_read_b64_tr_b16 v[46:47], v11 offset:4608
 s_waitcnt lgkmcnt(0)
 s_add_u32 s39, s34, s38
 buffer_store_dwordx4 v[32:35], v3, s[8:11], s34 offen offset:0 sc1
 buffer_store_dwordx4 v[36:39], v3, s[8:11], s34 offen offset:1024 sc1
 buffer_store_dwordx4 v[40:43], v3, s[8:11], s39 offen offset:0 sc1
 buffer_store_dwordx4 v[44:47], v3, s[8:11], s39 offen offset:1024 sc1
 s_add_u32 s34, s34, s35
 s_waitcnt vmcnt(12)
 ds_read_b64_tr_b16 v[48:49], v8 offset:8192
 ds_read_b64_tr_b16 v[50:51], v8 offset:8704
 ds_read_b64_tr_b16 v[52:53], v10 offset:8192
 ds_read_b64_tr_b16 v[54:55], v10 offset:8704
 ds_read_b64_tr_b16 v[56:57], v9 offset:8192
 ds_read_b64_tr_b16 v[58:59], v9 offset:8704
 ds_read_b64_tr_b16 v[60:61], v11 offset:8192
 ds_read_b64_tr_b16 v[62:63], v11 offset:8704
 s_waitcnt lgkmcnt(0)
 s_add_u32 s39, s34, s38
 buffer_store_dwordx4 v[48:51], v3, s[8:11], s34 offen offset:0 sc1
 buffer_store_dwordx4 v[52:55], v3, s[8:11], s34 offen offset:1024 sc1
 buffer_store_dwordx4 v[56:59], v3, s[8:11], s39 offen offset:0 sc1
 buffer_store_dwordx4 v[60:63], v3, s[8:11], s39 offen offset:1024 sc1
 s_add_u32 s34, s34, s35
 s_waitcnt vmcnt(12)
 ds_read_b64_tr_b16 v[64:65], v8 offset:12288
 ds_read_b64_tr_b16 v[66:67], v8 offset:12800
 ds_read_b64_tr_b16 v[68:69], v10 offset:12288
 ds_read_b64_tr_b16 v[70:71], v10 offset:12800
 ds_read_b64_tr_b16 v[72:73], v9 offset:12288
 ds_read_b64_tr_b16 v[74:75], v9 offset:12800
 ds_read_b64_tr_b16 v[76:77], v11 offset:12288
 ds_read_b64_tr_b16 v[78:79], v11 offset:12800
 s_waitcnt lgkmcnt(0)
 s_add_u32 s39, s34, s38
 buffer_store_dwordx4 v[64:67], v3, s[8:11], s34 offen offset:0 sc1
 buffer_store_dwordx4 v[68:71], v3, s[8:11], s34 offen offset:1024 sc1
 buffer_store_dwordx4 v[72:75], v3, s[8:11], s39 offen offset:0 sc1
 buffer_store_dwordx4 v[76:79], v3, s[8:11], s39 offen offset:1024 sc1
prep_kernel_xt:
 s_endpgm
prep_kernel_end:
 s_endpgm
.globl in_kernel
.p2align 8
.type in_kernel,@function
in_kernel:
 s_cmp_ge_u32 s2, 256
 s_cbranch_scc1 in_kernel_end
 s_load_dwordx2 s[4:5], s[0:1], 80
 v_lshrrev_b32 v1, 6, v0
 v_and_b32 v192, 63, v0
 v_readfirstlane_b32 s3, v1
 v_lshlrev_b32_e64 v193, 4, v192
 s_mov_b32 s40, s3
 s_and_b32 s21, s2, 7
 s_lshr_b32 s22, s2, 3
 s_and_b32 s23, s22, 3
 s_lshr_b32 s22, s22, 2
 s_and_b32 s24, s21, 3
 s_lshl_b32 s24, s24, 3
 s_add_u32 s24, s24, s22
 s_lshl_b32 s24, s24, 2
 s_add_u32 s24, s24, s40
 s_cmp_lt_u32 s24, 125
 s_cselect_b32 s18, 1, 0
 s_min_u32 s24, s24, 124
 s_lshr_b32 s25, s21, 2
 s_mul_i32 s25, s25, 125
 s_add_u32 s24, s24, s25
 s_lshl_b32 s43, s24, 15
 s_mul_i32 s26, s23, 250
 s_add_u32 s26, s26, s24
 s_lshl_b32 s19, s24, 17
 s_lshl_b32 s27, s23, 10
 s_add_u32 s19, s19, s27
 s_add_u32 s19, s19, 33554432
 s_lshl_b32 s20, s24, 9
 s_lshl_b32 s26, s23, 7
 s_add_u32 s20, s20, s26
 s_add_u32 s20, s20, 67108864
 s_add_u32 s43, s43, 8388608
 s_lshl_b32 s28, s23, 3
 s_lshr_b32 s27, 0x5e3f2000, s28
 s_and_b32 s27, s27, 0xff
 s_lshr_b32 s28, 0x01010100, s28
 s_and_b32 s28, s28, 0xff
 s_add_u32 s27, s27, s25
 s_lshl_b32 s42, s27, 15
 s_sub_u32 s17, 31, s28
 s_lshl_b32 s41, s40, 13
 s_lshl_b32 s44, s21, 3
 s_add_u32 s44, s44, s22
 s_and_b32 s45, s44, 31
 s_lshl_b32 s45, s45, 2
 s_add_u32 s13, s45, s25
 s_add_u32 s14, s13, s3
 s_lshl_b32 s14, s14, 15
 s_lshl_b32 s15, s3, 15
 s_lshl_b32 s46, s23, 2
 s_add_u32 s46, s46, s3
 s_mul_i32 s12, s46, 98304
 s_add_u32 s12, s12, 88080384
 s_lshl_b32 s86, s44, 7
 s_add_u32 s86, s86, 92299264
 s_waitcnt lgkmcnt(0)
 s_mov_b32 s8, s4
 s_and_b32 s9, s5, 0xffff
 s_mov_b32 s10, 268435456
 s_mov_b32 s11, 0x00020000
 s_mov_b32 s36, s4
 s_and_b32 s37, s5, 0xffff
 s_mov_b32 s38, 0
 s_mov_b32 s39, 0x00020000
 s_add_u32 s38, s25, 125
 s_lshl_b32 s38, s38, 15
 s_add_u32 m0, s15, 32768
 s_add_u32 s57, s14, 0
 buffer_load_dwordx4 v193, s[36:39], s57 offen offset:0 lds
 buffer_load_dwordx4 v193, s[36:39], s57 offen offset:1024 lds
 buffer_load_dwordx4 v193, s[36:39], s57 offen offset:2048 lds
 buffer_load_dwordx4 v193, s[36:39], s57 offen offset:3072 lds
 s_add_u32 m0, s15, 36864
 s_add_u32 s57, s14, 4096
 buffer_load_dwordx4 v193, s[36:39], s57 offen offset:0 lds
 buffer_load_dwordx4 v193, s[36:39], s57 offen offset:1024 lds
 buffer_load_dwordx4 v193, s[36:39], s57 offen offset:2048 lds
 buffer_load_dwordx4 v193, s[36:39], s57 offen offset:3072 lds
 buffer_load_dwordx4 a[0:3], v193, s[8:11], s12 offen offset:0
 buffer_load_dwordx4 a[4:7], v193, s[8:11], s12 offen offset:1024
 buffer_load_dwordx4 a[8:11], v193, s[8:11], s12 offen offset:2048
 buffer_load_dwordx4 a[12:15], v193, s[8:11], s12 offen offset:3072
 s_add_u32 s12, s12, 0x1000
 buffer_load_dwordx4 a[16:19], v193, s[8:11], s12 offen offset:0
 s_add_u32 m0, s15, 40960
 s_add_u32 s57, s14, 8192
 buffer_load_dwordx4 v193, s[36:39], s57 offen offset:0 lds
 buffer_load_dwordx4 v193, s[36:39], s57 offen offset:1024 lds
 buffer_load_dwordx4 v193, s[36:39], s57 offen offset:2048 lds
 buffer_load_dwordx4 v193, s[36:39], s57 offen offset:3072 lds
 buffer_load_dwordx4 a[20:23], v193, s[8:11], s12 offen offset:1024
 buffer_load_dwordx4 a[24:27], v193, s[8:11], s12 offen offset:2048
 buffer_load_dwordx4 a[28:31], v193, s[8:11], s12 offen offset:3072
 s_getpc_b64 s[60:61]
in_kernel_pf1752:
 s_add_u32 s60, s60, in_kernel-in_kernel_pf1752
 s_addc_u32 s61, s61, -1
 v_lshlrev_b32 v250, 7, v0
 v_min_u32 v251, attn_kernel_end-in_kernel, v250
 global_load_dword v251, v251, s[60:61]
 v_add_u32 v250, 0x8000, v250
 v_min_u32 v252, attn_kernel_end-in_kernel, v250
 global_load_dword v252, v252, s[60:61]
 s_mov_b32 s59, s57
 s_lshl_b32 s57, s25, 15
 s_add_u32 s57, s57, 8388608
 s_add_u32 s48, s4, s57
 s_addc_u32 s49, s5, 0
 s_and_b32 s49, s49, 0xffff
 s_mov_b32 s50, 4096000
 s_mov_b32 s51, 0x00020000
 s_lshl_b32 s57, s25, 15
 s_add_u32 s57, s57, 25165824
 s_add_u32 s52, s4, s57
 s_addc_u32 s53, s5, 0
 s_and_b32 s53, s53, 0xffff
 s_mov_b32 s54, 4096000
 s_mov_b32 s55, 0x00020000
 s_lshl_b32 s57, s25, 15
 s_add_u32 s57, s57, 16777216
 s_add_u32 s60, s4, s57
 s_addc_u32 s61, s5, 0
 s_and_b32 s61, s61, 0xffff
 s_mov_b32 s62, 4096000
 s_mov_b32 s63, 0x00020000
 s_mov_b32 s57, s59
 s_mov_b32 s90, 0xffff0000
 v_lshrrev_b32 v198, 4, v192
 v_and_b32 v197, 15, v192
 v_and_b32 v194, 1, v198
 v_lshlrev_b32 v196, 14, v194
 v_mul_u32_u24 v194, 12, v194
 v_xor_b32 v194, v194, v197
 v_lshlrev_b32 v194, 4, v194
 v_lshl_add_u32 v194, v198, 9, v194
 v_add_u32 v194, 32768, v194
 v_add_u32 v195, 0x10000, v194
 v_lshl_add_u32 v196, v197, 5, v196
 v_lshrrev_b32_e64 v201, 1, v198
 v_lshl_add_u32 v196, v201, 4, v196
 v_cmp_ne_u32 vcc, 0, v192
 v_mov_b32 v200, 0x40000000
 s_nop 0
 v_cndmask_b32 v199, 0, v200, vcc
 v_mov_b32 v200, 1
 v_mov_b32 v201, s86
 v_add_u32_e64 v202, s41, v193
 v_add_u32 v203, 0x1000, v202
 v_mov_b32 v204, 0xc0135761
 v_mov_b32 v205, 0xc0135761
 v_mov_b32 v206, 0xbdd2d3e8
 v_mov_b32 v207, 0xbdd2d3e8
 v_mov_b32 v216, 0x3f800000
 v_mov_b32 v217, 0x3f800000
 s_lshl_b32 s47, s45, 15
 s_lshl_b32 s56, s46, 11
 s_add_u32 s56, s56, s47
 s_lshl_b32 s58, s46, 10
 s_add_u32 s47, s47, s58
 s_lshl_b32 s64, s44, 12
 s_add_u32 s64, s64, 92356608
 s_add_u32 s12, s12, 0x1000
 buffer_load_dwordx4 a[32:35], v193, s[8:11], s12 offen offset:0
 buffer_load_dwordx4 a[36:39], v193, s[8:11], s12 offen offset:1024
 buffer_load_dwordx4 a[40:43], v193, s[8:11], s12 offen offset:2048
 buffer_load_dwordx4 a[44:47], v193, s[8:11], s12 offen offset:3072
 s_add_u32 s12, s12, 0x1000
 buffer_load_dwordx4 a[48:51], v193, s[8:11], s12 offen offset:0
 s_add_u32 m0, s15, 45056
 s_add_u32 s57, s14, 12288
 buffer_load_dwordx4 v193, s[36:39], s57 offen offset:0 lds
 buffer_load_dwordx4 v193, s[36:39], s57 offen offset:1024 lds
 buffer_load_dwordx4 v193, s[36:39], s57 offen offset:2048 lds
 s_waitcnt vmcnt(22)
 s_barrier
 ds_read_b128 a[192:195], v194 offset:0
 ds_read_b128 a[196:199], v194 offset:256
 ds_read_b128 a[200:203], v194 offset:32768
 ds_read_b128 a[204:207], v194 offset:33024
 ds_read_b128 a[208:211], v195 offset:0
 ds_read_b128 a[212:215], v195 offset:256
 ds_read_b128 a[216:219], v195 offset:32768
 ds_read_b128 a[220:223], v195 offset:33024
 s_waitcnt lgkmcnt(0)
 s_waitcnt vmcnt(18)
 MM v[0:3], a[0:3], a[192:195], 0
 ds_read_b128 a[224:227], v194 offset:2048
 MM v[8:11], a[0:3], a[196:199], 0
 buffer_load_dwordx4 v193, s[36:39], s57 offen offset:3072 lds
 MM v[16:19], a[0:3], a[200:203], 0
 ds_read_b128 a[228:231], v194 offset:2304
 MM v[24:27], a[0:3], a[204:207], 0
 ds_read_b128 a[232:235], v194 offset:34816
 MM v[32:35], a[0:3], a[208:211], 0
 ds_read_b128 a[236:239], v194 offset:35072
 MM v[40:43], a[0:3], a[212:215], 0
 buffer_load_dwordx4 a[52:55], v193, s[8:11], s12 offen offset:1024
 MM v[48:51], a[0:3], a[216:219], 0
 ds_read_b128 a[240:243], v195 offset:2048
 MM v[56:59], a[0:3], a[220:223], 0
 ds_read_b128 a[244:247], v195 offset:2304
 MM v[60:63], a[4:7], a[220:223], 0
 ds_read_b128 a[248:251], v195 offset:34816
 MM v[52:55], a[4:7], a[216:219], 0
 buffer_load_dwordx4 a[56:59], v193, s[8:11], s12 offen offset:2048
 MM v[44:47], a[4:7], a[212:215], 0
 ds_read_b128 a[252:255], v195 offset:35072
 MM v[36:39], a[4:7], a[208:211], 0
 MM v[28:31], a[4:7], a[204:207], 0
 MM v[20:23], a[4:7], a[200:203], 0
 buffer_load_dwordx4 a[60:63], v193, s[8:11], s12 offen offset:3072
 MM v[12:15], a[4:7], a[196:199], 0
 MM v[4:7], a[4:7], a[192:195], 0
 s_add_u32 s12, s12, 0x1000
 MM v[64:67], a[192:195], a[8:11], 0
 MM v[68:71], a[196:199], a[8:11], 0
 buffer_load_dwordx4 a[64:67], v193, s[8:11], s12 offen offset:0
 MM v[72:75], a[200:203], a[8:11], 0
 MM v[76:79], a[204:207], a[8:11], 0
 MM v[80:83], a[208:211], a[8:11], 0
 MM v[84:87], a[212:215], a[8:11], 0
 buffer_load_dwordx4 a[68:71], v193, s[8:11], s12 offen offset:1024
 MM v[88:91], a[216:219], a[8:11], 0
 MM v[92:95], a[220:223], a[8:11], 0
 MM v[124:127], a[220:223], a[12:15], 0
 MM v[120:123], a[216:219], a[12:15], 0
 buffer_load_dwordx4 a[72:75], v193, s[8:11], s12 offen offset:2048
 MM v[116:119], a[212:215], a[12:15], 0
 MM v[112:115], a[208:211], a[12:15], 0
 MM v[108:111], a[204:207], a[12:15], 0
 MM v[104:107], a[200:203], a[12:15], 0
 buffer_load_dwordx4 a[76:79], v193, s[8:11], s12 offen offset:3072
 MM v[100:103], a[196:199], a[12:15], 0
 MM v[96:99], a[192:195], a[12:15], 0
 s_waitcnt lgkmcnt(0)
 s_waitcnt vmcnt(18)
 MM v[0:3], a[16:19], a[224:227], v[0:3]
 ds_read_b128 a[192:195], v194 offset:4096
 s_add_u32 s12, s12, 0x1000
 MM v[8:11], a[16:19], a[228:231], v[8:11]
 buffer_load_dwordx4 a[80:83], v193, s[8:11], s12 offen offset:0
 MM v[16:19], a[16:19], a[232:235], v[16:19]
 ds_read_b128 a[196:199], v194 offset:4352
 MM v[24:27], a[16:19], a[236:239], v[24:27]
 ds_read_b128 a[200:203], v194 offset:36864
 s_add_u32 m0, s15, 49152
 MM v[32:35], a[16:19], a[240:243], v[32:35]
 ds_read_b128 a[204:207], v194 offset:37120
 s_add_u32 s57, s14, 16384
 MM v[40:43], a[16:19], a[244:247], v[40:43]
 buffer_load_dwordx4 v193, s[36:39], s57 offen offset:0 lds
 MM v[48:51], a[16:19], a[248:251], v[48:51]
 ds_read_b128 a[208:211], v195 offset:4096
 MM v[56:59], a[16:19], a[252:255], v[56:59]
 ds_read_b128 a[212:215], v195 offset:4352
 MM v[60:63], a[20:23], a[252:255], v[60:63]
 ds_read_b128 a[216:219], v195 offset:36864
 MM v[52:55], a[20:23], a[248:251], v[52:55]
 buffer_load_dwordx4 v193, s[36:39], s57 offen offset:1024 lds
 MM v[44:47], a[20:23], a[244:247], v[44:47]
 ds_read_b128 a[220:223], v195 offset:37120
 MM v[36:39], a[20:23], a[240:243], v[36:39]
 MM v[28:31], a[20:23], a[236:239], v[28:31]
 MM v[20:23], a[20:23], a[232:235], v[20:23]
 buffer_load_dwordx4 v193, s[36:39], s57 offen offset:2048 lds
 MM v[12:15], a[20:23], a[228:231], v[12:15]
 MM v[4:7], a[20:23], a[224:227], v[4:7]
 MM v[64:67], a[224:227], a[24:27], v[64:67]
 MM v[68:71], a[228:231], a[24:27], v[68:71]
 buffer_load_dwordx4 v193, s[36:39], s57 offen offset:3072 lds
 MM v[72:75], a[232:235], a[24:27], v[72:75]
 MM v[76:79], a[236:239], a[24:27], v[76:79]
 MM v[80:83], a[240:243], a[24:27], v[80:83]
 MM v[84:87], a[244:247], a[24:27], v[84:87]
 buffer_load_dwordx4 a[84:87], v193, s[8:11], s12 offen offset:1024
 MM v[88:91], a[248:251], a[24:27], v[88:91]
 MM v[92:95], a[252:255], a[24:27], v[92:95]
 MM v[124:127], a[252:255], a[28:31], v[124:127]
 MM v[120:123], a[248:251], a[28:31], v[120:123]
 buffer_load_dwordx4 a[88:91], v193, s[8:11], s12 offen offset:2048
 MM v[116:119], a[244:247], a[28:31], v[116:119]
 MM v[112:115], a[240:243], a[28:31], v[112:115]
 MM v[108:111], a[236:239], a[28:31], v[108:111]
 MM v[104:107], a[232:235], a[28:31], v[104:107]
 buffer_load_dwordx4 a[92:95], v193, s[8:11], s12 offen offset:3072
 MM v[100:103], a[228:231], a[28:31], v[100:103]
 MM v[96:99], a[224:227], a[28:31], v[96:99]
 s_waitcnt lgkmcnt(0)
 s_waitcnt vmcnt(20)
 MM v[0:3], a[32:35], a[192:195], v[0:3]
 ds_read_b128 a[224:227], v194 offset:6144
 s_add_u32 s12, s12, 0x1000
 MM v[8:11], a[32:35], a[196:199], v[8:11]
 buffer_load_dwordx4 a[96:99], v193, s[8:11], s12 offen offset:0
 MM v[16:19], a[32:35], a[200:203], v[16:19]
 ds_read_b128 a[228:231], v194 offset:6400
 MM v[24:27], a[32:35], a[204:207], v[24:27]
 ds_read_b128 a[232:235], v194 offset:38912
 MM v[32:35], a[32:35], a[208:211], v[32:35]
 ds_read_b128 a[236:239], v194 offset:39168
 MM v[40:43], a[32:35], a[212:215], v[40:43]
 buffer_load_dwordx4 a[100:103], v193, s[8:11], s12 offen offset:1024
 MM v[48:51], a[32:35], a[216:219], v[48:51]
 ds_read_b128 a[240:243], v195 offset:6144
 MM v[56:59], a[32:35], a[220:223], v[56:59]
 ds_read_b128 a[244:247], v195 offset:6400
 MM v[60:63], a[36:39], a[220:223], v[60:63]
 ds_read_b128 a[248:251], v195 offset:38912
 MM v[52:55], a[36:39], a[216:219], v[52:55]
 buffer_load_dwordx4 a[104:107], v193, s[8:11], s12 offen offset:2048
 MM v[44:47], a[36:39], a[212:215], v[44:47]
 ds_read_b128 a[252:255], v195 offset:39168
 MM v[36:39], a[36:39], a[208:211], v[36:39]
 MM v[28:31], a[36:39], a[204:207], v[28:31]
 MM v[20:23], a[36:39], a[200:203], v[20:23]
 buffer_load_dwordx4 a[108:111], v193, s[8:11], s12 offen offset:3072
 MM v[12:15], a[36:39], a[196:199], v[12:15]
 MM v[4:7], a[36:39], a[192:195], v[4:7]
 s_add_u32 s12, s12, 0x1000
 MM v[64:67], a[192:195], a[40:43], v[64:67]
 MM v[68:71], a[196:199], a[40:43], v[68:71]
 buffer_load_dwordx4 a[112:115], v193, s[8:11], s12 offen offset:0
 MM v[72:75], a[200:203], a[40:43], v[72:75]
 MM v[76:79], a[204:207], a[40:43], v[76:79]
 s_add_u32 m0, s15, 53248
 s_add_u32 s57, s14, 20480
 MM v[80:83], a[208:211], a[40:43], v[80:83]
 MM v[84:87], a[212:215], a[40:43], v[84:87]
 buffer_load_dwordx4 v193, s[36:39], s57 offen offset:0 lds
 MM v[88:91], a[216:219], a[40:43], v[88:91]
 MM v[92:95], a[220:223], a[40:43], v[92:95]
 MM v[124:127], a[220:223], a[44:47], v[124:127]
 MM v[120:123], a[216:219], a[44:47], v[120:123]
 buffer_load_dwordx4 v193, s[36:39], s57 offen offset:1024 lds
 MM v[116:119], a[212:215], a[44:47], v[116:119]
 MM v[112:115], a[208:211], a[44:47], v[112:115]
 MM v[108:111], a[204:207], a[44:47], v[108:111]
 MM v[104:107], a[200:203], a[44:47], v[104:107]
 buffer_load_dwordx4 v193, s[36:39], s57 offen offset:2048 lds
 MM v[100:103], a[196:199], a[44:47], v[100:103]
 MM v[96:99], a[192:195], a[44:47], v[96:99]
 s_waitcnt vmcnt(23)
 s_barrier
 s_waitcnt lgkmcnt(0)
 s_waitcnt vmcnt(20)
 MM v[0:3], a[48:51], a[224:227], v[0:3]
 buffer_load_dwordx4 v193, s[36:39], s57 offen offset:3072 lds
 MM v[8:11], a[48:51], a[228:231], v[8:11]
 ds_read_b128 a[192:195], v194 offset:8192
 MM v[16:19], a[48:51], a[232:235], v[16:19]
 ds_read_b128 a[196:199], v194 offset:8448
 MM v[24:27], a[48:51], a[236:239], v[24:27]
 ds_read_b128 a[200:203], v194 offset:40960
 MM v[32:35], a[48:51], a[240:243], v[32:35]
 buffer_load_dwordx4 a[116:119], v193, s[8:11], s12 offen offset:1024
 MM v[40:43], a[48:51], a[244:247], v[40:43]
 ds_read_b128 a[204:207], v194 offset:41216
 MM v[48:51], a[48:51], a[248:251], v[48:51]
 ds_read_b128 a[208:211], v195 offset:8192
 MM v[56:59], a[48:51], a[252:255], v[56:59]
 ds_read_b128 a[212:215], v195 offset:8448
 MM v[60:63], a[52:55], a[252:255], v[60:63]
 buffer_load_dwordx4 a[120:123], v193, s[8:11], s12 offen offset:2048
 MM v[52:55], a[52:55], a[248:251], v[52:55]
 ds_read_b128 a[216:219], v195 offset:40960
 MM v[44:47], a[52:55], a[244:247], v[44:47]
 ds_read_b128 a[220:223], v195 offset:41216
 MM v[36:39], a[52:55], a[240:243], v[36:39]
 MM v[28:31], a[52:55], a[236:239], v[28:31]
 buffer_load_dwordx4 a[124:127], v193, s[8:11], s12 offen offset:3072
 MM v[20:23], a[52:55], a[232:235], v[20:23]
 MM v[12:15], a[52:55], a[228:231], v[12:15]
 s_add_u32 s12, s12, 0x1000
 MM v[4:7], a[52:55], a[224:227], v[4:7]
 MM v[64:67], a[224:227], a[56:59], v[64:67]
 buffer_load_dwordx4 a[128:131], v193, s[8:11], s12 offen offset:0
 MM v[68:71], a[228:231], a[56:59], v[68:71]
 MM v[72:75], a[232:235], a[56:59], v[72:75]
 MM v[76:79], a[236:239], a[56:59], v[76:79]
 MM v[80:83], a[240:243], a[56:59], v[80:83]
 buffer_load_dwordx4 a[132:135], v193, s[8:11], s12 offen offset:1024
 MM v[84:87], a[244:247], a[56:59], v[84:87]
 MM v[88:91], a[248:251], a[56:59], v[88:91]
 MM v[92:95], a[252:255], a[56:59], v[92:95]
 MM v[124:127], a[252:255], a[60:63], v[124:127]
 buffer_load_dwordx4 a[136:139], v193, s[8:11], s12 offen offset:2048
 MM v[120:123], a[248:251], a[60:63], v[120:123]
 MM v[116:119], a[244:247], a[60:63], v[116:119]
 MM v[112:115], a[240:243], a[60:63], v[112:115]
 MM v[108:111], a[236:239], a[60:63], v[108:111]
 buffer_load_dwordx4 a[140:143], v193, s[8:11], s12 offen offset:3072
 MM v[104:107], a[232:235], a[60:63], v[104:107]
 MM v[100:103], a[228:231], a[60:63], v[100:103]
 s_add_u32 s12, s12, 0x1000
 MM v[96:99], a[224:227], a[60:63], v[96:99]
 s_waitcnt lgkmcnt(0)
 s_waitcnt vmcnt(24)
 MM v[0:3], a[64:67], a[192:195], v[0:3]
 buffer_load_dwordx4 a[144:147], v193, s[8:11], s12 offen offset:0
 MM v[8:11], a[64:67], a[196:199], v[8:11]
 ds_read_b128 a[224:227], v194 offset:10240
 MM v[16:19], a[64:67], a[200:203], v[16:19]
 ds_read_b128 a[228:231], v194 offset:10496
 s_add_u32 m0, s15, 57344
 MM v[24:27], a[64:67], a[204:207], v[24:27]
 ds_read_b128 a[232:235], v194 offset:43008
 s_add_u32 s57, s14, 24576
 MM v[32:35], a[64:67], a[208:211], v[32:35]
 buffer_load_dwordx4 v193, s[36:39], s57 offen offset:0 lds
 MM v[40:43], a[64:67], a[212:215], v[40:43]
 ds_read_b128 a[236:239], v194 offset:43264
 MM v[48:51], a[64:67], a[216:219], v[48:51]
 ds_read_b128 a[240:243], v195 offset:10240
 MM v[56:59], a[64:67], a[220:223], v[56:59]
 ds_read_b128 a[244:247], v195 offset:10496
 MM v[60:63], a[68:71], a[220:223], v[60:63]
 buffer_load_dwordx4 v193, s[36:39], s57 offen offset:1024 lds
 MM v[52:55], a[68:71], a[216:219], v[52:55]
 ds_read_b128 a[248:251], v195 offset:43008
 MM v[44:47], a[68:71], a[212:215], v[44:47]
 ds_read_b128 a[252:255], v195 offset:43264
 MM v[36:39], a[68:71], a[208:211], v[36:39]
 MM v[28:31], a[68:71], a[204:207], v[28:31]
 buffer_load_dwordx4 v193, s[36:39], s57 offen offset:2048 lds
 MM v[20:23], a[68:71], a[200:203], v[20:23]
 MM v[12:15], a[68:71], a[196:199], v[12:15]
 MM v[4:7], a[68:71], a[192:195], v[4:7]
 MM v[64:67], a[192:195], a[72:75], v[64:67]
 buffer_load_dwordx4 v193, s[36:39], s57 offen offset:3072 lds
 MM v[68:71], a[196:199], a[72:75], v[68:71]
 MM v[72:75], a[200:203], a[72:75], v[72:75]
 MM v[76:79], a[204:207], a[72:75], v[76:79]
 MM v[80:83], a[208:211], a[72:75], v[80:83]
 buffer_load_dwordx4 a[148:151], v193, s[8:11], s12 offen offset:1024
 MM v[84:87], a[212:215], a[72:75], v[84:87]
 MM v[88:91], a[216:219], a[72:75], v[88:91]
 MM v[92:95], a[220:223], a[72:75], v[92:95]
 MM v[124:127], a[220:223], a[76:79], v[124:127]
 buffer_load_dwordx4 a[152:155], v193, s[8:11], s12 offen offset:2048
 MM v[120:123], a[216:219], a[76:79], v[120:123]
 MM v[116:119], a[212:215], a[76:79], v[116:119]
 MM v[112:115], a[208:211], a[76:79], v[112:115]
 MM v[108:111], a[204:207], a[76:79], v[108:111]
 buffer_load_dwordx4 a[156:159], v193, s[8:11], s12 offen offset:3072
 MM v[104:107], a[200:203], a[76:79], v[104:107]
 MM v[100:103], a[196:199], a[76:79], v[100:103]
 s_add_u32 s12, s12, 0x1000
 MM v[96:99], a[192:195], a[76:79], v[96:99]
 s_waitcnt lgkmcnt(0)
 s_waitcnt vmcnt(24)
 MM v[0:3], a[80:83], a[224:227], v[0:3]
 buffer_load_dwordx4 a[160:163], v193, s[8:11], s12 offen offset:0
 MM v[8:11], a[80:83], a[228:231], v[8:11]
 ds_read_b128 a[192:195], v194 offset:12288
 MM v[16:19], a[80:83], a[232:235], v[16:19]
 ds_read_b128 a[196:199], v194 offset:12544
 MM v[24:27], a[80:83], a[236:239], v[24:27]
 ds_read_b128 a[200:203], v194 offset:45056
 MM v[32:35], a[80:83], a[240:243], v[32:35]
 buffer_load_dwordx4 a[164:167], v193, s[8:11], s12 offen offset:1024
 MM v[40:43], a[80:83], a[244:247], v[40:43]
 ds_read_b128 a[204:207], v194 offset:45312
 MM v[48:51], a[80:83], a[248:251], v[48:51]
 ds_read_b128 a[208:211], v195 offset:12288
 MM v[56:59], a[80:83], a[252:255], v[56:59]
 ds_read_b128 a[212:215], v195 offset:12544
 MM v[60:63], a[84:87], a[252:255], v[60:63]
 buffer_load_dwordx4 a[168:171], v193, s[8:11], s12 offen offset:2048
 MM v[52:55], a[84:87], a[248:251], v[52:55]
 ds_read_b128 a[216:219], v195 offset:45056
 MM v[44:47], a[84:87], a[244:247], v[44:47]
 ds_read_b128 a[220:223], v195 offset:45312
 MM v[36:39], a[84:87], a[240:243], v[36:39]
 MM v[28:31], a[84:87], a[236:239], v[28:31]
 buffer_load_dwordx4 a[172:175], v193, s[8:11], s12 offen offset:3072
 MM v[20:23], a[84:87], a[232:235], v[20:23]
 MM v[12:15], a[84:87], a[228:231], v[12:15]
 s_add_u32 s12, s12, 0x1000
 MM v[4:7], a[84:87], a[224:227], v[4:7]
 MM v[64:67], a[224:227], a[88:91], v[64:67]
 buffer_load_dwordx4 a[176:179], v193, s[8:11], s12 offen offset:0
 MM v[68:71], a[228:231], a[88:91], v[68:71]
 MM v[72:75], a[232:235], a[88:91], v[72:75]
 s_add_u32 m0, s15, 61440
 s_add_u32 s57, s14, 28672
 MM v[76:79], a[236:239], a[88:91], v[76:79]
 MM v[80:83], a[240:243], a[88:91], v[80:83]
 buffer_load_dwordx4 v193, s[36:39], s57 offen offset:0 lds
 MM v[84:87], a[244:247], a[88:91], v[84:87]
 MM v[88:91], a[248:251], a[88:91], v[88:91]
 MM v[92:95], a[252:255], a[88:91], v[92:95]
 MM v[124:127], a[252:255], a[92:95], v[124:127]
 buffer_load_dwordx4 v193, s[36:39], s57 offen offset:1024 lds
 MM v[120:123], a[248:251], a[92:95], v[120:123]
 MM v[116:119], a[244:247], a[92:95], v[116:119]
 MM v[112:115], a[240:243], a[92:95], v[112:115]
 MM v[108:111], a[236:239], a[92:95], v[108:111]
 buffer_load_dwordx4 v193, s[36:39], s57 offen offset:2048 lds
 MM v[104:107], a[232:235], a[92:95], v[104:107]
 MM v[100:103], a[228:231], a[92:95], v[100:103]
 MM v[96:99], a[224:227], a[92:95], v[96:99]
 s_waitcnt lgkmcnt(0)
 s_waitcnt vmcnt(28)
 MM v[0:3], a[96:99], a[192:195], v[0:3]
 buffer_load_dwordx4 v193, s[36:39], s57 offen offset:3072 lds
 MM v[8:11], a[96:99], a[196:199], v[8:11]
 ds_read_b128 a[224:227], v194 offset:14336
 MM v[16:19], a[96:99], a[200:203], v[16:19]
 ds_read_b128 a[228:231], v194 offset:14592
 MM v[24:27], a[96:99], a[204:207], v[24:27]
 ds_read_b128 a[232:235], v194 offset:47104
 MM v[32:35], a[96:99], a[208:211], v[32:35]
 buffer_load_dwordx4 a[180:183], v193, s[8:11], s12 offen offset:1024
 MM v[40:43], a[96:99], a[212:215], v[40:43]
 ds_read_b128 a[236:239], v194 offset:47360
 MM v[48:51], a[96:99], a[216:219], v[48:51]
 ds_read_b128 a[240:243], v195 offset:14336
 MM v[56:59], a[96:99], a[220:223], v[56:59]
 ds_read_b128 a[244:247], v195 offset:14592
 MM v[60:63], a[100:103], a[220:223], v[60:63]
 buffer_load_dwordx4 a[184:187], v193, s[8:11], s12 offen offset:2048
 MM v[52:55], a[100:103], a[216:219], v[52:55]
 ds_read_b128 a[248:251], v195 offset:47104
 MM v[44:47], a[100:103], a[212:215], v[44:47]
 ds_read_b128 a[252:255], v195 offset:47360
 MM v[36:39], a[100:103], a[208:211], v[36:39]
 MM v[28:31], a[100:103], a[204:207], v[28:31]
 buffer_load_dwordx4 a[188:191], v193, s[8:11], s12 offen offset:3072
 MM v[20:23], a[100:103], a[200:203], v[20:23]
 MM v[12:15], a[100:103], a[196:199], v[12:15]
 s_add_u32 s12, s12, 0x1000
 MM v[4:7], a[100:103], a[192:195], v[4:7]
 MM v[64:67], a[192:195], a[104:107], v[64:67]
 buffer_load_dwordx4 a[0:3], v193, s[8:11], s12 offen offset:0
 MM v[68:71], a[196:199], a[104:107], v[68:71]
 MM v[72:75], a[200:203], a[104:107], v[72:75]
 MM v[76:79], a[204:207], a[104:107], v[76:79]
 MM v[80:83], a[208:211], a[104:107], v[80:83]
 buffer_load_dwordx4 a[4:7], v193, s[8:11], s12 offen offset:1024
 MM v[84:87], a[212:215], a[104:107], v[84:87]
 MM v[88:91], a[216:219], a[104:107], v[88:91]
 MM v[92:95], a[220:223], a[104:107], v[92:95]
 MM v[124:127], a[220:223], a[108:111], v[124:127]
 buffer_load_dwordx4 a[8:11], v193, s[8:11], s12 offen offset:2048
 MM v[120:123], a[216:219], a[108:111], v[120:123]
 MM v[116:119], a[212:215], a[108:111], v[116:119]
 MM v[112:115], a[208:211], a[108:111], v[112:115]
 MM v[108:111], a[204:207], a[108:111], v[108:111]
 buffer_load_dwordx4 a[12:15], v193, s[8:11], s12 offen offset:3072
 MM v[104:107], a[200:203], a[108:111], v[104:107]
 MM v[100:103], a[196:199], a[108:111], v[100:103]
 s_add_u32 s12, s12, 0x1000
 MM v[96:99], a[192:195], a[108:111], v[96:99]
 buffer_load_dwordx4 a[16:19], v193, s[8:11], s12 offen offset:0
 s_waitcnt vmcnt(32)
 s_barrier
 s_waitcnt lgkmcnt(0)
 s_waitcnt vmcnt(29)
 MM v[0:3], a[112:115], a[224:227], v[0:3]
 ds_read_b128 a[192:195], v194 offset:16384
 MM v[8:11], a[112:115], a[228:231], v[8:11]
 ds_read_b128 a[196:199], v194 offset:16640
 MM v[16:19], a[112:115], a[232:235], v[16:19]
 ds_read_b128 a[200:203], v194 offset:49152
 MM v[24:27], a[112:115], a[236:239], v[24:27]
 buffer_load_dwordx4 a[20:23], v193, s[8:11], s12 offen offset:1024
 MM v[32:35], a[112:115], a[240:243], v[32:35]
 ds_read_b128 a[204:207], v194 offset:49408
 MM v[40:43], a[112:115], a[244:247], v[40:43]
 ds_read_b128 a[208:211], v195 offset:16384
 MM v[48:51], a[112:115], a[248:251], v[48:51]
 ds_read_b128 a[212:215], v195 offset:16640
 MM v[56:59], a[112:115], a[252:255], v[56:59]
 buffer_load_dwordx4 a[24:27], v193, s[8:11], s12 offen offset:2048
 MM v[60:63], a[116:119], a[252:255], v[60:63]
 ds_read_b128 a[216:219], v195 offset:49152
 MM v[52:55], a[116:119], a[248:251], v[52:55]
 ds_read_b128 a[220:223], v195 offset:49408
 MM v[44:47], a[116:119], a[244:247], v[44:47]
 MM v[36:39], a[116:119], a[240:243], v[36:39]
 buffer_load_dwordx4 a[28:31], v193, s[8:11], s12 offen offset:3072
 MM v[28:31], a[116:119], a[236:239], v[28:31]
 MM v[20:23], a[116:119], a[232:235], v[20:23]
 s_add_u32 s12, s12, 0x1000
 MM v[12:15], a[116:119], a[228:231], v[12:15]
 MM v[4:7], a[116:119], a[224:227], v[4:7]
 buffer_load_dwordx4 a[32:35], v193, s[8:11], s12 offen offset:0
 MM v[64:67], a[224:227], a[120:123], v[64:67]
 MM v[68:71], a[228:231], a[120:123], v[68:71]
 MM v[72:75], a[232:235], a[120:123], v[72:75]
 MM v[76:79], a[236:239], a[120:123], v[76:79]
 buffer_load_dwordx4 a[36:39], v193, s[8:11], s12 offen offset:1024
 MM v[80:83], a[240:243], a[120:123], v[80:83]
 MM v[84:87], a[244:247], a[120:123], v[84:87]
 MM v[88:91], a[248:251], a[120:123], v[88:91]
 MM v[92:95], a[252:255], a[120:123], v[92:95]
 buffer_load_dwordx4 a[40:43], v193, s[8:11], s12 offen offset:2048
 MM v[124:127], a[252:255], a[124:127], v[124:127]
 MM v[120:123], a[248:251], a[124:127], v[120:123]
 MM v[116:119], a[244:247], a[124:127], v[116:119]
 MM v[112:115], a[240:243], a[124:127], v[112:115]
 buffer_load_dwordx4 a[44:47], v193, s[8:11], s12 offen offset:3072
 MM v[108:111], a[236:239], a[124:127], v[108:111]
 MM v[104:107], a[232:235], a[124:127], v[104:107]
 s_add_u32 s12, s12, 0x1000
 MM v[100:103], a[228:231], a[124:127], v[100:103]
 MM v[96:99], a[224:227], a[124:127], v[96:99]
 s_waitcnt lgkmcnt(0)
 s_waitcnt vmcnt(32)
 MM v[0:3], a[128:131], a[192:195], v[0:3]
 buffer_load_dwordx4 a[48:51], v193, s[8:11], s12 offen offset:0
 MM v[8:11], a[128:131], a[196:199], v[8:11]
 ds_read_b128 a[224:227], v194 offset:18432
 MM v[16:19], a[128:131], a[200:203], v[16:19]
 ds_read_b128 a[228:231], v194 offset:18688
 MM v[24:27], a[128:131], a[204:207], v[24:27]
 buffer_load_dwordx4 a[52:55], v193, s[8:11], s12 offen offset:1024
 MM v[32:35], a[128:131], a[208:211], v[32:35]
 ds_read_b128 a[232:235], v194 offset:51200
 MM v[40:43], a[128:131], a[212:215], v[40:43]
 ds_read_b128 a[236:239], v194 offset:51456
 MM v[48:51], a[128:131], a[216:219], v[48:51]
 ds_read_b128 a[240:243], v195 offset:18432
 MM v[56:59], a[128:131], a[220:223], v[56:59]
 buffer_load_dwordx4 a[56:59], v193, s[8:11], s12 offen offset:2048
 MM v[60:63], a[132:135], a[220:223], v[60:63]
 ds_read_b128 a[244:247], v195 offset:18688
 MM v[52:55], a[132:135], a[216:219], v[52:55]
 ds_read_b128 a[248:251], v195 offset:51200
 MM v[44:47], a[132:135], a[212:215], v[44:47]
 ds_read_b128 a[252:255], v195 offset:51456
 MM v[36:39], a[132:135], a[208:211], v[36:39]
 buffer_load_dwordx4 a[60:63], v193, s[8:11], s12 offen offset:3072
 MM v[28:31], a[132:135], a[204:207], v[28:31]
 MM v[20:23], a[132:135], a[200:203], v[20:23]
 s_add_u32 s12, s12, 0x1000
 MM v[12:15], a[132:135], a[196:199], v[12:15]
 MM v[4:7], a[132:135], a[192:195], v[4:7]
 buffer_load_dwordx4 a[64:67], v193, s[8:11], s12 offen offset:0
 MM v[64:67], a[192:195], a[136:139], v[64:67]
 MM v[68:71], a[196:199], a[136:139], v[68:71]
 MM v[72:75], a[200:203], a[136:139], v[72:75]
 MM v[76:79], a[204:207], a[136:139], v[76:79]
 buffer_load_dwordx4 a[68:71], v193, s[8:11], s12 offen offset:1024
 MM v[80:83], a[208:211], a[136:139], v[80:83]
 MM v[84:87], a[212:215], a[136:139], v[84:87]
 MM v[88:91], a[216:219], a[136:139], v[88:91]
 MM v[92:95], a[220:223], a[136:139], v[92:95]
 buffer_load_dwordx4 a[72:75], v193, s[8:11], s12 offen offset:2048
 MM v[124:127], a[220:223], a[140:143], v[124:127]
 MM v[120:123], a[216:219], a[140:143], v[120:123]
 MM v[116:119], a[212:215], a[140:143], v[116:119]
 MM v[112:115], a[208:211], a[140:143], v[112:115]
 buffer_load_dwordx4 a[76:79], v193, s[8:11], s12 offen offset:3072
 MM v[108:111], a[204:207], a[140:143], v[108:111]
 MM v[104:107], a[200:203], a[140:143], v[104:107]
 s_add_u32 s12, s12, 0x1000
 MM v[100:103], a[196:199], a[140:143], v[100:103]
 MM v[96:99], a[192:195], a[140:143], v[96:99]
 s_waitcnt lgkmcnt(0)
 s_waitcnt vmcnt(32)
 MM v[0:3], a[144:147], a[224:227], v[0:3]
 buffer_load_dwordx4 a[80:83], v193, s[8:11], s12 offen offset:0
 MM v[8:11], a[144:147], a[228:231], v[8:11]
 ds_read_b128 a[192:195], v194 offset:20480
 MM v[16:19], a[144:147], a[232:235], v[16:19]
 ds_read_b128 a[196:199], v194 offset:20736
 MM v[24:27], a[144:147], a[236:239], v[24:27]
 buffer_load_dwordx4 a[84:87], v193, s[8:11], s12 offen offset:1024
 MM v[32:35], a[144:147], a[240:243], v[32:35]
 ds_read_b128 a[200:203], v194 offset:53248
 MM v[40:43], a[144:147], a[244:247], v[40:43]
 ds_read_b128 a[204:207], v194 offset:53504
 MM v[48:51], a[144:147], a[248:251], v[48:51]
 ds_read_b128 a[208:211], v195 offset:20480
 MM v[56:59], a[144:147], a[252:255], v[56:59]
 buffer_load_dwordx4 a[88:91], v193, s[8:11], s12 offen offset:2048
 MM v[60:63], a[148:151], a[252:255], v[60:63]
 ds_read_b128 a[212:215], v195 offset:20736
 MM v[52:55], a[148:151], a[248:251], v[52:55]
 ds_read_b128 a[216:219], v195 offset:53248
 MM v[44:47], a[148:151], a[244:247], v[44:47]
 ds_read_b128 a[220:223], v195 offset:53504
 MM v[36:39], a[148:151], a[240:243], v[36:39]
 buffer_load_dwordx4 a[92:95], v193, s[8:11], s12 offen offset:3072
 MM v[28:31], a[148:151], a[236:239], v[28:31]
 MM v[20:23], a[148:151], a[232:235], v[20:23]
 s_add_u32 s12, s12, 0x1000
 MM v[12:15], a[148:151], a[228:231], v[12:15]
 MM v[4:7], a[148:151], a[224:227], v[4:7]
 buffer_load_dwordx4 a[96:99], v193, s[8:11], s12 offen offset:0
 MM v[64:67], a[224:227], a[152:155], v[64:67]
 MM v[68:71], a[228:231], a[152:155], v[68:71]
 MM v[72:75], a[232:235], a[152:155], v[72:75]
 MM v[76:79], a[236:239], a[152:155], v[76:79]
 buffer_load_dwordx4 a[100:103], v193, s[8:11], s12 offen offset:1024
 MM v[80:83], a[240:243], a[152:155], v[80:83]
 MM v[84:87], a[244:247], a[152:155], v[84:87]
 MM v[88:91], a[248:251], a[152:155], v[88:91]
 MM v[92:95], a[252:255], a[152:155], v[92:95]
 buffer_load_dwordx4 a[104:107], v193, s[8:11], s12 offen offset:2048
 MM v[124:127], a[252:255], a[156:159], v[124:127]
 MM v[120:123], a[248:251], a[156:159], v[120:123]
 MM v[116:119], a[244:247], a[156:159], v[116:119]
 MM v[112:115], a[240:243], a[156:159], v[112:115]
 buffer_load_dwordx4 a[108:111], v193, s[8:11], s12 offen offset:3072
 MM v[108:111], a[236:239], a[156:159], v[108:111]
 MM v[104:107], a[232:235], a[156:159], v[104:107]
 s_add_u32 s12, s12, 0x1000
 MM v[100:103], a[228:231], a[156:159], v[100:103]
 MM v[96:99], a[224:227], a[156:159], v[96:99]
 s_waitcnt lgkmcnt(0)
 s_waitcnt vmcnt(36)
 MM v[0:3], a[160:163], a[192:195], v[0:3]
 buffer_load_dwordx4 a[112:115], v193, s[8:11], s12 offen offset:0
 MM v[8:11], a[160:163], a[196:199], v[8:11]
 ds_read_b128 a[224:227], v194 offset:22528
 MM v[16:19], a[160:163], a[200:203], v[16:19]
 ds_read_b128 a[228:231], v194 offset:22784
 MM v[24:27], a[160:163], a[204:207], v[24:27]
 buffer_load_dwordx4 a[116:119], v193, s[8:11], s12 offen offset:1024
 MM v[32:35], a[160:163], a[208:211], v[32:35]
 ds_read_b128 a[232:235], v194 offset:55296
 MM v[40:43], a[160:163], a[212:215], v[40:43]
 ds_read_b128 a[236:239], v194 offset:55552
 MM v[48:51], a[160:163], a[216:219], v[48:51]
 ds_read_b128 a[240:243], v195 offset:22528
 MM v[56:59], a[160:163], a[220:223], v[56:59]
 buffer_load_dwordx4 a[120:123], v193, s[8:11], s12 offen offset:2048
 MM v[60:63], a[164:167], a[220:223], v[60:63]
 ds_read_b128 a[244:247], v195 offset:22784
 MM v[52:55], a[164:167], a[216:219], v[52:55]
 ds_read_b128 a[248:251], v195 offset:55296
 MM v[44:47], a[164:167], a[212:215], v[44:47]
 ds_read_b128 a[252:255], v195 offset:55552
 MM v[36:39], a[164:167], a[208:211], v[36:39]
 buffer_load_dwordx4 a[124:127], v193, s[8:11], s12 offen offset:3072
 MM v[28:31], a[164:167], a[204:207], v[28:31]
 MM v[20:23], a[164:167], a[200:203], v[20:23]
 s_add_u32 s12, s12, 0x1000
 MM v[12:15], a[164:167], a[196:199], v[12:15]
 MM v[4:7], a[164:167], a[192:195], v[4:7]
 buffer_load_dwordx4 a[128:131], v193, s[8:11], s12 offen offset:0
 MM v[64:67], a[192:195], a[168:171], v[64:67]
 MM v[68:71], a[196:199], a[168:171], v[68:71]
 MM v[72:75], a[200:203], a[168:171], v[72:75]
 MM v[76:79], a[204:207], a[168:171], v[76:79]
 buffer_load_dwordx4 a[132:135], v193, s[8:11], s12 offen offset:1024
 MM v[80:83], a[208:211], a[168:171], v[80:83]
 MM v[84:87], a[212:215], a[168:171], v[84:87]
 MM v[88:91], a[216:219], a[168:171], v[88:91]
 MM v[92:95], a[220:223], a[168:171], v[92:95]
 buffer_load_dwordx4 a[136:139], v193, s[8:11], s12 offen offset:2048
 MM v[124:127], a[220:223], a[172:175], v[124:127]
 MM v[120:123], a[216:219], a[172:175], v[120:123]
 MM v[116:119], a[212:215], a[172:175], v[116:119]
 MM v[112:115], a[208:211], a[172:175], v[112:115]
 buffer_load_dwordx4 a[140:143], v193, s[8:11], s12 offen offset:3072
 MM v[108:111], a[204:207], a[172:175], v[108:111]
 MM v[104:107], a[200:203], a[172:175], v[104:107]
 s_add_u32 s12, s12, 0x1000
 MM v[100:103], a[196:199], a[172:175], v[100:103]
 MM v[96:99], a[192:195], a[172:175], v[96:99]
 buffer_load_dwordx4 a[144:147], v193, s[8:11], s12 offen offset:0
 s_waitcnt vmcnt(40)
 s_barrier
 s_waitcnt lgkmcnt(0)
 s_waitcnt vmcnt(37)
 MM v[0:3], a[176:179], a[224:227], v[0:3]
 ds_read_b128 a[192:195], v194 offset:24576
 MM v[8:11], a[176:179], a[228:231], v[8:11]
 ds_read_b128 a[196:199], v194 offset:24832
 MM v[16:19], a[176:179], a[232:235], v[16:19]
 buffer_load_dwordx4 a[148:151], v193, s[8:11], s12 offen offset:1024
 MM v[24:27], a[176:179], a[236:239], v[24:27]
 ds_read_b128 a[200:203], v194 offset:57344
 MM v[32:35], a[176:179], a[240:243], v[32:35]
 ds_read_b128 a[204:207], v194 offset:57600
 MM v[40:43], a[176:179], a[244:247], v[40:43]
 ds_read_b128 a[208:211], v195 offset:24576
 MM v[48:51], a[176:179], a[248:251], v[48:51]
 buffer_load_dwordx4 a[152:155], v193, s[8:11], s12 offen offset:2048
 MM v[56:59], a[176:179], a[252:255], v[56:59]
 ds_read_b128 a[212:215], v195 offset:24832
 MM v[60:63], a[180:183], a[252:255], v[60:63]
 ds_read_b128 a[216:219], v195 offset:57344
 MM v[52:55], a[180:183], a[248:251], v[52:55]
 ds_read_b128 a[220:223], v195 offset:57600
 MM v[44:47], a[180:183], a[244:247], v[44:47]
 buffer_load_dwordx4 a[156:159], v193, s[8:11], s12 offen offset:3072
 MM v[36:39], a[180:183], a[240:243], v[36:39]
 MM v[28:31], a[180:183], a[236:239], v[28:31]
 s_add_u32 s12, s12, 0x1000
 MM v[20:23], a[180:183], a[232:235], v[20:23]
 MM v[12:15], a[180:183], a[228:231], v[12:15]
 buffer_load_dwordx4 a[160:163], v193, s[8:11], s12 offen offset:0
 MM v[4:7], a[180:183], a[224:227], v[4:7]
 MM v[64:67], a[224:227], a[184:187], v[64:67]
 MM v[68:71], a[228:231], a[184:187], v[68:71]
 MM v[72:75], a[232:235], a[184:187], v[72:75]
 buffer_load_dwordx4 a[164:167], v193, s[8:11], s12 offen offset:1024
 MM v[76:79], a[236:239], a[184:187], v[76:79]
 MM v[80:83], a[240:243], a[184:187], v[80:83]
 MM v[84:87], a[244:247], a[184:187], v[84:87]
 MM v[88:91], a[248:251], a[184:187], v[88:91]
 buffer_load_dwordx4 a[168:171], v193, s[8:11], s12 offen offset:2048
 MM v[92:95], a[252:255], a[184:187], v[92:95]
 MM v[124:127], a[252:255], a[188:191], v[124:127]
 MM v[120:123], a[248:251], a[188:191], v[120:123]
 MM v[116:119], a[244:247], a[188:191], v[116:119]
 buffer_load_dwordx4 a[172:175], v193, s[8:11], s12 offen offset:3072
 MM v[112:115], a[240:243], a[188:191], v[112:115]
 MM v[108:111], a[236:239], a[188:191], v[108:111]
 s_add_u32 s12, s12, 0x1000
 MM v[104:107], a[232:235], a[188:191], v[104:107]
 MM v[100:103], a[228:231], a[188:191], v[100:103]
 buffer_load_dwordx4 a[176:179], v193, s[8:11], s12 offen offset:0
 MM v[96:99], a[224:227], a[188:191], v[96:99]
 s_waitcnt lgkmcnt(0)
 s_waitcnt vmcnt(41)
 MM v[0:3], a[0:3], a[192:195], v[0:3]
 ds_read_b128 a[224:227], v194 offset:26624
 MM v[8:11], a[0:3], a[196:199], v[8:11]
 ds_read_b128 a[228:231], v194 offset:26880
 MM v[16:19], a[0:3], a[200:203], v[16:19]
 buffer_load_dwordx4 a[180:183], v193, s[8:11], s12 offen offset:1024
 MM v[24:27], a[0:3], a[204:207], v[24:27]
 ds_read_b128 a[232:235], v194 offset:59392
 MM v[32:35], a[0:3], a[208:211], v[32:35]
 ds_read_b128 a[236:239], v194 offset:59648
 MM v[40:43], a[0:3], a[212:215], v[40:43]
 ds_read_b128 a[240:243], v195 offset:26624
 MM v[48:51], a[0:3], a[216:219], v[48:51]
 buffer_load_dwordx4 a[184:187], v193, s[8:11], s12 offen offset:2048
 MM v[56:59], a[0:3], a[220:223], v[56:59]
 ds_read_b128 a[244:247], v195 offset:26880
 MM v[60:63], a[4:7], a[220:223], v[60:63]
 ds_read_b128 a[248:251], v195 offset:59392
 MM v[52:55], a[4:7], a[216:219], v[52:55]
 ds_read_b128 a[252:255], v195 offset:59648
 MM v[44:47], a[4:7], a[212:215], v[44:47]
 buffer_load_dwordx4 a[188:191], v193, s[8:11], s12 offen offset:3072
 MM v[36:39], a[4:7], a[208:211], v[36:39]
 MM v[28:31], a[4:7], a[204:207], v[28:31]
 MM v[20:23], a[4:7], a[200:203], v[20:23]
 MM v[12:15], a[4:7], a[196:199], v[12:15]
 MM v[4:7], a[4:7], a[192:195], v[4:7]
 MM v[64:67], a[192:195], a[8:11], v[64:67]
 MM v[68:71], a[196:199], a[8:11], v[68:71]
 MM v[72:75], a[200:203], a[8:11], v[72:75]
 MM v[76:79], a[204:207], a[8:11], v[76:79]
 MM v[80:83], a[208:211], a[8:11], v[80:83]
 MM v[84:87], a[212:215], a[8:11], v[84:87]
 MM v[88:91], a[216:219], a[8:11], v[88:91]
 MM v[92:95], a[220:223], a[8:11], v[92:95]
 MM v[124:127], a[220:223], a[12:15], v[124:127]
 MM v[120:123], a[216:219], a[12:15], v[120:123]
 MM v[116:119], a[212:215], a[12:15], v[116:119]
 MM v[112:115], a[208:211], a[12:15], v[112:115]
 MM v[108:111], a[204:207], a[12:15], v[108:111]
 MM v[104:107], a[200:203], a[12:15], v[104:107]
 MM v[100:103], a[196:199], a[12:15], v[100:103]
 MM v[96:99], a[192:195], a[12:15], v[96:99]
 s_waitcnt lgkmcnt(0)
 s_waitcnt vmcnt(40)
 MM v[0:3], a[16:19], a[224:227], v[0:3]
 ds_read_b128 a[192:195], v194 offset:28672
 s_add_u32 m0, s41, 0
 MM v[8:11], a[16:19], a[228:231], v[8:11]
 buffer_load_dwordx4 v202, s[8:11], s42 offen offset:0 lds
 MM v[16:19], a[16:19], a[232:235], v[16:19]
 buffer_load_dwordx4 v202, s[8:11], s42 offen offset:1024 lds
 MM v[24:27], a[16:19], a[236:239], v[24:27]
 ds_read_b128 a[196:199], v194 offset:28928
 MM v[32:35], a[16:19], a[240:243], v[32:35]
 ds_read_b128 a[200:203], v194 offset:61440
 MM v[40:43], a[16:19], a[244:247], v[40:43]
 ds_read_b128 a[204:207], v194 offset:61696
 MM v[48:51], a[16:19], a[248:251], v[48:51]
 buffer_load_dwordx4 v202, s[8:11], s42 offen offset:2048 lds
 MM v[56:59], a[16:19], a[252:255], v[56:59]
 ds_read_b128 a[208:211], v195 offset:28672
 MM v[60:63], a[20:23], a[252:255], v[60:63]
 ds_read_b128 a[212:215], v195 offset:28928
 MM v[52:55], a[20:23], a[248:251], v[52:55]
 ds_read_b128 a[216:219], v195 offset:61440
 MM v[44:47], a[20:23], a[244:247], v[44:47]
 buffer_load_dwordx4 v202, s[8:11], s42 offen offset:3072 lds
 MM v[36:39], a[20:23], a[240:243], v[36:39]
 ds_read_b128 a[220:223], v195 offset:61696
 MM v[28:31], a[20:23], a[236:239], v[28:31]
 s_add_u32 m0, s41, 4096
 MM v[20:23], a[20:23], a[232:235], v[20:23]
 MM v[12:15], a[20:23], a[228:231], v[12:15]
 buffer_load_dwordx4 v203, s[8:11], s42 offen offset:0 lds
 MM v[4:7], a[20:23], a[224:227], v[4:7]
 MM v[64:67], a[224:227], a[24:27], v[64:67]
 MM v[68:71], a[228:231], a[24:27], v[68:71]
 MM v[72:75], a[232:235], a[24:27], v[72:75]
 buffer_load_dwordx4 v203, s[8:11], s42 offen offset:1024 lds
 MM v[76:79], a[236:239], a[24:27], v[76:79]
 MM v[80:83], a[240:243], a[24:27], v[80:83]
 MM v[84:87], a[244:247], a[24:27], v[84:87]
 MM v[88:91], a[248:251], a[24:27], v[88:91]
 buffer_load_dwordx4 v203, s[8:11], s42 offen offset:2048 lds
 MM v[92:95], a[252:255], a[24:27], v[92:95]
 MM v[124:127], a[252:255], a[28:31], v[124:127]
 MM v[120:123], a[248:251], a[28:31], v[120:123]
 MM v[116:119], a[244:247], a[28:31], v[116:119]
 buffer_load_dwordx4 v203, s[8:11], s42 offen offset:3072 lds
 MM v[112:115], a[240:243], a[28:31], v[112:115]
 MM v[108:111], a[236:239], a[28:31], v[108:111]
 MM v[104:107], a[232:235], a[28:31], v[104:107]
 MM v[100:103], a[228:231], a[28:31], v[100:103]
 MM v[96:99], a[224:227], a[28:31], v[96:99]
 s_waitcnt lgkmcnt(0)
 s_waitcnt vmcnt(44)
 MM v[0:3], a[32:35], a[192:195], v[0:3]
 ds_read_b128 a[224:227], v194 offset:30720
 MM v[8:11], a[32:35], a[196:199], v[8:11]
 ds_read_b128 a[228:231], v194 offset:30976
 MM v[16:19], a[32:35], a[200:203], v[16:19]
 ds_read_b128 a[232:235], v194 offset:63488
 MM v[24:27], a[32:35], a[204:207], v[24:27]
 ds_read_b128 a[236:239], v194 offset:63744
 MM v[32:35], a[32:35], a[208:211], v[32:35]
 ds_read_b128 a[240:243], v195 offset:30720
 MM v[40:43], a[32:35], a[212:215], v[40:43]
 ds_read_b128 a[244:247], v195 offset:30976
 MM v[48:51], a[32:35], a[216:219], v[48:51]
 ds_read_b128 a[248:251], v195 offset:63488
 MM v[56:59], a[32:35], a[220:223], v[56:59]
 ds_read_b128 a[252:255], v195 offset:63744
 MM v[60:63], a[36:39], a[220:223], v[60:63]
 MM v[52:55], a[36:39], a[216:219], v[52:55]
 MM v[44:47], a[36:39], a[212:215], v[44:47]
 MM v[36:39], a[36:39], a[208:211], v[36:39]
 MM v[28:31], a[36:39], a[204:207], v[28:31]
 MM v[20:23], a[36:39], a[200:203], v[20:23]
 MM v[12:15], a[36:39], a[196:199], v[12:15]
 MM v[4:7], a[36:39], a[192:195], v[4:7]
 MM v[64:67], a[192:195], a[40:43], v[64:67]
 MM v[68:71], a[196:199], a[40:43], v[68:71]
 MM v[72:75], a[200:203], a[40:43], v[72:75]
 MM v[76:79], a[204:207], a[40:43], v[76:79]
 MM v[80:83], a[208:211], a[40:43], v[80:83]
 MM v[84:87], a[212:215], a[40:43], v[84:87]
 MM v[88:91], a[216:219], a[40:43], v[88:91]
 MM v[92:95], a[220:223], a[40:43], v[92:95]
 MM v[124:127], a[220:223], a[44:47], v[124:127]
 MM v[120:123], a[216:219], a[44:47], v[120:123]
 MM v[116:119], a[212:215], a[44:47], v[116:119]
 MM v[112:115], a[208:211], a[44:47], v[112:115]
 MM v[108:111], a[204:207], a[44:47], v[108:111]
 MM v[104:107], a[200:203], a[44:47], v[104:107]
 MM v[100:103], a[196:199], a[44:47], v[100:103]
 MM v[96:99], a[192:195], a[44:47], v[96:99]
 s_waitcnt lgkmcnt(0)
 s_waitcnt vmcnt(40)
 MM v[0:3], a[48:51], a[224:227], v[0:3]
 ds_read_b128 a[192:195], v194 offset:0
 MM v[8:11], a[48:51], a[228:231], v[8:11]
 ds_read_b128 a[196:199], v194 offset:256
 MM v[16:19], a[48:51], a[232:235], v[16:19]
 ds_read_b128 a[200:203], v194 offset:32768
 MM v[24:27], a[48:51], a[236:239], v[24:27]
 ds_read_b128 a[204:207], v194 offset:33024
 MM v[32:35], a[48:51], a[240:243], v[32:35]
 ds_read_b128 a[208:211], v195 offset:0
 MM v[40:43], a[48:51], a[244:247], v[40:43]
 ds_read_b128 a[212:215], v195 offset:256
 MM v[48:51], a[48:51], a[248:251], v[48:51]
 ds_read_b128 a[216:219], v195 offset:32768
 MM v[56:59], a[48:51], a[252:255], v[56:59]
 ds_read_b128 a[220:223], v195 offset:33024
 MM v[60:63], a[52:55], a[252:255], v[60:63]
 MM v[52:55], a[52:55], a[248:251], v[52:55]
 MM v[44:47], a[52:55], a[244:247], v[44:47]
 MM v[36:39], a[52:55], a[240:243], v[36:39]
 MM v[28:31], a[52:55], a[236:239], v[28:31]
 MM v[20:23], a[52:55], a[232:235], v[20:23]
 MM v[12:15], a[52:55], a[228:231], v[12:15]
 MM v[4:7], a[52:55], a[224:227], v[4:7]
 MM v[64:67], a[224:227], a[56:59], v[64:67]
 MM v[68:71], a[228:231], a[56:59], v[68:71]
 MM v[72:75], a[232:235], a[56:59], v[72:75]
 MM v[76:79], a[236:239], a[56:59], v[76:79]
 MM v[80:83], a[240:243], a[56:59], v[80:83]
 MM v[84:87], a[244:247], a[56:59], v[84:87]
 MM v[88:91], a[248:251], a[56:59], v[88:91]
 MM v[92:95], a[252:255], a[56:59], v[92:95]
 MM v[124:127], a[252:255], a[60:63], v[124:127]
 MM v[120:123], a[248:251], a[60:63], v[120:123]
 MM v[116:119], a[244:247], a[60:63], v[116:119]
 MM v[112:115], a[240:243], a[60:63], v[112:115]
 MM v[108:111], a[236:239], a[60:63], v[108:111]
 MM v[104:107], a[232:235], a[60:63], v[104:107]
 MM v[100:103], a[228:231], a[60:63], v[100:103]
 MM v[96:99], a[224:227], a[60:63], v[96:99]
 s_nop 0
 v_pk_mul_f32 v[208:209], v[64:65], v[64:65]
 v_pk_mul_f32 v[210:211], v[66:67], v[66:67]
 v_pk_mul_f32 v[212:213], v[68:69], v[68:69]
 v_pk_mul_f32 v[214:215], v[70:71], v[70:71]
 v_pk_fma_f32 v[208:209], v[208:209], v[206:207], v[204:205]
 v_pk_fma_f32 v[210:211], v[210:211], v[206:207], v[204:205]
 v_pk_fma_f32 v[212:213], v[212:213], v[206:207], v[204:205]
 v_pk_fma_f32 v[214:215], v[214:215], v[206:207], v[204:205]
 v_pk_mul_f32 v[208:209], v[208:209], v[64:65]
 v_pk_mul_f32 v[210:211], v[210:211], v[66:67]
 v_pk_mul_f32 v[212:213], v[212:213], v[68:69]
 v_pk_mul_f32 v[214:215], v[214:215], v[70:71]
 s_waitcnt lgkmcnt(0)
 s_waitcnt vmcnt(38)
 MM v[128:131], a[192:195], a[64:67], 0
 ds_read_b128 a[224:227], v194 offset:2048
 ds_read_b128 a[228:231], v194 offset:2304
 ds_read_b128 a[232:235], v194 offset:34816
 MM v[132:135], a[196:199], a[64:67], 0
 ds_read_b128 a[236:239], v194 offset:35072
 ds_read_b128 a[240:243], v195 offset:2048
 ds_read_b128 a[244:247], v195 offset:2304
 MM v[136:139], a[200:203], a[64:67], 0
 ds_read_b128 a[248:251], v195 offset:34816
 ds_read_b128 a[252:255], v195 offset:35072
 MM v[140:143], a[204:207], a[64:67], 0
 v_exp_f32_e64 v208, v208
 MM v[144:147], a[208:211], a[64:67], 0
 v_exp_f32_e64 v209, v209
 MM v[148:151], a[212:215], a[64:67], 0
 v_exp_f32_e64 v210, v210
 MM v[152:155], a[216:219], a[64:67], 0
 v_exp_f32_e64 v211, v211
 MM v[156:159], a[220:223], a[64:67], 0
 v_exp_f32_e64 v212, v212
 MM v[188:191], a[220:223], a[68:71], 0
 v_exp_f32_e64 v213, v213
 MM v[184:187], a[216:219], a[68:71], 0
 v_exp_f32_e64 v214, v214
 MM v[180:183], a[212:215], a[68:71], 0
 v_exp_f32 v215, v215
 v_add_f32 v208, 1.0, v208
 MM v[176:179], a[208:211], a[68:71], 0
 v_add_f32 v209, 1.0, v209
 v_add_f32 v210, 1.0, v210
 v_add_f32_e64 v211, 1.0, v211
 MM v[172:175], a[204:207], a[68:71], 0
 v_add_f32 v212, 1.0, v212
 v_add_f32 v213, 1.0, v213
 v_add_f32_e64 v214, 1.0, v214
 MM v[168:171], a[200:203], a[68:71], 0
 v_add_f32 v215, 1.0, v215
 v_rcp_f32 v208, v208
 MM v[164:167], a[196:199], a[68:71], 0
 v_rcp_f32_e64 v209, v209
 MM v[160:163], a[192:195], a[68:71], 0
 s_waitcnt lgkmcnt(0)
 s_waitcnt vmcnt(36)
 MM v[128:131], a[224:227], a[72:75], v[128:131]
 ds_read_b128 a[192:195], v194 offset:4096
 ds_read_b128 a[196:199], v194 offset:4352
 ds_read_b128 a[200:203], v194 offset:36864
 MM v[132:135], a[228:231], a[72:75], v[132:135]
 ds_read_b128 a[204:207], v194 offset:37120
 ds_read_b128 a[208:211], v195 offset:4096
 ds_read_b128 a[212:215], v195 offset:4352
 MM v[136:139], a[232:235], a[72:75], v[136:139]
 ds_read_b128 a[216:219], v195 offset:36864
 ds_read_b128 a[220:223], v195 offset:37120
 MM v[140:143], a[236:239], a[72:75], v[140:143]
 v_rcp_f32_e64 v210, v210
 MM v[144:147], a[240:243], a[72:75], v[144:147]
 v_rcp_f32_e64 v211, v211
 MM v[148:151], a[244:247], a[72:75], v[148:151]
 v_rcp_f32_e64 v212, v212
 MM v[152:155], a[248:251], a[72:75], v[152:155]
 v_rcp_f32_e64 v213, v213
 MM v[156:159], a[252:255], a[72:75], v[156:159]
 v_rcp_f32_e64 v214, v214
 MM v[188:191], a[252:255], a[76:79], v[188:191]
 v_rcp_f32 v215, v215
 v_mul_f32 v64, v64, v208
 MM v[184:187], a[248:251], a[76:79], v[184:187]
 v_mul_f32 v65, v65, v209
 v_mul_f32 v66, v66, v210
 v_mul_f32_e64 v67, v67, v211
 MM v[180:183], a[244:247], a[76:79], v[180:183]
 v_mul_f32 v68, v68, v212
 v_mul_f32 v69, v69, v213
 v_mul_f32_e64 v70, v70, v214
 MM v[176:179], a[240:243], a[76:79], v[176:179]
 v_mul_f32_e64 v71, v71, v215
 CB v0, v0, v1
 CB v1, v2, v3
 MM v[172:175], a[236:239], a[76:79], v[172:175]
 CB v2, v4, v5
 CB v3, v6, v7
 s_add_u32 s59, s56, 0
 MM v[168:171], a[232:235], a[76:79], v[168:171]
 buffer_store_dwordx4 v[0:3], v193, s[48:51], s59 offen offset:0 sc1
 CB v8, v8, v9
 MM v[164:167], a[228:231], a[76:79], v[164:167]
 CB v9, v10, v11
 CB v10, v12, v13
 CB v11, v14, v15
 MM v[160:163], a[224:227], a[76:79], v[160:163]
 buffer_store_dwordx4 v[8:11], v193, s[48:51], s59 offen offset:1024 sc1
 CB v16, v16, v17
 CB v17, v18, v19
 CB v18, v20, v21
 CB v19, v22, v23
 s_add_u32 s59, s56, 32768
 buffer_store_dwordx4 v[16:19], v193, s[48:51], s59 offen offset:0 sc1
 CB v24, v24, v25
 CB v25, v26, v27
 CB v26, v28, v29
 CB v27, v30, v31
 buffer_store_dwordx4 v[24:27], v193, s[48:51], s59 offen offset:1024 sc1
 s_nop 0
 v_pk_mul_f32 v[208:209], v[72:73], v[72:73]
 v_pk_mul_f32 v[210:211], v[74:75], v[74:75]
 v_pk_mul_f32 v[212:213], v[76:77], v[76:77]
 v_pk_mul_f32 v[214:215], v[78:79], v[78:79]
 v_pk_fma_f32 v[208:209], v[208:209], v[206:207], v[204:205]
 v_pk_fma_f32 v[210:211], v[210:211], v[206:207], v[204:205]
 v_pk_fma_f32 v[212:213], v[212:213], v[206:207], v[204:205]
 v_pk_fma_f32 v[214:215], v[214:215], v[206:207], v[204:205]
 v_pk_mul_f32 v[208:209], v[208:209], v[72:73]
 v_pk_mul_f32 v[210:211], v[210:211], v[74:75]
 v_pk_mul_f32 v[212:213], v[212:213], v[76:77]
 v_pk_mul_f32 v[214:215], v[214:215], v[78:79]
 s_waitcnt lgkmcnt(0)
 s_waitcnt vmcnt(38)
 MM v[128:131], a[192:195], a[80:83], v[128:131]
 ds_read_b128 a[224:227], v194 offset:6144
 ds_read_b128 a[228:231], v194 offset:6400
 ds_read_b128 a[232:235], v194 offset:38912
 MM v[132:135], a[196:199], a[80:83], v[132:135]
 ds_read_b128 a[236:239], v194 offset:39168
 ds_read_b128 a[240:243], v195 offset:6144
 ds_read_b128 a[244:247], v195 offset:6400
 MM v[136:139], a[200:203], a[80:83], v[136:139]
 ds_read_b128 a[248:251], v195 offset:38912
 ds_read_b128 a[252:255], v195 offset:39168
 MM v[140:143], a[204:207], a[80:83], v[140:143]
 v_exp_f32_e64 v208, v208
 MM v[144:147], a[208:211], a[80:83], v[144:147]
 v_exp_f32_e64 v209, v209
 MM v[148:151], a[212:215], a[80:83], v[148:151]
 v_exp_f32_e64 v210, v210
 MM v[152:155], a[216:219], a[80:83], v[152:155]
 v_exp_f32_e64 v211, v211
 MM v[156:159], a[220:223], a[80:83], v[156:159]
 v_exp_f32_e64 v212, v212
 MM v[188:191], a[220:223], a[84:87], v[188:191]
 v_exp_f32_e64 v213, v213
 MM v[184:187], a[216:219], a[84:87], v[184:187]
 v_exp_f32_e64 v214, v214
 MM v[180:183], a[212:215], a[84:87], v[180:183]
 v_exp_f32 v215, v215
 v_add_f32 v208, 1.0, v208
 MM v[176:179], a[208:211], a[84:87], v[176:179]
 v_add_f32 v209, 1.0, v209
 v_add_f32 v210, 1.0, v210
 v_add_f32_e64 v211, 1.0, v211
 MM v[172:175], a[204:207], a[84:87], v[172:175]
 v_add_f32 v212, 1.0, v212
 v_add_f32 v213, 1.0, v213
 v_add_f32_e64 v214, 1.0, v214
 MM v[168:171], a[200:203], a[84:87], v[168:171]
 v_add_f32 v215, 1.0, v215
 v_rcp_f32 v208, v208
 MM v[164:167], a[196:199], a[84:87], v[164:167]
 v_rcp_f32_e64 v209, v209
 MM v[160:163], a[192:195], a[84:87], v[160:163]
 s_waitcnt lgkmcnt(0)
 s_waitcnt vmcnt(36)
 MM v[128:131], a[224:227], a[88:91], v[128:131]
 ds_read_b128 a[192:195], v194 offset:8192
 ds_read_b128 a[196:199], v194 offset:8448
 ds_read_b128 a[200:203], v194 offset:40960
 MM v[132:135], a[228:231], a[88:91], v[132:135]
 ds_read_b128 a[204:207], v194 offset:41216
 ds_read_b128 a[208:211], v195 offset:8192
 ds_read_b128 a[212:215], v195 offset:8448
 MM v[136:139], a[232:235], a[88:91], v[136:139]
 ds_read_b128 a[216:219], v195 offset:40960
 ds_read_b128 a[220:223], v195 offset:41216
 MM v[140:143], a[236:239], a[88:91], v[140:143]
 v_rcp_f32_e64 v210, v210
 MM v[144:147], a[240:243], a[88:91], v[144:147]
 v_rcp_f32_e64 v211, v211
 MM v[148:151], a[244:247], a[88:91], v[148:151]
 v_rcp_f32_e64 v212, v212
 MM v[152:155], a[248:251], a[88:91], v[152:155]
 v_rcp_f32_e64 v213, v213
 MM v[156:159], a[252:255], a[88:91], v[156:159]
 v_rcp_f32_e64 v214, v214
 MM v[188:191], a[252:255], a[92:95], v[188:191]
 v_rcp_f32 v215, v215
 v_mul_f32 v72, v72, v208
 MM v[184:187], a[248:251], a[92:95], v[184:187]
 v_mul_f32 v73, v73, v209
 v_mul_f32 v74, v74, v210
 v_mul_f32_e64 v75, v75, v211
 MM v[180:183], a[244:247], a[92:95], v[180:183]
 v_mul_f32 v76, v76, v212
 v_mul_f32 v77, v77, v213
 v_mul_f32_e64 v78, v78, v214
 MM v[176:179], a[240:243], a[92:95], v[176:179]
 v_mul_f32_e64 v79, v79, v215
 CB v32, v32, v33
 CB v33, v34, v35
 MM v[172:175], a[236:239], a[92:95], v[172:175]
 CB v34, v36, v37
 CB v35, v38, v39
 s_add_u32 s59, s56, 65536
 MM v[168:171], a[232:235], a[92:95], v[168:171]
 buffer_store_dwordx4 v[32:35], v193, s[48:51], s59 offen offset:0 sc1
 CB v40, v40, v41
 MM v[164:167], a[228:231], a[92:95], v[164:167]
 CB v41, v42, v43
 CB v42, v44, v45
 CB v43, v46, v47
 MM v[160:163], a[224:227], a[92:95], v[160:163]
 buffer_store_dwordx4 v[40:43], v193, s[48:51], s59 offen offset:1024 sc1
 CB v48, v48, v49
 CB v49, v50, v51
 CB v50, v52, v53
 CB v51, v54, v55
 s_add_u32 s59, s56, 98304
 buffer_store_dwordx4 v[48:51], v193, s[48:51], s59 offen offset:0 sc1
 CB v56, v56, v57
 CB v57, v58, v59
 CB v58, v60, v61
 CB v59, v62, v63
 buffer_store_dwordx4 v[56:59], v193, s[48:51], s59 offen offset:1024 sc1
 v_pk_mul_f32 v[208:209], v[80:81], v[80:81]
 v_pk_mul_f32 v[210:211], v[82:83], v[82:83]
 v_pk_mul_f32 v[212:213], v[84:85], v[84:85]
 v_pk_mul_f32 v[214:215], v[86:87], v[86:87]
 v_pk_fma_f32 v[208:209], v[208:209], v[206:207], v[204:205]
 v_pk_fma_f32 v[210:211], v[210:211], v[206:207], v[204:205]
 v_pk_fma_f32 v[212:213], v[212:213], v[206:207], v[204:205]
 v_pk_fma_f32 v[214:215], v[214:215], v[206:207], v[204:205]
 v_pk_mul_f32 v[208:209], v[208:209], v[80:81]
 v_pk_mul_f32 v[210:211], v[210:211], v[82:83]
 v_pk_mul_f32 v[212:213], v[212:213], v[84:85]
 v_pk_mul_f32 v[214:215], v[214:215], v[86:87]
 s_waitcnt lgkmcnt(0)
 s_waitcnt vmcnt(38)
 MM v[128:131], a[192:195], a[96:99], v[128:131]
 ds_read_b128 a[224:227], v194 offset:10240
 ds_read_b128 a[228:231], v194 offset:10496
 ds_read_b128 a[232:235], v194 offset:43008
 MM v[132:135], a[196:199], a[96:99], v[132:135]
 ds_read_b128 a[236:239], v194 offset:43264
 ds_read_b128 a[240:243], v195 offset:10240
 ds_read_b128 a[244:247], v195 offset:10496
 MM v[136:139], a[200:203], a[96:99], v[136:139]
 ds_read_b128 a[248:251], v195 offset:43008
 ds_read_b128 a[252:255], v195 offset:43264
 MM v[140:143], a[204:207], a[96:99], v[140:143]
 v_exp_f32_e64 v208, v208
 MM v[144:147], a[208:211], a[96:99], v[144:147]
 v_exp_f32_e64 v209, v209
 MM v[148:151], a[212:215], a[96:99], v[148:151]
 v_exp_f32_e64 v210, v210
 MM v[152:155], a[216:219], a[96:99], v[152:155]
 v_exp_f32_e64 v211, v211
 MM v[156:159], a[220:223], a[96:99], v[156:159]
 v_exp_f32_e64 v212, v212
 MM v[188:191], a[220:223], a[100:103], v[188:191]
 v_exp_f32_e64 v213, v213
 MM v[184:187], a[216:219], a[100:103], v[184:187]
 v_exp_f32_e64 v214, v214
 MM v[180:183], a[212:215], a[100:103], v[180:183]
 v_exp_f32 v215, v215
 v_add_f32 v208, 1.0, v208
 MM v[176:179], a[208:211], a[100:103], v[176:179]
 v_add_f32 v209, 1.0, v209
 v_add_f32 v210, 1.0, v210
 v_add_f32_e64 v211, 1.0, v211
 MM v[172:175], a[204:207], a[100:103], v[172:175]
 v_add_f32 v212, 1.0, v212
 v_add_f32 v213, 1.0, v213
 v_add_f32_e64 v214, 1.0, v214
 MM v[168:171], a[200:203], a[100:103], v[168:171]
 v_add_f32 v215, 1.0, v215
 v_rcp_f32 v208, v208
 MM v[164:167], a[196:199], a[100:103], v[164:167]
 v_rcp_f32_e64 v209, v209
 MM v[160:163], a[192:195], a[100:103], v[160:163]
 s_waitcnt lgkmcnt(0)
 s_waitcnt vmcnt(36)
 MM v[128:131], a[224:227], a[104:107], v[128:131]
 ds_read_b128 a[192:195], v194 offset:12288
 ds_read_b128 a[196:199], v194 offset:12544
 ds_read_b128 a[200:203], v194 offset:45056
 MM v[132:135], a[228:231], a[104:107], v[132:135]
 ds_read_b128 a[204:207], v194 offset:45312
 ds_read_b128 a[208:211], v195 offset:12288
 ds_read_b128 a[212:215], v195 offset:12544
 MM v[136:139], a[232:235], a[104:107], v[136:139]
 ds_read_b128 a[216:219], v195 offset:45056
 MM v[140:143], a[236:239], a[104:107], v[140:143]
 ds_read_b128 a[220:223], v195 offset:45312
 v_rcp_f32_e64 v210, v210
 MM v[144:147], a[240:243], a[104:107], v[144:147]
 v_rcp_f32_e64 v211, v211
 MM v[148:151], a[244:247], a[104:107], v[148:151]
 v_rcp_f32_e64 v212, v212
 MM v[152:155], a[248:251], a[104:107], v[152:155]
 v_rcp_f32_e64 v213, v213
 MM v[156:159], a[252:255], a[104:107], v[156:159]
 v_rcp_f32_e64 v214, v214
 MM v[188:191], a[252:255], a[108:111], v[188:191]
 v_rcp_f32_e64 v215, v215
 MM v[184:187], a[248:251], a[108:111], v[184:187]
 v_mul_f32 v80, v80, v208
 v_mul_f32 v81, v81, v209
 MM v[180:183], a[244:247], a[108:111], v[180:183]
 v_mul_f32 v82, v82, v210
 v_mul_f32 v83, v83, v211
 MM v[176:179], a[240:243], a[108:111], v[176:179]
 v_mul_f32 v84, v84, v212
 v_mul_f32 v85, v85, v213
 MM v[172:175], a[236:239], a[108:111], v[172:175]
 v_mul_f32 v86, v86, v214
 v_mul_f32 v87, v87, v215
 MM v[168:171], a[232:235], a[108:111], v[168:171]
 MM v[164:167], a[228:231], a[108:111], v[164:167]
 MM v[160:163], a[224:227], a[108:111], v[160:163]
 v_pk_mul_f32 v[208:209], v[88:89], v[88:89]
 v_pk_mul_f32 v[210:211], v[90:91], v[90:91]
 v_pk_mul_f32 v[212:213], v[92:93], v[92:93]
 v_pk_mul_f32 v[214:215], v[94:95], v[94:95]
 v_pk_fma_f32 v[208:209], v[208:209], v[206:207], v[204:205]
 v_pk_fma_f32 v[210:211], v[210:211], v[206:207], v[204:205]
 v_pk_fma_f32 v[212:213], v[212:213], v[206:207], v[204:205]
 v_pk_fma_f32 v[214:215], v[214:215], v[206:207], v[204:205]
 v_pk_mul_f32 v[208:209], v[208:209], v[88:89]
 v_pk_mul_f32 v[210:211], v[210:211], v[90:91]
 v_pk_mul_f32 v[212:213], v[212:213], v[92:93]
 v_pk_mul_f32 v[214:215], v[214:215], v[94:95]
 s_waitcnt lgkmcnt(0)
 s_waitcnt vmcnt(34)
 MM v[128:131], a[192:195], a[112:115], v[128:131]
 ds_read_b128 a[224:227], v194 offset:14336
 ds_read_b128 a[228:231], v194 offset:14592
 ds_read_b128 a[232:235], v194 offset:47104
 MM v[132:135], a[196:199], a[112:115], v[132:135]
 ds_read_b128 a[236:239], v194 offset:47360
 ds_read_b128 a[240:243], v195 offset:14336
 ds_read_b128 a[244:247], v195 offset:14592
 MM v[136:139], a[200:203], a[112:115], v[136:139]
 ds_read_b128 a[248:251], v195 offset:47104
 ds_read_b128 a[252:255], v195 offset:47360
 MM v[140:143], a[204:207], a[112:115], v[140:143]
 v_exp_f32_e64 v208, v208
 MM v[144:147], a[208:211], a[112:115], v[144:147]
 v_exp_f32_e64 v209, v209
 MM v[148:151], a[212:215], a[112:115], v[148:151]
 v_exp_f32_e64 v210, v210
 MM v[152:155], a[216:219], a[112:115], v[152:155]
 v_exp_f32_e64 v211, v211
 MM v[156:159], a[220:223], a[112:115], v[156:159]
 v_exp_f32_e64 v212, v212
 MM v[188:191], a[220:223], a[116:119], v[188:191]
 v_exp_f32_e64 v213, v213
 MM v[184:187], a[216:219], a[116:119], v[184:187]
 v_exp_f32_e64 v214, v214
 MM v[180:183], a[212:215], a[116:119], v[180:183]
 v_exp_f32 v215, v215
 v_add_f32 v208, 1.0, v208
 MM v[176:179], a[208:211], a[116:119], v[176:179]
 v_add_f32 v209, 1.0, v209
 v_add_f32 v210, 1.0, v210
 v_add_f32_e64 v211, 1.0, v211
 MM v[172:175], a[204:207], a[116:119], v[172:175]
 v_add_f32 v212, 1.0, v212
 v_add_f32 v213, 1.0, v213
 v_add_f32_e64 v214, 1.0, v214
 MM v[168:171], a[200:203], a[116:119], v[168:171]
 v_add_f32 v215, 1.0, v215
 v_rcp_f32 v208, v208
 MM v[164:167], a[196:199], a[116:119], v[164:167]
 v_rcp_f32_e64 v209, v209
 MM v[160:163], a[192:195], a[116:119], v[160:163]
 s_waitcnt lgkmcnt(0)
 s_waitcnt vmcnt(32)
 MM v[128:131], a[224:227], a[120:123], v[128:131]
 ds_read_b128 a[192:195], v194 offset:16384
 ds_read_b128 a[196:199], v194 offset:16640
 ds_read_b128 a[200:203], v194 offset:49152
 MM v[132:135], a[228:231], a[120:123], v[132:135]
 ds_read_b128 a[204:207], v194 offset:49408
 ds_read_b128 a[208:211], v195 offset:16384
 ds_read_b128 a[212:215], v195 offset:16640
 MM v[136:139], a[232:235], a[120:123], v[136:139]
 ds_read_b128 a[216:219], v195 offset:49152
 MM v[140:143], a[236:239], a[120:123], v[140:143]
 ds_read_b128 a[220:223], v195 offset:49408
 v_rcp_f32_e64 v210, v210
 MM v[144:147], a[240:243], a[120:123], v[144:147]
 v_rcp_f32_e64 v211, v211
 MM v[148:151], a[244:247], a[120:123], v[148:151]
 v_rcp_f32_e64 v212, v212
 MM v[152:155], a[248:251], a[120:123], v[152:155]
 v_rcp_f32_e64 v213, v213
 MM v[156:159], a[252:255], a[120:123], v[156:159]
 v_rcp_f32_e64 v214, v214
 MM v[188:191], a[252:255], a[124:127], v[188:191]
 v_rcp_f32_e64 v215, v215
 MM v[184:187], a[248:251], a[124:127], v[184:187]
 v_mul_f32 v88, v88, v208
 v_mul_f32 v89, v89, v209
 MM v[180:183], a[244:247], a[124:127], v[180:183]
 v_mul_f32 v90, v90, v210
 v_mul_f32 v91, v91, v211
 MM v[176:179], a[240:243], a[124:127], v[176:179]
 v_mul_f32 v92, v92, v212
 v_mul_f32 v93, v93, v213
 MM v[172:175], a[236:239], a[124:127], v[172:175]
 v_mul_f32 v94, v94, v214
 v_mul_f32 v95, v95, v215
 MM v[168:171], a[232:235], a[124:127], v[168:171]
 MM v[164:167], a[228:231], a[124:127], v[164:167]
 MM v[160:163], a[224:227], a[124:127], v[160:163]
 v_pk_mul_f32 v[208:209], v[96:97], v[96:97]
 v_pk_mul_f32 v[210:211], v[98:99], v[98:99]
 v_pk_mul_f32 v[212:213], v[100:101], v[100:101]
 v_pk_mul_f32 v[214:215], v[102:103], v[102:103]
 v_pk_fma_f32 v[208:209], v[208:209], v[206:207], v[204:205]
 v_pk_fma_f32 v[210:211], v[210:211], v[206:207], v[204:205]
 v_pk_fma_f32 v[212:213], v[212:213], v[206:207], v[204:205]
 v_pk_fma_f32 v[214:215], v[214:215], v[206:207], v[204:205]
 v_pk_mul_f32 v[208:209], v[208:209], v[96:97]
 v_pk_mul_f32 v[210:211], v[210:211], v[98:99]
 v_pk_mul_f32 v[212:213], v[212:213], v[100:101]
 v_pk_mul_f32 v[214:215], v[214:215], v[102:103]
 s_waitcnt lgkmcnt(0)
 s_waitcnt vmcnt(30)
 s_waitcnt vmcnt(0)
 MM v[128:131], a[192:195], a[128:131], v[128:131]
 buffer_atomic_add v200, v199, s[8:11], s86 offen sc1
 ds_read_b128 a[224:227], v194 offset:18432
 MM v[132:135], a[196:199], a[128:131], v[132:135]
 ds_read_b128 a[228:231], v194 offset:18688
 ds_read_b128 a[232:235], v194 offset:51200
 ds_read_b128 a[236:239], v194 offset:51456
 MM v[136:139], a[200:203], a[128:131], v[136:139]
 ds_read_b128 a[240:243], v195 offset:18432
 ds_read_b128 a[244:247], v195 offset:18688
 ds_read_b128 a[248:251], v195 offset:51200
 MM v[140:143], a[204:207], a[128:131], v[140:143]
 ds_read_b128 a[252:255], v195 offset:51456
 v_exp_f32 v208, v208
 MM v[144:147], a[208:211], a[128:131], v[144:147]
 v_exp_f32_e64 v209, v209
 MM v[148:151], a[212:215], a[128:131], v[148:151]
 v_exp_f32_e64 v210, v210
 MM v[152:155], a[216:219], a[128:131], v[152:155]
 v_exp_f32_e64 v211, v211
 MM v[156:159], a[220:223], a[128:131], v[156:159]
 v_exp_f32_e64 v212, v212
 MM v[188:191], a[220:223], a[132:135], v[188:191]
 v_exp_f32_e64 v213, v213
 MM v[184:187], a[216:219], a[132:135], v[184:187]
 v_exp_f32_e64 v214, v214
 MM v[180:183], a[212:215], a[132:135], v[180:183]
 v_exp_f32 v215, v215
 v_add_f32 v208, 1.0, v208
 MM v[176:179], a[208:211], a[132:135], v[176:179]
 v_add_f32 v209, 1.0, v209
 v_add_f32 v210, 1.0, v210
 v_add_f32_e64 v211, 1.0, v211
 MM v[172:175], a[204:207], a[132:135], v[172:175]
 v_add_f32 v212, 1.0, v212
 v_add_f32 v213, 1.0, v213
 v_add_f32_e64 v214, 1.0, v214
 MM v[168:171], a[200:203], a[132:135], v[168:171]
 v_add_f32 v215, 1.0, v215
 v_rcp_f32 v208, v208
 MM v[164:167], a[196:199], a[132:135], v[164:167]
 v_rcp_f32_e64 v209, v209
 MM v[160:163], a[192:195], a[132:135], v[160:163]
 s_waitcnt lgkmcnt(0)
 MM v[128:131], a[224:227], a[136:139], v[128:131]
 ds_read_b128 a[192:195], v194 offset:20480
 ds_read_b128 a[196:199], v194 offset:20736
 ds_read_b128 a[200:203], v194 offset:53248
 MM v[132:135], a[228:231], a[136:139], v[132:135]
 ds_read_b128 a[204:207], v194 offset:53504
 ds_read_b128 a[208:211], v195 offset:20480
 ds_read_b128 a[212:215], v195 offset:20736
 MM v[136:139], a[232:235], a[136:139], v[136:139]
 ds_read_b128 a[216:219], v195 offset:53248
 MM v[140:143], a[236:239], a[136:139], v[140:143]
 ds_read_b128 a[220:223], v195 offset:53504
 v_rcp_f32 v210, v210
 MM v[144:147], a[240:243], a[136:139], v[144:147]
 v_rcp_f32_e64 v211, v211
 MM v[148:151], a[244:247], a[136:139], v[148:151]
 v_rcp_f32_e64 v212, v212
 MM v[152:155], a[248:251], a[136:139], v[152:155]
 v_rcp_f32_e64 v213, v213
 MM v[156:159], a[252:255], a[136:139], v[156:159]
 v_rcp_f32_e64 v214, v214
 MM v[188:191], a[252:255], a[140:143], v[188:191]
 v_rcp_f32_e64 v215, v215
 MM v[184:187], a[248:251], a[140:143], v[184:187]
 v_mul_f32 v96, v96, v208
 v_mul_f32 v97, v97, v209
 MM v[180:183], a[244:247], a[140:143], v[180:183]
 v_mul_f32 v98, v98, v210
 v_mul_f32 v99, v99, v211
 MM v[176:179], a[240:243], a[140:143], v[176:179]
 v_mul_f32 v100, v100, v212
 v_mul_f32 v101, v101, v213
 MM v[172:175], a[236:239], a[140:143], v[172:175]
 v_mul_f32 v102, v102, v214
 v_mul_f32 v103, v103, v215
 MM v[168:171], a[232:235], a[140:143], v[168:171]
 MM v[164:167], a[228:231], a[140:143], v[164:167]
 MM v[160:163], a[224:227], a[140:143], v[160:163]
 v_pk_mul_f32 v[208:209], v[104:105], v[104:105]
 v_pk_mul_f32 v[210:211], v[106:107], v[106:107]
 v_pk_mul_f32 v[212:213], v[108:109], v[108:109]
 v_pk_mul_f32 v[214:215], v[110:111], v[110:111]
 v_pk_fma_f32 v[208:209], v[208:209], v[206:207], v[204:205]
 v_pk_fma_f32 v[210:211], v[210:211], v[206:207], v[204:205]
 v_pk_fma_f32 v[212:213], v[212:213], v[206:207], v[204:205]
 v_pk_fma_f32 v[214:215], v[214:215], v[206:207], v[204:205]
 v_pk_mul_f32 v[208:209], v[208:209], v[104:105]
 v_pk_mul_f32 v[210:211], v[210:211], v[106:107]
 v_pk_mul_f32 v[212:213], v[212:213], v[108:109]
 v_pk_mul_f32 v[214:215], v[214:215], v[110:111]
 s_waitcnt lgkmcnt(0)
 MM v[128:131], a[192:195], a[144:147], v[128:131]
 ds_read_b128 a[224:227], v194 offset:22528
 ds_read_b128 a[228:231], v194 offset:22784
 ds_read_b128 a[232:235], v194 offset:55296
 MM v[132:135], a[196:199], a[144:147], v[132:135]
 ds_read_b128 a[236:239], v194 offset:55552
 ds_read_b128 a[240:243], v195 offset:22528
 ds_read_b128 a[244:247], v195 offset:22784
 MM v[136:139], a[200:203], a[144:147], v[136:139]
 ds_read_b128 a[248:251], v195 offset:55296
 ds_read_b128 a[252:255], v195 offset:55552
 MM v[140:143], a[204:207], a[144:147], v[140:143]
 v_exp_f32 v208, v208
 MM v[144:147], a[208:211], a[144:147], v[144:147]
 v_exp_f32_e64 v209, v209
 MM v[148:151], a[212:215], a[144:147], v[148:151]
 v_exp_f32_e64 v210, v210
 MM v[152:155], a[216:219], a[144:147], v[152:155]
 v_exp_f32_e64 v211, v211
 MM v[156:159], a[220:223], a[144:147], v[156:159]
 v_exp_f32_e64 v212, v212
 MM v[188:191], a[220:223], a[148:151], v[188:191]
 v_exp_f32_e64 v213, v213
 MM v[184:187], a[216:219], a[148:151], v[184:187]
 v_exp_f32_e64 v214, v214
 MM v[180:183], a[212:215], a[148:151], v[180:183]
 v_exp_f32 v215, v215
 v_add_f32 v208, 1.0, v208
 MM v[176:179], a[208:211], a[148:151], v[176:179]
 v_add_f32 v209, 1.0, v209
 v_add_f32 v210, 1.0, v210
 v_add_f32_e64 v211, 1.0, v211
 MM v[172:175], a[204:207], a[148:151], v[172:175]
 v_add_f32 v212, 1.0, v212
 v_add_f32 v213, 1.0, v213
 v_add_f32_e64 v214, 1.0, v214
 MM v[168:171], a[200:203], a[148:151], v[168:171]
 v_add_f32 v215, 1.0, v215
 v_rcp_f32 v208, v208
 MM v[164:167], a[196:199], a[148:151], v[164:167]
 v_rcp_f32_e64 v209, v209
 MM v[160:163], a[192:195], a[148:151], v[160:163]
 s_waitcnt lgkmcnt(0)
 MM v[128:131], a[224:227], a[152:155], v[128:131]
 global_load_dword v218, v201, s[4:5] sc1
 ds_read_b128 a[192:195], v194 offset:24576
 MM v[132:135], a[228:231], a[152:155], v[132:135]
 ds_read_b128 a[196:199], v194 offset:24832
 ds_read_b128 a[200:203], v194 offset:57344
 ds_read_b128 a[204:207], v194 offset:57600
 MM v[136:139], a[232:235], a[152:155], v[136:139]
 ds_read_b128 a[208:211], v195 offset:24576
 ds_read_b128 a[212:215], v195 offset:24832
 ds_read_b128 a[216:219], v195 offset:57344
 MM v[140:143], a[236:239], a[152:155], v[140:143]
 ds_read_b128 a[220:223], v195 offset:57600
 v_rcp_f32 v210, v210
 MM v[144:147], a[240:243], a[152:155], v[144:147]
 v_rcp_f32_e64 v211, v211
 MM v[148:151], a[244:247], a[152:155], v[148:151]
 v_rcp_f32_e64 v212, v212
 MM v[152:155], a[248:251], a[152:155], v[152:155]
 v_rcp_f32_e64 v213, v213
 MM v[156:159], a[252:255], a[152:155], v[156:159]
 v_rcp_f32_e64 v214, v214
 MM v[188:191], a[252:255], a[156:159], v[188:191]
 v_rcp_f32_e64 v215, v215
 MM v[184:187], a[248:251], a[156:159], v[184:187]
 v_mul_f32 v104, v104, v208
 v_mul_f32 v105, v105, v209
 MM v[180:183], a[244:247], a[156:159], v[180:183]
 v_mul_f32 v106, v106, v210
 v_mul_f32 v107, v107, v211
 MM v[176:179], a[240:243], a[156:159], v[176:179]
 v_mul_f32 v108, v108, v212
 v_mul_f32 v109, v109, v213
 MM v[172:175], a[236:239], a[156:159], v[172:175]
 v_mul_f32 v110, v110, v214
 v_mul_f32 v111, v111, v215
 MM v[168:171], a[232:235], a[156:159], v[168:171]
 MM v[164:167], a[228:231], a[156:159], v[164:167]
 MM v[160:163], a[224:227], a[156:159], v[160:163]
 v_pk_mul_f32 v[208:209], v[112:113], v[112:113]
 v_pk_mul_f32 v[210:211], v[114:115], v[114:115]
 v_pk_mul_f32 v[212:213], v[116:117], v[116:117]
 v_pk_mul_f32 v[214:215], v[118:119], v[118:119]
 v_pk_fma_f32 v[208:209], v[208:209], v[206:207], v[204:205]
 v_pk_fma_f32 v[210:211], v[210:211], v[206:207], v[204:205]
 v_pk_fma_f32 v[212:213], v[212:213], v[206:207], v[204:205]
 v_pk_fma_f32 v[214:215], v[214:215], v[206:207], v[204:205]
 v_pk_mul_f32 v[208:209], v[208:209], v[112:113]
 v_pk_mul_f32 v[210:211], v[210:211], v[114:115]
 v_pk_mul_f32 v[212:213], v[212:213], v[116:117]
 v_pk_mul_f32 v[214:215], v[214:215], v[118:119]
 s_waitcnt lgkmcnt(0)
 MM v[128:131], a[192:195], a[160:163], v[128:131]
 ds_read_b128 a[224:227], v194 offset:26624
 ds_read_b128 a[228:231], v194 offset:26880
 ds_read_b128 a[232:235], v194 offset:59392
 MM v[132:135], a[196:199], a[160:163], v[132:135]
 ds_read_b128 a[236:239], v194 offset:59648
 ds_read_b128 a[240:243], v195 offset:26624
 ds_read_b128 a[244:247], v195 offset:26880
 MM v[136:139], a[200:203], a[160:163], v[136:139]
 ds_read_b128 a[248:251], v195 offset:59392
 ds_read_b128 a[252:255], v195 offset:59648
 MM v[140:143], a[204:207], a[160:163], v[140:143]
 v_exp_f32 v208, v208
 MM v[144:147], a[208:211], a[160:163], v[144:147]
 v_exp_f32_e64 v209, v209
 MM v[148:151], a[212:215], a[160:163], v[148:151]
 v_exp_f32_e64 v210, v210
 MM v[152:155], a[216:219], a[160:163], v[152:155]
 v_exp_f32_e64 v211, v211
 MM v[156:159], a[220:223], a[160:163], v[156:159]
 v_exp_f32_e64 v212, v212
 MM v[188:191], a[220:223], a[164:167], v[188:191]
 v_exp_f32_e64 v213, v213
 MM v[184:187], a[216:219], a[164:167], v[184:187]
 v_exp_f32_e64 v214, v214
 MM v[180:183], a[212:215], a[164:167], v[180:183]
 v_exp_f32 v215, v215
 v_add_f32 v208, 1.0, v208
 MM v[176:179], a[208:211], a[164:167], v[176:179]
 v_add_f32 v209, 1.0, v209
 v_add_f32 v210, 1.0, v210
 v_add_f32_e64 v211, 1.0, v211
 MM v[172:175], a[204:207], a[164:167], v[172:175]
 v_add_f32 v212, 1.0, v212
 v_add_f32 v213, 1.0, v213
 v_add_f32_e64 v214, 1.0, v214
 MM v[168:171], a[200:203], a[164:167], v[168:171]
 v_add_f32 v215, 1.0, v215
 v_rcp_f32 v208, v208
 MM v[164:167], a[196:199], a[164:167], v[164:167]
 v_rcp_f32_e64 v209, v209
 MM v[160:163], a[192:195], a[164:167], v[160:163]
 s_waitcnt lgkmcnt(0)
 s_waitcnt vmcnt(0)
 v_cmp_gt_u32_e64 vcc, 16, v218
 s_cbranch_vccz in_kernel_pe_ok
 s_mov_b32 s34, 0
in_kernel_pe:
 global_load_dword v218, v201, s[4:5] offset:0 sc1
 s_waitcnt vmcnt(0)
 v_cmp_gt_u32_e64 vcc, 16, v218
 s_cbranch_vccz in_kernel_pe_ok
 s_sleep 1
 s_add_u32 s34, s34, 1
 s_cmp_lt_u32 s34, 0x80000
 s_cbranch_scc1 in_kernel_pe
in_kernel_pe_ok:
 s_barrier
 MM v[128:131], a[224:227], a[168:171], v[128:131]
 ds_read_b128 a[192:195], v194 offset:28672
 ds_read_b128 a[196:199], v194 offset:28928
 ds_read_b128 a[200:203], v194 offset:61440
 MM v[132:135], a[228:231], a[168:171], v[132:135]
 ds_read_b128 a[204:207], v194 offset:61696
 ds_read_b128 a[208:211], v195 offset:28672
 ds_read_b128 a[212:215], v195 offset:28928
 MM v[136:139], a[232:235], a[168:171], v[136:139]
 ds_read_b128 a[216:219], v195 offset:61440
 s_add_u32 s42, s42, 0x8000
 MM v[140:143], a[236:239], a[168:171], v[140:143]
 buffer_load_dwordx4 a[0:3], v193, s[8:11], s43 offen offset:0 sc1
 ds_read_b128 a[220:223], v195 offset:61696
 MM v[144:147], a[240:243], a[168:171], v[144:147]
 buffer_load_dwordx4 a[4:7], v193, s[8:11], s43 offen offset:1024 sc1
 MM v[148:151], a[244:247], a[168:171], v[148:151]
 v_rcp_f32_e64 v210, v210
 MM v[152:155], a[248:251], a[168:171], v[152:155]
 v_rcp_f32_e64 v211, v211
 MM v[156:159], a[252:255], a[168:171], v[156:159]
 buffer_load_dwordx4 a[8:11], v193, s[8:11], s43 offen offset:2048 sc1
 MM v[188:191], a[252:255], a[172:175], v[188:191]
 v_rcp_f32_e64 v212, v212
 MM v[184:187], a[248:251], a[172:175], v[184:187]
 v_rcp_f32_e64 v213, v213
 MM v[180:183], a[244:247], a[172:175], v[180:183]
 v_rcp_f32_e64 v214, v214
 MM v[176:179], a[240:243], a[172:175], v[176:179]
 buffer_load_dwordx4 a[12:15], v193, s[8:11], s43 offen offset:3072 sc1
 MM v[172:175], a[236:239], a[172:175], v[172:175]
 v_rcp_f32 v215, v215
 v_mul_f32 v112, v112, v208
 MM v[168:171], a[232:235], a[172:175], v[168:171]
 s_add_u32 s43, s43, 0x1000
 v_mul_f32 v113, v113, v209
 v_mul_f32 v114, v114, v210
 MM v[164:167], a[228:231], a[172:175], v[164:167]
 v_mul_f32 v115, v115, v211
 v_mul_f32 v116, v116, v212
 v_mul_f32_e64 v117, v117, v213
 MM v[160:163], a[224:227], a[172:175], v[160:163]
 v_mul_f32 v118, v118, v214
 v_mul_f32 v119, v119, v215
 buffer_load_dwordx4 a[16:19], v193, s[8:11], s43 offen offset:0 sc1
 v_pk_mul_f32 v[208:209], v[120:121], v[120:121]
 v_pk_mul_f32 v[210:211], v[122:123], v[122:123]
 v_pk_mul_f32 v[212:213], v[124:125], v[124:125]
 v_pk_mul_f32 v[214:215], v[126:127], v[126:127]
 v_pk_fma_f32 v[208:209], v[208:209], v[206:207], v[204:205]
 v_pk_fma_f32 v[210:211], v[210:211], v[206:207], v[204:205]
 v_pk_fma_f32 v[212:213], v[212:213], v[206:207], v[204:205]
 v_pk_fma_f32 v[214:215], v[214:215], v[206:207], v[204:205]
 v_pk_mul_f32 v[208:209], v[208:209], v[120:121]
 v_pk_mul_f32 v[210:211], v[210:211], v[122:123]
 v_pk_mul_f32 v[212:213], v[212:213], v[124:125]
 v_pk_mul_f32 v[214:215], v[214:215], v[126:127]
 s_waitcnt lgkmcnt(0)
 MM v[128:131], a[192:195], a[176:179], v[128:131]
 buffer_load_dwordx4 a[20:23], v193, s[8:11], s43 offen offset:1024 sc1
 ds_read_b128 a[224:227], v194 offset:30720
 MM v[132:135], a[196:199], a[176:179], v[132:135]
 ds_read_b128 a[228:231], v194 offset:30976
 ds_read_b128 a[232:235], v194 offset:63488
 ds_read_b128 a[236:239], v194 offset:63744
 MM v[136:139], a[200:203], a[176:179], v[136:139]
 buffer_load_dwordx4 a[24:27], v193, s[8:11], s43 offen offset:2048 sc1
 ds_read_b128 a[240:243], v195 offset:30720
 MM v[140:143], a[204:207], a[176:179], v[140:143]
 ds_read_b128 a[244:247], v195 offset:30976
 ds_read_b128 a[248:251], v195 offset:63488
 ds_read_b128 a[252:255], v195 offset:63744
 MM v[144:147], a[208:211], a[176:179], v[144:147]
 v_exp_f32 v208, v208
 MM v[148:151], a[212:215], a[176:179], v[148:151]
 buffer_load_dwordx4 a[28:31], v193, s[8:11], s43 offen offset:3072 sc1
 MM v[152:155], a[216:219], a[176:179], v[152:155]
 v_exp_f32_e64 v209, v209
 MM v[156:159], a[220:223], a[176:179], v[156:159]
 v_exp_f32_e64 v210, v210
 s_add_u32 s43, s43, 0x1000
 MM v[188:191], a[220:223], a[180:183], v[188:191]
 v_exp_f32_e64 v211, v211
 MM v[184:187], a[216:219], a[180:183], v[184:187]
 buffer_load_dwordx4 a[32:35], v193, s[8:11], s43 offen offset:0 sc1
 MM v[180:183], a[212:215], a[180:183], v[180:183]
 v_exp_f32_e64 v212, v212
 MM v[176:179], a[208:211], a[180:183], v[176:179]
 v_exp_f32_e64 v213, v213
 MM v[172:175], a[204:207], a[180:183], v[172:175]
 v_exp_f32_e64 v214, v214
 MM v[168:171], a[200:203], a[180:183], v[168:171]
 buffer_load_dwordx4 a[36:39], v193, s[8:11], s43 offen offset:1024 sc1
 MM v[164:167], a[196:199], a[180:183], v[164:167]
 v_exp_f32 v215, v215
 v_add_f32 v208, 1.0, v208
 MM v[160:163], a[192:195], a[180:183], v[160:163]
 s_waitcnt lgkmcnt(0)
 MM v[128:131], a[224:227], a[184:187], v[128:131]
 v_add_f32 v209, 1.0, v209
 v_add_f32 v210, 1.0, v210
 v_add_f32 v211, 1.0, v211
 MM v[132:135], a[228:231], a[184:187], v[132:135]
 buffer_load_dwordx4 a[40:43], v193, s[8:11], s43 offen offset:2048 sc1
 v_add_f32_e64 v212, 1.0, v212
 MM v[136:139], a[232:235], a[184:187], v[136:139]
 v_add_f32 v213, 1.0, v213
 v_add_f32 v214, 1.0, v214
 v_add_f32_e64 v215, 1.0, v215
 MM v[140:143], a[236:239], a[184:187], v[140:143]
 v_rcp_f32_e64 v208, v208
 MM v[144:147], a[240:243], a[184:187], v[144:147]
 buffer_load_dwordx4 a[44:47], v193, s[8:11], s43 offen offset:3072 sc1
 MM v[148:151], a[244:247], a[184:187], v[148:151]
 v_rcp_f32_e64 v209, v209
 MM v[152:155], a[248:251], a[184:187], v[152:155]
 s_add_u32 s43, s43, 0x1000
 v_rcp_f32_e64 v210, v210
 MM v[156:159], a[252:255], a[184:187], v[156:159]
 v_rcp_f32_e64 v211, v211
 MM v[188:191], a[252:255], a[188:191], v[188:191]
 buffer_load_dwordx4 a[48:51], v193, s[8:11], s43 offen offset:0 sc1
 MM v[184:187], a[248:251], a[188:191], v[184:187]
 v_rcp_f32_e64 v212, v212
 MM v[180:183], a[244:247], a[188:191], v[180:183]
 v_rcp_f32_e64 v213, v213
 MM v[176:179], a[240:243], a[188:191], v[176:179]
 v_rcp_f32_e64 v214, v214
 MM v[172:175], a[236:239], a[188:191], v[172:175]
 buffer_load_dwordx4 a[52:55], v193, s[8:11], s43 offen offset:1024 sc1
 MM v[168:171], a[232:235], a[188:191], v[168:171]
 v_rcp_f32 v215, v215
 v_mul_f32 v120, v120, v208
 MM v[164:167], a[228:231], a[188:191], v[164:167]
 v_mul_f32 v121, v121, v209
 v_mul_f32 v122, v122, v210
 v_mul_f32_e64 v123, v123, v211
 MM v[160:163], a[224:227], a[188:191], v[160:163]
 v_mul_f32 v124, v124, v212
 v_mul_f32 v125, v125, v213
 v_mul_f32 v126, v126, v214
 v_mul_f32 v127, v127, v215
 buffer_load_dwordx4 a[56:59], v193, s[8:11], s43 offen offset:2048 sc1
 buffer_load_dwordx4 a[60:63], v193, s[8:11], s43 offen offset:3072 sc1
 s_add_u32 s43, s43, 0x1000
 buffer_load_dwordx4 a[64:67], v193, s[8:11], s43 offen offset:0 sc1
 buffer_load_dwordx4 a[68:71], v193, s[8:11], s43 offen offset:1024 sc1
 buffer_load_dwordx4 a[72:75], v193, s[8:11], s43 offen offset:2048 sc1
 buffer_load_dwordx4 a[76:79], v193, s[8:11], s43 offen offset:3072 sc1
 s_add_u32 s43, s43, 0x1000
 buffer_load_dwordx4 a[80:83], v193, s[8:11], s43 offen offset:0 sc1
 v_pk_add_f32 v[0:1], v[64:65], v[96:97]
 v_pk_mul_f32 v[32:33], v[64:65], v[64:65]
 v_pk_fma_f32 v[32:33], v[96:97], v[96:97], v[32:33]
 v_pk_add_f32 v[2:3], v[66:67], v[98:99]
 v_pk_mul_f32 v[34:35], v[66:67], v[66:67]
 v_pk_fma_f32 v[34:35], v[98:99], v[98:99], v[34:35]
 v_pk_add_f32 v[4:5], v[68:69], v[100:101]
 v_pk_mul_f32 v[36:37], v[68:69], v[68:69]
 v_pk_fma_f32 v[36:37], v[100:101], v[100:101], v[36:37]
 v_pk_add_f32 v[6:7], v[70:71], v[102:103]
 v_pk_mul_f32 v[38:39], v[70:71], v[70:71]
 v_pk_fma_f32 v[38:39], v[102:103], v[102:103], v[38:39]
 v_pk_add_f32 v[8:9], v[72:73], v[104:105]
 v_pk_mul_f32 v[40:41], v[72:73], v[72:73]
 v_pk_fma_f32 v[40:41], v[104:105], v[104:105], v[40:41]
 v_pk_add_f32 v[10:11], v[74:75], v[106:107]
 v_pk_mul_f32 v[42:43], v[74:75], v[74:75]
 v_pk_fma_f32 v[42:43], v[106:107], v[106:107], v[42:43]
 v_pk_add_f32 v[12:13], v[76:77], v[108:109]
 v_pk_mul_f32 v[44:45], v[76:77], v[76:77]
 v_pk_fma_f32 v[44:45], v[108:109], v[108:109], v[44:45]
 v_pk_add_f32 v[14:15], v[78:79], v[110:111]
 v_pk_mul_f32 v[46:47], v[78:79], v[78:79]
 v_pk_fma_f32 v[46:47], v[110:111], v[110:111], v[46:47]
 v_pk_add_f32 v[16:17], v[80:81], v[112:113]
 v_pk_mul_f32 v[48:49], v[80:81], v[80:81]
 v_pk_fma_f32 v[48:49], v[112:113], v[112:113], v[48:49]
 v_pk_add_f32 v[18:19], v[82:83], v[114:115]
 v_pk_mul_f32 v[50:51], v[82:83], v[82:83]
 v_pk_fma_f32 v[50:51], v[114:115], v[114:115], v[50:51]
 v_pk_add_f32 v[20:21], v[84:85], v[116:117]
 v_pk_mul_f32 v[52:53], v[84:85], v[84:85]
 v_pk_fma_f32 v[52:53], v[116:117], v[116:117], v[52:53]
 v_pk_add_f32 v[22:23], v[86:87], v[118:119]
 v_pk_mul_f32 v[54:55], v[86:87], v[86:87]
 v_pk_fma_f32 v[54:55], v[118:119], v[118:119], v[54:55]
 v_pk_add_f32 v[24:25], v[88:89], v[120:121]
 v_pk_mul_f32 v[56:57], v[88:89], v[88:89]
 v_pk_fma_f32 v[56:57], v[120:121], v[120:121], v[56:57]
 v_pk_add_f32 v[26:27], v[90:91], v[122:123]
 v_pk_mul_f32 v[58:59], v[90:91], v[90:91]
 v_pk_fma_f32 v[58:59], v[122:123], v[122:123], v[58:59]
 v_pk_add_f32 v[28:29], v[92:93], v[124:125]
 v_pk_mul_f32 v[60:61], v[92:93], v[92:93]
 v_pk_fma_f32 v[60:61], v[124:125], v[124:125], v[60:61]
 v_pk_add_f32 v[30:31], v[94:95], v[126:127]
 v_pk_mul_f32 v[62:63], v[94:95], v[94:95]
 v_pk_fma_f32 v[62:63], v[126:127], v[126:127], v[62:63]
 buffer_load_dwordx4 a[84:87], v193, s[8:11], s43 offen offset:1024 sc1
 buffer_load_dwordx4 a[88:91], v193, s[8:11], s43 offen offset:2048 sc1
 buffer_load_dwordx4 a[92:95], v193, s[8:11], s43 offen offset:3072 sc1
 s_add_u32 s43, s43, 0x1000
 buffer_load_dwordx4 a[96:99], v193, s[8:11], s43 offen offset:0 sc1
 v_add_f32_dpp v224, v0, v0 row_ror:8 row_mask:0xf bank_mask:0x3
 v_add_f32_dpp v225, v1, v1 row_ror:8 row_mask:0xf bank_mask:0x3
 v_add_f32_dpp v226, v2, v2 row_ror:8 row_mask:0xf bank_mask:0x3
 v_add_f32_dpp v227, v3, v3 row_ror:8 row_mask:0xf bank_mask:0x3
 v_add_f32_dpp v228, v4, v4 row_ror:8 row_mask:0xf bank_mask:0x3
 v_add_f32_dpp v229, v5, v5 row_ror:8 row_mask:0xf bank_mask:0x3
 v_add_f32_dpp v230, v6, v6 row_ror:8 row_mask:0xf bank_mask:0x3
 v_add_f32_dpp v231, v7, v7 row_ror:8 row_mask:0xf bank_mask:0x3
 v_add_f32_dpp v232, v8, v8 row_ror:8 row_mask:0xf bank_mask:0x3
 v_add_f32_dpp v233, v9, v9 row_ror:8 row_mask:0xf bank_mask:0x3
 v_add_f32_dpp v234, v10, v10 row_ror:8 row_mask:0xf bank_mask:0x3
 v_add_f32_dpp v235, v11, v11 row_ror:8 row_mask:0xf bank_mask:0x3
 v_add_f32_dpp v236, v12, v12 row_ror:8 row_mask:0xf bank_mask:0x3
 v_add_f32_dpp v237, v13, v13 row_ror:8 row_mask:0xf bank_mask:0x3
 v_add_f32_dpp v238, v14, v14 row_ror:8 row_mask:0xf bank_mask:0x3
 v_add_f32_dpp v239, v15, v15 row_ror:8 row_mask:0xf bank_mask:0x3
 v_add_f32_dpp v240, v16, v16 row_ror:8 row_mask:0xf bank_mask:0x3
 v_add_f32_dpp v241, v17, v17 row_ror:8 row_mask:0xf bank_mask:0x3
 v_add_f32_dpp v242, v18, v18 row_ror:8 row_mask:0xf bank_mask:0x3
 v_add_f32_dpp v243, v19, v19 row_ror:8 row_mask:0xf bank_mask:0x3
 v_add_f32_dpp v244, v20, v20 row_ror:8 row_mask:0xf bank_mask:0x3
 v_add_f32_dpp v245, v21, v21 row_ror:8 row_mask:0xf bank_mask:0x3
 v_add_f32_dpp v246, v22, v22 row_ror:8 row_mask:0xf bank_mask:0x3
 v_add_f32_dpp v247, v23, v23 row_ror:8 row_mask:0xf bank_mask:0x3
 v_add_f32_dpp v248, v24, v24 row_ror:8 row_mask:0xf bank_mask:0x3
 v_add_f32_dpp v249, v25, v25 row_ror:8 row_mask:0xf bank_mask:0x3
 v_add_f32_dpp v250, v26, v26 row_ror:8 row_mask:0xf bank_mask:0x3
 v_add_f32_dpp v251, v27, v27 row_ror:8 row_mask:0xf bank_mask:0x3
 v_add_f32_dpp v252, v28, v28 row_ror:8 row_mask:0xf bank_mask:0x3
 v_add_f32_dpp v253, v29, v29 row_ror:8 row_mask:0xf bank_mask:0x3
 v_add_f32_dpp v254, v30, v30 row_ror:8 row_mask:0xf bank_mask:0x3
 v_add_f32_dpp v255, v31, v31 row_ror:8 row_mask:0xf bank_mask:0x3
 v_add_f32_dpp v224, v32, v32 row_ror:8 row_mask:0xf bank_mask:0xc
 v_add_f32_dpp v225, v33, v33 row_ror:8 row_mask:0xf bank_mask:0xc
 v_add_f32_dpp v226, v34, v34 row_ror:8 row_mask:0xf bank_mask:0xc
 v_add_f32_dpp v227, v35, v35 row_ror:8 row_mask:0xf bank_mask:0xc
 v_add_f32_dpp v228, v36, v36 row_ror:8 row_mask:0xf bank_mask:0xc
 v_add_f32_dpp v229, v37, v37 row_ror:8 row_mask:0xf bank_mask:0xc
 v_add_f32_dpp v230, v38, v38 row_ror:8 row_mask:0xf bank_mask:0xc
 v_add_f32_dpp v231, v39, v39 row_ror:8 row_mask:0xf bank_mask:0xc
 v_add_f32_dpp v232, v40, v40 row_ror:8 row_mask:0xf bank_mask:0xc
 v_add_f32_dpp v233, v41, v41 row_ror:8 row_mask:0xf bank_mask:0xc
 v_add_f32_dpp v234, v42, v42 row_ror:8 row_mask:0xf bank_mask:0xc
 v_add_f32_dpp v235, v43, v43 row_ror:8 row_mask:0xf bank_mask:0xc
 v_add_f32_dpp v236, v44, v44 row_ror:8 row_mask:0xf bank_mask:0xc
 v_add_f32_dpp v237, v45, v45 row_ror:8 row_mask:0xf bank_mask:0xc
 v_add_f32_dpp v238, v46, v46 row_ror:8 row_mask:0xf bank_mask:0xc
 v_add_f32_dpp v239, v47, v47 row_ror:8 row_mask:0xf bank_mask:0xc
 v_add_f32_dpp v240, v48, v48 row_ror:8 row_mask:0xf bank_mask:0xc
 v_add_f32_dpp v241, v49, v49 row_ror:8 row_mask:0xf bank_mask:0xc
 v_add_f32_dpp v242, v50, v50 row_ror:8 row_mask:0xf bank_mask:0xc
 v_add_f32_dpp v243, v51, v51 row_ror:8 row_mask:0xf bank_mask:0xc
 v_add_f32_dpp v244, v52, v52 row_ror:8 row_mask:0xf bank_mask:0xc
 v_add_f32_dpp v245, v53, v53 row_ror:8 row_mask:0xf bank_mask:0xc
 v_add_f32_dpp v246, v54, v54 row_ror:8 row_mask:0xf bank_mask:0xc
 v_add_f32_dpp v247, v55, v55 row_ror:8 row_mask:0xf bank_mask:0xc
 v_add_f32_dpp v248, v56, v56 row_ror:8 row_mask:0xf bank_mask:0xc
 v_add_f32_dpp v249, v57, v57 row_ror:8 row_mask:0xf bank_mask:0xc
 v_add_f32_dpp v250, v58, v58 row_ror:8 row_mask:0xf bank_mask:0xc
 v_add_f32_dpp v251, v59, v59 row_ror:8 row_mask:0xf bank_mask:0xc
 v_add_f32_dpp v252, v60, v60 row_ror:8 row_mask:0xf bank_mask:0xc
 v_add_f32_dpp v253, v61, v61 row_ror:8 row_mask:0xf bank_mask:0xc
 v_add_f32_dpp v254, v62, v62 row_ror:8 row_mask:0xf bank_mask:0xc
 v_add_f32_dpp v255, v63, v63 row_ror:8 row_mask:0xf bank_mask:0xc
 buffer_load_dwordx4 a[100:103], v193, s[8:11], s43 offen offset:1024 sc1
 buffer_load_dwordx4 a[104:107], v193, s[8:11], s43 offen offset:2048 sc1
 buffer_load_dwordx4 a[108:111], v193, s[8:11], s43 offen offset:3072 sc1
 s_add_u32 s43, s43, 0x1000
 buffer_load_dwordx4 a[112:115], v193, s[8:11], s43 offen offset:0 sc1
 v_add_f32_dpp v0, v224, v224 row_half_mirror row_mask:0xf bank_mask:0x5
 v_add_f32_dpp v1, v225, v225 row_half_mirror row_mask:0xf bank_mask:0x5
 v_add_f32_dpp v2, v226, v226 row_half_mirror row_mask:0xf bank_mask:0x5
 v_add_f32_dpp v3, v227, v227 row_half_mirror row_mask:0xf bank_mask:0x5
 v_add_f32_dpp v4, v228, v228 row_half_mirror row_mask:0xf bank_mask:0x5
 v_add_f32_dpp v5, v229, v229 row_half_mirror row_mask:0xf bank_mask:0x5
 v_add_f32_dpp v6, v230, v230 row_half_mirror row_mask:0xf bank_mask:0x5
 v_add_f32_dpp v7, v231, v231 row_half_mirror row_mask:0xf bank_mask:0x5
 v_add_f32_dpp v8, v232, v232 row_half_mirror row_mask:0xf bank_mask:0x5
 v_add_f32_dpp v9, v233, v233 row_half_mirror row_mask:0xf bank_mask:0x5
 v_add_f32_dpp v10, v234, v234 row_half_mirror row_mask:0xf bank_mask:0x5
 v_add_f32_dpp v11, v235, v235 row_half_mirror row_mask:0xf bank_mask:0x5
 v_add_f32_dpp v12, v236, v236 row_half_mirror row_mask:0xf bank_mask:0x5
 v_add_f32_dpp v13, v237, v237 row_half_mirror row_mask:0xf bank_mask:0x5
 v_add_f32_dpp v14, v238, v238 row_half_mirror row_mask:0xf bank_mask:0x5
 v_add_f32_dpp v15, v239, v239 row_half_mirror row_mask:0xf bank_mask:0x5
 v_add_f32_dpp v0, v240, v240 row_half_mirror row_mask:0xf bank_mask:0xa
 v_add_f32_dpp v1, v241, v241 row_half_mirror row_mask:0xf bank_mask:0xa
 v_add_f32_dpp v2, v242, v242 row_half_mirror row_mask:0xf bank_mask:0xa
 v_add_f32_dpp v3, v243, v243 row_half_mirror row_mask:0xf bank_mask:0xa
 v_add_f32_dpp v4, v244, v244 row_half_mirror row_mask:0xf bank_mask:0xa
 v_add_f32_dpp v5, v245, v245 row_half_mirror row_mask:0xf bank_mask:0xa
 v_add_f32_dpp v6, v246, v246 row_half_mirror row_mask:0xf bank_mask:0xa
 v_add_f32_dpp v7, v247, v247 row_half_mirror row_mask:0xf bank_mask:0xa
 v_add_f32_dpp v8, v248, v248 row_half_mirror row_mask:0xf bank_mask:0xa
 v_add_f32_dpp v9, v249, v249 row_half_mirror row_mask:0xf bank_mask:0xa
 v_add_f32_dpp v10, v250, v250 row_half_mirror row_mask:0xf bank_mask:0xa
 v_add_f32_dpp v11, v251, v251 row_half_mirror row_mask:0xf bank_mask:0xa
 v_add_f32_dpp v12, v252, v252 row_half_mirror row_mask:0xf bank_mask:0xa
 v_add_f32_dpp v13, v253, v253 row_half_mirror row_mask:0xf bank_mask:0xa
 v_add_f32_dpp v14, v254, v254 row_half_mirror row_mask:0xf bank_mask:0xa
 v_add_f32_dpp v15, v255, v255 row_half_mirror row_mask:0xf bank_mask:0xa
 v_add_f32_dpp v0, v0, v0 quad_perm:[1,0,3,2] row_mask:0xf bank_mask:0xf
 v_add_f32_dpp v1, v1, v1 quad_perm:[1,0,3,2] row_mask:0xf bank_mask:0xf
 v_add_f32_dpp v2, v2, v2 quad_perm:[1,0,3,2] row_mask:0xf bank_mask:0xf
 v_add_f32_dpp v3, v3, v3 quad_perm:[1,0,3,2] row_mask:0xf bank_mask:0xf
 v_add_f32_dpp v4, v4, v4 quad_perm:[1,0,3,2] row_mask:0xf bank_mask:0xf
 v_add_f32_dpp v5, v5, v5 quad_perm:[1,0,3,2] row_mask:0xf bank_mask:0xf
 v_add_f32_dpp v6, v6, v6 quad_perm:[1,0,3,2] row_mask:0xf bank_mask:0xf
 v_add_f32_dpp v7, v7, v7 quad_perm:[1,0,3,2] row_mask:0xf bank_mask:0xf
 v_add_f32_dpp v8, v8, v8 quad_perm:[1,0,3,2] row_mask:0xf bank_mask:0xf
 v_add_f32_dpp v9, v9, v9 quad_perm:[1,0,3,2] row_mask:0xf bank_mask:0xf
 v_add_f32_dpp v10, v10, v10 quad_perm:[1,0,3,2] row_mask:0xf bank_mask:0xf
 v_add_f32_dpp v11, v11, v11 quad_perm:[1,0,3,2] row_mask:0xf bank_mask:0xf
 v_add_f32_dpp v12, v12, v12 quad_perm:[1,0,3,2] row_mask:0xf bank_mask:0xf
 v_add_f32_dpp v13, v13, v13 quad_perm:[1,0,3,2] row_mask:0xf bank_mask:0xf
 v_add_f32_dpp v14, v14, v14 quad_perm:[1,0,3,2] row_mask:0xf bank_mask:0xf
 v_add_f32_dpp v15, v15, v15 quad_perm:[1,0,3,2] row_mask:0xf bank_mask:0xf
 v_add_f32_dpp v0, v0, v0 quad_perm:[2,3,0,1] row_mask:0xf bank_mask:0xf
 v_add_f32_dpp v1, v1, v1 quad_perm:[2,3,0,1] row_mask:0xf bank_mask:0xf
 v_add_f32_dpp v2, v2, v2 quad_perm:[2,3,0,1] row_mask:0xf bank_mask:0xf
 v_add_f32_dpp v3, v3, v3 quad_perm:[2,3,0,1] row_mask:0xf bank_mask:0xf
 v_add_f32_dpp v4, v4, v4 quad_perm:[2,3,0,1] row_mask:0xf bank_mask:0xf
 v_add_f32_dpp v5, v5, v5 quad_perm:[2,3,0,1] row_mask:0xf bank_mask:0xf
 v_add_f32_dpp v6, v6, v6 quad_perm:[2,3,0,1] row_mask:0xf bank_mask:0xf
 v_add_f32_dpp v7, v7, v7 quad_perm:[2,3,0,1] row_mask:0xf bank_mask:0xf
 v_add_f32_dpp v8, v8, v8 quad_perm:[2,3,0,1] row_mask:0xf bank_mask:0xf
 v_add_f32_dpp v9, v9, v9 quad_perm:[2,3,0,1] row_mask:0xf bank_mask:0xf
 v_add_f32_dpp v10, v10, v10 quad_perm:[2,3,0,1] row_mask:0xf bank_mask:0xf
 v_add_f32_dpp v11, v11, v11 quad_perm:[2,3,0,1] row_mask:0xf bank_mask:0xf
 v_add_f32_dpp v12, v12, v12 quad_perm:[2,3,0,1] row_mask:0xf bank_mask:0xf
 v_add_f32_dpp v13, v13, v13 quad_perm:[2,3,0,1] row_mask:0xf bank_mask:0xf
 v_add_f32_dpp v14, v14, v14 quad_perm:[2,3,0,1] row_mask:0xf bank_mask:0xf
 v_add_f32_dpp v15, v15, v15 quad_perm:[2,3,0,1] row_mask:0xf bank_mask:0xf
 v_lshrrev_b32 v219, 2, v197
 v_lshlrev_b32 v219, 8, v219
 v_lshl_add_u32 v219, v198, 4, v219
 s_lshl_b32 s58, s3, 10
 s_nop 0
 s_add_u32 s58, s58, 131072
 v_add_u32_e64 v219, s58, v219
 ds_write_b128 v219, v[0:3] offset:0
 ds_write_b128 v219, v[4:7] offset:64
 ds_write_b128 v219, v[8:11] offset:128
 ds_write_b128 v219, v[12:15] offset:192
 v_lshlrev_b32 v220, 2, v192
 s_lshl_b32 s58, s3, 8
 v_add_u32_e64 v220, s58, v220
 s_waitcnt lgkmcnt(0)
 s_barrier
 v_add_u32 v219, 131072, v220
 ds_read_b32 v16, v219 offset:0
 ds_read_b32 v17, v219 offset:1024
 ds_read_b32 v18, v219 offset:2048
 ds_read_b32 v19, v219 offset:3072
 s_lshl_b32 s58, s23, 10
 s_add_u32 s58, s58, s64
 s_waitcnt lgkmcnt(0)
 v_add_f32 v16, v16, v17
 v_add_f32 v18, v18, v19
 v_add_f32 v16, v16, v18
 v_min_u32_e64 v16, -2, v16
 buffer_store_dword v16, v220, s[8:11], s58 offen sc1
 buffer_load_dwordx4 a[116:119], v193, s[8:11], s43 offen offset:1024 sc1
 buffer_load_dwordx4 a[120:123], v193, s[8:11], s43 offen offset:2048 sc1
 buffer_load_dwordx4 a[124:127], v193, s[8:11], s43 offen offset:3072 sc1
 s_add_u32 m0, s41, 32768
 s_nop 0
 s_nop 0
 buffer_load_dwordx4 v202, s[8:11], s42 offen offset:0 lds
 buffer_load_dwordx4 v202, s[8:11], s42 offen offset:1024 lds
 buffer_load_dwordx4 v202, s[8:11], s42 offen offset:2048 lds
 v_lshlrev_b32_e64 v221, 3, v192
 v_pk_mul_f32 v[208:209], v[128:129], v[128:129]
 v_pk_mul_f32 v[210:211], v[130:131], v[130:131]
 v_pk_mul_f32 v[212:213], v[132:133], v[132:133]
 v_pk_mul_f32 v[214:215], v[134:135], v[134:135]
 v_pk_fma_f32 v[208:209], v[208:209], v[206:207], v[204:205]
 v_pk_fma_f32 v[210:211], v[210:211], v[206:207], v[204:205]
 v_pk_fma_f32 v[212:213], v[212:213], v[206:207], v[204:205]
 v_pk_fma_f32 v[214:215], v[214:215], v[206:207], v[204:205]
 v_pk_mul_f32 v[208:209], v[208:209], v[128:129]
 v_pk_mul_f32 v[210:211], v[210:211], v[130:131]
 v_pk_mul_f32 v[212:213], v[212:213], v[132:133]
 v_pk_mul_f32 v[214:215], v[214:215], v[134:135]
 v_exp_f32 v208, v208
 v_exp_f32 v209, v209
 v_exp_f32 v210, v210
 v_exp_f32 v211, v211
 v_exp_f32 v212, v212
 v_exp_f32 v213, v213
 v_exp_f32 v214, v214
 v_exp_f32 v215, v215
 v_pk_add_f32 v[208:209], v[208:209], v[216:217]
 v_pk_add_f32 v[210:211], v[210:211], v[216:217]
 v_pk_add_f32 v[212:213], v[212:213], v[216:217]
 v_pk_add_f32 v[214:215], v[214:215], v[216:217]
 v_rcp_f32 v208, v208
 v_rcp_f32 v209, v209
 v_rcp_f32 v210, v210
 v_rcp_f32 v211, v211
 v_rcp_f32 v212, v212
 v_rcp_f32 v213, v213
 v_rcp_f32 v214, v214
 v_rcp_f32 v215, v215
 v_pk_mul_f32 v[128:129], v[128:129], v[208:209]
 v_pk_mul_f32 v[130:131], v[130:131], v[210:211]
 v_pk_mul_f32 v[132:133], v[132:133], v[212:213]
 v_pk_mul_f32 v[134:135], v[134:135], v[214:215]
 buffer_load_dwordx4 v202, s[8:11], s42 offen offset:3072 lds
 s_add_u32 m0, s41, 36864
 s_nop 0
 s_nop 0
 buffer_load_dwordx4 v203, s[8:11], s42 offen offset:0 lds
 buffer_load_dwordx4 v203, s[8:11], s42 offen offset:1024 lds
 buffer_load_dwordx4 v203, s[8:11], s42 offen offset:2048 lds
 v_pk_mul_f32 v[208:209], v[136:137], v[136:137]
 v_pk_mul_f32 v[210:211], v[138:139], v[138:139]
 v_pk_mul_f32 v[212:213], v[140:141], v[140:141]
 v_pk_mul_f32 v[214:215], v[142:143], v[142:143]
 v_pk_fma_f32 v[208:209], v[208:209], v[206:207], v[204:205]
 v_pk_fma_f32 v[210:211], v[210:211], v[206:207], v[204:205]
 v_pk_fma_f32 v[212:213], v[212:213], v[206:207], v[204:205]
 v_pk_fma_f32 v[214:215], v[214:215], v[206:207], v[204:205]
 v_pk_mul_f32 v[208:209], v[208:209], v[136:137]
 v_pk_mul_f32 v[210:211], v[210:211], v[138:139]
 v_pk_mul_f32 v[212:213], v[212:213], v[140:141]
 v_pk_mul_f32 v[214:215], v[214:215], v[142:143]
 v_exp_f32 v208, v208
 v_exp_f32 v209, v209
 v_exp_f32 v210, v210
 v_exp_f32 v211, v211
 v_exp_f32 v212, v212
 v_exp_f32 v213, v213
 v_exp_f32 v214, v214
 v_exp_f32 v215, v215
 v_pk_add_f32 v[208:209], v[208:209], v[216:217]
 v_pk_add_f32 v[210:211], v[210:211], v[216:217]
 v_pk_add_f32 v[212:213], v[212:213], v[216:217]
 v_pk_add_f32 v[214:215], v[214:215], v[216:217]
 v_rcp_f32 v208, v208
 v_rcp_f32 v209, v209
 v_rcp_f32 v210, v210
 v_rcp_f32 v211, v211
 v_rcp_f32 v212, v212
 v_rcp_f32 v213, v213
 v_rcp_f32 v214, v214
 v_rcp_f32 v215, v215
 v_pk_mul_f32 v[136:137], v[136:137], v[208:209]
 v_pk_mul_f32 v[138:139], v[138:139], v[210:211]
 v_pk_mul_f32 v[140:141], v[140:141], v[212:213]
 v_pk_mul_f32 v[142:143], v[142:143], v[214:215]
 buffer_load_dwordx4 v203, s[8:11], s42 offen offset:3072 lds
 s_add_u32 s42, s42, 0x8000
 s_add_u32 m0, s41, 65536
 s_nop 0
 s_nop 0
 buffer_load_dwordx4 v202, s[8:11], s42 offen offset:0 lds
 buffer_load_dwordx4 v202, s[8:11], s42 offen offset:1024 lds
 buffer_load_dwordx4 v202, s[8:11], s42 offen offset:2048 lds
 v_pk_mul_f32 v[208:209], v[144:145], v[144:145]
 v_pk_mul_f32 v[210:211], v[146:147], v[146:147]
 v_pk_mul_f32 v[212:213], v[148:149], v[148:149]
 v_pk_mul_f32 v[214:215], v[150:151], v[150:151]
 v_pk_fma_f32 v[208:209], v[208:209], v[206:207], v[204:205]
 v_pk_fma_f32 v[210:211], v[210:211], v[206:207], v[204:205]
 v_pk_fma_f32 v[212:213], v[212:213], v[206:207], v[204:205]
 v_pk_fma_f32 v[214:215], v[214:215], v[206:207], v[204:205]
 v_pk_mul_f32 v[208:209], v[208:209], v[144:145]
 v_pk_mul_f32 v[210:211], v[210:211], v[146:147]
 v_pk_mul_f32 v[212:213], v[212:213], v[148:149]
 v_pk_mul_f32 v[214:215], v[214:215], v[150:151]
 v_exp_f32 v208, v208
 v_exp_f32 v209, v209
 v_exp_f32 v210, v210
 v_exp_f32 v211, v211
 v_exp_f32 v212, v212
 v_exp_f32 v213, v213
 v_exp_f32 v214, v214
 v_exp_f32 v215, v215
 v_pk_add_f32 v[208:209], v[208:209], v[216:217]
 v_pk_add_f32 v[210:211], v[210:211], v[216:217]
 v_pk_add_f32 v[212:213], v[212:213], v[216:217]
 v_pk_add_f32 v[214:215], v[214:215], v[216:217]
 v_rcp_f32 v208, v208
 v_rcp_f32 v209, v209
 v_rcp_f32 v210, v210
 v_rcp_f32 v211, v211
 v_rcp_f32 v212, v212
 v_rcp_f32 v213, v213
 v_rcp_f32 v214, v214
 v_rcp_f32 v215, v215
 v_pk_mul_f32 v[144:145], v[144:145], v[208:209]
 v_pk_mul_f32 v[146:147], v[146:147], v[210:211]
 v_pk_mul_f32 v[148:149], v[148:149], v[212:213]
 v_pk_mul_f32 v[150:151], v[150:151], v[214:215]
 buffer_load_dwordx4 v202, s[8:11], s42 offen offset:3072 lds
 s_add_u32 m0, s41, 69632
 s_nop 0
 s_nop 0
 buffer_load_dwordx4 v203, s[8:11], s42 offen offset:0 lds
 buffer_load_dwordx4 v203, s[8:11], s42 offen offset:1024 lds
 buffer_load_dwordx4 v203, s[8:11], s42 offen offset:2048 lds
 v_pk_mul_f32 v[208:209], v[152:153], v[152:153]
 v_pk_mul_f32 v[210:211], v[154:155], v[154:155]
 v_pk_mul_f32 v[212:213], v[156:157], v[156:157]
 v_pk_mul_f32 v[214:215], v[158:159], v[158:159]
 v_pk_fma_f32 v[208:209], v[208:209], v[206:207], v[204:205]
 v_pk_fma_f32 v[210:211], v[210:211], v[206:207], v[204:205]
 v_pk_fma_f32 v[212:213], v[212:213], v[206:207], v[204:205]
 v_pk_fma_f32 v[214:215], v[214:215], v[206:207], v[204:205]
 v_pk_mul_f32 v[208:209], v[208:209], v[152:153]
 v_pk_mul_f32 v[210:211], v[210:211], v[154:155]
 v_pk_mul_f32 v[212:213], v[212:213], v[156:157]
 v_pk_mul_f32 v[214:215], v[214:215], v[158:159]
 v_exp_f32 v208, v208
 v_exp_f32 v209, v209
 v_exp_f32 v210, v210
 v_exp_f32 v211, v211
 v_exp_f32 v212, v212
 v_exp_f32 v213, v213
 v_exp_f32 v214, v214
 v_exp_f32 v215, v215
 v_pk_add_f32 v[208:209], v[208:209], v[216:217]
 v_pk_add_f32 v[210:211], v[210:211], v[216:217]
 v_pk_add_f32 v[212:213], v[212:213], v[216:217]
 v_pk_add_f32 v[214:215], v[214:215], v[216:217]
 v_rcp_f32 v208, v208
 v_rcp_f32 v209, v209
 v_rcp_f32 v210, v210
 v_rcp_f32 v211, v211
 v_rcp_f32 v212, v212
 v_rcp_f32 v213, v213
 v_rcp_f32 v214, v214
 v_rcp_f32 v215, v215
 v_pk_mul_f32 v[152:153], v[152:153], v[208:209]
 v_pk_mul_f32 v[154:155], v[154:155], v[210:211]
 v_pk_mul_f32 v[156:157], v[156:157], v[212:213]
 v_pk_mul_f32 v[158:159], v[158:159], v[214:215]
 buffer_load_dwordx4 v203, s[8:11], s42 offen offset:3072 lds
 s_add_u32 s42, s42, 0x8000
 v_pk_mul_f32 v[208:209], v[160:161], v[160:161]
 v_pk_mul_f32 v[210:211], v[162:163], v[162:163]
 v_pk_mul_f32 v[212:213], v[164:165], v[164:165]
 v_pk_mul_f32 v[214:215], v[166:167], v[166:167]
 v_pk_fma_f32 v[208:209], v[208:209], v[206:207], v[204:205]
 v_pk_fma_f32 v[210:211], v[210:211], v[206:207], v[204:205]
 v_pk_fma_f32 v[212:213], v[212:213], v[206:207], v[204:205]
 v_pk_fma_f32 v[214:215], v[214:215], v[206:207], v[204:205]
 v_pk_mul_f32 v[208:209], v[208:209], v[160:161]
 v_pk_mul_f32 v[210:211], v[210:211], v[162:163]
 v_pk_mul_f32 v[212:213], v[212:213], v[164:165]
 v_pk_mul_f32 v[214:215], v[214:215], v[166:167]
 v_exp_f32 v208, v208
 v_exp_f32 v209, v209
 v_exp_f32 v210, v210
 v_exp_f32 v211, v211
 v_exp_f32 v212, v212
 v_exp_f32 v213, v213
 v_exp_f32 v214, v214
 v_exp_f32 v215, v215
 v_pk_add_f32 v[208:209], v[208:209], v[216:217]
 v_pk_add_f32 v[210:211], v[210:211], v[216:217]
 v_pk_add_f32 v[212:213], v[212:213], v[216:217]
 v_pk_add_f32 v[214:215], v[214:215], v[216:217]
 v_rcp_f32 v208, v208
 v_rcp_f32 v209, v209
 v_rcp_f32 v210, v210
 v_rcp_f32 v211, v211
 v_rcp_f32 v212, v212
 v_rcp_f32 v213, v213
 v_rcp_f32 v214, v214
 v_rcp_f32 v215, v215
 v_pk_mul_f32 v[160:161], v[160:161], v[208:209]
 v_pk_mul_f32 v[162:163], v[162:163], v[210:211]
 v_pk_mul_f32 v[164:165], v[164:165], v[212:213]
 v_pk_mul_f32 v[166:167], v[166:167], v[214:215]
 v_pk_mul_f32 v[208:209], v[168:169], v[168:169]
 v_pk_mul_f32 v[210:211], v[170:171], v[170:171]
 v_pk_mul_f32 v[212:213], v[172:173], v[172:173]
 v_pk_mul_f32 v[214:215], v[174:175], v[174:175]
 v_pk_fma_f32 v[208:209], v[208:209], v[206:207], v[204:205]
 v_pk_fma_f32 v[210:211], v[210:211], v[206:207], v[204:205]
 v_pk_fma_f32 v[212:213], v[212:213], v[206:207], v[204:205]
 v_pk_fma_f32 v[214:215], v[214:215], v[206:207], v[204:205]
 v_pk_mul_f32 v[208:209], v[208:209], v[168:169]
 v_pk_mul_f32 v[210:211], v[210:211], v[170:171]
 v_pk_mul_f32 v[212:213], v[212:213], v[172:173]
 v_pk_mul_f32 v[214:215], v[214:215], v[174:175]
 v_exp_f32 v208, v208
 v_exp_f32 v209, v209
 v_exp_f32 v210, v210
 v_exp_f32 v211, v211
 v_exp_f32 v212, v212
 v_exp_f32 v213, v213
 v_exp_f32 v214, v214
 v_exp_f32 v215, v215
 v_pk_add_f32 v[208:209], v[208:209], v[216:217]
 v_pk_add_f32 v[210:211], v[210:211], v[216:217]
 v_pk_add_f32 v[212:213], v[212:213], v[216:217]
 v_pk_add_f32 v[214:215], v[214:215], v[216:217]
 v_rcp_f32 v208, v208
 v_rcp_f32 v209, v209
 v_rcp_f32 v210, v210
 v_rcp_f32 v211, v211
 v_rcp_f32 v212, v212
 v_rcp_f32 v213, v213
 v_rcp_f32 v214, v214
 v_rcp_f32 v215, v215
 v_pk_mul_f32 v[168:169], v[168:169], v[208:209]
 v_pk_mul_f32 v[170:171], v[170:171], v[210:211]
 v_pk_mul_f32 v[172:173], v[172:173], v[212:213]
 v_pk_mul_f32 v[174:175], v[174:175], v[214:215]
 v_pk_mul_f32 v[208:209], v[176:177], v[176:177]
 v_pk_mul_f32 v[210:211], v[178:179], v[178:179]
 v_pk_mul_f32 v[212:213], v[180:181], v[180:181]
 v_pk_mul_f32 v[214:215], v[182:183], v[182:183]
 v_pk_fma_f32 v[208:209], v[208:209], v[206:207], v[204:205]
 v_pk_fma_f32 v[210:211], v[210:211], v[206:207], v[204:205]
 v_pk_fma_f32 v[212:213], v[212:213], v[206:207], v[204:205]
 v_pk_fma_f32 v[214:215], v[214:215], v[206:207], v[204:205]
 v_pk_mul_f32 v[208:209], v[208:209], v[176:177]
 v_pk_mul_f32 v[210:211], v[210:211], v[178:179]
 v_pk_mul_f32 v[212:213], v[212:213], v[180:181]
 v_pk_mul_f32 v[214:215], v[214:215], v[182:183]
 v_exp_f32 v208, v208
 v_exp_f32 v209, v209
 v_exp_f32 v210, v210
 v_exp_f32 v211, v211
 v_exp_f32 v212, v212
 v_exp_f32 v213, v213
 v_exp_f32 v214, v214
 v_exp_f32 v215, v215
 v_pk_add_f32 v[208:209], v[208:209], v[216:217]
 v_pk_add_f32 v[210:211], v[210:211], v[216:217]
 v_pk_add_f32 v[212:213], v[212:213], v[216:217]
 v_pk_add_f32 v[214:215], v[214:215], v[216:217]
 v_rcp_f32 v208, v208
 v_rcp_f32 v209, v209
 v_rcp_f32 v210, v210
 v_rcp_f32 v211, v211
 v_rcp_f32 v212, v212
 v_rcp_f32 v213, v213
 v_rcp_f32 v214, v214
 v_rcp_f32 v215, v215
 v_pk_mul_f32 v[176:177], v[176:177], v[208:209]
 v_pk_mul_f32 v[178:179], v[178:179], v[210:211]
 v_pk_mul_f32 v[180:181], v[180:181], v[212:213]
 v_pk_mul_f32 v[182:183], v[182:183], v[214:215]
 v_pk_mul_f32 v[208:209], v[184:185], v[184:185]
 v_pk_mul_f32 v[210:211], v[186:187], v[186:187]
 v_pk_mul_f32 v[212:213], v[188:189], v[188:189]
 v_pk_mul_f32 v[214:215], v[190:191], v[190:191]
 v_pk_fma_f32 v[208:209], v[208:209], v[206:207], v[204:205]
 v_pk_fma_f32 v[210:211], v[210:211], v[206:207], v[204:205]
 v_pk_fma_f32 v[212:213], v[212:213], v[206:207], v[204:205]
 v_pk_fma_f32 v[214:215], v[214:215], v[206:207], v[204:205]
 v_pk_mul_f32 v[208:209], v[208:209], v[184:185]
 v_pk_mul_f32 v[210:211], v[210:211], v[186:187]
 v_pk_mul_f32 v[212:213], v[212:213], v[188:189]
 v_pk_mul_f32 v[214:215], v[214:215], v[190:191]
 v_exp_f32 v208, v208
 v_exp_f32 v209, v209
 v_exp_f32 v210, v210
 v_exp_f32 v211, v211
 v_exp_f32 v212, v212
 v_exp_f32 v213, v213
 v_exp_f32 v214, v214
 v_exp_f32 v215, v215
 v_pk_add_f32 v[208:209], v[208:209], v[216:217]
 v_pk_add_f32 v[210:211], v[210:211], v[216:217]
 v_pk_add_f32 v[212:213], v[212:213], v[216:217]
 v_pk_add_f32 v[214:215], v[214:215], v[216:217]
 v_rcp_f32 v208, v208
 v_rcp_f32 v209, v209
 v_rcp_f32 v210, v210
 v_rcp_f32 v211, v211
 v_rcp_f32 v212, v212
 v_rcp_f32 v213, v213
 v_rcp_f32 v214, v214
 v_rcp_f32 v215, v215
 v_pk_mul_f32 v[184:185], v[184:185], v[208:209]
 v_pk_mul_f32 v[186:187], v[186:187], v[210:211]
 v_pk_mul_f32 v[188:189], v[188:189], v[212:213]
 v_pk_mul_f32 v[190:191], v[190:191], v[214:215]
 buffer_load_dwordx2 v[16:17], v221, s[8:11], s64 offen offset:0 sc1
 buffer_load_dwordx2 v[18:19], v221, s[8:11], s64 offen offset:512 sc1
 buffer_load_dwordx2 v[20:21], v221, s[8:11], s64 offen offset:1024 sc1
 buffer_load_dwordx2 v[22:23], v221, s[8:11], s64 offen offset:1536 sc1
 buffer_load_dwordx2 v[24:25], v221, s[8:11], s64 offen offset:2048 sc1
 buffer_load_dwordx2 v[26:27], v221, s[8:11], s64 offen offset:2560 sc1
 buffer_load_dwordx2 v[28:29], v221, s[8:11], s64 offen offset:3072 sc1
 buffer_load_dwordx2 v[30:31], v221, s[8:11], s64 offen offset:3584 sc1
 CB v128, v128, v129
 CB v129, v130, v131
 CB v130, v132, v133
 CB v131, v134, v135
 s_add_u32 s58, s47, 0
 v_permlane16_swap_b32 v128, v130
 v_permlane16_swap_b32 v129, v131
 s_nop 0
 buffer_store_dwordx4 v[128:131], v196, s[60:63], s58 offen offset:0 sc1
 CB v136, v136, v137
 CB v137, v138, v139
 CB v138, v140, v141
 CB v139, v142, v143
 s_add_u32 s58, s47, 32768
 v_permlane16_swap_b32 v136, v138
 v_permlane16_swap_b32 v137, v139
 buffer_store_dwordx4 v[136:139], v196, s[60:63], s58 offen offset:0 sc1
 CB v144, v144, v145
 CB v145, v146, v147
 CB v146, v148, v149
 CB v147, v150, v151
 s_add_u32 s58, s47, 65536
 v_permlane16_swap_b32 v144, v146
 v_permlane16_swap_b32 v145, v147
 buffer_store_dwordx4 v[144:147], v196, s[60:63], s58 offen offset:0 sc1
 CB v152, v152, v153
 CB v153, v154, v155
 CB v154, v156, v157
 CB v155, v158, v159
 s_add_u32 s58, s47, 98304
 v_permlane16_swap_b32 v152, v154
 v_permlane16_swap_b32 v153, v155
 buffer_store_dwordx4 v[152:155], v196, s[60:63], s58 offen offset:0 sc1
 CB v160, v160, v161
 CB v161, v162, v163
 CB v162, v164, v165
 CB v163, v166, v167
 s_add_u32 s58, s47, 0
 v_permlane16_swap_b32 v160, v162
 v_permlane16_swap_b32 v161, v163
 s_nop 0
 buffer_store_dwordx4 v[160:163], v196, s[60:63], s58 offen offset:512 sc1
 CB v168, v168, v169
 CB v169, v170, v171
 CB v170, v172, v173
 CB v171, v174, v175
 s_add_u32 s58, s47, 32768
 v_permlane16_swap_b32 v168, v170
 v_permlane16_swap_b32 v169, v171
 buffer_store_dwordx4 v[168:171], v196, s[60:63], s58 offen offset:512 sc1
 CB v176, v176, v177
 CB v177, v178, v179
 CB v178, v180, v181
 CB v179, v182, v183
 s_add_u32 s58, s47, 65536
 v_permlane16_swap_b32 v176, v178
 v_permlane16_swap_b32 v177, v179
 buffer_store_dwordx4 v[176:179], v196, s[60:63], s58 offen offset:512 sc1
 CB v184, v184, v185
 CB v185, v186, v187
 CB v186, v188, v189
 CB v187, v190, v191
 s_add_u32 s58, s47, 98304
 v_permlane16_swap_b32 v184, v186
 v_permlane16_swap_b32 v185, v187
 buffer_store_dwordx4 v[184:187], v196, s[60:63], s58 offen offset:512 sc1
 s_waitcnt vmcnt(8)
 s_mov_b32 s34, 0
in_kernel_sx:
 v_max3_u32 v32, v16, v17, v18
 v_max3_u32 v32, v32, v19, v20
 v_max3_u32 v32, v32, v21, v22
 v_max3_u32 v32, v32, v23, v24
 v_max3_u32 v32, v32, v25, v26
 v_max3_u32 v32, v32, v27, v28
 v_max3_u32 v32, v32, v29, v30
 v_max_u32 v32, v32, v31
 v_cmp_eq_u32_e64 vcc, -1, v32
 s_cbranch_vccz in_kernel_sxok
 buffer_load_dwordx2 v[16:17], v221, s[8:11], s64 offen offset:0 sc1
 buffer_load_dwordx2 v[18:19], v221, s[8:11], s64 offen offset:512 sc1
 buffer_load_dwordx2 v[20:21], v221, s[8:11], s64 offen offset:1024 sc1
 buffer_load_dwordx2 v[22:23], v221, s[8:11], s64 offen offset:1536 sc1
 buffer_load_dwordx2 v[24:25], v221, s[8:11], s64 offen offset:2048 sc1
 buffer_load_dwordx2 v[26:27], v221, s[8:11], s64 offen offset:2560 sc1
 buffer_load_dwordx2 v[28:29], v221, s[8:11], s64 offen offset:3072 sc1
 buffer_load_dwordx2 v[30:31], v221, s[8:11], s64 offen offset:3584 sc1
 s_waitcnt vmcnt(0)
 s_add_u32 s34, s34, 1
 s_cmp_lt_u32 s34, 0x40000
 s_cbranch_scc1 in_kernel_sx
in_kernel_sxok:
 s_nop 0
 v_pk_add_f32 v[16:17], v[16:17], v[20:21]
 v_pk_add_f32 v[24:25], v[24:25], v[28:29]
 v_pk_add_f32 v[16:17], v[16:17], v[24:25]
 v_pk_add_f32 v[18:19], v[18:19], v[22:23]
 v_pk_add_f32 v[26:27], v[26:27], v[30:31]
 v_pk_add_f32 v[18:19], v[18:19], v[26:27]
 v_mul_f32 v16, 0x3b000000, v16
 v_mul_f32 v18, 0x3b000000, v18
 v_fma_f32 v18, -v16, v16, v18
 v_max_f32_e64 v18, 0, v18
 v_add_f32 v18, 0x3727c5ac, v18
 v_rsq_f32 v18, v18
 s_nop 0
 v_mul_f32 v16, -v16, v18
 v_mul_f32 v17, 0x3b000000, v17
 v_mul_f32 v19, 0x3b000000, v19
 v_fma_f32 v19, -v17, v17, v19
 v_max_f32_e64 v19, 0, v19
 v_add_f32 v19, 0x3727c5ac, v19
 v_rsq_f32 v19, v19
 s_nop 0
 v_mul_f32 v17, -v17, v19
 s_lshl_b32 s58, s3, 10
 s_nop 0
 s_add_u32 s58, s58, 135168
 v_add_u32 v221, s58, v221
 v_lshlrev_b32 v219, 4, v198
 v_add_u32_e64 v219, s58, v219
 ds_write_b64 v221, v[18:19]
 ds_write_b64 v221, v[16:17] offset:512
 s_waitcnt lgkmcnt(0)
 s_nop 0
 ds_read_b128 v[0:3], v219 offset:0
 ds_read_b128 v[4:7], v219 offset:64
 ds_read_b128 v[8:11], v219 offset:128
 ds_read_b128 v[12:15], v219 offset:192
 ds_read_b128 v[16:19], v219 offset:256
 ds_read_b128 v[20:23], v219 offset:320
 ds_read_b128 v[24:27], v219 offset:384
 ds_read_b128 v[28:31], v219 offset:448
 ds_read_b128 v[32:35], v219 offset:512
 ds_read_b128 v[36:39], v219 offset:576
 ds_read_b128 v[40:43], v219 offset:640
 ds_read_b128 v[44:47], v219 offset:704
 ds_read_b128 v[48:51], v219 offset:768
 ds_read_b128 v[52:55], v219 offset:832
 ds_read_b128 v[56:59], v219 offset:896
 ds_read_b128 v[60:63], v219 offset:960
 s_waitcnt lgkmcnt(0)
 s_nop 0
 v_pk_fma_f32 v[64:65], v[64:65], v[0:1], v[32:33]
 v_pk_fma_f32 v[66:67], v[66:67], v[2:3], v[34:35]
 v_pk_fma_f32 v[68:69], v[68:69], v[4:5], v[36:37]
 v_pk_fma_f32 v[70:71], v[70:71], v[6:7], v[38:39]
 CB v64, v64, v65
 CB v65, v66, v67
 CB v66, v68, v69
 CB v67, v70, v71
 s_add_u32 s58, s47, 0
 v_permlane16_swap_b32 v64, v66
 v_permlane16_swap_b32 v65, v67
 s_nop 0
 buffer_store_dwordx4 v[64:67], v196, s[52:55], s58 offen offset:0 sc1
 v_pk_fma_f32 v[72:73], v[72:73], v[8:9], v[40:41]
 v_pk_fma_f32 v[74:75], v[74:75], v[10:11], v[42:43]
 v_pk_fma_f32 v[76:77], v[76:77], v[12:13], v[44:45]
 v_pk_fma_f32 v[78:79], v[78:79], v[14:15], v[46:47]
 CB v72, v72, v73
 CB v73, v74, v75
 CB v74, v76, v77
 CB v75, v78, v79
 s_add_u32 s58, s47, 32768
 v_permlane16_swap_b32 v72, v74
 v_permlane16_swap_b32 v73, v75
 buffer_store_dwordx4 v[72:75], v196, s[52:55], s58 offen offset:0 sc1
 v_pk_fma_f32 v[80:81], v[80:81], v[16:17], v[48:49]
 v_pk_fma_f32 v[82:83], v[82:83], v[18:19], v[50:51]
 v_pk_fma_f32 v[84:85], v[84:85], v[20:21], v[52:53]
 v_pk_fma_f32 v[86:87], v[86:87], v[22:23], v[54:55]
 CB v80, v80, v81
 CB v81, v82, v83
 CB v82, v84, v85
 CB v83, v86, v87
 s_add_u32 s58, s47, 65536
 v_permlane16_swap_b32 v80, v82
 v_permlane16_swap_b32 v81, v83
 buffer_store_dwordx4 v[80:83], v196, s[52:55], s58 offen offset:0 sc1
 v_pk_fma_f32 v[88:89], v[88:89], v[24:25], v[56:57]
 v_pk_fma_f32 v[90:91], v[90:91], v[26:27], v[58:59]
 v_pk_fma_f32 v[92:93], v[92:93], v[28:29], v[60:61]
 v_pk_fma_f32 v[94:95], v[94:95], v[30:31], v[62:63]
 CB v88, v88, v89
 CB v89, v90, v91
 CB v90, v92, v93
 CB v91, v94, v95
 s_add_u32 s58, s47, 98304
 v_permlane16_swap_b32 v88, v90
 v_permlane16_swap_b32 v89, v91
 buffer_store_dwordx4 v[88:91], v196, s[52:55], s58 offen offset:0 sc1
 v_pk_fma_f32 v[96:97], v[96:97], v[0:1], v[32:33]
 v_pk_fma_f32 v[98:99], v[98:99], v[2:3], v[34:35]
 v_pk_fma_f32 v[100:101], v[100:101], v[4:5], v[36:37]
 v_pk_fma_f32 v[102:103], v[102:103], v[6:7], v[38:39]
 CB v96, v96, v97
 CB v97, v98, v99
 CB v98, v100, v101
 CB v99, v102, v103
 s_add_u32 s58, s47, 0
 v_permlane16_swap_b32 v96, v98
 v_permlane16_swap_b32 v97, v99
 s_nop 0
 buffer_store_dwordx4 v[96:99], v196, s[52:55], s58 offen offset:512 sc1
 v_pk_fma_f32 v[104:105], v[104:105], v[8:9], v[40:41]
 v_pk_fma_f32 v[106:107], v[106:107], v[10:11], v[42:43]
 v_pk_fma_f32 v[108:109], v[108:109], v[12:13], v[44:45]
 v_pk_fma_f32 v[110:111], v[110:111], v[14:15], v[46:47]
 CB v104, v104, v105
 CB v105, v106, v107
 CB v106, v108, v109
 CB v107, v110, v111
 s_add_u32 s58, s47, 32768
 v_permlane16_swap_b32 v104, v106
 v_permlane16_swap_b32 v105, v107
 buffer_store_dwordx4 v[104:107], v196, s[52:55], s58 offen offset:512 sc1
 v_pk_fma_f32 v[112:113], v[112:113], v[16:17], v[48:49]
 v_pk_fma_f32 v[114:115], v[114:115], v[18:19], v[50:51]
 v_pk_fma_f32 v[116:117], v[116:117], v[20:21], v[52:53]
 v_pk_fma_f32 v[118:119], v[118:119], v[22:23], v[54:55]
 CB v112, v112, v113
 CB v113, v114, v115
 CB v114, v116, v117
 CB v115, v118, v119
 s_add_u32 s58, s47, 65536
 v_permlane16_swap_b32 v112, v114
 v_permlane16_swap_b32 v113, v115
 buffer_store_dwordx4 v[112:115], v196, s[52:55], s58 offen offset:512 sc1
 v_pk_fma_f32 v[120:121], v[120:121], v[24:25], v[56:57]
 v_pk_fma_f32 v[122:123], v[122:123], v[26:27], v[58:59]
 v_pk_fma_f32 v[124:125], v[124:125], v[28:29], v[60:61]
 v_pk_fma_f32 v[126:127], v[126:127], v[30:31], v[62:63]
 CB v120, v120, v121
 CB v121, v122, v123
 CB v122, v124, v125
 CB v123, v126, v127
 s_add_u32 s58, s47, 98304
 v_permlane16_swap_b32 v120, v122
 v_permlane16_swap_b32 v121, v123
 buffer_store_dwordx4 v[120:123], v196, s[52:55], s58 offen offset:512 sc1
 s_lshl_b32 s50, s3, 6
 v_add_u32 v0, s50, v192
 s_branch attn_body
in_kernel_end:
 s_endpgm
.p2align 8
attn_kernel:
attn_body:
 s_nop 1
 v_mov_b32 v32, 0
 v_mov_b32 v33, 0
 v_mov_b32 v34, 0
 v_mov_b32 v35, 0
 v_lshrrev_b32 v1, 6, v0
 v_and_b32 v2, 63, v0
 v_lshlrev_b32 v123, 4, v2
 v_add_u32_e64 v116, s41, v123
 v_add_u32 v117, 0x1000, v116
 s_and_b32 s29, s21, 3
 s_lshl_b32 s29, s29, 5
 v_mfma_f32_32x32x16_bf16 v[128:143], v[32:35], v[32:35], 0
 s_lshr_b32 s34, s2, 3
 s_add_u32 s29, s29, s34
 s_add_u32 s29, s29, s25
 s_lshl_b32 s29, s29, 15
 s_add_u32 s35, s29, 16777216
 s_add_u32 s29, s29, 25165824
 s_sub_u32 s30, s17, 3
 v_mfma_f32_32x32x16_bf16 a[128:143], v[32:35], v[32:35], 0
 s_sub_u32 s31, s17, 2
 v_lshrrev_b32 v3, 4, v2
 v_and_b32 v4, 15, v2
 v_and_b32 v5, 1, v3
 v_mul_u32_u24 v5, 12, v5
 v_xor_b32 v5, v4, v5
 v_lshlrev_b32 v5, 4, v5
 v_mfma_f32_32x32x16_bf16 v[144:159], v[32:35], v[32:35], 0
 v_lshl_add_u32 v112, v3, 9, v5
 v_add_u32 v113, 0x10000, v112
 v_lshrrev_b32_e64 v4, 2, v2
 v_bfe_u32 v5, v2, 1, 1
 v_and_b32 v6, 1, v2
 v_mul_u32_u24 v7, 12, v5
 v_xor_b32_e64 v4, v4, v7
 v_mfma_f32_32x32x16_bf16 a[144:159], v[32:35], v[32:35], 0
 v_lshlrev_b32_e64 v4, 4, v4
 v_lshl_add_u32 v4, v5, 9, v4
 v_lshl_add_u32 v114, v6, 3, v4
 v_add_u32 v115, 0x10000, v114
 v_lshlrev_b32 v126, 7, v2
 v_lshlrev_b32 v127, 7, v0
 v_cmp_ne_u32_e64 vcc, 0, v2
 v_mfma_f32_32x32x16_bf16 v[160:175], v[32:35], v[32:35], 0
 v_mov_b32 v125, 0x40000000
 v_cndmask_b32 v124, 0, v125, vcc
 v_mov_b32_e64 v125, 1
 s_and_b32 s36, s2, 3
 s_lshl_b32 s36, s36, 4
 s_lshr_b32 s37, s2, 4
 s_add_u32 s36, s36, s37
 v_mfma_f32_32x32x16_bf16 a[160:175], v[32:35], v[32:35], 0
 s_lshl_b32 s36, s36, 6
 s_add_u32 s37, s36, 95
 s_min_u32 s37, s37, 3999
 s_lshr_b32 s37, s37, 7
 s_max_u32 s36, s36, 32
 s_sub_u32 s36, s36, 32
 s_lshr_b32 s36, s36, 7
 v_mfma_f32_32x32x16_bf16 v[176:191], v[32:35], v[32:35], 0
 v_add_u32 v126, s36, v2
 v_min_u32 v126, s37, v126
 s_and_b32 s36, s2, 4
 s_lshl_b32 s36, s36, 3
 v_add_u32 v126, s36, v126
 v_lshlrev_b32_e64 v126, 7, v126
 v_add_u32 v126, 92299264, v126
 v_mfma_f32_32x32x16_bf16 a[176:191], v[32:35], v[32:35], 0
 v_mfma_f32_32x32x16_bf16 v[192:207], v[32:35], v[32:35], 0
 v_mfma_f32_32x32x16_bf16 a[192:207], v[32:35], v[32:35], 0
 v_mov_b32 v118, 0
 v_mov_b32 v119, 0
 s_mov_b32 s16, 0
 s_barrier
 ds_read_b128 v[40:43], v112 offset:0
 ds_read_b128 v[44:47], v112 offset:256
 ds_read_b128 v[48:51], v112 offset:2048
 ds_read_b128 v[52:55], v112 offset:2304
 ds_read_b128 v[56:59], v112 offset:4096
 ds_read_b128 v[60:63], v112 offset:4352
 ds_read_b128 v[64:67], v112 offset:6144
 ds_read_b128 v[68:71], v112 offset:6400
 s_waitcnt lgkmcnt(7)
 MM v[0:3], v[40:43], a[0:3], 0
 ds_read_b128 v[72:75], v112 offset:8192
 v_mov_b32 v208, 0
 MM v[4:7], v[40:43], a[4:7], 0
 v_mov_b32 v209, 0
 v_mov_b32_e64 v210, 0
 s_waitcnt lgkmcnt(7)
 MM v[8:11], v[44:47], a[0:3], 0
 ds_read_b128 v[76:79], v112 offset:8448
 v_mov_b32_e64 v211, 0
 MM v[12:15], v[44:47], a[4:7], 0
 v_mov_b32 v212, 0
 v_mov_b32_e64 v213, 0
 s_waitcnt lgkmcnt(7)
 MM v[0:3], v[48:51], a[8:11], v[0:3]
 ds_read_b128 v[80:83], v112 offset:10240
 v_mov_b32_e64 v214, 0
 MM v[4:7], v[48:51], a[12:15], v[4:7]
 v_mov_b32 v215, 0
 v_mov_b32_e64 v216, 0
 s_waitcnt lgkmcnt(7)
 MM v[8:11], v[52:55], a[8:11], v[8:11]
 ds_read_b128 v[84:87], v112 offset:10496
 v_mov_b32_e64 v217, 0
 MM v[12:15], v[52:55], a[12:15], v[12:15]
 v_mov_b32 v218, 0
 v_mov_b32_e64 v219, 0
 s_waitcnt lgkmcnt(7)
 MM v[0:3], v[56:59], a[16:19], v[0:3]
 ds_read_b128 v[88:91], v112 offset:12288
 v_mov_b32_e64 v220, 0
 MM v[4:7], v[56:59], a[20:23], v[4:7]
 v_mov_b32 v221, 0
 v_mov_b32_e64 v222, 0
 s_waitcnt lgkmcnt(7)
 MM v[8:11], v[60:63], a[16:19], v[8:11]
 ds_read_b128 v[92:95], v112 offset:12544
 v_mov_b32_e64 v223, 0
 MM v[12:15], v[60:63], a[20:23], v[12:15]
 v_mov_b32 v224, 0
 v_mov_b32_e64 v225, 0
 s_waitcnt lgkmcnt(7)
 MM v[0:3], v[64:67], a[24:27], v[0:3]
 ds_read_b128 v[96:99], v112 offset:14336
 v_mov_b32_e64 v226, 0
 MM v[4:7], v[64:67], a[28:31], v[4:7]
 v_mov_b32 v227, 0
 v_mov_b32_e64 v228, 0
 s_waitcnt lgkmcnt(7)
 MM v[8:11], v[68:71], a[24:27], v[8:11]
 ds_read_b128 v[100:103], v112 offset:14592
 v_mov_b32_e64 v229, 0
 MM v[12:15], v[68:71], a[28:31], v[12:15]
 v_mov_b32 v230, 0
 v_mov_b32_e64 v231, 0
 s_waitcnt lgkmcnt(7)
 MM v[0:3], v[72:75], a[32:35], v[0:3]
 ds_read_b128 v[40:43], v112 offset:16384
 v_mov_b32_e64 v232, 0
 MM v[4:7], v[72:75], a[36:39], v[4:7]
 v_mov_b32 v233, 0
 v_mov_b32_e64 v234, 0
 s_waitcnt lgkmcnt(7)
 MM v[8:11], v[76:79], a[32:35], v[8:11]
 ds_read_b128 v[44:47], v112 offset:16640
 v_mov_b32_e64 v235, 0
 MM v[12:15], v[76:79], a[36:39], v[12:15]
 v_mov_b32 v236, 0
 v_mov_b32_e64 v237, 0
 s_waitcnt lgkmcnt(7)
 MM v[0:3], v[80:83], a[40:43], v[0:3]
 ds_read_b128 v[48:51], v112 offset:18432
 v_mov_b32_e64 v238, 0
 MM v[4:7], v[80:83], a[44:47], v[4:7]
 v_mov_b32 v239, 0
 v_mov_b32_e64 v240, 0
 s_waitcnt lgkmcnt(7)
 MM v[8:11], v[84:87], a[40:43], v[8:11]
 ds_read_b128 v[52:55], v112 offset:18688
 v_mov_b32_e64 v241, 0
 MM v[12:15], v[84:87], a[44:47], v[12:15]
 v_mov_b32 v242, 0
 v_mov_b32_e64 v243, 0
 s_waitcnt lgkmcnt(7)
 MM v[0:3], v[88:91], a[48:51], v[0:3]
 ds_read_b128 v[56:59], v112 offset:20480
 v_mov_b32_e64 v244, 0
 MM v[4:7], v[88:91], a[52:55], v[4:7]
 v_mov_b32 v245, 0
 v_mov_b32_e64 v246, 0
 s_waitcnt lgkmcnt(7)
 MM v[8:11], v[92:95], a[48:51], v[8:11]
 ds_read_b128 v[60:63], v112 offset:20736
 v_mov_b32_e64 v247, 0
 MM v[12:15], v[92:95], a[52:55], v[12:15]
 v_mov_b32 v248, 0
 v_mov_b32_e64 v249, 0
 s_waitcnt lgkmcnt(7)
 MM v[0:3], v[96:99], a[56:59], v[0:3]
 ds_read_b128 v[64:67], v112 offset:22528
 v_mov_b32_e64 v250, 0
 MM v[4:7], v[96:99], a[60:63], v[4:7]
 v_mov_b32 v251, 0
 v_mov_b32_e64 v252, 0
 s_waitcnt lgkmcnt(7)
 MM v[8:11], v[100:103], a[56:59], v[8:11]
 ds_read_b128 v[68:71], v112 offset:22784
 v_mov_b32_e64 v253, 0
 MM v[12:15], v[100:103], a[60:63], v[12:15]
 v_mov_b32 v254, 0
 v_mov_b32_e64 v255, 0
 s_waitcnt lgkmcnt(7)
 MM v[0:3], v[40:43], a[64:67], v[0:3]
 ds_read_b128 v[72:75], v112 offset:24576
 WA a208, 0
 MM v[4:7], v[40:43], a[68:71], v[4:7]
 WA a209, 0
 WA a210, 0
 s_waitcnt lgkmcnt(7)
 MM v[8:11], v[44:47], a[64:67], v[8:11]
 ds_read_b128 v[76:79], v112 offset:24832
 WA a211, 0
 MM v[12:15], v[44:47], a[68:71], v[12:15]
 WA a212, 0
 WA a213, 0
 s_waitcnt lgkmcnt(7)
 MM v[0:3], v[48:51], a[72:75], v[0:3]
 ds_read_b128 v[80:83], v112 offset:26624
 WA a214, 0
 MM v[4:7], v[48:51], a[76:79], v[4:7]
 WA a215, 0
 WA a216, 0
 s_waitcnt lgkmcnt(7)
 MM v[8:11], v[52:55], a[72:75], v[8:11]
 ds_read_b128 v[84:87], v112 offset:26880
 WA a217, 0
 MM v[12:15], v[52:55], a[76:79], v[12:15]
 WA a218, 0
 WA a219, 0
 s_waitcnt lgkmcnt(7)
 MM v[0:3], v[56:59], a[80:83], v[0:3]
 ds_read_b128 v[88:91], v112 offset:28672
 WA a220, 0
 MM v[4:7], v[56:59], a[84:87], v[4:7]
 WA a221, 0
 WA a222, 0
 s_waitcnt lgkmcnt(7)
 MM v[8:11], v[60:63], a[80:83], v[8:11]
 ds_read_b128 v[92:95], v112 offset:28928
 WA a223, 0
 MM v[12:15], v[60:63], a[84:87], v[12:15]
 WA a224, 0
 WA a225, 0
 s_waitcnt lgkmcnt(7)
 MM v[0:3], v[64:67], a[88:91], v[0:3]
 ds_read_b128 v[96:99], v112 offset:30720
 WA a226, 0
 MM v[4:7], v[64:67], a[92:95], v[4:7]
 WA a227, 0
 WA a228, 0
 s_waitcnt lgkmcnt(7)
 MM v[8:11], v[68:71], a[88:91], v[8:11]
 ds_read_b128 v[100:103], v112 offset:30976
 WA a229, 0
 MM v[12:15], v[68:71], a[92:95], v[12:15]
 WA a230, 0
 WA a231, 0
 s_waitcnt lgkmcnt(7)
 MM v[0:3], v[72:75], a[96:99], v[0:3]
 WA a232, 0
 MM v[4:7], v[72:75], a[100:103], v[4:7]
 WA a233, 0
 WA a234, 0
 s_waitcnt lgkmcnt(6)
 MM v[8:11], v[76:79], a[96:99], v[8:11]
 WA a235, 0
 MM v[12:15], v[76:79], a[100:103], v[12:15]
 WA a236, 0
 WA a237, 0
 s_waitcnt lgkmcnt(5)
 MM v[0:3], v[80:83], a[104:107], v[0:3]
 WA a238, 0
 MM v[4:7], v[80:83], a[108:111], v[4:7]
 WA a239, 0
 WA a240, 0
 s_waitcnt lgkmcnt(4)
 MM v[8:11], v[84:87], a[104:107], v[8:11]
 WA a241, 0
 MM v[12:15], v[84:87], a[108:111], v[12:15]
 WA a242, 0
 WA a243, 0
 s_waitcnt lgkmcnt(3)
 MM v[0:3], v[88:91], a[112:115], v[0:3]
 WA a244, 0
 MM v[4:7], v[88:91], a[116:119], v[4:7]
 WA a245, 0
 WA a246, 0
 s_waitcnt lgkmcnt(2)
 MM v[8:11], v[92:95], a[112:115], v[8:11]
 WA a247, 0
 MM v[12:15], v[92:95], a[116:119], v[12:15]
 WA a248, 0
 WA a249, 0
 s_waitcnt lgkmcnt(1)
 MM v[0:3], v[96:99], a[120:123], v[0:3]
 WA a250, 0
 MM v[4:7], v[96:99], a[124:127], v[4:7]
 WA a251, 0
 WA a252, 0
 s_waitcnt lgkmcnt(0)
 MM v[8:11], v[100:103], a[120:123], v[8:11]
 WA a253, 0
 MM v[12:15], v[100:103], a[124:127], v[12:15]
 WA a254, 0
 WA a255, 0
 v_mov_b32 v32, -1
 v_mov_b32 v33, -1
 v_mov_b32 v34, -1
 v_mov_b32_e64 v35, -1
 s_lshl_b32 s34, s21, 4
 s_lshr_b32 s36, s2, 4
 s_add_u32 s34, s34, s36
 s_lshl_b32 s34, s34, 16
 s_bfe_u32 s36, s2, 0x10003
 s_xor_b32 s36, s36, 1
 s_lshl_b32 s36, s36, 15
 s_add_u32 s34, s34, s36
 s_add_u32 s34, s34, 69206016
 buffer_store_dwordx4 v[32:35], v116, s[8:11], s34 offen offset:0 sc1
 buffer_store_dwordx4 v[32:35], v116, s[8:11], s34 offen offset:1024 sc1
 buffer_store_dwordx4 v[32:35], v116, s[8:11], s34 offen offset:2048 sc1
 buffer_store_dwordx4 v[32:35], v116, s[8:11], s34 offen offset:3072 sc1
 buffer_store_dwordx4 v[32:35], v117, s[8:11], s34 offen offset:0 sc1
 buffer_store_dwordx4 v[32:35], v117, s[8:11], s34 offen offset:1024 sc1
 buffer_store_dwordx4 v[32:35], v117, s[8:11], s34 offen offset:2048 sc1
 buffer_store_dwordx4 v[32:35], v117, s[8:11], s34 offen offset:3072 sc1
 ds_read_b128 v[40:43], v112 offset:32768
 ds_read_b128 v[44:47], v112 offset:33024
 ds_read_b128 v[48:51], v112 offset:34816
 ds_read_b128 v[52:55], v112 offset:35072
 ds_read_b128 v[56:59], v112 offset:36864
 ds_read_b128 v[60:63], v112 offset:37120
 ds_read_b128 v[64:67], v112 offset:38912
 ds_read_b128 v[68:71], v112 offset:39168
 v_max3_f32 v120, v0, v1, v2
 v_max3_f32 v120, v120, v3, v8
 v_max3_f32 v120, v120, v9, v10
 v_max_f32 v120, v120, v11
 v_mov_b32 v121, v120
 s_nop 1
 v_permlane16_swap_b32 v121, v120
 v_max_f32 v120, v120, v121
 v_mov_b32 v121, v120
 s_nop 1
 v_permlane32_swap_b32 v121, v120
 v_max_f32 v120, v120, v121
 v_sub_f32 v0, v0, v120
 v_sub_f32 v1, v1, v120
 v_sub_f32 v2, v2, v120
 v_sub_f32 v3, v3, v120
 v_sub_f32 v8, v8, v120
 v_sub_f32 v9, v9, v120
 v_sub_f32 v10, v10, v120
 v_sub_f32 v11, v11, v120
 v_sub_f32 v104, 0, v120
 v_sub_f32 v105, 0, v120
 v_sub_f32 v106, 0, v120
 v_sub_f32 v107, 0, v120
 v_max3_f32 v120, v4, v5, v6
 v_max3_f32 v120, v120, v7, v12
 v_max3_f32 v120, v120, v13, v14
 v_max_f32 v120, v120, v15
 v_mov_b32 v121, v120
 s_nop 1
 v_permlane16_swap_b32 v121, v120
 v_max_f32 v120, v120, v121
 v_mov_b32 v121, v120
 s_nop 1
 v_permlane32_swap_b32 v121, v120
 v_max_f32 v120, v120, v121
 v_sub_f32 v4, v4, v120
 v_sub_f32 v5, v5, v120
 v_sub_f32 v6, v6, v120
 v_sub_f32 v7, v7, v120
 v_sub_f32 v12, v12, v120
 v_sub_f32 v13, v13, v120
 v_sub_f32 v14, v14, v120
 v_sub_f32 v15, v15, v120
 v_sub_f32 v108, 0, v120
 v_sub_f32 v109, 0, v120
 v_sub_f32 v110, 0, v120
 v_sub_f32 v111, 0, v120
 s_cmp_eq_u32 s18, 0
 s_cselect_b32 s39, 0x40000000, s19
 s_waitcnt lgkmcnt(4)
.p2align 6
attn_kernel_loop:
 MM v[16:19], v[40:43], a[0:3], v[104:107]
 v_exp_f32_e64 v0, v0
 MM v[20:23], v[40:43], a[4:7], v[108:111]
 v_exp_f32_e64 v1, v1
 MM v[28:31], v[44:47], a[4:7], v[108:111]
 ds_read_b128 v[72:75], v112 offset:40960
 v_add_f32_e64 v118, v118, v0
 MM v[24:27], v[44:47], a[0:3], v[104:107]
 ds_read_b128 v[76:79], v112 offset:41216
 CB v32, v0, v1
 MM v[16:19], v[48:51], a[8:11], v[16:19]
 ds_read_b128 v[80:83], v112 offset:43008
 v_add_f32_e64 v118, v118, v1
 MM v[20:23], v[48:51], a[12:15], v[20:23]
 v_exp_f32_e64 v2, v2
 MM v[28:31], v[52:55], a[12:15], v[28:31]
 v_exp_f32_e64 v3, v3
 MM v[24:27], v[52:55], a[8:11], v[24:27]
 ds_read_b128 v[84:87], v112 offset:43264
 s_waitcnt lgkmcnt(4)
 MM v[16:19], v[56:59], a[16:19], v[16:19]
 ds_read_b128 v[88:91], v112 offset:45056
 v_add_f32 v118, v118, v2
 MM v[20:23], v[56:59], a[20:23], v[20:23]
 ds_read_b128 v[92:95], v112 offset:45312
 CB v33, v2, v3
 MM v[28:31], v[60:63], a[20:23], v[28:31]
 ds_read_b128 v[96:99], v112 offset:47104
 v_add_f32_e64 v118, v118, v3
 MM v[24:27], v[60:63], a[16:19], v[24:27]
 v_exp_f32_e64 v8, v8
 MM v[16:19], v[64:67], a[24:27], v[16:19]
 v_exp_f32_e64 v9, v9
 MM v[20:23], v[64:67], a[28:31], v[20:23]
 ds_read_b128 v[100:103], v112 offset:47360
 v_add_f32_e64 v118, v118, v8
 MM v[28:31], v[68:71], a[28:31], v[28:31]
 ds_read_b128 v[40:43], v112 offset:49152
 CB v34, v8, v9
 MM v[24:27], v[68:71], a[24:27], v[24:27]
 ds_read_b128 v[44:47], v112 offset:49408
 s_waitcnt lgkmcnt(6)
 MM v[16:19], v[72:75], a[32:35], v[16:19]
 ds_read_b128 v[48:51], v112 offset:51200
 v_add_f32 v118, v118, v9
 MM v[20:23], v[72:75], a[36:39], v[20:23]
 v_exp_f32_e64 v10, v10
 MM v[28:31], v[76:79], a[36:39], v[28:31]
 v_exp_f32_e64 v11, v11
 MM v[24:27], v[76:79], a[32:35], v[24:27]
 ds_read_b128 v[52:55], v112 offset:51456
 v_add_f32_e64 v118, v118, v10
 MM v[16:19], v[80:83], a[40:43], v[16:19]
 ds_read_b128 v[56:59], v112 offset:53248
 CB v35, v10, v11
 MM v[20:23], v[80:83], a[44:47], v[20:23]
 ds_read_b128 v[60:63], v112 offset:53504
 v_add_f32_e64 v118, v118, v11
 MM v[28:31], v[84:87], a[44:47], v[28:31]
 v_exp_f32_e64 v4, v4
 MM v[24:27], v[84:87], a[40:43], v[24:27]
 ds_read_b128 v[64:67], v112 offset:55296
 s_waitcnt lgkmcnt(7)
 MM v[16:19], v[88:91], a[48:51], v[16:19]
 v_exp_f32 v5, v5
 MM v[20:23], v[88:91], a[52:55], v[20:23]
 ds_read_b128 v[68:71], v112 offset:55552
 v_add_f32_e64 v119, v119, v4
 MM v[28:31], v[92:95], a[52:55], v[28:31]
 ds_read_b128 v[72:75], v112 offset:57344
 CB v36, v4, v5
 MM v[24:27], v[92:95], a[48:51], v[24:27]
 ds_read_b128 v[76:79], v112 offset:57600
 v_add_f32_e64 v119, v119, v5
 MM v[16:19], v[96:99], a[56:59], v[16:19]
 v_exp_f32_e64 v6, v6
 MM v[20:23], v[96:99], a[60:63], v[20:23]
 v_exp_f32_e64 v7, v7
 MM v[28:31], v[100:103], a[60:63], v[28:31]
 ds_read_b128 v[80:83], v112 offset:59392
 v_add_f32_e64 v119, v119, v6
 MM v[24:27], v[100:103], a[56:59], v[24:27]
 ds_read_b128 v[84:87], v112 offset:59648
 s_waitcnt lgkmcnt(8)
 MM v[16:19], v[40:43], a[64:67], v[16:19]
 CB v37, v6, v7
 v_add_f32 v119, v119, v7
 MM v[20:23], v[40:43], a[68:71], v[20:23]
 v_exp_f32_e64 v12, v12
 MM v[28:31], v[44:47], a[68:71], v[28:31]
 v_exp_f32_e64 v13, v13
 MM v[24:27], v[44:47], a[64:67], v[24:27]
 ds_read_b128 v[88:91], v112 offset:61440
 v_add_f32_e64 v119, v119, v12
 MM v[16:19], v[48:51], a[72:75], v[16:19]
 ds_read_b128 v[92:95], v112 offset:61696
 CB v38, v12, v13
 MM v[20:23], v[48:51], a[76:79], v[20:23]
 ds_read_b128 v[96:99], v112 offset:63488
 v_add_f32_e64 v119, v119, v13
 MM v[28:31], v[52:55], a[76:79], v[28:31]
 v_exp_f32_e64 v14, v14
 MM v[24:27], v[52:55], a[72:75], v[24:27]
 ds_read_b128 v[100:103], v112 offset:63744
 s_waitcnt lgkmcnt(8)
 MM v[16:19], v[56:59], a[80:83], v[16:19]
 v_exp_f32 v15, v15
 MM v[20:23], v[56:59], a[84:87], v[20:23]
 ds_read_b64_tr_b16 v[40:41], v114 offset:0
 v_add_f32_e64 v119, v119, v14
 MM v[28:31], v[60:63], a[84:87], v[28:31]
 ds_read_b64_tr_b16 v[42:43], v114 offset:256
 CB v39, v14, v15
 MM v[24:27], v[60:63], a[80:83], v[24:27]
 ds_read_b64_tr_b16 v[44:45], v114 offset:1024
 v_add_f32_e64 v119, v119, v15
 MM v[16:19], v[64:67], a[88:91], v[16:19]
 ds_read_b64_tr_b16 v[46:47], v114 offset:1280
 MM v[20:23], v[64:67], a[92:95], v[20:23]
 ds_read_b64_tr_b16 v[48:49], v114 offset:2048
 MM v[28:31], v[68:71], a[92:95], v[28:31]
 ds_read_b64_tr_b16 v[50:51], v114 offset:2304
 MM v[24:27], v[68:71], a[88:91], v[24:27]
 ds_read_b64_tr_b16 v[52:53], v114 offset:3072
 s_waitcnt lgkmcnt(11)
 MM v[16:19], v[72:75], a[96:99], v[16:19]
 ds_read_b64_tr_b16 v[54:55], v114 offset:3328
 MM v[20:23], v[72:75], a[100:103], v[20:23]
 ds_read_b64_tr_b16 v[56:57], v114 offset:4096
 MM v[28:31], v[76:79], a[100:103], v[28:31]
 ds_read_b64_tr_b16 v[58:59], v114 offset:4352
 MM v[24:27], v[76:79], a[96:99], v[24:27]
 ds_read_b64_tr_b16 v[60:61], v114 offset:5120
 MM v[16:19], v[80:83], a[104:107], v[16:19]
 ds_read_b64_tr_b16 v[62:63], v114 offset:5376
 MM v[20:23], v[80:83], a[108:111], v[20:23]
 ds_read_b64_tr_b16 v[64:65], v114 offset:6144
 MM v[28:31], v[84:87], a[108:111], v[28:31]
 ds_read_b64_tr_b16 v[66:67], v114 offset:6400
 MM v[24:27], v[84:87], a[104:107], v[24:27]
 ds_read_b64_tr_b16 v[68:69], v114 offset:7168
 s_waitcnt lgkmcnt(15)
 MM v[16:19], v[88:91], a[112:115], v[16:19]
 ds_read_b64_tr_b16 v[70:71], v114 offset:7424
 MM v[20:23], v[88:91], a[116:119], v[20:23]
 ds_read_b64_tr_b16 v[72:73], v114 offset:8192
 MM v[28:31], v[92:95], a[116:119], v[28:31]
 ds_read_b64_tr_b16 v[74:75], v114 offset:8448
 MM v[24:27], v[92:95], a[112:115], v[24:27]
 ds_read_b64_tr_b16 v[76:77], v114 offset:9216
 MM v[16:19], v[96:99], a[120:123], v[16:19]
 ds_read_b64_tr_b16 v[78:79], v114 offset:9472
 MM v[20:23], v[96:99], a[124:127], v[20:23]
 ds_read_b64_tr_b16 v[80:81], v114 offset:10240
 MM v[28:31], v[100:103], a[124:127], v[28:31]
 ds_read_b64_tr_b16 v[82:83], v114 offset:10496
 MM v[24:27], v[100:103], a[120:123], v[24:27]
 ds_read_b64_tr_b16 v[84:85], v114 offset:11264
 s_waitcnt lgkmcnt(15)
 MM v[128:131], v[40:43], v[32:35], v[128:131]
 ds_read_b64_tr_b16 v[86:87], v114 offset:11520
 s_add_u32 m0, s41, 98304
 MM v[132:135], v[40:43], v[36:39], v[132:135]
 ds_read_b64_tr_b16 v[88:89], v114 offset:12288
 buffer_load_dwordx4 v116, s[8:11], s42 offen offset:0 lds
 MM v[140:143], v[44:47], v[36:39], v[140:143]
 ds_read_b64_tr_b16 v[90:91], v114 offset:12544
 MM v[136:139], v[44:47], v[32:35], v[136:139]
 ds_read_b64_tr_b16 v[92:93], v114 offset:13312
 MM v[144:147], v[48:51], v[32:35], v[144:147]
 ds_read_b64_tr_b16 v[94:95], v114 offset:13568
 MM v[148:151], v[48:51], v[36:39], v[148:151]
 ds_read_b64_tr_b16 v[96:97], v114 offset:14336
 v_max3_f32 v120, v16, v17, v18
 MM v[156:159], v[52:55], v[36:39], v[156:159]
 ds_read_b64_tr_b16 v[98:99], v114 offset:14592
 buffer_load_dwordx4 v116, s[8:11], s42 offen offset:1024 lds
 MM v[152:155], v[52:55], v[32:35], v[152:155]
 ds_read_b64_tr_b16 v[100:101], v114 offset:15360
 s_waitcnt lgkmcnt(15)
 MM v[160:163], v[56:59], v[32:35], v[160:163]
 ds_read_b64_tr_b16 v[102:103], v114 offset:15616
 v_max3_f32 v120, v120, v19, v20
 MM v[164:167], v[56:59], v[36:39], v[164:167]
 ds_read_b64_tr_b16 v[40:41], v114 offset:16384
 v_max3_f32 v120, v120, v21, v22
 MM v[172:175], v[60:63], v[36:39], v[172:175]
 ds_read_b64_tr_b16 v[42:43], v114 offset:16640
 v_max3_f32 v120, v120, v23, v24
 MM v[168:171], v[60:63], v[32:35], v[168:171]
 ds_read_b64_tr_b16 v[44:45], v114 offset:17408
 buffer_load_dwordx4 v116, s[8:11], s42 offen offset:2048 lds
 MM v[176:179], v[64:67], v[32:35], v[176:179]
 ds_read_b64_tr_b16 v[46:47], v114 offset:17664
 v_max3_f32 v120, v120, v25, v26
 MM v[180:183], v[64:67], v[36:39], v[180:183]
 ds_read_b64_tr_b16 v[48:49], v114 offset:18432
 v_max3_f32 v120, v120, v27, v28
 MM v[188:191], v[68:71], v[36:39], v[188:191]
 ds_read_b64_tr_b16 v[50:51], v114 offset:18688
 v_max3_f32 v120, v120, v29, v30
 MM v[184:187], v[68:71], v[32:35], v[184:187]
 ds_read_b64_tr_b16 v[52:53], v114 offset:19456
 s_waitcnt lgkmcnt(15)
 MM v[192:195], v[72:75], v[32:35], v[192:195]
 ds_read_b64_tr_b16 v[54:55], v114 offset:19712
 buffer_load_dwordx4 v116, s[8:11], s42 offen offset:3072 lds
 MM v[196:199], v[72:75], v[36:39], v[196:199]
 ds_read_b64_tr_b16 v[56:57], v114 offset:20480
 v_max_f32 v120, v120, v31
 MM v[204:207], v[76:79], v[36:39], v[204:207]
 ds_read_b64_tr_b16 v[58:59], v114 offset:20736
 v_cmp_lt_f32 vcc, 0x41000000, v120
 MM v[200:203], v[76:79], v[32:35], v[200:203]
 ds_read_b64_tr_b16 v[60:61], v114 offset:21504
 MM v[208:211], v[80:83], v[32:35], v[208:211]
 ds_read_b64_tr_b16 v[62:63], v114 offset:21760
 s_add_u32 m0, s41, 102400
 MM v[212:215], v[80:83], v[36:39], v[212:215]
 ds_read_b64_tr_b16 v[64:65], v114 offset:22528
 buffer_load_dwordx4 v117, s[8:11], s42 offen offset:0 lds
 MM v[220:223], v[84:87], v[36:39], v[220:223]
 ds_read_b64_tr_b16 v[66:67], v114 offset:22784
 MM v[216:219], v[84:87], v[32:35], v[216:219]
 ds_read_b64_tr_b16 v[68:69], v114 offset:23552
 s_waitcnt lgkmcnt(15)
 MM v[224:227], v[88:91], v[32:35], v[224:227]
 ds_read_b64_tr_b16 v[70:71], v114 offset:23808
 MM v[228:231], v[88:91], v[36:39], v[228:231]
 ds_read_b64_tr_b16 v[72:73], v114 offset:24576
 MM v[236:239], v[92:95], v[36:39], v[236:239]
 ds_read_b64_tr_b16 v[74:75], v114 offset:24832
 buffer_load_dwordx4 v117, s[8:11], s42 offen offset:1024 lds
 MM v[232:235], v[92:95], v[32:35], v[232:235]
 ds_read_b64_tr_b16 v[76:77], v114 offset:25600
 MM v[240:243], v[96:99], v[32:35], v[240:243]
 ds_read_b64_tr_b16 v[78:79], v114 offset:25856
 MM v[244:247], v[96:99], v[36:39], v[244:247]
 ds_read_b64_tr_b16 v[80:81], v114 offset:26624
 MM v[252:255], v[100:103], v[36:39], v[252:255]
 ds_read_b64_tr_b16 v[82:83], v114 offset:26880
 MM v[248:251], v[100:103], v[32:35], v[248:251]
 ds_read_b64_tr_b16 v[84:85], v114 offset:27648
 s_waitcnt lgkmcnt(15)
 MM a[128:131], v[40:43], v[32:35], a[128:131]
 ds_read_b64_tr_b16 v[86:87], v114 offset:27904
 buffer_load_dwordx4 v117, s[8:11], s42 offen offset:2048 lds
 MM a[132:135], v[40:43], v[36:39], a[132:135]
 ds_read_b64_tr_b16 v[88:89], v114 offset:28672
 MM a[140:143], v[44:47], v[36:39], a[140:143]
 ds_read_b64_tr_b16 v[90:91], v114 offset:28928
 MM a[136:139], v[44:47], v[32:35], a[136:139]
 ds_read_b64_tr_b16 v[92:93], v114 offset:29696
 MM a[144:147], v[48:51], v[32:35], a[144:147]
 ds_read_b64_tr_b16 v[94:95], v114 offset:29952
 buffer_load_dwordx4 v117, s[8:11], s42 offen offset:3072 lds
 MM a[148:151], v[48:51], v[36:39], a[148:151]
 ds_read_b64_tr_b16 v[96:97], v114 offset:30720
 s_add_u32 s42, s42, 0x8000
 MM a[156:159], v[52:55], v[36:39], a[156:159]
 ds_read_b64_tr_b16 v[98:99], v114 offset:30976
 MM a[152:155], v[52:55], v[32:35], a[152:155]
 ds_read_b64_tr_b16 v[100:101], v114 offset:31744
 s_waitcnt lgkmcnt(15)
 MM a[160:163], v[56:59], v[32:35], a[160:163]
 ds_read_b64_tr_b16 v[102:103], v114 offset:32000
 MM a[164:167], v[56:59], v[36:39], a[164:167]
 MM a[172:175], v[60:63], v[36:39], a[172:175]
 MM a[168:171], v[60:63], v[32:35], a[168:171]
 MM a[176:179], v[64:67], v[32:35], a[176:179]
 MM a[180:183], v[64:67], v[36:39], a[180:183]
 MM a[188:191], v[68:71], v[36:39], a[188:191]
 MM a[184:187], v[68:71], v[32:35], a[184:187]
 s_waitcnt vmcnt(8) lgkmcnt(0)
 s_barrier
 MM a[192:195], v[72:75], v[32:35], a[192:195]
 ds_read_b128 v[40:43], v113 offset:0
 MM a[196:199], v[72:75], v[36:39], a[196:199]
 ds_read_b128 v[44:47], v113 offset:256
 MM a[204:207], v[76:79], v[36:39], a[204:207]
 ds_read_b128 v[48:51], v113 offset:2048
 MM a[200:203], v[76:79], v[32:35], a[200:203]
 ds_read_b128 v[52:55], v113 offset:2304
 MM a[208:211], v[80:83], v[32:35], a[208:211]
 ds_read_b128 v[56:59], v113 offset:4096
 MM a[212:215], v[80:83], v[36:39], a[212:215]
 ds_read_b128 v[60:63], v113 offset:4352
 MM a[220:223], v[84:87], v[36:39], a[220:223]
 ds_read_b128 v[64:67], v113 offset:6144
 MM a[216:219], v[84:87], v[32:35], a[216:219]
 ds_read_b128 v[68:71], v113 offset:6400
 MM a[224:227], v[88:91], v[32:35], a[224:227]
 MM a[228:231], v[88:91], v[36:39], a[228:231]
 buffer_atomic_add v125, v124, s[8:11], s86 offen offset:8 sc1
 MM a[236:239], v[92:95], v[36:39], a[236:239]
 s_mov_b32 s86, 0x40000000
 MM a[232:235], v[92:95], v[32:35], a[232:235]
 MM a[240:243], v[96:99], v[32:35], a[240:243]
 s_add_u32 s16, s16, 1
 MM a[244:247], v[96:99], v[36:39], a[244:247]
 MM a[252:255], v[100:103], v[36:39], a[252:255]
 s_waitcnt lgkmcnt(4)
 MM a[248:251], v[100:103], v[32:35], a[248:251]
 s_cbranch_vccnz attn_kernel_rare0
attn_kernel_back0:
 MM v[0:3], v[40:43], a[0:3], v[104:107]
 v_exp_f32 v16, v16
 MM v[4:7], v[40:43], a[4:7], v[108:111]
 v_exp_f32_e64 v17, v17
 MM v[12:15], v[44:47], a[4:7], v[108:111]
 ds_read_b128 v[72:75], v113 offset:8192
 v_add_f32_e64 v118, v118, v16
 MM v[8:11], v[44:47], a[0:3], v[104:107]
 ds_read_b128 v[76:79], v113 offset:8448
 CB v32, v16, v17
 MM v[0:3], v[48:51], a[8:11], v[0:3]
 ds_read_b128 v[80:83], v113 offset:10240
 v_add_f32_e64 v118, v118, v17
 MM v[4:7], v[48:51], a[12:15], v[4:7]
 v_exp_f32_e64 v18, v18
 MM v[12:15], v[52:55], a[12:15], v[12:15]
 v_exp_f32_e64 v19, v19
 MM v[8:11], v[52:55], a[8:11], v[8:11]
 ds_read_b128 v[84:87], v113 offset:10496
 s_waitcnt lgkmcnt(4)
 MM v[0:3], v[56:59], a[16:19], v[0:3]
 ds_read_b128 v[88:91], v113 offset:12288
 v_add_f32 v118, v118, v18
 MM v[4:7], v[56:59], a[20:23], v[4:7]
 ds_read_b128 v[92:95], v113 offset:12544
 CB v33, v18, v19
 MM v[12:15], v[60:63], a[20:23], v[12:15]
 ds_read_b128 v[96:99], v113 offset:14336
 v_add_f32_e64 v118, v118, v19
 MM v[8:11], v[60:63], a[16:19], v[8:11]
 v_exp_f32_e64 v24, v24
 MM v[0:3], v[64:67], a[24:27], v[0:3]
 v_exp_f32_e64 v25, v25
 MM v[4:7], v[64:67], a[28:31], v[4:7]
 ds_read_b128 v[100:103], v113 offset:14592
 v_add_f32_e64 v118, v118, v24
 MM v[12:15], v[68:71], a[28:31], v[12:15]
 ds_read_b128 v[40:43], v113 offset:16384
 CB v34, v24, v25
 MM v[8:11], v[68:71], a[24:27], v[8:11]
 ds_read_b128 v[44:47], v113 offset:16640
 s_waitcnt lgkmcnt(6)
 MM v[0:3], v[72:75], a[32:35], v[0:3]
 ds_read_b128 v[48:51], v113 offset:18432
 v_add_f32 v118, v118, v25
 MM v[4:7], v[72:75], a[36:39], v[4:7]
 v_exp_f32_e64 v26, v26
 MM v[12:15], v[76:79], a[36:39], v[12:15]
 v_exp_f32_e64 v27, v27
 MM v[8:11], v[76:79], a[32:35], v[8:11]
 ds_read_b128 v[52:55], v113 offset:18688
 v_add_f32_e64 v118, v118, v26
 MM v[0:3], v[80:83], a[40:43], v[0:3]
 ds_read_b128 v[56:59], v113 offset:20480
 CB v35, v26, v27
 MM v[4:7], v[80:83], a[44:47], v[4:7]
 ds_read_b128 v[60:63], v113 offset:20736
 v_add_f32_e64 v118, v118, v27
 MM v[12:15], v[84:87], a[44:47], v[12:15]
 v_exp_f32_e64 v20, v20
 MM v[8:11], v[84:87], a[40:43], v[8:11]
 ds_read_b128 v[64:67], v113 offset:22528
 s_waitcnt lgkmcnt(7)
 MM v[0:3], v[88:91], a[48:51], v[0:3]
 v_exp_f32 v21, v21
 MM v[4:7], v[88:91], a[52:55], v[4:7]
 ds_read_b128 v[68:71], v113 offset:22784
 v_add_f32_e64 v119, v119, v20
 MM v[12:15], v[92:95], a[52:55], v[12:15]
 ds_read_b128 v[72:75], v113 offset:24576
 CB v36, v20, v21
 MM v[8:11], v[92:95], a[48:51], v[8:11]
 ds_read_b128 v[76:79], v113 offset:24832
 v_add_f32_e64 v119, v119, v21
 MM v[0:3], v[96:99], a[56:59], v[0:3]
 v_exp_f32_e64 v22, v22
 MM v[4:7], v[96:99], a[60:63], v[4:7]
 v_exp_f32_e64 v23, v23
 MM v[12:15], v[100:103], a[60:63], v[12:15]
 ds_read_b128 v[80:83], v113 offset:26624
 v_add_f32_e64 v119, v119, v22
 MM v[8:11], v[100:103], a[56:59], v[8:11]
 ds_read_b128 v[84:87], v113 offset:26880
 s_waitcnt lgkmcnt(8)
 MM v[0:3], v[40:43], a[64:67], v[0:3]
 CB v37, v22, v23
 v_add_f32 v119, v119, v23
 MM v[4:7], v[40:43], a[68:71], v[4:7]
 v_exp_f32_e64 v28, v28
 MM v[12:15], v[44:47], a[68:71], v[12:15]
 v_exp_f32_e64 v29, v29
 MM v[8:11], v[44:47], a[64:67], v[8:11]
 ds_read_b128 v[88:91], v113 offset:28672
 v_add_f32_e64 v119, v119, v28
 MM v[0:3], v[48:51], a[72:75], v[0:3]
 ds_read_b128 v[92:95], v113 offset:28928
 CB v38, v28, v29
 MM v[4:7], v[48:51], a[76:79], v[4:7]
 ds_read_b128 v[96:99], v113 offset:30720
 v_add_f32_e64 v119, v119, v29
 MM v[12:15], v[52:55], a[76:79], v[12:15]
 v_exp_f32_e64 v30, v30
 MM v[8:11], v[52:55], a[72:75], v[8:11]
 ds_read_b128 v[100:103], v113 offset:30976
 s_waitcnt lgkmcnt(8)
 MM v[0:3], v[56:59], a[80:83], v[0:3]
 v_exp_f32 v31, v31
 MM v[4:7], v[56:59], a[84:87], v[4:7]
 ds_read_b64_tr_b16 v[40:41], v114 offset:32768
 v_add_f32_e64 v119, v119, v30
 MM v[12:15], v[60:63], a[84:87], v[12:15]
 ds_read_b64_tr_b16 v[42:43], v114 offset:33024
 CB v39, v30, v31
 MM v[8:11], v[60:63], a[80:83], v[8:11]
 ds_read_b64_tr_b16 v[44:45], v114 offset:33792
 v_add_f32_e64 v119, v119, v31
 MM v[0:3], v[64:67], a[88:91], v[0:3]
 ds_read_b64_tr_b16 v[46:47], v114 offset:34048
 MM v[4:7], v[64:67], a[92:95], v[4:7]
 ds_read_b64_tr_b16 v[48:49], v114 offset:34816
 MM v[12:15], v[68:71], a[92:95], v[12:15]
 ds_read_b64_tr_b16 v[50:51], v114 offset:35072
 MM v[8:11], v[68:71], a[88:91], v[8:11]
 ds_read_b64_tr_b16 v[52:53], v114 offset:35840
 s_waitcnt lgkmcnt(11)
 MM v[0:3], v[72:75], a[96:99], v[0:3]
 ds_read_b64_tr_b16 v[54:55], v114 offset:36096
 MM v[4:7], v[72:75], a[100:103], v[4:7]
 ds_read_b64_tr_b16 v[56:57], v114 offset:36864
 MM v[12:15], v[76:79], a[100:103], v[12:15]
 ds_read_b64_tr_b16 v[58:59], v114 offset:37120
 MM v[8:11], v[76:79], a[96:99], v[8:11]
 ds_read_b64_tr_b16 v[60:61], v114 offset:37888
 MM v[0:3], v[80:83], a[104:107], v[0:3]
 ds_read_b64_tr_b16 v[62:63], v114 offset:38144
 MM v[4:7], v[80:83], a[108:111], v[4:7]
 ds_read_b64_tr_b16 v[64:65], v114 offset:38912
 MM v[12:15], v[84:87], a[108:111], v[12:15]
 ds_read_b64_tr_b16 v[66:67], v114 offset:39168
 MM v[8:11], v[84:87], a[104:107], v[8:11]
 ds_read_b64_tr_b16 v[68:69], v114 offset:39936
 s_waitcnt lgkmcnt(15)
 MM v[0:3], v[88:91], a[112:115], v[0:3]
 ds_read_b64_tr_b16 v[70:71], v114 offset:40192
 MM v[4:7], v[88:91], a[116:119], v[4:7]
 ds_read_b64_tr_b16 v[72:73], v114 offset:40960
 MM v[12:15], v[92:95], a[116:119], v[12:15]
 ds_read_b64_tr_b16 v[74:75], v114 offset:41216
 MM v[8:11], v[92:95], a[112:115], v[8:11]
 ds_read_b64_tr_b16 v[76:77], v114 offset:41984
 MM v[0:3], v[96:99], a[120:123], v[0:3]
 ds_read_b64_tr_b16 v[78:79], v114 offset:42240
 MM v[4:7], v[96:99], a[124:127], v[4:7]
 ds_read_b64_tr_b16 v[80:81], v114 offset:43008
 MM v[12:15], v[100:103], a[124:127], v[12:15]
 ds_read_b64_tr_b16 v[82:83], v114 offset:43264
 MM v[8:11], v[100:103], a[120:123], v[8:11]
 ds_read_b64_tr_b16 v[84:85], v114 offset:44032
 s_waitcnt lgkmcnt(15)
 MM v[128:131], v[40:43], v[32:35], v[128:131]
 ds_read_b64_tr_b16 v[86:87], v114 offset:44288
 s_add_u32 m0, s41, 0
 MM v[132:135], v[40:43], v[36:39], v[132:135]
 ds_read_b64_tr_b16 v[88:89], v114 offset:45056
 buffer_load_dwordx4 v116, s[8:11], s42 offen offset:0 lds
 MM v[140:143], v[44:47], v[36:39], v[140:143]
 ds_read_b64_tr_b16 v[90:91], v114 offset:45312
 MM v[136:139], v[44:47], v[32:35], v[136:139]
 ds_read_b64_tr_b16 v[92:93], v114 offset:46080
 MM v[144:147], v[48:51], v[32:35], v[144:147]
 ds_read_b64_tr_b16 v[94:95], v114 offset:46336
 MM v[148:151], v[48:51], v[36:39], v[148:151]
 ds_read_b64_tr_b16 v[96:97], v114 offset:47104
 v_max3_f32 v120, v0, v1, v2
 MM v[156:159], v[52:55], v[36:39], v[156:159]
 ds_read_b64_tr_b16 v[98:99], v114 offset:47360
 buffer_load_dwordx4 v116, s[8:11], s42 offen offset:1024 lds
 MM v[152:155], v[52:55], v[32:35], v[152:155]
 ds_read_b64_tr_b16 v[100:101], v114 offset:48128
 s_waitcnt lgkmcnt(15)
 MM v[160:163], v[56:59], v[32:35], v[160:163]
 ds_read_b64_tr_b16 v[102:103], v114 offset:48384
 v_max3_f32 v120, v120, v3, v4
 MM v[164:167], v[56:59], v[36:39], v[164:167]
 ds_read_b64_tr_b16 v[40:41], v114 offset:49152
 v_max3_f32 v120, v120, v5, v6
 MM v[172:175], v[60:63], v[36:39], v[172:175]
 ds_read_b64_tr_b16 v[42:43], v114 offset:49408
 v_max3_f32 v120, v120, v7, v8
 MM v[168:171], v[60:63], v[32:35], v[168:171]
 ds_read_b64_tr_b16 v[44:45], v114 offset:50176
 buffer_load_dwordx4 v116, s[8:11], s42 offen offset:2048 lds
 MM v[176:179], v[64:67], v[32:35], v[176:179]
 ds_read_b64_tr_b16 v[46:47], v114 offset:50432
 v_max3_f32 v120, v120, v9, v10
 MM v[180:183], v[64:67], v[36:39], v[180:183]
 ds_read_b64_tr_b16 v[48:49], v114 offset:51200
 v_max3_f32 v120, v120, v11, v12
 MM v[188:191], v[68:71], v[36:39], v[188:191]
 ds_read_b64_tr_b16 v[50:51], v114 offset:51456
 v_max3_f32 v120, v120, v13, v14
 MM v[184:187], v[68:71], v[32:35], v[184:187]
 ds_read_b64_tr_b16 v[52:53], v114 offset:52224
 s_waitcnt lgkmcnt(15)
 MM v[192:195], v[72:75], v[32:35], v[192:195]
 ds_read_b64_tr_b16 v[54:55], v114 offset:52480
 buffer_load_dwordx4 v116, s[8:11], s42 offen offset:3072 lds
 MM v[196:199], v[72:75], v[36:39], v[196:199]
 ds_read_b64_tr_b16 v[56:57], v114 offset:53248
 v_max_f32_e64 v120, v120, v15
 MM v[204:207], v[76:79], v[36:39], v[204:207]
 ds_read_b64_tr_b16 v[58:59], v114 offset:53504
 v_cmp_lt_f32 vcc, 0x41000000, v120
 MM v[200:203], v[76:79], v[32:35], v[200:203]
 ds_read_b64_tr_b16 v[60:61], v114 offset:54272
 MM v[208:211], v[80:83], v[32:35], v[208:211]
 ds_read_b64_tr_b16 v[62:63], v114 offset:54528
 s_add_u32 m0, s41, 4096
 MM v[212:215], v[80:83], v[36:39], v[212:215]
 ds_read_b64_tr_b16 v[64:65], v114 offset:55296
 buffer_load_dwordx4 v117, s[8:11], s42 offen offset:0 lds
 MM v[220:223], v[84:87], v[36:39], v[220:223]
 ds_read_b64_tr_b16 v[66:67], v114 offset:55552
 MM v[216:219], v[84:87], v[32:35], v[216:219]
 ds_read_b64_tr_b16 v[68:69], v114 offset:56320
 s_waitcnt lgkmcnt(15)
 MM v[224:227], v[88:91], v[32:35], v[224:227]
 ds_read_b64_tr_b16 v[70:71], v114 offset:56576
 MM v[228:231], v[88:91], v[36:39], v[228:231]
 ds_read_b64_tr_b16 v[72:73], v114 offset:57344
 MM v[236:239], v[92:95], v[36:39], v[236:239]
 ds_read_b64_tr_b16 v[74:75], v114 offset:57600
 buffer_load_dwordx4 v117, s[8:11], s42 offen offset:1024 lds
 MM v[232:235], v[92:95], v[32:35], v[232:235]
 ds_read_b64_tr_b16 v[76:77], v114 offset:58368
 MM v[240:243], v[96:99], v[32:35], v[240:243]
 ds_read_b64_tr_b16 v[78:79], v114 offset:58624
 MM v[244:247], v[96:99], v[36:39], v[244:247]
 ds_read_b64_tr_b16 v[80:81], v114 offset:59392
 MM v[252:255], v[100:103], v[36:39], v[252:255]
 ds_read_b64_tr_b16 v[82:83], v114 offset:59648
 MM v[248:251], v[100:103], v[32:35], v[248:251]
 ds_read_b64_tr_b16 v[84:85], v114 offset:60416
 s_waitcnt lgkmcnt(15)
 MM a[128:131], v[40:43], v[32:35], a[128:131]
 ds_read_b64_tr_b16 v[86:87], v114 offset:60672
 buffer_load_dwordx4 v117, s[8:11], s42 offen offset:2048 lds
 MM a[132:135], v[40:43], v[36:39], a[132:135]
 ds_read_b64_tr_b16 v[88:89], v114 offset:61440
 MM a[140:143], v[44:47], v[36:39], a[140:143]
 ds_read_b64_tr_b16 v[90:91], v114 offset:61696
 MM a[136:139], v[44:47], v[32:35], a[136:139]
 ds_read_b64_tr_b16 v[92:93], v114 offset:62464
 MM a[144:147], v[48:51], v[32:35], a[144:147]
 ds_read_b64_tr_b16 v[94:95], v114 offset:62720
 buffer_load_dwordx4 v117, s[8:11], s42 offen offset:3072 lds
 MM a[148:151], v[48:51], v[36:39], a[148:151]
 ds_read_b64_tr_b16 v[96:97], v114 offset:63488
 s_add_u32 s42, s42, 0x8000
 MM a[156:159], v[52:55], v[36:39], a[156:159]
 ds_read_b64_tr_b16 v[98:99], v114 offset:63744
 MM a[152:155], v[52:55], v[32:35], a[152:155]
 ds_read_b64_tr_b16 v[100:101], v114 offset:64512
 s_waitcnt lgkmcnt(15)
 MM a[160:163], v[56:59], v[32:35], a[160:163]
 ds_read_b64_tr_b16 v[102:103], v114 offset:64768
 MM a[164:167], v[56:59], v[36:39], a[164:167]
 MM a[172:175], v[60:63], v[36:39], a[172:175]
 MM a[168:171], v[60:63], v[32:35], a[168:171]
 MM a[176:179], v[64:67], v[32:35], a[176:179]
 MM a[180:183], v[64:67], v[36:39], a[180:183]
 MM a[188:191], v[68:71], v[36:39], a[188:191]
 MM a[184:187], v[68:71], v[32:35], a[184:187]
 s_waitcnt vmcnt(8) lgkmcnt(0)
 s_barrier
 MM a[192:195], v[72:75], v[32:35], a[192:195]
 ds_read_b128 v[40:43], v113 offset:32768
 MM a[196:199], v[72:75], v[36:39], a[196:199]
 ds_read_b128 v[44:47], v113 offset:33024
 MM a[204:207], v[76:79], v[36:39], a[204:207]
 ds_read_b128 v[48:51], v113 offset:34816
 MM a[200:203], v[76:79], v[32:35], a[200:203]
 ds_read_b128 v[52:55], v113 offset:35072
 MM a[208:211], v[80:83], v[32:35], a[208:211]
 ds_read_b128 v[56:59], v113 offset:36864
 MM a[212:215], v[80:83], v[36:39], a[212:215]
 ds_read_b128 v[60:63], v113 offset:37120
 MM a[220:223], v[84:87], v[36:39], a[220:223]
 ds_read_b128 v[64:67], v113 offset:38912
 MM a[216:219], v[84:87], v[32:35], a[216:219]
 ds_read_b128 v[68:71], v113 offset:39168
 MM a[224:227], v[88:91], v[32:35], a[224:227]
 MM a[228:231], v[88:91], v[36:39], a[228:231]
 MM a[236:239], v[92:95], v[36:39], a[236:239]
 MM a[232:235], v[92:95], v[32:35], a[232:235]
 MM a[240:243], v[96:99], v[32:35], a[240:243]
 s_add_u32 s16, s16, 1
 MM a[244:247], v[96:99], v[36:39], a[244:247]
 s_cmp_eq_u32 s16, s17
 MM a[252:255], v[100:103], v[36:39], a[252:255]
 s_waitcnt lgkmcnt(4)
 MM a[248:251], v[100:103], v[32:35], a[248:251]
 s_cbranch_vccnz attn_kernel_rare1
attn_kernel_back1:
 s_cbranch_scc1 attn_kernel_final2
 MM v[16:19], v[40:43], a[0:3], v[104:107]
 v_exp_f32_e64 v0, v0
 MM v[20:23], v[40:43], a[4:7], v[108:111]
 v_exp_f32_e64 v1, v1
 MM v[28:31], v[44:47], a[4:7], v[108:111]
 ds_read_b128 v[72:75], v113 offset:40960
 v_add_f32_e64 v118, v118, v0
 MM v[24:27], v[44:47], a[0:3], v[104:107]
 ds_read_b128 v[76:79], v113 offset:41216
 CB v32, v0, v1
 MM v[16:19], v[48:51], a[8:11], v[16:19]
 ds_read_b128 v[80:83], v113 offset:43008
 v_add_f32_e64 v118, v118, v1
 MM v[20:23], v[48:51], a[12:15], v[20:23]
 v_exp_f32_e64 v2, v2
 MM v[28:31], v[52:55], a[12:15], v[28:31]
 v_exp_f32_e64 v3, v3
 MM v[24:27], v[52:55], a[8:11], v[24:27]
 ds_read_b128 v[84:87], v113 offset:43264
 s_waitcnt lgkmcnt(4)
 MM v[16:19], v[56:59], a[16:19], v[16:19]
 ds_read_b128 v[88:91], v113 offset:45056
 v_add_f32 v118, v118, v2
 MM v[20:23], v[56:59], a[20:23], v[20:23]
 ds_read_b128 v[92:95], v113 offset:45312
 CB v33, v2, v3
 MM v[28:31], v[60:63], a[20:23], v[28:31]
 ds_read_b128 v[96:99], v113 offset:47104
 v_add_f32_e64 v118, v118, v3
 MM v[24:27], v[60:63], a[16:19], v[24:27]
 v_exp_f32_e64 v8, v8
 MM v[16:19], v[64:67], a[24:27], v[16:19]
 v_exp_f32_e64 v9, v9
 MM v[20:23], v[64:67], a[28:31], v[20:23]
 ds_read_b128 v[100:103], v113 offset:47360
 v_add_f32_e64 v118, v118, v8
 MM v[28:31], v[68:71], a[28:31], v[28:31]
 ds_read_b128 v[40:43], v113 offset:49152
 CB v34, v8, v9
 MM v[24:27], v[68:71], a[24:27], v[24:27]
 ds_read_b128 v[44:47], v113 offset:49408
 s_waitcnt lgkmcnt(6)
 MM v[16:19], v[72:75], a[32:35], v[16:19]
 ds_read_b128 v[48:51], v113 offset:51200
 v_add_f32 v118, v118, v9
 MM v[20:23], v[72:75], a[36:39], v[20:23]
 v_exp_f32_e64 v10, v10
 MM v[28:31], v[76:79], a[36:39], v[28:31]
 v_exp_f32_e64 v11, v11
 MM v[24:27], v[76:79], a[32:35], v[24:27]
 ds_read_b128 v[52:55], v113 offset:51456
 v_add_f32_e64 v118, v118, v10
 MM v[16:19], v[80:83], a[40:43], v[16:19]
 ds_read_b128 v[56:59], v113 offset:53248
 CB v35, v10, v11
 MM v[20:23], v[80:83], a[44:47], v[20:23]
 ds_read_b128 v[60:63], v113 offset:53504
 v_add_f32_e64 v118, v118, v11
 MM v[28:31], v[84:87], a[44:47], v[28:31]
 v_exp_f32_e64 v4, v4
 MM v[24:27], v[84:87], a[40:43], v[24:27]
 ds_read_b128 v[64:67], v113 offset:55296
 s_waitcnt lgkmcnt(7)
 MM v[16:19], v[88:91], a[48:51], v[16:19]
 v_exp_f32 v5, v5
 MM v[20:23], v[88:91], a[52:55], v[20:23]
 ds_read_b128 v[68:71], v113 offset:55552
 v_add_f32_e64 v119, v119, v4
 MM v[28:31], v[92:95], a[52:55], v[28:31]
 ds_read_b128 v[72:75], v113 offset:57344
 CB v36, v4, v5
 MM v[24:27], v[92:95], a[48:51], v[24:27]
 ds_read_b128 v[76:79], v113 offset:57600
 v_add_f32_e64 v119, v119, v5
 MM v[16:19], v[96:99], a[56:59], v[16:19]
 v_exp_f32_e64 v6, v6
 MM v[20:23], v[96:99], a[60:63], v[20:23]
 v_exp_f32_e64 v7, v7
 MM v[28:31], v[100:103], a[60:63], v[28:31]
 ds_read_b128 v[80:83], v113 offset:59392
 v_add_f32_e64 v119, v119, v6
 MM v[24:27], v[100:103], a[56:59], v[24:27]
 ds_read_b128 v[84:87], v113 offset:59648
 s_waitcnt lgkmcnt(8)
 MM v[16:19], v[40:43], a[64:67], v[16:19]
 CB v37, v6, v7
 v_add_f32 v119, v119, v7
 MM v[20:23], v[40:43], a[68:71], v[20:23]
 v_exp_f32_e64 v12, v12
 MM v[28:31], v[44:47], a[68:71], v[28:31]
 v_exp_f32_e64 v13, v13
 MM v[24:27], v[44:47], a[64:67], v[24:27]
 ds_read_b128 v[88:91], v113 offset:61440
 v_add_f32_e64 v119, v119, v12
 MM v[16:19], v[48:51], a[72:75], v[16:19]
 ds_read_b128 v[92:95], v113 offset:61696
 CB v38, v12, v13
 MM v[20:23], v[48:51], a[76:79], v[20:23]
 ds_read_b128 v[96:99], v113 offset:63488
 v_add_f32_e64 v119, v119, v13
 MM v[28:31], v[52:55], a[76:79], v[28:31]
 v_exp_f32_e64 v14, v14
 MM v[24:27], v[52:55], a[72:75], v[24:27]
 ds_read_b128 v[100:103], v113 offset:63744
 s_waitcnt lgkmcnt(8)
 MM v[16:19], v[56:59], a[80:83], v[16:19]
 v_exp_f32 v15, v15
 MM v[20:23], v[56:59], a[84:87], v[20:23]
 ds_read_b64_tr_b16 v[40:41], v115 offset:0
 v_add_f32_e64 v119, v119, v14
 MM v[28:31], v[60:63], a[84:87], v[28:31]
 ds_read_b64_tr_b16 v[42:43], v115 offset:256
 CB v39, v14, v15
 MM v[24:27], v[60:63], a[80:83], v[24:27]
 ds_read_b64_tr_b16 v[44:45], v115 offset:1024
 v_add_f32_e64 v119, v119, v15
 MM v[16:19], v[64:67], a[88:91], v[16:19]
 ds_read_b64_tr_b16 v[46:47], v115 offset:1280
 MM v[20:23], v[64:67], a[92:95], v[20:23]
 ds_read_b64_tr_b16 v[48:49], v115 offset:2048
 MM v[28:31], v[68:71], a[92:95], v[28:31]
 ds_read_b64_tr_b16 v[50:51], v115 offset:2304
 MM v[24:27], v[68:71], a[88:91], v[24:27]
 ds_read_b64_tr_b16 v[52:53], v115 offset:3072
 s_waitcnt lgkmcnt(11)
 MM v[16:19], v[72:75], a[96:99], v[16:19]
 ds_read_b64_tr_b16 v[54:55], v115 offset:3328
 MM v[20:23], v[72:75], a[100:103], v[20:23]
 ds_read_b64_tr_b16 v[56:57], v115 offset:4096
 MM v[28:31], v[76:79], a[100:103], v[28:31]
 ds_read_b64_tr_b16 v[58:59], v115 offset:4352
 MM v[24:27], v[76:79], a[96:99], v[24:27]
 ds_read_b64_tr_b16 v[60:61], v115 offset:5120
 MM v[16:19], v[80:83], a[104:107], v[16:19]
 ds_read_b64_tr_b16 v[62:63], v115 offset:5376
 MM v[20:23], v[80:83], a[108:111], v[20:23]
 ds_read_b64_tr_b16 v[64:65], v115 offset:6144
 MM v[28:31], v[84:87], a[108:111], v[28:31]
 ds_read_b64_tr_b16 v[66:67], v115 offset:6400
 MM v[24:27], v[84:87], a[104:107], v[24:27]
 ds_read_b64_tr_b16 v[68:69], v115 offset:7168
 s_waitcnt lgkmcnt(15)
 MM v[16:19], v[88:91], a[112:115], v[16:19]
 ds_read_b64_tr_b16 v[70:71], v115 offset:7424
 MM v[20:23], v[88:91], a[116:119], v[20:23]
 ds_read_b64_tr_b16 v[72:73], v115 offset:8192
 MM v[28:31], v[92:95], a[116:119], v[28:31]
 ds_read_b64_tr_b16 v[74:75], v115 offset:8448
 MM v[24:27], v[92:95], a[112:115], v[24:27]
 ds_read_b64_tr_b16 v[76:77], v115 offset:9216
 MM v[16:19], v[96:99], a[120:123], v[16:19]
 ds_read_b64_tr_b16 v[78:79], v115 offset:9472
 MM v[20:23], v[96:99], a[124:127], v[20:23]
 ds_read_b64_tr_b16 v[80:81], v115 offset:10240
 MM v[28:31], v[100:103], a[124:127], v[28:31]
 ds_read_b64_tr_b16 v[82:83], v115 offset:10496
 MM v[24:27], v[100:103], a[120:123], v[24:27]
 ds_read_b64_tr_b16 v[84:85], v115 offset:11264
 s_waitcnt lgkmcnt(15)
 MM v[128:131], v[40:43], v[32:35], v[128:131]
 ds_read_b64_tr_b16 v[86:87], v115 offset:11520
 s_add_u32 m0, s41, 32768
 MM v[132:135], v[40:43], v[36:39], v[132:135]
 ds_read_b64_tr_b16 v[88:89], v115 offset:12288
 buffer_load_dwordx4 v116, s[8:11], s42 offen offset:0 lds
 MM v[140:143], v[44:47], v[36:39], v[140:143]
 ds_read_b64_tr_b16 v[90:91], v115 offset:12544
 MM v[136:139], v[44:47], v[32:35], v[136:139]
 ds_read_b64_tr_b16 v[92:93], v115 offset:13312
 MM v[144:147], v[48:51], v[32:35], v[144:147]
 ds_read_b64_tr_b16 v[94:95], v115 offset:13568
 MM v[148:151], v[48:51], v[36:39], v[148:151]
 ds_read_b64_tr_b16 v[96:97], v115 offset:14336
 v_max3_f32 v120, v16, v17, v18
 MM v[156:159], v[52:55], v[36:39], v[156:159]
 ds_read_b64_tr_b16 v[98:99], v115 offset:14592
 buffer_load_dwordx4 v116, s[8:11], s42 offen offset:1024 lds
 MM v[152:155], v[52:55], v[32:35], v[152:155]
 ds_read_b64_tr_b16 v[100:101], v115 offset:15360
 s_waitcnt lgkmcnt(15)
 MM v[160:163], v[56:59], v[32:35], v[160:163]
 ds_read_b64_tr_b16 v[102:103], v115 offset:15616
 v_max3_f32 v120, v120, v19, v20
 MM v[164:167], v[56:59], v[36:39], v[164:167]
 ds_read_b64_tr_b16 v[40:41], v115 offset:16384
 v_max3_f32 v120, v120, v21, v22
 MM v[172:175], v[60:63], v[36:39], v[172:175]
 ds_read_b64_tr_b16 v[42:43], v115 offset:16640
 v_max3_f32 v120, v120, v23, v24
 MM v[168:171], v[60:63], v[32:35], v[168:171]
 ds_read_b64_tr_b16 v[44:45], v115 offset:17408
 buffer_load_dwordx4 v116, s[8:11], s42 offen offset:2048 lds
 MM v[176:179], v[64:67], v[32:35], v[176:179]
 ds_read_b64_tr_b16 v[46:47], v115 offset:17664
 v_max3_f32 v120, v120, v25, v26
 MM v[180:183], v[64:67], v[36:39], v[180:183]
 ds_read_b64_tr_b16 v[48:49], v115 offset:18432
 v_max3_f32 v120, v120, v27, v28
 MM v[188:191], v[68:71], v[36:39], v[188:191]
 ds_read_b64_tr_b16 v[50:51], v115 offset:18688
 v_max3_f32 v120, v120, v29, v30
 MM v[184:187], v[68:71], v[32:35], v[184:187]
 ds_read_b64_tr_b16 v[52:53], v115 offset:19456
 s_waitcnt lgkmcnt(15)
 MM v[192:195], v[72:75], v[32:35], v[192:195]
 ds_read_b64_tr_b16 v[54:55], v115 offset:19712
 buffer_load_dwordx4 v116, s[8:11], s42 offen offset:3072 lds
 MM v[196:199], v[72:75], v[36:39], v[196:199]
 ds_read_b64_tr_b16 v[56:57], v115 offset:20480
 v_max_f32 v120, v120, v31
 MM v[204:207], v[76:79], v[36:39], v[204:207]
 ds_read_b64_tr_b16 v[58:59], v115 offset:20736
 v_cmp_lt_f32 vcc, 0x41000000, v120
 MM v[200:203], v[76:79], v[32:35], v[200:203]
 ds_read_b64_tr_b16 v[60:61], v115 offset:21504
 MM v[208:211], v[80:83], v[32:35], v[208:211]
 ds_read_b64_tr_b16 v[62:63], v115 offset:21760
 s_add_u32 m0, s41, 36864
 MM v[212:215], v[80:83], v[36:39], v[212:215]
 ds_read_b64_tr_b16 v[64:65], v115 offset:22528
 buffer_load_dwordx4 v117, s[8:11], s42 offen offset:0 lds
 MM v[220:223], v[84:87], v[36:39], v[220:223]
 ds_read_b64_tr_b16 v[66:67], v115 offset:22784
 MM v[216:219], v[84:87], v[32:35], v[216:219]
 ds_read_b64_tr_b16 v[68:69], v115 offset:23552
 s_waitcnt lgkmcnt(15)
 MM v[224:227], v[88:91], v[32:35], v[224:227]
 ds_read_b64_tr_b16 v[70:71], v115 offset:23808
 MM v[228:231], v[88:91], v[36:39], v[228:231]
 ds_read_b64_tr_b16 v[72:73], v115 offset:24576
 MM v[236:239], v[92:95], v[36:39], v[236:239]
 ds_read_b64_tr_b16 v[74:75], v115 offset:24832
 buffer_load_dwordx4 v117, s[8:11], s42 offen offset:1024 lds
 MM v[232:235], v[92:95], v[32:35], v[232:235]
 ds_read_b64_tr_b16 v[76:77], v115 offset:25600
 MM v[240:243], v[96:99], v[32:35], v[240:243]
 ds_read_b64_tr_b16 v[78:79], v115 offset:25856
 MM v[244:247], v[96:99], v[36:39], v[244:247]
 ds_read_b64_tr_b16 v[80:81], v115 offset:26624
 MM v[252:255], v[100:103], v[36:39], v[252:255]
 ds_read_b64_tr_b16 v[82:83], v115 offset:26880
 MM v[248:251], v[100:103], v[32:35], v[248:251]
 ds_read_b64_tr_b16 v[84:85], v115 offset:27648
 s_waitcnt lgkmcnt(15)
 MM a[128:131], v[40:43], v[32:35], a[128:131]
 ds_read_b64_tr_b16 v[86:87], v115 offset:27904
 buffer_load_dwordx4 v117, s[8:11], s42 offen offset:2048 lds
 MM a[132:135], v[40:43], v[36:39], a[132:135]
 ds_read_b64_tr_b16 v[88:89], v115 offset:28672
 MM a[140:143], v[44:47], v[36:39], a[140:143]
 ds_read_b64_tr_b16 v[90:91], v115 offset:28928
 MM a[136:139], v[44:47], v[32:35], a[136:139]
 ds_read_b64_tr_b16 v[92:93], v115 offset:29696
 MM a[144:147], v[48:51], v[32:35], a[144:147]
 ds_read_b64_tr_b16 v[94:95], v115 offset:29952
 buffer_load_dwordx4 v117, s[8:11], s42 offen offset:3072 lds
 MM a[148:151], v[48:51], v[36:39], a[148:151]
 ds_read_b64_tr_b16 v[96:97], v115 offset:30720
 s_add_u32 s42, s42, 0x8000
 MM a[156:159], v[52:55], v[36:39], a[156:159]
 ds_read_b64_tr_b16 v[98:99], v115 offset:30976
 MM a[152:155], v[52:55], v[32:35], a[152:155]
 ds_read_b64_tr_b16 v[100:101], v115 offset:31744
 s_waitcnt lgkmcnt(15)
 MM a[160:163], v[56:59], v[32:35], a[160:163]
 ds_read_b64_tr_b16 v[102:103], v115 offset:32000
 MM a[164:167], v[56:59], v[36:39], a[164:167]
 MM a[172:175], v[60:63], v[36:39], a[172:175]
 MM a[168:171], v[60:63], v[32:35], a[168:171]
 MM a[176:179], v[64:67], v[32:35], a[176:179]
 MM a[180:183], v[64:67], v[36:39], a[180:183]
 MM a[188:191], v[68:71], v[36:39], a[188:191]
 MM a[184:187], v[68:71], v[32:35], a[184:187]
 s_waitcnt vmcnt(8) lgkmcnt(0)
 s_barrier
 MM a[192:195], v[72:75], v[32:35], a[192:195]
 ds_read_b128 v[40:43], v112 offset:0
 MM a[196:199], v[72:75], v[36:39], a[196:199]
 ds_read_b128 v[44:47], v112 offset:256
 MM a[204:207], v[76:79], v[36:39], a[204:207]
 ds_read_b128 v[48:51], v112 offset:2048
 MM a[200:203], v[76:79], v[32:35], a[200:203]
 ds_read_b128 v[52:55], v112 offset:2304
 MM a[208:211], v[80:83], v[32:35], a[208:211]
 ds_read_b128 v[56:59], v112 offset:4096
 MM a[212:215], v[80:83], v[36:39], a[212:215]
 ds_read_b128 v[60:63], v112 offset:4352
 MM a[220:223], v[84:87], v[36:39], a[220:223]
 ds_read_b128 v[64:67], v112 offset:6144
 MM a[216:219], v[84:87], v[32:35], a[216:219]
 ds_read_b128 v[68:71], v112 offset:6400
 MM a[224:227], v[88:91], v[32:35], a[224:227]
 MM a[228:231], v[88:91], v[36:39], a[228:231]
 MM a[236:239], v[92:95], v[36:39], a[236:239]
 MM a[232:235], v[92:95], v[32:35], a[232:235]
 MM a[240:243], v[96:99], v[32:35], a[240:243]
 s_add_u32 s16, s16, 1
 MM a[244:247], v[96:99], v[36:39], a[244:247]
 s_cmp_eq_u32 s16, s17
 MM a[252:255], v[100:103], v[36:39], a[252:255]
 s_waitcnt lgkmcnt(4)
 MM a[248:251], v[100:103], v[32:35], a[248:251]
 s_cbranch_vccnz attn_kernel_rare2
attn_kernel_back2:
 s_cbranch_scc1 attn_kernel_final3
 MM v[0:3], v[40:43], a[0:3], v[104:107]
 v_exp_f32_e64 v16, v16
 MM v[4:7], v[40:43], a[4:7], v[108:111]
 v_exp_f32_e64 v17, v17
 MM v[12:15], v[44:47], a[4:7], v[108:111]
 ds_read_b128 v[72:75], v112 offset:8192
 v_add_f32_e64 v118, v118, v16
 MM v[8:11], v[44:47], a[0:3], v[104:107]
 ds_read_b128 v[76:79], v112 offset:8448
 CB v32, v16, v17
 MM v[0:3], v[48:51], a[8:11], v[0:3]
 ds_read_b128 v[80:83], v112 offset:10240
 v_add_f32_e64 v118, v118, v17
 MM v[4:7], v[48:51], a[12:15], v[4:7]
 v_exp_f32_e64 v18, v18
 MM v[12:15], v[52:55], a[12:15], v[12:15]
 v_exp_f32_e64 v19, v19
 MM v[8:11], v[52:55], a[8:11], v[8:11]
 ds_read_b128 v[84:87], v112 offset:10496
 s_waitcnt lgkmcnt(4)
 MM v[0:3], v[56:59], a[16:19], v[0:3]
 ds_read_b128 v[88:91], v112 offset:12288
 v_add_f32 v118, v118, v18
 MM v[4:7], v[56:59], a[20:23], v[4:7]
 ds_read_b128 v[92:95], v112 offset:12544
 CB v33, v18, v19
 MM v[12:15], v[60:63], a[20:23], v[12:15]
 ds_read_b128 v[96:99], v112 offset:14336
 v_add_f32_e64 v118, v118, v19
 MM v[8:11], v[60:63], a[16:19], v[8:11]
 v_exp_f32_e64 v24, v24
 MM v[0:3], v[64:67], a[24:27], v[0:3]
 v_exp_f32_e64 v25, v25
 MM v[4:7], v[64:67], a[28:31], v[4:7]
 ds_read_b128 v[100:103], v112 offset:14592
 v_add_f32_e64 v118, v118, v24
 MM v[12:15], v[68:71], a[28:31], v[12:15]
 ds_read_b128 v[40:43], v112 offset:16384
 CB v34, v24, v25
 MM v[8:11], v[68:71], a[24:27], v[8:11]
 ds_read_b128 v[44:47], v112 offset:16640
 s_waitcnt lgkmcnt(6)
 MM v[0:3], v[72:75], a[32:35], v[0:3]
 ds_read_b128 v[48:51], v112 offset:18432
 v_add_f32 v118, v118, v25
 MM v[4:7], v[72:75], a[36:39], v[4:7]
 v_exp_f32_e64 v26, v26
 MM v[12:15], v[76:79], a[36:39], v[12:15]
 v_exp_f32_e64 v27, v27
 MM v[8:11], v[76:79], a[32:35], v[8:11]
 ds_read_b128 v[52:55], v112 offset:18688
 v_add_f32_e64 v118, v118, v26
 MM v[0:3], v[80:83], a[40:43], v[0:3]
 ds_read_b128 v[56:59], v112 offset:20480
 CB v35, v26, v27
 MM v[4:7], v[80:83], a[44:47], v[4:7]
 ds_read_b128 v[60:63], v112 offset:20736
 v_add_f32_e64 v118, v118, v27
 MM v[12:15], v[84:87], a[44:47], v[12:15]
 v_exp_f32_e64 v20, v20
 MM v[8:11], v[84:87], a[40:43], v[8:11]
 ds_read_b128 v[64:67], v112 offset:22528
 s_waitcnt lgkmcnt(7)
 MM v[0:3], v[88:91], a[48:51], v[0:3]
 v_exp_f32 v21, v21
 MM v[4:7], v[88:91], a[52:55], v[4:7]
 ds_read_b128 v[68:71], v112 offset:22784
 v_add_f32_e64 v119, v119, v20
 MM v[12:15], v[92:95], a[52:55], v[12:15]
 ds_read_b128 v[72:75], v112 offset:24576
 CB v36, v20, v21
 MM v[8:11], v[92:95], a[48:51], v[8:11]
 ds_read_b128 v[76:79], v112 offset:24832
 v_add_f32_e64 v119, v119, v21
 MM v[0:3], v[96:99], a[56:59], v[0:3]
 v_exp_f32_e64 v22, v22
 MM v[4:7], v[96:99], a[60:63], v[4:7]
 v_exp_f32_e64 v23, v23
 MM v[12:15], v[100:103], a[60:63], v[12:15]
 ds_read_b128 v[80:83], v112 offset:26624
 v_add_f32_e64 v119, v119, v22
 MM v[8:11], v[100:103], a[56:59], v[8:11]
 ds_read_b128 v[84:87], v112 offset:26880
 s_waitcnt lgkmcnt(8)
 MM v[0:3], v[40:43], a[64:67], v[0:3]
 CB v37, v22, v23
 v_add_f32 v119, v119, v23
 MM v[4:7], v[40:43], a[68:71], v[4:7]
 v_exp_f32_e64 v28, v28
 MM v[12:15], v[44:47], a[68:71], v[12:15]
 v_exp_f32_e64 v29, v29
 MM v[8:11], v[44:47], a[64:67], v[8:11]
 ds_read_b128 v[88:91], v112 offset:28672
 v_add_f32_e64 v119, v119, v28
 MM v[0:3], v[48:51], a[72:75], v[0:3]
 ds_read_b128 v[92:95], v112 offset:28928
 CB v38, v28, v29
 MM v[4:7], v[48:51], a[76:79], v[4:7]
 ds_read_b128 v[96:99], v112 offset:30720
 v_add_f32_e64 v119, v119, v29
 MM v[12:15], v[52:55], a[76:79], v[12:15]
 v_exp_f32_e64 v30, v30
 MM v[8:11], v[52:55], a[72:75], v[8:11]
 ds_read_b128 v[100:103], v112 offset:30976
 s_waitcnt lgkmcnt(8)
 MM v[0:3], v[56:59], a[80:83], v[0:3]
 v_exp_f32 v31, v31
 MM v[4:7], v[56:59], a[84:87], v[4:7]
 ds_read_b64_tr_b16 v[40:41], v115 offset:32768
 v_add_f32_e64 v119, v119, v30
 MM v[12:15], v[60:63], a[84:87], v[12:15]
 ds_read_b64_tr_b16 v[42:43], v115 offset:33024
 CB v39, v30, v31
 MM v[8:11], v[60:63], a[80:83], v[8:11]
 ds_read_b64_tr_b16 v[44:45], v115 offset:33792
 v_add_f32_e64 v119, v119, v31
 MM v[0:3], v[64:67], a[88:91], v[0:3]
 ds_read_b64_tr_b16 v[46:47], v115 offset:34048
 MM v[4:7], v[64:67], a[92:95], v[4:7]
 ds_read_b64_tr_b16 v[48:49], v115 offset:34816
 MM v[12:15], v[68:71], a[92:95], v[12:15]
 ds_read_b64_tr_b16 v[50:51], v115 offset:35072
 MM v[8:11], v[68:71], a[88:91], v[8:11]
 ds_read_b64_tr_b16 v[52:53], v115 offset:35840
 s_waitcnt lgkmcnt(11)
 MM v[0:3], v[72:75], a[96:99], v[0:3]
 ds_read_b64_tr_b16 v[54:55], v115 offset:36096
 MM v[4:7], v[72:75], a[100:103], v[4:7]
 ds_read_b64_tr_b16 v[56:57], v115 offset:36864
 MM v[12:15], v[76:79], a[100:103], v[12:15]
 ds_read_b64_tr_b16 v[58:59], v115 offset:37120
 MM v[8:11], v[76:79], a[96:99], v[8:11]
 ds_read_b64_tr_b16 v[60:61], v115 offset:37888
 MM v[0:3], v[80:83], a[104:107], v[0:3]
 ds_read_b64_tr_b16 v[62:63], v115 offset:38144
 MM v[4:7], v[80:83], a[108:111], v[4:7]
 ds_read_b64_tr_b16 v[64:65], v115 offset:38912
 MM v[12:15], v[84:87], a[108:111], v[12:15]
 ds_read_b64_tr_b16 v[66:67], v115 offset:39168
 MM v[8:11], v[84:87], a[104:107], v[8:11]
 ds_read_b64_tr_b16 v[68:69], v115 offset:39936
 s_waitcnt lgkmcnt(15)
 MM v[0:3], v[88:91], a[112:115], v[0:3]
 ds_read_b64_tr_b16 v[70:71], v115 offset:40192
 MM v[4:7], v[88:91], a[116:119], v[4:7]
 ds_read_b64_tr_b16 v[72:73], v115 offset:40960
 MM v[12:15], v[92:95], a[116:119], v[12:15]
 ds_read_b64_tr_b16 v[74:75], v115 offset:41216
 MM v[8:11], v[92:95], a[112:115], v[8:11]
 ds_read_b64_tr_b16 v[76:77], v115 offset:41984
 MM v[0:3], v[96:99], a[120:123], v[0:3]
 ds_read_b64_tr_b16 v[78:79], v115 offset:42240
 MM v[4:7], v[96:99], a[124:127], v[4:7]
 ds_read_b64_tr_b16 v[80:81], v115 offset:43008
 MM v[12:15], v[100:103], a[124:127], v[12:15]
 ds_read_b64_tr_b16 v[82:83], v115 offset:43264
 MM v[8:11], v[100:103], a[120:123], v[8:11]
 ds_read_b64_tr_b16 v[84:85], v115 offset:44032
 s_waitcnt lgkmcnt(15)
 MM v[128:131], v[40:43], v[32:35], v[128:131]
 ds_read_b64_tr_b16 v[86:87], v115 offset:44288
 s_add_u32 m0, s41, 65536
 MM v[132:135], v[40:43], v[36:39], v[132:135]
 ds_read_b64_tr_b16 v[88:89], v115 offset:45056
 buffer_load_dwordx4 v116, s[8:11], s42 offen offset:0 lds
 MM v[140:143], v[44:47], v[36:39], v[140:143]
 ds_read_b64_tr_b16 v[90:91], v115 offset:45312
 MM v[136:139], v[44:47], v[32:35], v[136:139]
 ds_read_b64_tr_b16 v[92:93], v115 offset:46080
 MM v[144:147], v[48:51], v[32:35], v[144:147]
 ds_read_b64_tr_b16 v[94:95], v115 offset:46336
 MM v[148:151], v[48:51], v[36:39], v[148:151]
 ds_read_b64_tr_b16 v[96:97], v115 offset:47104
 v_max3_f32 v120, v0, v1, v2
 MM v[156:159], v[52:55], v[36:39], v[156:159]
 ds_read_b64_tr_b16 v[98:99], v115 offset:47360
 buffer_load_dwordx4 v116, s[8:11], s42 offen offset:1024 lds
 MM v[152:155], v[52:55], v[32:35], v[152:155]
 ds_read_b64_tr_b16 v[100:101], v115 offset:48128
 s_waitcnt lgkmcnt(15)
 MM v[160:163], v[56:59], v[32:35], v[160:163]
 ds_read_b64_tr_b16 v[102:103], v115 offset:48384
 v_max3_f32 v120, v120, v3, v4
 MM v[164:167], v[56:59], v[36:39], v[164:167]
 ds_read_b64_tr_b16 v[40:41], v115 offset:49152
 v_max3_f32 v120, v120, v5, v6
 MM v[172:175], v[60:63], v[36:39], v[172:175]
 ds_read_b64_tr_b16 v[42:43], v115 offset:49408
 v_max3_f32 v120, v120, v7, v8
 MM v[168:171], v[60:63], v[32:35], v[168:171]
 ds_read_b64_tr_b16 v[44:45], v115 offset:50176
 buffer_load_dwordx4 v116, s[8:11], s42 offen offset:2048 lds
 MM v[176:179], v[64:67], v[32:35], v[176:179]
 ds_read_b64_tr_b16 v[46:47], v115 offset:50432
 v_max3_f32 v120, v120, v9, v10
 MM v[180:183], v[64:67], v[36:39], v[180:183]
 ds_read_b64_tr_b16 v[48:49], v115 offset:51200
 v_max3_f32 v120, v120, v11, v12
 MM v[188:191], v[68:71], v[36:39], v[188:191]
 ds_read_b64_tr_b16 v[50:51], v115 offset:51456
 v_max3_f32 v120, v120, v13, v14
 MM v[184:187], v[68:71], v[32:35], v[184:187]
 ds_read_b64_tr_b16 v[52:53], v115 offset:52224
 s_waitcnt lgkmcnt(15)
 MM v[192:195], v[72:75], v[32:35], v[192:195]
 ds_read_b64_tr_b16 v[54:55], v115 offset:52480
 buffer_load_dwordx4 v116, s[8:11], s42 offen offset:3072 lds
 MM v[196:199], v[72:75], v[36:39], v[196:199]
 ds_read_b64_tr_b16 v[56:57], v115 offset:53248
 v_max_f32 v120, v120, v15
 MM v[204:207], v[76:79], v[36:39], v[204:207]
 ds_read_b64_tr_b16 v[58:59], v115 offset:53504
 v_cmp_lt_f32 vcc, 0x41000000, v120
 MM v[200:203], v[76:79], v[32:35], v[200:203]
 ds_read_b64_tr_b16 v[60:61], v115 offset:54272
 MM v[208:211], v[80:83], v[32:35], v[208:211]
 ds_read_b64_tr_b16 v[62:63], v115 offset:54528
 s_add_u32 m0, s41, 69632
 MM v[212:215], v[80:83], v[36:39], v[212:215]
 ds_read_b64_tr_b16 v[64:65], v115 offset:55296
 buffer_load_dwordx4 v117, s[8:11], s42 offen offset:0 lds
 MM v[220:223], v[84:87], v[36:39], v[220:223]
 ds_read_b64_tr_b16 v[66:67], v115 offset:55552
 MM v[216:219], v[84:87], v[32:35], v[216:219]
 ds_read_b64_tr_b16 v[68:69], v115 offset:56320
 s_waitcnt lgkmcnt(15)
 MM v[224:227], v[88:91], v[32:35], v[224:227]
 ds_read_b64_tr_b16 v[70:71], v115 offset:56576
 MM v[228:231], v[88:91], v[36:39], v[228:231]
 ds_read_b64_tr_b16 v[72:73], v115 offset:57344
 MM v[236:239], v[92:95], v[36:39], v[236:239]
 ds_read_b64_tr_b16 v[74:75], v115 offset:57600
 buffer_load_dwordx4 v117, s[8:11], s42 offen offset:1024 lds
 MM v[232:235], v[92:95], v[32:35], v[232:235]
 ds_read_b64_tr_b16 v[76:77], v115 offset:58368
 MM v[240:243], v[96:99], v[32:35], v[240:243]
 ds_read_b64_tr_b16 v[78:79], v115 offset:58624
 MM v[244:247], v[96:99], v[36:39], v[244:247]
 ds_read_b64_tr_b16 v[80:81], v115 offset:59392
 MM v[252:255], v[100:103], v[36:39], v[252:255]
 ds_read_b64_tr_b16 v[82:83], v115 offset:59648
 MM v[248:251], v[100:103], v[32:35], v[248:251]
 ds_read_b64_tr_b16 v[84:85], v115 offset:60416
 s_waitcnt lgkmcnt(15)
 MM a[128:131], v[40:43], v[32:35], a[128:131]
 ds_read_b64_tr_b16 v[86:87], v115 offset:60672
 buffer_load_dwordx4 v117, s[8:11], s42 offen offset:2048 lds
 MM a[132:135], v[40:43], v[36:39], a[132:135]
 ds_read_b64_tr_b16 v[88:89], v115 offset:61440
 MM a[140:143], v[44:47], v[36:39], a[140:143]
 ds_read_b64_tr_b16 v[90:91], v115 offset:61696
 MM a[136:139], v[44:47], v[32:35], a[136:139]
 ds_read_b64_tr_b16 v[92:93], v115 offset:62464
 MM a[144:147], v[48:51], v[32:35], a[144:147]
 ds_read_b64_tr_b16 v[94:95], v115 offset:62720
 buffer_load_dwordx4 v117, s[8:11], s42 offen offset:3072 lds
 MM a[148:151], v[48:51], v[36:39], a[148:151]
 ds_read_b64_tr_b16 v[96:97], v115 offset:63488
 s_add_u32 s42, s42, 0x8000
 MM a[156:159], v[52:55], v[36:39], a[156:159]
 ds_read_b64_tr_b16 v[98:99], v115 offset:63744
 MM a[152:155], v[52:55], v[32:35], a[152:155]
 ds_read_b64_tr_b16 v[100:101], v115 offset:64512
 s_waitcnt lgkmcnt(15)
 MM a[160:163], v[56:59], v[32:35], a[160:163]
 ds_read_b64_tr_b16 v[102:103], v115 offset:64768
 MM a[164:167], v[56:59], v[36:39], a[164:167]
 MM a[172:175], v[60:63], v[36:39], a[172:175]
 MM a[168:171], v[60:63], v[32:35], a[168:171]
 MM a[176:179], v[64:67], v[32:35], a[176:179]
 MM a[180:183], v[64:67], v[36:39], a[180:183]
 MM a[188:191], v[68:71], v[36:39], a[188:191]
 MM a[184:187], v[68:71], v[32:35], a[184:187]
 s_waitcnt vmcnt(8) lgkmcnt(0)
 s_barrier
 MM a[192:195], v[72:75], v[32:35], a[192:195]
 ds_read_b128 v[40:43], v112 offset:32768
 MM a[196:199], v[72:75], v[36:39], a[196:199]
 ds_read_b128 v[44:47], v112 offset:33024
 MM a[204:207], v[76:79], v[36:39], a[204:207]
 ds_read_b128 v[48:51], v112 offset:34816
 MM a[200:203], v[76:79], v[32:35], a[200:203]
 ds_read_b128 v[52:55], v112 offset:35072
 MM a[208:211], v[80:83], v[32:35], a[208:211]
 ds_read_b128 v[56:59], v112 offset:36864
 MM a[212:215], v[80:83], v[36:39], a[212:215]
 ds_read_b128 v[60:63], v112 offset:37120
 MM a[220:223], v[84:87], v[36:39], a[220:223]
 ds_read_b128 v[64:67], v112 offset:38912
 MM a[216:219], v[84:87], v[32:35], a[216:219]
 ds_read_b128 v[68:71], v112 offset:39168
 MM a[224:227], v[88:91], v[32:35], a[224:227]
 MM a[228:231], v[88:91], v[36:39], a[228:231]
 MM a[236:239], v[92:95], v[36:39], a[236:239]
 MM a[232:235], v[92:95], v[32:35], a[232:235]
 MM a[240:243], v[96:99], v[32:35], a[240:243]
 s_add_u32 s16, s16, 1
 MM a[244:247], v[96:99], v[36:39], a[244:247]
 MM a[252:255], v[100:103], v[36:39], a[252:255]
 s_waitcnt lgkmcnt(4)
 MM a[248:251], v[100:103], v[32:35], a[248:251]
 s_cbranch_vccnz attn_kernel_rare3
attn_kernel_back3:
 s_branch attn_kernel_loop
attn_kernel_final2:
 global_load_dword v127, v126, s[4:5] offset:8 sc1
 ds_read_b64_tr_b16 v[40:41], v115 offset:0
 v_exp_f32 v0, v0
 v_exp_f32 v1, v1
 v_add_f32 v118, v118, v0
 ds_read_b64_tr_b16 v[42:43], v115 offset:256
 CB v32, v0, v1
 v_add_f32_e64 v118, v118, v1
 ds_read_b64_tr_b16 v[44:45], v115 offset:1024
 v_exp_f32 v2, v2
 v_exp_f32 v3, v3
 ds_read_b64_tr_b16 v[46:47], v115 offset:1280
 v_add_f32_e64 v118, v118, v2
 CB v33, v2, v3
 ds_read_b64_tr_b16 v[48:49], v115 offset:2048
 v_add_f32 v118, v118, v3
 v_exp_f32 v8, v8
 v_exp_f32_e64 v9, v9
 ds_read_b64_tr_b16 v[50:51], v115 offset:2304
 v_add_f32_e64 v118, v118, v8
 CB v34, v8, v9
 ds_read_b64_tr_b16 v[52:53], v115 offset:3072
 v_add_f32 v118, v118, v9
 v_exp_f32 v10, v10
 ds_read_b64_tr_b16 v[54:55], v115 offset:3328
 v_exp_f32 v11, v11
 v_add_f32 v118, v118, v10
 ds_read_b64_tr_b16 v[56:57], v115 offset:4096
 CB v35, v10, v11
 v_add_f32_e64 v118, v118, v11
 ds_read_b64_tr_b16 v[58:59], v115 offset:4352
 v_exp_f32 v4, v4
 v_exp_f32 v5, v5
 v_add_f32_e64 v119, v119, v4
 ds_read_b64_tr_b16 v[60:61], v115 offset:5120
 CB v36, v4, v5
 v_add_f32_e64 v119, v119, v5
 ds_read_b64_tr_b16 v[62:63], v115 offset:5376
 v_exp_f32 v6, v6
 v_exp_f32 v7, v7
 ds_read_b64_tr_b16 v[64:65], v115 offset:6144
 v_add_f32_e64 v119, v119, v6
 CB v37, v6, v7
 ds_read_b64_tr_b16 v[66:67], v115 offset:6400
 v_add_f32 v119, v119, v7
 v_exp_f32 v12, v12
 v_exp_f32_e64 v13, v13
 ds_read_b64_tr_b16 v[68:69], v115 offset:7168
 v_add_f32_e64 v119, v119, v12
 CB v38, v12, v13
 ds_read_b64_tr_b16 v[70:71], v115 offset:7424
 v_add_f32 v119, v119, v13
 v_exp_f32 v14, v14
 ds_read_b64_tr_b16 v[72:73], v115 offset:8192
 v_exp_f32 v15, v15
 v_add_f32 v119, v119, v14
 ds_read_b64_tr_b16 v[74:75], v115 offset:8448
 CB v39, v14, v15
 v_add_f32_e64 v119, v119, v15
 ds_read_b64_tr_b16 v[76:77], v115 offset:9216
 s_waitcnt lgkmcnt(15)
 MM v[128:131], v[40:43], v[32:35], v[128:131]
 ds_read_b64_tr_b16 v[78:79], v115 offset:9472
 MM v[132:135], v[40:43], v[36:39], v[132:135]
 ds_read_b64_tr_b16 v[80:81], v115 offset:10240
 MM v[140:143], v[44:47], v[36:39], v[140:143]
 ds_read_b64_tr_b16 v[82:83], v115 offset:10496
 MM v[136:139], v[44:47], v[32:35], v[136:139]
 ds_read_b64_tr_b16 v[84:85], v115 offset:11264
 s_waitcnt lgkmcnt(15)
 MM v[144:147], v[48:51], v[32:35], v[144:147]
 ds_read_b64_tr_b16 v[86:87], v115 offset:11520
 MM v[148:151], v[48:51], v[36:39], v[148:151]
 ds_read_b64_tr_b16 v[88:89], v115 offset:12288
 MM v[156:159], v[52:55], v[36:39], v[156:159]
 ds_read_b64_tr_b16 v[90:91], v115 offset:12544
 MM v[152:155], v[52:55], v[32:35], v[152:155]
 ds_read_b64_tr_b16 v[92:93], v115 offset:13312
 s_waitcnt lgkmcnt(15)
 MM v[160:163], v[56:59], v[32:35], v[160:163]
 ds_read_b64_tr_b16 v[94:95], v115 offset:13568
 MM v[164:167], v[56:59], v[36:39], v[164:167]
 ds_read_b64_tr_b16 v[96:97], v115 offset:14336
 MM v[172:175], v[60:63], v[36:39], v[172:175]
 ds_read_b64_tr_b16 v[98:99], v115 offset:14592
 MM v[168:171], v[60:63], v[32:35], v[168:171]
 ds_read_b64_tr_b16 v[100:101], v115 offset:15360
 s_waitcnt lgkmcnt(15)
 MM v[176:179], v[64:67], v[32:35], v[176:179]
 ds_read_b64_tr_b16 v[102:103], v115 offset:15616
 MM v[180:183], v[64:67], v[36:39], v[180:183]
 ds_read_b64_tr_b16 v[40:41], v115 offset:16384
 MM v[188:191], v[68:71], v[36:39], v[188:191]
 ds_read_b64_tr_b16 v[42:43], v115 offset:16640
 MM v[184:187], v[68:71], v[32:35], v[184:187]
 ds_read_b64_tr_b16 v[44:45], v115 offset:17408
 s_waitcnt lgkmcnt(15)
 MM v[192:195], v[72:75], v[32:35], v[192:195]
 ds_read_b64_tr_b16 v[46:47], v115 offset:17664
 MM v[196:199], v[72:75], v[36:39], v[196:199]
 ds_read_b64_tr_b16 v[48:49], v115 offset:18432
 MM v[204:207], v[76:79], v[36:39], v[204:207]
 ds_read_b64_tr_b16 v[50:51], v115 offset:18688
 MM v[200:203], v[76:79], v[32:35], v[200:203]
 ds_read_b64_tr_b16 v[52:53], v115 offset:19456
 s_waitcnt lgkmcnt(15)
 MM v[208:211], v[80:83], v[32:35], v[208:211]
 ds_read_b64_tr_b16 v[54:55], v115 offset:19712
 MM v[212:215], v[80:83], v[36:39], v[212:215]
 ds_read_b64_tr_b16 v[56:57], v115 offset:20480
 MM v[220:223], v[84:87], v[36:39], v[220:223]
 ds_read_b64_tr_b16 v[58:59], v115 offset:20736
 MM v[216:219], v[84:87], v[32:35], v[216:219]
 ds_read_b64_tr_b16 v[60:61], v115 offset:21504
 s_waitcnt lgkmcnt(15)
 MM v[224:227], v[88:91], v[32:35], v[224:227]
 ds_read_b64_tr_b16 v[62:63], v115 offset:21760
 MM v[228:231], v[88:91], v[36:39], v[228:231]
 ds_read_b64_tr_b16 v[64:65], v115 offset:22528
 MM v[236:239], v[92:95], v[36:39], v[236:239]
 ds_read_b64_tr_b16 v[66:67], v115 offset:22784
 MM v[232:235], v[92:95], v[32:35], v[232:235]
 ds_read_b64_tr_b16 v[68:69], v115 offset:23552
 s_waitcnt lgkmcnt(15)
 MM v[240:243], v[96:99], v[32:35], v[240:243]
 ds_read_b64_tr_b16 v[70:71], v115 offset:23808
 MM v[244:247], v[96:99], v[36:39], v[244:247]
 ds_read_b64_tr_b16 v[72:73], v115 offset:24576
 MM v[252:255], v[100:103], v[36:39], v[252:255]
 ds_read_b64_tr_b16 v[74:75], v115 offset:24832
 MM v[248:251], v[100:103], v[32:35], v[248:251]
 ds_read_b64_tr_b16 v[76:77], v115 offset:25600
 s_waitcnt lgkmcnt(15)
 MM a[128:131], v[40:43], v[32:35], a[128:131]
 ds_read_b64_tr_b16 v[78:79], v115 offset:25856
 MM a[132:135], v[40:43], v[36:39], a[132:135]
 ds_read_b64_tr_b16 v[80:81], v115 offset:26624
 MM a[140:143], v[44:47], v[36:39], a[140:143]
 ds_read_b64_tr_b16 v[82:83], v115 offset:26880
 MM a[136:139], v[44:47], v[32:35], a[136:139]
 ds_read_b64_tr_b16 v[84:85], v115 offset:27648
 s_waitcnt lgkmcnt(15)
 MM a[144:147], v[48:51], v[32:35], a[144:147]
 ds_read_b64_tr_b16 v[86:87], v115 offset:27904
 MM a[148:151], v[48:51], v[36:39], a[148:151]
 ds_read_b64_tr_b16 v[88:89], v115 offset:28672
 MM a[156:159], v[52:55], v[36:39], a[156:159]
 ds_read_b64_tr_b16 v[90:91], v115 offset:28928
 MM a[152:155], v[52:55], v[32:35], a[152:155]
 ds_read_b64_tr_b16 v[92:93], v115 offset:29696
 s_waitcnt lgkmcnt(15)
 MM a[160:163], v[56:59], v[32:35], a[160:163]
 ds_read_b64_tr_b16 v[94:95], v115 offset:29952
 MM a[164:167], v[56:59], v[36:39], a[164:167]
 ds_read_b64_tr_b16 v[96:97], v115 offset:30720
 MM a[172:175], v[60:63], v[36:39], a[172:175]
 ds_read_b64_tr_b16 v[98:99], v115 offset:30976
 MM a[168:171], v[60:63], v[32:35], a[168:171]
 ds_read_b64_tr_b16 v[100:101], v115 offset:31744
 s_waitcnt lgkmcnt(15)
 MM a[176:179], v[64:67], v[32:35], a[176:179]
 ds_read_b64_tr_b16 v[102:103], v115 offset:32000
 MM a[180:183], v[64:67], v[36:39], a[180:183]
 MM a[188:191], v[68:71], v[36:39], a[188:191]
 MM a[184:187], v[68:71], v[32:35], a[184:187]
 s_waitcnt lgkmcnt(12)
 MM a[192:195], v[72:75], v[32:35], a[192:195]
 MM a[196:199], v[72:75], v[36:39], a[196:199]
 MM a[204:207], v[76:79], v[36:39], a[204:207]
 MM a[200:203], v[76:79], v[32:35], a[200:203]
 s_waitcnt lgkmcnt(8)
 MM a[208:211], v[80:83], v[32:35], a[208:211]
 MM a[212:215], v[80:83], v[36:39], a[212:215]
 MM a[220:223], v[84:87], v[36:39], a[220:223]
 MM a[216:219], v[84:87], v[32:35], a[216:219]
 s_waitcnt lgkmcnt(4)
 MM a[224:227], v[88:91], v[32:35], a[224:227]
 MM a[228:231], v[88:91], v[36:39], a[228:231]
 MM a[236:239], v[92:95], v[36:39], a[236:239]
 MM a[232:235], v[92:95], v[32:35], a[232:235]
 s_waitcnt lgkmcnt(0)
 MM a[240:243], v[96:99], v[32:35], a[240:243]
 MM a[244:247], v[96:99], v[36:39], a[244:247]
 MM a[252:255], v[100:103], v[36:39], a[252:255]
 MM a[248:251], v[100:103], v[32:35], a[248:251]
 s_branch attn_kernel_epi
attn_kernel_final3:
 global_load_dword v127, v126, s[4:5] offset:8 sc1
 ds_read_b64_tr_b16 v[40:41], v115 offset:32768
 v_exp_f32 v16, v16
 v_exp_f32 v17, v17
 v_add_f32 v118, v118, v16
 ds_read_b64_tr_b16 v[42:43], v115 offset:33024
 CB v32, v16, v17
 v_add_f32_e64 v118, v118, v17
 ds_read_b64_tr_b16 v[44:45], v115 offset:33792
 v_exp_f32 v18, v18
 v_exp_f32 v19, v19
 ds_read_b64_tr_b16 v[46:47], v115 offset:34048
 v_add_f32_e64 v118, v118, v18
 CB v33, v18, v19
 ds_read_b64_tr_b16 v[48:49], v115 offset:34816
 v_add_f32 v118, v118, v19
 v_exp_f32 v24, v24
 v_exp_f32_e64 v25, v25
 ds_read_b64_tr_b16 v[50:51], v115 offset:35072
 v_add_f32_e64 v118, v118, v24
 CB v34, v24, v25
 ds_read_b64_tr_b16 v[52:53], v115 offset:35840
 v_add_f32 v118, v118, v25
 v_exp_f32 v26, v26
 ds_read_b64_tr_b16 v[54:55], v115 offset:36096
 v_exp_f32 v27, v27
 v_add_f32 v118, v118, v26
 ds_read_b64_tr_b16 v[56:57], v115 offset:36864
 CB v35, v26, v27
 v_add_f32_e64 v118, v118, v27
 ds_read_b64_tr_b16 v[58:59], v115 offset:37120
 v_exp_f32 v20, v20
 v_exp_f32 v21, v21
 v_add_f32_e64 v119, v119, v20
 ds_read_b64_tr_b16 v[60:61], v115 offset:37888
 CB v36, v20, v21
 v_add_f32_e64 v119, v119, v21
 ds_read_b64_tr_b16 v[62:63], v115 offset:38144
 v_exp_f32 v22, v22
 v_exp_f32 v23, v23
 ds_read_b64_tr_b16 v[64:65], v115 offset:38912
 v_add_f32_e64 v119, v119, v22
 CB v37, v22, v23
 ds_read_b64_tr_b16 v[66:67], v115 offset:39168
 v_add_f32 v119, v119, v23
 v_exp_f32 v28, v28
 v_exp_f32_e64 v29, v29
 ds_read_b64_tr_b16 v[68:69], v115 offset:39936
 v_add_f32_e64 v119, v119, v28
 CB v38, v28, v29
 ds_read_b64_tr_b16 v[70:71], v115 offset:40192
 v_add_f32 v119, v119, v29
 v_exp_f32 v30, v30
 ds_read_b64_tr_b16 v[72:73], v115 offset:40960
 v_exp_f32 v31, v31
 v_add_f32 v119, v119, v30
 ds_read_b64_tr_b16 v[74:75], v115 offset:41216
 CB v39, v30, v31
 v_add_f32_e64 v119, v119, v31
 ds_read_b64_tr_b16 v[76:77], v115 offset:41984
 s_waitcnt lgkmcnt(15)
 MM v[128:131], v[40:43], v[32:35], v[128:131]
 ds_read_b64_tr_b16 v[78:79], v115 offset:42240
 MM v[132:135], v[40:43], v[36:39], v[132:135]
 ds_read_b64_tr_b16 v[80:81], v115 offset:43008
 MM v[140:143], v[44:47], v[36:39], v[140:143]
 ds_read_b64_tr_b16 v[82:83], v115 offset:43264
 MM v[136:139], v[44:47], v[32:35], v[136:139]
 ds_read_b64_tr_b16 v[84:85], v115 offset:44032
 s_waitcnt lgkmcnt(15)
 MM v[144:147], v[48:51], v[32:35], v[144:147]
 ds_read_b64_tr_b16 v[86:87], v115 offset:44288
 MM v[148:151], v[48:51], v[36:39], v[148:151]
 ds_read_b64_tr_b16 v[88:89], v115 offset:45056
 MM v[156:159], v[52:55], v[36:39], v[156:159]
 ds_read_b64_tr_b16 v[90:91], v115 offset:45312
 MM v[152:155], v[52:55], v[32:35], v[152:155]
 ds_read_b64_tr_b16 v[92:93], v115 offset:46080
 s_waitcnt lgkmcnt(15)
 MM v[160:163], v[56:59], v[32:35], v[160:163]
 ds_read_b64_tr_b16 v[94:95], v115 offset:46336
 MM v[164:167], v[56:59], v[36:39], v[164:167]
 ds_read_b64_tr_b16 v[96:97], v115 offset:47104
 MM v[172:175], v[60:63], v[36:39], v[172:175]
 ds_read_b64_tr_b16 v[98:99], v115 offset:47360
 MM v[168:171], v[60:63], v[32:35], v[168:171]
 ds_read_b64_tr_b16 v[100:101], v115 offset:48128
 s_waitcnt lgkmcnt(15)
 MM v[176:179], v[64:67], v[32:35], v[176:179]
 ds_read_b64_tr_b16 v[102:103], v115 offset:48384
 MM v[180:183], v[64:67], v[36:39], v[180:183]
 ds_read_b64_tr_b16 v[40:41], v115 offset:49152
 MM v[188:191], v[68:71], v[36:39], v[188:191]
 ds_read_b64_tr_b16 v[42:43], v115 offset:49408
 MM v[184:187], v[68:71], v[32:35], v[184:187]
 ds_read_b64_tr_b16 v[44:45], v115 offset:50176
 s_waitcnt lgkmcnt(15)
 MM v[192:195], v[72:75], v[32:35], v[192:195]
 ds_read_b64_tr_b16 v[46:47], v115 offset:50432
 MM v[196:199], v[72:75], v[36:39], v[196:199]
 ds_read_b64_tr_b16 v[48:49], v115 offset:51200
 MM v[204:207], v[76:79], v[36:39], v[204:207]
 ds_read_b64_tr_b16 v[50:51], v115 offset:51456
 MM v[200:203], v[76:79], v[32:35], v[200:203]
 ds_read_b64_tr_b16 v[52:53], v115 offset:52224
 s_waitcnt lgkmcnt(15)
 MM v[208:211], v[80:83], v[32:35], v[208:211]
 ds_read_b64_tr_b16 v[54:55], v115 offset:52480
 MM v[212:215], v[80:83], v[36:39], v[212:215]
 ds_read_b64_tr_b16 v[56:57], v115 offset:53248
 MM v[220:223], v[84:87], v[36:39], v[220:223]
 ds_read_b64_tr_b16 v[58:59], v115 offset:53504
 MM v[216:219], v[84:87], v[32:35], v[216:219]
 ds_read_b64_tr_b16 v[60:61], v115 offset:54272
 s_waitcnt lgkmcnt(15)
 MM v[224:227], v[88:91], v[32:35], v[224:227]
 ds_read_b64_tr_b16 v[62:63], v115 offset:54528
 MM v[228:231], v[88:91], v[36:39], v[228:231]
 ds_read_b64_tr_b16 v[64:65], v115 offset:55296
 MM v[236:239], v[92:95], v[36:39], v[236:239]
 ds_read_b64_tr_b16 v[66:67], v115 offset:55552
 MM v[232:235], v[92:95], v[32:35], v[232:235]
 ds_read_b64_tr_b16 v[68:69], v115 offset:56320
 s_waitcnt lgkmcnt(15)
 MM v[240:243], v[96:99], v[32:35], v[240:243]
 ds_read_b64_tr_b16 v[70:71], v115 offset:56576
 MM v[244:247], v[96:99], v[36:39], v[244:247]
 ds_read_b64_tr_b16 v[72:73], v115 offset:57344
 MM v[252:255], v[100:103], v[36:39], v[252:255]
 ds_read_b64_tr_b16 v[74:75], v115 offset:57600
 MM v[248:251], v[100:103], v[32:35], v[248:251]
 ds_read_b64_tr_b16 v[76:77], v115 offset:58368
 s_waitcnt lgkmcnt(15)
 MM a[128:131], v[40:43], v[32:35], a[128:131]
 ds_read_b64_tr_b16 v[78:79], v115 offset:58624
 MM a[132:135], v[40:43], v[36:39], a[132:135]
 ds_read_b64_tr_b16 v[80:81], v115 offset:59392
 MM a[140:143], v[44:47], v[36:39], a[140:143]
 ds_read_b64_tr_b16 v[82:83], v115 offset:59648
 MM a[136:139], v[44:47], v[32:35], a[136:139]
 ds_read_b64_tr_b16 v[84:85], v115 offset:60416
 s_waitcnt lgkmcnt(15)
 MM a[144:147], v[48:51], v[32:35], a[144:147]
 ds_read_b64_tr_b16 v[86:87], v115 offset:60672
 MM a[148:151], v[48:51], v[36:39], a[148:151]
 ds_read_b64_tr_b16 v[88:89], v115 offset:61440
 MM a[156:159], v[52:55], v[36:39], a[156:159]
 ds_read_b64_tr_b16 v[90:91], v115 offset:61696
 MM a[152:155], v[52:55], v[32:35], a[152:155]
 ds_read_b64_tr_b16 v[92:93], v115 offset:62464
 s_waitcnt lgkmcnt(15)
 MM a[160:163], v[56:59], v[32:35], a[160:163]
 ds_read_b64_tr_b16 v[94:95], v115 offset:62720
 MM a[164:167], v[56:59], v[36:39], a[164:167]
 ds_read_b64_tr_b16 v[96:97], v115 offset:63488
 MM a[172:175], v[60:63], v[36:39], a[172:175]
 ds_read_b64_tr_b16 v[98:99], v115 offset:63744
 MM a[168:171], v[60:63], v[32:35], a[168:171]
 ds_read_b64_tr_b16 v[100:101], v115 offset:64512
 s_waitcnt lgkmcnt(15)
 MM a[176:179], v[64:67], v[32:35], a[176:179]
 ds_read_b64_tr_b16 v[102:103], v115 offset:64768
 MM a[180:183], v[64:67], v[36:39], a[180:183]
 MM a[188:191], v[68:71], v[36:39], a[188:191]
 MM a[184:187], v[68:71], v[32:35], a[184:187]
 s_waitcnt lgkmcnt(12)
 MM a[192:195], v[72:75], v[32:35], a[192:195]
 MM a[196:199], v[72:75], v[36:39], a[196:199]
 MM a[204:207], v[76:79], v[36:39], a[204:207]
 MM a[200:203], v[76:79], v[32:35], a[200:203]
 s_waitcnt lgkmcnt(8)
 MM a[208:211], v[80:83], v[32:35], a[208:211]
 MM a[212:215], v[80:83], v[36:39], a[212:215]
 MM a[220:223], v[84:87], v[36:39], a[220:223]
 MM a[216:219], v[84:87], v[32:35], a[216:219]
 s_waitcnt lgkmcnt(4)
 MM a[224:227], v[88:91], v[32:35], a[224:227]
 MM a[228:231], v[88:91], v[36:39], a[228:231]
 MM a[236:239], v[92:95], v[36:39], a[236:239]
 MM a[232:235], v[92:95], v[32:35], a[232:235]
 s_waitcnt lgkmcnt(0)
 MM a[240:243], v[96:99], v[32:35], a[240:243]
 MM a[244:247], v[96:99], v[36:39], a[244:247]
 MM a[252:255], v[100:103], v[36:39], a[252:255]
 MM a[248:251], v[100:103], v[32:35], a[248:251]
attn_kernel_epi:
 s_waitcnt vmcnt(0)
 v_cmp_gt_u32 vcc, 16, v127
 s_cbranch_vccz attn_kernel_pg_ok
 s_mov_b32 s38, 0
attn_kernel_pg:
 global_load_dword v127, v126, s[4:5] offset:8 sc1
 s_waitcnt vmcnt(0)
 v_cmp_gt_u32_e64 vcc, 16, v127
 s_cbranch_vccz attn_kernel_pg_ok
 s_sleep 1
 s_add_u32 s38, s38, 1
 s_cmp_lt_u32 s38, 0x80000
 s_cbranch_scc1 attn_kernel_pg
attn_kernel_pg_ok:
 s_cmp_eq_u32 s18, 0
 s_cbranch_scc1 attn_kernel_sig
 s_nop 15
 v_mov_b32 v121, v118
 s_nop 1
 v_permlane16_swap_b32 v121, v118
 v_add_f32 v118, v118, v121
 v_mov_b32 v121, v118
 s_nop 1
 v_permlane32_swap_b32 v121, v118
 v_add_f32 v118, v118, v121
 v_mov_b32 v121, v119
 s_nop 1
 v_permlane16_swap_b32 v121, v119
 v_add_f32 v119, v119, v121
 v_mov_b32 v121, v119
 s_nop 1
 v_permlane32_swap_b32 v121, v119
 v_add_f32 v119, v119, v121
 v_cmp_gt_u32 vcc, 0x100, v123
 s_nop 1
 v_cndmask_b32 v0, v108, v104, vcc
 v_cndmask_b32 v1, v119, v118, vcc
 v_log_f32 v1, v1
 s_nop 0
 v_sub_f32 v0, v1, v0
 v_lshrrev_b32_e64 v2, 2, v123
 s_mov_b64 exec, 0xffffffff
 buffer_store_dword v0, v2, s[8:11], s20 offen sc1
 s_mov_b64 exec, -1
 v_rcp_f32 v4, v118
 v_rcp_f32 v5, v119
 s_nop 0
 v_pk_mul_f32 v[128:129], v[128:129], v[4:5] op_sel:[0,0] op_sel_hi:[1,0]
 v_pk_mul_f32 v[130:131], v[130:131], v[4:5] op_sel:[0,0] op_sel_hi:[1,0]
 v_pk_mul_f32 v[136:137], v[136:137], v[4:5] op_sel:[0,0] op_sel_hi:[1,0]
 v_pk_mul_f32 v[138:139], v[138:139], v[4:5] op_sel:[0,0] op_sel_hi:[1,0]
 v_cvt_pk_f16_f32 v40, v128, v129
 v_cvt_pk_f16_f32 v41, v130, v131
 v_cvt_pk_f16_f32 v42, v136, v137
 v_cvt_pk_f16_f32 v43, v138, v139
 buffer_store_dwordx4 v[40:43], v123, s[8:11], s19 offen sc1
 v_pk_mul_f32 v[132:133], v[132:133], v[4:5] op_sel:[0,1] op_sel_hi:[1,1]
 v_pk_mul_f32 v[134:135], v[134:135], v[4:5] op_sel:[0,1] op_sel_hi:[1,1]
 v_pk_mul_f32 v[140:141], v[140:141], v[4:5] op_sel:[0,1] op_sel_hi:[1,1]
 v_pk_mul_f32 v[142:143], v[142:143], v[4:5] op_sel:[0,1] op_sel_hi:[1,1]
 v_cvt_pk_f16_f32 v44, v132, v133
 v_cvt_pk_f16_f32 v45, v134, v135
 v_cvt_pk_f16_f32 v46, v140, v141
 v_cvt_pk_f16_f32 v47, v142, v143
 s_add_u32 s19, s19, 0x1000
 buffer_store_dwordx4 v[44:47], v123, s[8:11], s19 offen sc1
 v_pk_mul_f32 v[144:145], v[144:145], v[4:5] op_sel:[0,0] op_sel_hi:[1,0]
 v_pk_mul_f32 v[146:147], v[146:147], v[4:5] op_sel:[0,0] op_sel_hi:[1,0]
 v_pk_mul_f32 v[152:153], v[152:153], v[4:5] op_sel:[0,0] op_sel_hi:[1,0]
 v_pk_mul_f32 v[154:155], v[154:155], v[4:5] op_sel:[0,0] op_sel_hi:[1,0]
 v_cvt_pk_f16_f32 v48, v144, v145
 v_cvt_pk_f16_f32 v49, v146, v147
 v_cvt_pk_f16_f32 v50, v152, v153
 v_cvt_pk_f16_f32 v51, v154, v155
 s_add_u32 s19, s19, 0x1000
 buffer_store_dwordx4 v[48:51], v123, s[8:11], s19 offen sc1
 v_pk_mul_f32 v[148:149], v[148:149], v[4:5] op_sel:[0,1] op_sel_hi:[1,1]
 v_pk_mul_f32 v[150:151], v[150:151], v[4:5] op_sel:[0,1] op_sel_hi:[1,1]
 v_pk_mul_f32 v[156:157], v[156:157], v[4:5] op_sel:[0,1] op_sel_hi:[1,1]
 v_pk_mul_f32 v[158:159], v[158:159], v[4:5] op_sel:[0,1] op_sel_hi:[1,1]
 v_cvt_pk_f16_f32 v52, v148, v149
 v_cvt_pk_f16_f32 v53, v150, v151
 v_cvt_pk_f16_f32 v54, v156, v157
 v_cvt_pk_f16_f32 v55, v158, v159
 s_add_u32 s19, s19, 0x1000
 buffer_store_dwordx4 v[52:55], v123, s[8:11], s19 offen sc1
 v_pk_mul_f32 v[160:161], v[160:161], v[4:5] op_sel:[0,0] op_sel_hi:[1,0]
 v_pk_mul_f32 v[162:163], v[162:163], v[4:5] op_sel:[0,0] op_sel_hi:[1,0]
 v_pk_mul_f32 v[168:169], v[168:169], v[4:5] op_sel:[0,0] op_sel_hi:[1,0]
 v_pk_mul_f32 v[170:171], v[170:171], v[4:5] op_sel:[0,0] op_sel_hi:[1,0]
 v_cvt_pk_f16_f32 v56, v160, v161
 v_cvt_pk_f16_f32 v57, v162, v163
 v_cvt_pk_f16_f32 v58, v168, v169
 v_cvt_pk_f16_f32 v59, v170, v171
 s_add_u32 s19, s19, 0x1000
 buffer_store_dwordx4 v[56:59], v123, s[8:11], s19 offen sc1
 v_pk_mul_f32 v[164:165], v[164:165], v[4:5] op_sel:[0,1] op_sel_hi:[1,1]
 v_pk_mul_f32 v[166:167], v[166:167], v[4:5] op_sel:[0,1] op_sel_hi:[1,1]
 v_pk_mul_f32 v[172:173], v[172:173], v[4:5] op_sel:[0,1] op_sel_hi:[1,1]
 v_pk_mul_f32 v[174:175], v[174:175], v[4:5] op_sel:[0,1] op_sel_hi:[1,1]
 v_cvt_pk_f16_f32 v60, v164, v165
 v_cvt_pk_f16_f32 v61, v166, v167
 v_cvt_pk_f16_f32 v62, v172, v173
 v_cvt_pk_f16_f32 v63, v174, v175
 s_add_u32 s19, s19, 0x1000
 buffer_store_dwordx4 v[60:63], v123, s[8:11], s19 offen sc1
 v_pk_mul_f32 v[176:177], v[176:177], v[4:5] op_sel:[0,0] op_sel_hi:[1,0]
 v_pk_mul_f32 v[178:179], v[178:179], v[4:5] op_sel:[0,0] op_sel_hi:[1,0]
 v_pk_mul_f32 v[184:185], v[184:185], v[4:5] op_sel:[0,0] op_sel_hi:[1,0]
 v_pk_mul_f32 v[186:187], v[186:187], v[4:5] op_sel:[0,0] op_sel_hi:[1,0]
 v_cvt_pk_f16_f32 v64, v176, v177
 v_cvt_pk_f16_f32 v65, v178, v179
 v_cvt_pk_f16_f32 v66, v184, v185
 v_cvt_pk_f16_f32 v67, v186, v187
 s_add_u32 s19, s19, 0x1000
 buffer_store_dwordx4 v[64:67], v123, s[8:11], s19 offen sc1
 v_pk_mul_f32 v[180:181], v[180:181], v[4:5] op_sel:[0,1] op_sel_hi:[1,1]
 v_pk_mul_f32 v[182:183], v[182:183], v[4:5] op_sel:[0,1] op_sel_hi:[1,1]
 v_pk_mul_f32 v[188:189], v[188:189], v[4:5] op_sel:[0,1] op_sel_hi:[1,1]
 v_pk_mul_f32 v[190:191], v[190:191], v[4:5] op_sel:[0,1] op_sel_hi:[1,1]
 v_cvt_pk_f16_f32 v68, v180, v181
 v_cvt_pk_f16_f32 v69, v182, v183
 v_cvt_pk_f16_f32 v70, v188, v189
 v_cvt_pk_f16_f32 v71, v190, v191
 s_add_u32 s19, s19, 0x1000
 buffer_store_dwordx4 v[68:71], v123, s[8:11], s19 offen sc1
 v_pk_mul_f32 v[192:193], v[192:193], v[4:5] op_sel:[0,0] op_sel_hi:[1,0]
 v_pk_mul_f32 v[194:195], v[194:195], v[4:5] op_sel:[0,0] op_sel_hi:[1,0]
 v_pk_mul_f32 v[200:201], v[200:201], v[4:5] op_sel:[0,0] op_sel_hi:[1,0]
 v_pk_mul_f32 v[202:203], v[202:203], v[4:5] op_sel:[0,0] op_sel_hi:[1,0]
 v_cvt_pk_f16_f32 v40, v192, v193
 v_cvt_pk_f16_f32 v41, v194, v195
 v_cvt_pk_f16_f32 v42, v200, v201
 v_cvt_pk_f16_f32 v43, v202, v203
 s_add_u32 s19, s19, 0x1000
 buffer_store_dwordx4 v[40:43], v123, s[8:11], s19 offen sc1
 v_pk_mul_f32 v[196:197], v[196:197], v[4:5] op_sel:[0,1] op_sel_hi:[1,1]
 v_pk_mul_f32 v[198:199], v[198:199], v[4:5] op_sel:[0,1] op_sel_hi:[1,1]
 v_pk_mul_f32 v[204:205], v[204:205], v[4:5] op_sel:[0,1] op_sel_hi:[1,1]
 v_pk_mul_f32 v[206:207], v[206:207], v[4:5] op_sel:[0,1] op_sel_hi:[1,1]
 v_cvt_pk_f16_f32 v44, v196, v197
 v_cvt_pk_f16_f32 v45, v198, v199
 v_cvt_pk_f16_f32 v46, v204, v205
 v_cvt_pk_f16_f32 v47, v206, v207
 s_add_u32 s19, s19, 0x1000
 buffer_store_dwordx4 v[44:47], v123, s[8:11], s19 offen sc1
 v_pk_mul_f32 v[208:209], v[208:209], v[4:5] op_sel:[0,0] op_sel_hi:[1,0]
 v_pk_mul_f32 v[210:211], v[210:211], v[4:5] op_sel:[0,0] op_sel_hi:[1,0]
 v_pk_mul_f32 v[216:217], v[216:217], v[4:5] op_sel:[0,0] op_sel_hi:[1,0]
 v_pk_mul_f32 v[218:219], v[218:219], v[4:5] op_sel:[0,0] op_sel_hi:[1,0]
 v_cvt_pk_f16_f32 v48, v208, v209
 v_cvt_pk_f16_f32 v49, v210, v211
 v_cvt_pk_f16_f32 v50, v216, v217
 v_cvt_pk_f16_f32 v51, v218, v219
 s_add_u32 s19, s19, 0x1000
 buffer_store_dwordx4 v[48:51], v123, s[8:11], s19 offen sc1
 v_pk_mul_f32 v[212:213], v[212:213], v[4:5] op_sel:[0,1] op_sel_hi:[1,1]
 v_pk_mul_f32 v[214:215], v[214:215], v[4:5] op_sel:[0,1] op_sel_hi:[1,1]
 v_pk_mul_f32 v[220:221], v[220:221], v[4:5] op_sel:[0,1] op_sel_hi:[1,1]
 v_pk_mul_f32 v[222:223], v[222:223], v[4:5] op_sel:[0,1] op_sel_hi:[1,1]
 v_cvt_pk_f16_f32 v52, v212, v213
 v_cvt_pk_f16_f32 v53, v214, v215
 v_cvt_pk_f16_f32 v54, v220, v221
 v_cvt_pk_f16_f32 v55, v222, v223
 s_add_u32 s19, s19, 0x1000
 buffer_store_dwordx4 v[52:55], v123, s[8:11], s19 offen sc1
 v_pk_mul_f32 v[224:225], v[224:225], v[4:5] op_sel:[0,0] op_sel_hi:[1,0]
 v_pk_mul_f32 v[226:227], v[226:227], v[4:5] op_sel:[0,0] op_sel_hi:[1,0]
 v_pk_mul_f32 v[232:233], v[232:233], v[4:5] op_sel:[0,0] op_sel_hi:[1,0]
 v_pk_mul_f32 v[234:235], v[234:235], v[4:5] op_sel:[0,0] op_sel_hi:[1,0]
 v_cvt_pk_f16_f32 v56, v224, v225
 v_cvt_pk_f16_f32 v57, v226, v227
 v_cvt_pk_f16_f32 v58, v232, v233
 v_cvt_pk_f16_f32 v59, v234, v235
 s_add_u32 s19, s19, 0x1000
 buffer_store_dwordx4 v[56:59], v123, s[8:11], s19 offen sc1
 v_pk_mul_f32 v[228:229], v[228:229], v[4:5] op_sel:[0,1] op_sel_hi:[1,1]
 v_pk_mul_f32 v[230:231], v[230:231], v[4:5] op_sel:[0,1] op_sel_hi:[1,1]
 v_pk_mul_f32 v[236:237], v[236:237], v[4:5] op_sel:[0,1] op_sel_hi:[1,1]
 v_pk_mul_f32 v[238:239], v[238:239], v[4:5] op_sel:[0,1] op_sel_hi:[1,1]
 v_cvt_pk_f16_f32 v60, v228, v229
 v_cvt_pk_f16_f32 v61, v230, v231
 v_cvt_pk_f16_f32 v62, v236, v237
 v_cvt_pk_f16_f32 v63, v238, v239
 s_add_u32 s19, s19, 0x1000
 buffer_store_dwordx4 v[60:63], v123, s[8:11], s19 offen sc1
 v_pk_mul_f32 v[240:241], v[240:241], v[4:5] op_sel:[0,0] op_sel_hi:[1,0]
 v_pk_mul_f32 v[242:243], v[242:243], v[4:5] op_sel:[0,0] op_sel_hi:[1,0]
 v_pk_mul_f32 v[248:249], v[248:249], v[4:5] op_sel:[0,0] op_sel_hi:[1,0]
 v_pk_mul_f32 v[250:251], v[250:251], v[4:5] op_sel:[0,0] op_sel_hi:[1,0]
 v_cvt_pk_f16_f32 v64, v240, v241
 v_cvt_pk_f16_f32 v65, v242, v243
 v_cvt_pk_f16_f32 v66, v248, v249
 v_cvt_pk_f16_f32 v67, v250, v251
 s_add_u32 s19, s19, 0x1000
 buffer_store_dwordx4 v[64:67], v123, s[8:11], s19 offen sc1
 v_pk_mul_f32 v[244:245], v[244:245], v[4:5] op_sel:[0,1] op_sel_hi:[1,1]
 v_pk_mul_f32 v[246:247], v[246:247], v[4:5] op_sel:[0,1] op_sel_hi:[1,1]
 v_pk_mul_f32 v[252:253], v[252:253], v[4:5] op_sel:[0,1] op_sel_hi:[1,1]
 v_pk_mul_f32 v[254:255], v[254:255], v[4:5] op_sel:[0,1] op_sel_hi:[1,1]
 v_cvt_pk_f16_f32 v68, v244, v245
 v_cvt_pk_f16_f32 v69, v246, v247
 v_cvt_pk_f16_f32 v70, v252, v253
 v_cvt_pk_f16_f32 v71, v254, v255
 s_add_u32 s19, s19, 0x1000
 buffer_store_dwordx4 v[68:71], v123, s[8:11], s19 offen sc1
 RA v16, a128
 RA v17, a129
 RA v18, a130
 RA v19, a131
 RA v20, a136
 RA v21, a137
 RA v22, a138
 RA v23, a139
 v_pk_mul_f32 v[16:17], v[16:17], v[4:5] op_sel:[0,0] op_sel_hi:[1,0]
 v_pk_mul_f32 v[18:19], v[18:19], v[4:5] op_sel:[0,0] op_sel_hi:[1,0]
 v_pk_mul_f32 v[20:21], v[20:21], v[4:5] op_sel:[0,0] op_sel_hi:[1,0]
 v_pk_mul_f32 v[22:23], v[22:23], v[4:5] op_sel:[0,0] op_sel_hi:[1,0]
 v_cvt_pk_f16_f32 v40, v16, v17
 v_cvt_pk_f16_f32 v41, v18, v19
 v_cvt_pk_f16_f32 v42, v20, v21
 v_cvt_pk_f16_f32 v43, v22, v23
 s_add_u32 s19, s19, 0x1000
 buffer_store_dwordx4 v[40:43], v123, s[8:11], s19 offen sc1
 RA v24, a132
 RA v25, a133
 RA v26, a134
 RA v27, a135
 RA v28, a140
 RA v29, a141
 RA v30, a142
 RA v31, a143
 v_pk_mul_f32 v[24:25], v[24:25], v[4:5] op_sel:[0,1] op_sel_hi:[1,1]
 v_pk_mul_f32 v[26:27], v[26:27], v[4:5] op_sel:[0,1] op_sel_hi:[1,1]
 v_pk_mul_f32 v[28:29], v[28:29], v[4:5] op_sel:[0,1] op_sel_hi:[1,1]
 v_pk_mul_f32 v[30:31], v[30:31], v[4:5] op_sel:[0,1] op_sel_hi:[1,1]
 v_cvt_pk_f16_f32 v44, v24, v25
 v_cvt_pk_f16_f32 v45, v26, v27
 v_cvt_pk_f16_f32 v46, v28, v29
 v_cvt_pk_f16_f32 v47, v30, v31
 s_add_u32 s19, s19, 0x1000
 buffer_store_dwordx4 v[44:47], v123, s[8:11], s19 offen sc1
 RA v8, a144
 RA v9, a145
 RA v10, a146
 RA v11, a147
 RA v12, a152
 RA v13, a153
 RA v14, a154
 RA v15, a155
 v_pk_mul_f32 v[8:9], v[8:9], v[4:5] op_sel:[0,0] op_sel_hi:[1,0]
 v_pk_mul_f32 v[10:11], v[10:11], v[4:5] op_sel:[0,0] op_sel_hi:[1,0]
 v_pk_mul_f32 v[12:13], v[12:13], v[4:5] op_sel:[0,0] op_sel_hi:[1,0]
 v_pk_mul_f32 v[14:15], v[14:15], v[4:5] op_sel:[0,0] op_sel_hi:[1,0]
 v_cvt_pk_f16_f32 v48, v8, v9
 v_cvt_pk_f16_f32 v49, v10, v11
 v_cvt_pk_f16_f32 v50, v12, v13
 v_cvt_pk_f16_f32 v51, v14, v15
 s_add_u32 s19, s19, 0x1000
 buffer_store_dwordx4 v[48:51], v123, s[8:11], s19 offen sc1
 RA v16, a148
 RA v17, a149
 RA v18, a150
 RA v19, a151
 RA v20, a156
 RA v21, a157
 RA v22, a158
 RA v23, a159
 v_pk_mul_f32 v[16:17], v[16:17], v[4:5] op_sel:[0,1] op_sel_hi:[1,1]
 v_pk_mul_f32 v[18:19], v[18:19], v[4:5] op_sel:[0,1] op_sel_hi:[1,1]
 v_pk_mul_f32 v[20:21], v[20:21], v[4:5] op_sel:[0,1] op_sel_hi:[1,1]
 v_pk_mul_f32 v[22:23], v[22:23], v[4:5] op_sel:[0,1] op_sel_hi:[1,1]
 v_cvt_pk_f16_f32 v52, v16, v17
 v_cvt_pk_f16_f32 v53, v18, v19
 v_cvt_pk_f16_f32 v54, v20, v21
 v_cvt_pk_f16_f32 v55, v22, v23
 s_add_u32 s19, s19, 0x1000
 buffer_store_dwordx4 v[52:55], v123, s[8:11], s19 offen sc1
 RA v24, a160
 RA v25, a161
 RA v26, a162
 RA v27, a163
 RA v28, a168
 RA v29, a169
 RA v30, a170
 RA v31, a171
 v_pk_mul_f32 v[24:25], v[24:25], v[4:5] op_sel:[0,0] op_sel_hi:[1,0]
 v_pk_mul_f32 v[26:27], v[26:27], v[4:5] op_sel:[0,0] op_sel_hi:[1,0]
 v_pk_mul_f32 v[28:29], v[28:29], v[4:5] op_sel:[0,0] op_sel_hi:[1,0]
 v_pk_mul_f32 v[30:31], v[30:31], v[4:5] op_sel:[0,0] op_sel_hi:[1,0]
 v_cvt_pk_f16_f32 v56, v24, v25
 v_cvt_pk_f16_f32 v57, v26, v27
 v_cvt_pk_f16_f32 v58, v28, v29
 v_cvt_pk_f16_f32 v59, v30, v31
 s_add_u32 s19, s19, 0x1000
 buffer_store_dwordx4 v[56:59], v123, s[8:11], s19 offen sc1
 RA v8, a164
 RA v9, a165
 RA v10, a166
 RA v11, a167
 RA v12, a172
 RA v13, a173
 RA v14, a174
 RA v15, a175
 v_pk_mul_f32 v[8:9], v[8:9], v[4:5] op_sel:[0,1] op_sel_hi:[1,1]
 v_pk_mul_f32 v[10:11], v[10:11], v[4:5] op_sel:[0,1] op_sel_hi:[1,1]
 v_pk_mul_f32 v[12:13], v[12:13], v[4:5] op_sel:[0,1] op_sel_hi:[1,1]
 v_pk_mul_f32 v[14:15], v[14:15], v[4:5] op_sel:[0,1] op_sel_hi:[1,1]
 v_cvt_pk_f16_f32 v60, v8, v9
 v_cvt_pk_f16_f32 v61, v10, v11
 v_cvt_pk_f16_f32 v62, v12, v13
 v_cvt_pk_f16_f32 v63, v14, v15
 s_add_u32 s19, s19, 0x1000
 buffer_store_dwordx4 v[60:63], v123, s[8:11], s19 offen sc1
 RA v16, a176
 RA v17, a177
 RA v18, a178
 RA v19, a179
 RA v20, a184
 RA v21, a185
 RA v22, a186
 RA v23, a187
 v_pk_mul_f32 v[16:17], v[16:17], v[4:5] op_sel:[0,0] op_sel_hi:[1,0]
 v_pk_mul_f32 v[18:19], v[18:19], v[4:5] op_sel:[0,0] op_sel_hi:[1,0]
 v_pk_mul_f32 v[20:21], v[20:21], v[4:5] op_sel:[0,0] op_sel_hi:[1,0]
 v_pk_mul_f32 v[22:23], v[22:23], v[4:5] op_sel:[0,0] op_sel_hi:[1,0]
 v_cvt_pk_f16_f32 v64, v16, v17
 v_cvt_pk_f16_f32 v65, v18, v19
 v_cvt_pk_f16_f32 v66, v20, v21
 v_cvt_pk_f16_f32 v67, v22, v23
 s_add_u32 s19, s19, 0x1000
 buffer_store_dwordx4 v[64:67], v123, s[8:11], s19 offen sc1
 RA v24, a180
 RA v25, a181
 RA v26, a182
 RA v27, a183
 RA v28, a188
 RA v29, a189
 RA v30, a190
 RA v31, a191
 v_pk_mul_f32 v[24:25], v[24:25], v[4:5] op_sel:[0,1] op_sel_hi:[1,1]
 v_pk_mul_f32 v[26:27], v[26:27], v[4:5] op_sel:[0,1] op_sel_hi:[1,1]
 v_pk_mul_f32 v[28:29], v[28:29], v[4:5] op_sel:[0,1] op_sel_hi:[1,1]
 v_pk_mul_f32 v[30:31], v[30:31], v[4:5] op_sel:[0,1] op_sel_hi:[1,1]
 v_cvt_pk_f16_f32 v68, v24, v25
 v_cvt_pk_f16_f32 v69, v26, v27
 v_cvt_pk_f16_f32 v70, v28, v29
 v_cvt_pk_f16_f32 v71, v30, v31
 s_add_u32 s19, s19, 0x1000
 buffer_store_dwordx4 v[68:71], v123, s[8:11], s19 offen sc1
 RA v8, a192
 RA v9, a193
 RA v10, a194
 RA v11, a195
 RA v12, a200
 RA v13, a201
 RA v14, a202
 RA v15, a203
 v_pk_mul_f32 v[8:9], v[8:9], v[4:5] op_sel:[0,0] op_sel_hi:[1,0]
 v_pk_mul_f32 v[10:11], v[10:11], v[4:5] op_sel:[0,0] op_sel_hi:[1,0]
 v_pk_mul_f32 v[12:13], v[12:13], v[4:5] op_sel:[0,0] op_sel_hi:[1,0]
 v_pk_mul_f32 v[14:15], v[14:15], v[4:5] op_sel:[0,0] op_sel_hi:[1,0]
 v_cvt_pk_f16_f32 v40, v8, v9
 v_cvt_pk_f16_f32 v41, v10, v11
 v_cvt_pk_f16_f32 v42, v12, v13
 v_cvt_pk_f16_f32 v43, v14, v15
 s_add_u32 s19, s19, 0x1000
 buffer_store_dwordx4 v[40:43], v123, s[8:11], s19 offen sc1
 RA v16, a196
 RA v17, a197
 RA v18, a198
 RA v19, a199
 RA v20, a204
 RA v21, a205
 RA v22, a206
 RA v23, a207
 v_pk_mul_f32 v[16:17], v[16:17], v[4:5] op_sel:[0,1] op_sel_hi:[1,1]
 v_pk_mul_f32 v[18:19], v[18:19], v[4:5] op_sel:[0,1] op_sel_hi:[1,1]
 v_pk_mul_f32 v[20:21], v[20:21], v[4:5] op_sel:[0,1] op_sel_hi:[1,1]
 v_pk_mul_f32 v[22:23], v[22:23], v[4:5] op_sel:[0,1] op_sel_hi:[1,1]
 v_cvt_pk_f16_f32 v44, v16, v17
 v_cvt_pk_f16_f32 v45, v18, v19
 v_cvt_pk_f16_f32 v46, v20, v21
 v_cvt_pk_f16_f32 v47, v22, v23
 s_add_u32 s19, s19, 0x1000
 buffer_store_dwordx4 v[44:47], v123, s[8:11], s19 offen sc1
 RA v24, a208
 RA v25, a209
 RA v26, a210
 RA v27, a211
 RA v28, a216
 RA v29, a217
 RA v30, a218
 RA v31, a219
 v_pk_mul_f32 v[24:25], v[24:25], v[4:5] op_sel:[0,0] op_sel_hi:[1,0]
 v_pk_mul_f32 v[26:27], v[26:27], v[4:5] op_sel:[0,0] op_sel_hi:[1,0]
 v_pk_mul_f32 v[28:29], v[28:29], v[4:5] op_sel:[0,0] op_sel_hi:[1,0]
 v_pk_mul_f32 v[30:31], v[30:31], v[4:5] op_sel:[0,0] op_sel_hi:[1,0]
 v_cvt_pk_f16_f32 v48, v24, v25
 v_cvt_pk_f16_f32 v49, v26, v27
 v_cvt_pk_f16_f32 v50, v28, v29
 v_cvt_pk_f16_f32 v51, v30, v31
 s_add_u32 s19, s19, 0x1000
 buffer_store_dwordx4 v[48:51], v123, s[8:11], s19 offen sc1
 RA v8, a212
 RA v9, a213
 RA v10, a214
 RA v11, a215
 RA v12, a220
 RA v13, a221
 RA v14, a222
 RA v15, a223
 v_pk_mul_f32 v[8:9], v[8:9], v[4:5] op_sel:[0,1] op_sel_hi:[1,1]
 v_pk_mul_f32 v[10:11], v[10:11], v[4:5] op_sel:[0,1] op_sel_hi:[1,1]
 v_pk_mul_f32 v[12:13], v[12:13], v[4:5] op_sel:[0,1] op_sel_hi:[1,1]
 v_pk_mul_f32 v[14:15], v[14:15], v[4:5] op_sel:[0,1] op_sel_hi:[1,1]
 v_cvt_pk_f16_f32 v52, v8, v9
 v_cvt_pk_f16_f32 v53, v10, v11
 v_cvt_pk_f16_f32 v54, v12, v13
 v_cvt_pk_f16_f32 v55, v14, v15
 s_add_u32 s19, s19, 0x1000
 buffer_store_dwordx4 v[52:55], v123, s[8:11], s19 offen sc1
 RA v16, a224
 RA v17, a225
 RA v18, a226
 RA v19, a227
 RA v20, a232
 RA v21, a233
 RA v22, a234
 RA v23, a235
 v_pk_mul_f32 v[16:17], v[16:17], v[4:5] op_sel:[0,0] op_sel_hi:[1,0]
 v_pk_mul_f32 v[18:19], v[18:19], v[4:5] op_sel:[0,0] op_sel_hi:[1,0]
 v_pk_mul_f32 v[20:21], v[20:21], v[4:5] op_sel:[0,0] op_sel_hi:[1,0]
 v_pk_mul_f32 v[22:23], v[22:23], v[4:5] op_sel:[0,0] op_sel_hi:[1,0]
 v_cvt_pk_f16_f32 v56, v16, v17
 v_cvt_pk_f16_f32 v57, v18, v19
 v_cvt_pk_f16_f32 v58, v20, v21
 v_cvt_pk_f16_f32 v59, v22, v23
 s_add_u32 s19, s19, 0x1000
 buffer_store_dwordx4 v[56:59], v123, s[8:11], s19 offen sc1
 RA v24, a228
 RA v25, a229
 RA v26, a230
 RA v27, a231
 RA v28, a236
 RA v29, a237
 RA v30, a238
 RA v31, a239
 v_pk_mul_f32 v[24:25], v[24:25], v[4:5] op_sel:[0,1] op_sel_hi:[1,1]
 v_pk_mul_f32 v[26:27], v[26:27], v[4:5] op_sel:[0,1] op_sel_hi:[1,1]
 v_pk_mul_f32 v[28:29], v[28:29], v[4:5] op_sel:[0,1] op_sel_hi:[1,1]
 v_pk_mul_f32 v[30:31], v[30:31], v[4:5] op_sel:[0,1] op_sel_hi:[1,1]
 v_cvt_pk_f16_f32 v60, v24, v25
 v_cvt_pk_f16_f32 v61, v26, v27
 v_cvt_pk_f16_f32 v62, v28, v29
 v_cvt_pk_f16_f32 v63, v30, v31
 s_add_u32 s19, s19, 0x1000
 buffer_store_dwordx4 v[60:63], v123, s[8:11], s19 offen sc1
 RA v8, a240
 RA v9, a241
 RA v10, a242
 RA v11, a243
 RA v12, a248
 RA v13, a249
 RA v14, a250
 RA v15, a251
 v_pk_mul_f32 v[8:9], v[8:9], v[4:5] op_sel:[0,0] op_sel_hi:[1,0]
 v_pk_mul_f32 v[10:11], v[10:11], v[4:5] op_sel:[0,0] op_sel_hi:[1,0]
 v_pk_mul_f32 v[12:13], v[12:13], v[4:5] op_sel:[0,0] op_sel_hi:[1,0]
 v_pk_mul_f32 v[14:15], v[14:15], v[4:5] op_sel:[0,0] op_sel_hi:[1,0]
 v_cvt_pk_f16_f32 v64, v8, v9
 v_cvt_pk_f16_f32 v65, v10, v11
 v_cvt_pk_f16_f32 v66, v12, v13
 v_cvt_pk_f16_f32 v67, v14, v15
 s_add_u32 s19, s19, 0x1000
 buffer_store_dwordx4 v[64:67], v123, s[8:11], s19 offen sc1
 RA v16, a244
 RA v17, a245
 RA v18, a246
 RA v19, a247
 RA v20, a252
 RA v21, a253
 RA v22, a254
 RA v23, a255
 v_pk_mul_f32 v[16:17], v[16:17], v[4:5] op_sel:[0,1] op_sel_hi:[1,1]
 v_pk_mul_f32 v[18:19], v[18:19], v[4:5] op_sel:[0,1] op_sel_hi:[1,1]
 v_pk_mul_f32 v[20:21], v[20:21], v[4:5] op_sel:[0,1] op_sel_hi:[1,1]
 v_pk_mul_f32 v[22:23], v[22:23], v[4:5] op_sel:[0,1] op_sel_hi:[1,1]
 v_cvt_pk_f16_f32 v68, v16, v17
 v_cvt_pk_f16_f32 v69, v18, v19
 v_cvt_pk_f16_f32 v70, v20, v21
 v_cvt_pk_f16_f32 v71, v22, v23
 s_add_u32 s19, s19, 0x1000
 buffer_store_dwordx4 v[68:71], v123, s[8:11], s19 offen sc1
attn_kernel_sig:
 s_lshl_b32 s34, s21, 3
 s_add_u32 s34, s34, s22
 s_lshl_b32 s34, s34, 7
 s_add_u32 s34, s34, 92291072
 s_mov_b32 s87, s34
 s_lshl_b32 s35, s40, 6
 v_lshrrev_b32 v0, 4, v123
 v_add_u32_e64 v0, s35, v0
 s_barrier
 s_branch tail_body
attn_kernel_end:
 s_endpgm
attn_kernel_rare0:
 s_nop 15
 v_max3_f32 v120, v16, v17, v18
 v_max3_f32 v120, v120, v19, v24
 v_max3_f32 v120, v120, v25, v26
 v_max_f32 v120, v120, v27
 v_mov_b32 v121, v120
 s_nop 1
 v_permlane16_swap_b32 v121, v120
 v_max_f32 v120, v120, v121
 v_mov_b32 v121, v120
 s_nop 1
 v_permlane32_swap_b32 v121, v120
 v_max_f32 v120, v120, v121
 v_max_f32 v120, 0, v120
 v_sub_f32 v121, 0, v120
 v_exp_f32 v121, v121
 v_sub_f32 v16, v16, v120
 v_sub_f32 v17, v17, v120
 v_sub_f32 v18, v18, v120
 v_sub_f32 v19, v19, v120
 v_sub_f32 v24, v24, v120
 v_sub_f32 v25, v25, v120
 v_sub_f32 v26, v26, v120
 v_sub_f32 v27, v27, v120
 v_sub_f32 v104, v104, v120
 v_sub_f32 v105, v105, v120
 v_sub_f32 v106, v106, v120
 v_sub_f32 v107, v107, v120
 v_mul_f32 v118, v118, v121
 v_mul_f32 v128, v128, v121
 v_mul_f32 v129, v129, v121
 v_mul_f32 v130, v130, v121
 v_mul_f32 v131, v131, v121
 v_mul_f32 v136, v136, v121
 v_mul_f32 v137, v137, v121
 v_mul_f32 v138, v138, v121
 v_mul_f32 v139, v139, v121
 v_mul_f32 v144, v144, v121
 v_mul_f32 v145, v145, v121
 v_mul_f32 v146, v146, v121
 v_mul_f32 v147, v147, v121
 v_mul_f32 v152, v152, v121
 v_mul_f32 v153, v153, v121
 v_mul_f32 v154, v154, v121
 v_mul_f32 v155, v155, v121
 v_mul_f32 v160, v160, v121
 v_mul_f32 v161, v161, v121
 v_mul_f32 v162, v162, v121
 v_mul_f32 v163, v163, v121
 v_mul_f32 v168, v168, v121
 v_mul_f32 v169, v169, v121
 v_mul_f32 v170, v170, v121
 v_mul_f32 v171, v171, v121
 v_mul_f32 v176, v176, v121
 v_mul_f32 v177, v177, v121
 v_mul_f32 v178, v178, v121
 v_mul_f32 v179, v179, v121
 v_mul_f32 v184, v184, v121
 v_mul_f32 v185, v185, v121
 v_mul_f32 v186, v186, v121
 v_mul_f32 v187, v187, v121
 v_mul_f32 v192, v192, v121
 v_mul_f32 v193, v193, v121
 v_mul_f32 v194, v194, v121
 v_mul_f32 v195, v195, v121
 v_mul_f32 v200, v200, v121
 v_mul_f32 v201, v201, v121
 v_mul_f32 v202, v202, v121
 v_mul_f32 v203, v203, v121
 v_mul_f32 v208, v208, v121
 v_mul_f32 v209, v209, v121
 v_mul_f32 v210, v210, v121
 v_mul_f32 v211, v211, v121
 v_mul_f32 v216, v216, v121
 v_mul_f32 v217, v217, v121
 v_mul_f32 v218, v218, v121
 v_mul_f32 v219, v219, v121
 v_mul_f32 v224, v224, v121
 v_mul_f32 v225, v225, v121
 v_mul_f32 v226, v226, v121
 v_mul_f32 v227, v227, v121
 v_mul_f32 v232, v232, v121
 v_mul_f32 v233, v233, v121
 v_mul_f32 v234, v234, v121
 v_mul_f32 v235, v235, v121
 v_mul_f32 v240, v240, v121
 v_mul_f32 v241, v241, v121
 v_mul_f32 v242, v242, v121
 v_mul_f32 v243, v243, v121
 v_mul_f32 v248, v248, v121
 v_mul_f32 v249, v249, v121
 v_mul_f32 v250, v250, v121
 v_mul_f32_e64 v251, v251, v121
 RA v32, a128
 RA v33, a129
 RA v34, a130
 RA v35, a131
 v_mul_f32 v32, v32, v121
 v_mul_f32 v33, v33, v121
 v_mul_f32 v34, v34, v121
 v_mul_f32 v35, v35, v121
 WA a128, v32
 WA a129, v33
 WA a130, v34
 WA a131, v35
 RA v32, a136
 RA v33, a137
 RA v34, a138
 RA v35, a139
 v_mul_f32 v32, v32, v121
 v_mul_f32 v33, v33, v121
 v_mul_f32 v34, v34, v121
 v_mul_f32 v35, v35, v121
 WA a136, v32
 WA a137, v33
 WA a138, v34
 WA a139, v35
 RA v32, a144
 RA v33, a145
 RA v34, a146
 RA v35, a147
 v_mul_f32 v32, v32, v121
 v_mul_f32 v33, v33, v121
 v_mul_f32 v34, v34, v121
 v_mul_f32 v35, v35, v121
 WA a144, v32
 WA a145, v33
 WA a146, v34
 WA a147, v35
 RA v32, a152
 RA v33, a153
 RA v34, a154
 RA v35, a155
 v_mul_f32 v32, v32, v121
 v_mul_f32 v33, v33, v121
 v_mul_f32 v34, v34, v121
 v_mul_f32 v35, v35, v121
 WA a152, v32
 WA a153, v33
 WA a154, v34
 WA a155, v35
 RA v32, a160
 RA v33, a161
 RA v34, a162
 RA v35, a163
 v_mul_f32 v32, v32, v121
 v_mul_f32 v33, v33, v121
 v_mul_f32 v34, v34, v121
 v_mul_f32 v35, v35, v121
 WA a160, v32
 WA a161, v33
 WA a162, v34
 WA a163, v35
 RA v32, a168
 RA v33, a169
 RA v34, a170
 RA v35, a171
 v_mul_f32 v32, v32, v121
 v_mul_f32 v33, v33, v121
 v_mul_f32 v34, v34, v121
 v_mul_f32 v35, v35, v121
 WA a168, v32
 WA a169, v33
 WA a170, v34
 WA a171, v35
 RA v32, a176
 RA v33, a177
 RA v34, a178
 RA v35, a179
 v_mul_f32 v32, v32, v121
 v_mul_f32 v33, v33, v121
 v_mul_f32 v34, v34, v121
 v_mul_f32 v35, v35, v121
 WA a176, v32
 WA a177, v33
 WA a178, v34
 WA a179, v35
 RA v32, a184
 RA v33, a185
 RA v34, a186
 RA v35, a187
 v_mul_f32 v32, v32, v121
 v_mul_f32 v33, v33, v121
 v_mul_f32 v34, v34, v121
 v_mul_f32 v35, v35, v121
 WA a184, v32
 WA a185, v33
 WA a186, v34
 WA a187, v35
 RA v32, a192
 RA v33, a193
 RA v34, a194
 RA v35, a195
 v_mul_f32 v32, v32, v121
 v_mul_f32 v33, v33, v121
 v_mul_f32 v34, v34, v121
 v_mul_f32 v35, v35, v121
 WA a192, v32
 WA a193, v33
 WA a194, v34
 WA a195, v35
 RA v32, a200
 RA v33, a201
 RA v34, a202
 RA v35, a203
 v_mul_f32 v32, v32, v121
 v_mul_f32 v33, v33, v121
 v_mul_f32 v34, v34, v121
 v_mul_f32 v35, v35, v121
 WA a200, v32
 WA a201, v33
 WA a202, v34
 WA a203, v35
 RA v32, a208
 RA v33, a209
 RA v34, a210
 RA v35, a211
 v_mul_f32 v32, v32, v121
 v_mul_f32 v33, v33, v121
 v_mul_f32 v34, v34, v121
 v_mul_f32 v35, v35, v121
 WA a208, v32
 WA a209, v33
 WA a210, v34
 WA a211, v35
 RA v32, a216
 RA v33, a217
 RA v34, a218
 RA v35, a219
 v_mul_f32 v32, v32, v121
 v_mul_f32 v33, v33, v121
 v_mul_f32 v34, v34, v121
 v_mul_f32 v35, v35, v121
 WA a216, v32
 WA a217, v33
 WA a218, v34
 WA a219, v35
 RA v32, a224
 RA v33, a225
 RA v34, a226
 RA v35, a227
 v_mul_f32 v32, v32, v121
 v_mul_f32 v33, v33, v121
 v_mul_f32 v34, v34, v121
 v_mul_f32 v35, v35, v121
 WA a224, v32
 WA a225, v33
 WA a226, v34
 WA a227, v35
 RA v32, a232
 RA v33, a233
 RA v34, a234
 RA v35, a235
 v_mul_f32 v32, v32, v121
 v_mul_f32 v33, v33, v121
 v_mul_f32 v34, v34, v121
 v_mul_f32 v35, v35, v121
 WA a232, v32
 WA a233, v33
 WA a234, v34
 WA a235, v35
 RA v32, a240
 RA v33, a241
 RA v34, a242
 RA v35, a243
 v_mul_f32 v32, v32, v121
 v_mul_f32 v33, v33, v121
 v_mul_f32 v34, v34, v121
 v_mul_f32 v35, v35, v121
 WA a240, v32
 WA a241, v33
 WA a242, v34
 WA a243, v35
 RA v32, a248
 RA v33, a249
 RA v34, a250
 RA v35, a251
 v_mul_f32 v32, v32, v121
 v_mul_f32 v33, v33, v121
 v_mul_f32 v34, v34, v121
 v_mul_f32 v35, v35, v121
 WA a248, v32
 WA a249, v33
 WA a250, v34
 WA a251, v35
 v_max3_f32 v120, v20, v21, v22
 v_max3_f32 v120, v120, v23, v28
 v_max3_f32 v120, v120, v29, v30
 v_max_f32 v120, v120, v31
 v_mov_b32 v121, v120
 s_nop 1
 v_permlane16_swap_b32 v121, v120
 v_max_f32 v120, v120, v121
 v_mov_b32 v121, v120
 s_nop 1
 v_permlane32_swap_b32 v121, v120
 v_max_f32 v120, v120, v121
 v_max_f32 v120, 0, v120
 v_sub_f32 v121, 0, v120
 v_exp_f32 v121, v121
 v_sub_f32 v20, v20, v120
 v_sub_f32 v21, v21, v120
 v_sub_f32 v22, v22, v120
 v_sub_f32 v23, v23, v120
 v_sub_f32 v28, v28, v120
 v_sub_f32 v29, v29, v120
 v_sub_f32 v30, v30, v120
 v_sub_f32 v31, v31, v120
 v_sub_f32 v108, v108, v120
 v_sub_f32 v109, v109, v120
 v_sub_f32 v110, v110, v120
 v_sub_f32 v111, v111, v120
 v_mul_f32 v119, v119, v121
 v_mul_f32 v132, v132, v121
 v_mul_f32 v133, v133, v121
 v_mul_f32 v134, v134, v121
 v_mul_f32 v135, v135, v121
 v_mul_f32 v140, v140, v121
 v_mul_f32 v141, v141, v121
 v_mul_f32 v142, v142, v121
 v_mul_f32 v143, v143, v121
 v_mul_f32 v148, v148, v121
 v_mul_f32 v149, v149, v121
 v_mul_f32 v150, v150, v121
 v_mul_f32 v151, v151, v121
 v_mul_f32 v156, v156, v121
 v_mul_f32 v157, v157, v121
 v_mul_f32 v158, v158, v121
 v_mul_f32 v159, v159, v121
 v_mul_f32 v164, v164, v121
 v_mul_f32 v165, v165, v121
 v_mul_f32 v166, v166, v121
 v_mul_f32 v167, v167, v121
 v_mul_f32 v172, v172, v121
 v_mul_f32 v173, v173, v121
 v_mul_f32 v174, v174, v121
 v_mul_f32 v175, v175, v121
 v_mul_f32 v180, v180, v121
 v_mul_f32 v181, v181, v121
 v_mul_f32 v182, v182, v121
 v_mul_f32 v183, v183, v121
 v_mul_f32 v188, v188, v121
 v_mul_f32 v189, v189, v121
 v_mul_f32 v190, v190, v121
 v_mul_f32 v191, v191, v121
 v_mul_f32 v196, v196, v121
 v_mul_f32 v197, v197, v121
 v_mul_f32 v198, v198, v121
 v_mul_f32 v199, v199, v121
 v_mul_f32 v204, v204, v121
 v_mul_f32 v205, v205, v121
 v_mul_f32 v206, v206, v121
 v_mul_f32 v207, v207, v121
 v_mul_f32 v212, v212, v121
 v_mul_f32 v213, v213, v121
 v_mul_f32 v214, v214, v121
 v_mul_f32 v215, v215, v121
 v_mul_f32 v220, v220, v121
 v_mul_f32 v221, v221, v121
 v_mul_f32 v222, v222, v121
 v_mul_f32 v223, v223, v121
 v_mul_f32 v228, v228, v121
 v_mul_f32 v229, v229, v121
 v_mul_f32 v230, v230, v121
 v_mul_f32 v231, v231, v121
 v_mul_f32 v236, v236, v121
 v_mul_f32 v237, v237, v121
 v_mul_f32 v238, v238, v121
 v_mul_f32 v239, v239, v121
 v_mul_f32 v244, v244, v121
 v_mul_f32 v245, v245, v121
 v_mul_f32 v246, v246, v121
 v_mul_f32 v247, v247, v121
 v_mul_f32 v252, v252, v121
 v_mul_f32 v253, v253, v121
 v_mul_f32 v254, v254, v121
 v_mul_f32_e64 v255, v255, v121
 RA v32, a132
 RA v33, a133
 RA v34, a134
 RA v35, a135
 v_mul_f32 v32, v32, v121
 v_mul_f32 v33, v33, v121
 v_mul_f32 v34, v34, v121
 v_mul_f32 v35, v35, v121
 WA a132, v32
 WA a133, v33
 WA a134, v34
 WA a135, v35
 RA v32, a140
 RA v33, a141
 RA v34, a142
 RA v35, a143
 v_mul_f32 v32, v32, v121
 v_mul_f32 v33, v33, v121
 v_mul_f32 v34, v34, v121
 v_mul_f32 v35, v35, v121
 WA a140, v32
 WA a141, v33
 WA a142, v34
 WA a143, v35
 RA v32, a148
 RA v33, a149
 RA v34, a150
 RA v35, a151
 v_mul_f32 v32, v32, v121
 v_mul_f32 v33, v33, v121
 v_mul_f32 v34, v34, v121
 v_mul_f32 v35, v35, v121
 WA a148, v32
 WA a149, v33
 WA a150, v34
 WA a151, v35
 RA v32, a156
 RA v33, a157
 RA v34, a158
 RA v35, a159
 v_mul_f32 v32, v32, v121
 v_mul_f32 v33, v33, v121
 v_mul_f32 v34, v34, v121
 v_mul_f32 v35, v35, v121
 WA a156, v32
 WA a157, v33
 WA a158, v34
 WA a159, v35
 RA v32, a164
 RA v33, a165
 RA v34, a166
 RA v35, a167
 v_mul_f32 v32, v32, v121
 v_mul_f32 v33, v33, v121
 v_mul_f32 v34, v34, v121
 v_mul_f32 v35, v35, v121
 WA a164, v32
 WA a165, v33
 WA a166, v34
 WA a167, v35
 RA v32, a172
 RA v33, a173
 RA v34, a174
 RA v35, a175
 v_mul_f32 v32, v32, v121
 v_mul_f32 v33, v33, v121
 v_mul_f32 v34, v34, v121
 v_mul_f32 v35, v35, v121
 WA a172, v32
 WA a173, v33
 WA a174, v34
 WA a175, v35
 RA v32, a180
 RA v33, a181
 RA v34, a182
 RA v35, a183
 v_mul_f32 v32, v32, v121
 v_mul_f32 v33, v33, v121
 v_mul_f32 v34, v34, v121
 v_mul_f32 v35, v35, v121
 WA a180, v32
 WA a181, v33
 WA a182, v34
 WA a183, v35
 RA v32, a188
 RA v33, a189
 RA v34, a190
 RA v35, a191
 v_mul_f32 v32, v32, v121
 v_mul_f32 v33, v33, v121
 v_mul_f32 v34, v34, v121
 v_mul_f32 v35, v35, v121
 WA a188, v32
 WA a189, v33
 WA a190, v34
 WA a191, v35
 RA v32, a196
 RA v33, a197
 RA v34, a198
 RA v35, a199
 v_mul_f32 v32, v32, v121
 v_mul_f32 v33, v33, v121
 v_mul_f32 v34, v34, v121
 v_mul_f32 v35, v35, v121
 WA a196, v32
 WA a197, v33
 WA a198, v34
 WA a199, v35
 RA v32, a204
 RA v33, a205
 RA v34, a206
 RA v35, a207
 v_mul_f32 v32, v32, v121
 v_mul_f32 v33, v33, v121
 v_mul_f32 v34, v34, v121
 v_mul_f32 v35, v35, v121
 WA a204, v32
 WA a205, v33
 WA a206, v34
 WA a207, v35
 RA v32, a212
 RA v33, a213
 RA v34, a214
 RA v35, a215
 v_mul_f32 v32, v32, v121
 v_mul_f32 v33, v33, v121
 v_mul_f32 v34, v34, v121
 v_mul_f32 v35, v35, v121
 WA a212, v32
 WA a213, v33
 WA a214, v34
 WA a215, v35
 RA v32, a220
 RA v33, a221
 RA v34, a222
 RA v35, a223
 v_mul_f32 v32, v32, v121
 v_mul_f32 v33, v33, v121
 v_mul_f32 v34, v34, v121
 v_mul_f32 v35, v35, v121
 WA a220, v32
 WA a221, v33
 WA a222, v34
 WA a223, v35
 RA v32, a228
 RA v33, a229
 RA v34, a230
 RA v35, a231
 v_mul_f32 v32, v32, v121
 v_mul_f32 v33, v33, v121
 v_mul_f32 v34, v34, v121
 v_mul_f32 v35, v35, v121
 WA a228, v32
 WA a229, v33
 WA a230, v34
 WA a231, v35
 RA v32, a236
 RA v33, a237
 RA v34, a238
 RA v35, a239
 v_mul_f32 v32, v32, v121
 v_mul_f32 v33, v33, v121
 v_mul_f32 v34, v34, v121
 v_mul_f32 v35, v35, v121
 WA a236, v32
 WA a237, v33
 WA a238, v34
 WA a239, v35
 RA v32, a244
 RA v33, a245
 RA v34, a246
 RA v35, a247
 v_mul_f32 v32, v32, v121
 v_mul_f32 v33, v33, v121
 v_mul_f32 v34, v34, v121
 v_mul_f32 v35, v35, v121
 WA a244, v32
 WA a245, v33
 WA a246, v34
 WA a247, v35
 RA v32, a252
 RA v33, a253
 RA v34, a254
 RA v35, a255
 v_mul_f32 v32, v32, v121
 v_mul_f32 v33, v33, v121
 v_mul_f32 v34, v34, v121
 v_mul_f32 v35, v35, v121
 WA a252, v32
 WA a253, v33
 WA a254, v34
 WA a255, v35
 s_nop 3
 s_branch attn_kernel_back0
attn_kernel_rare1:
 s_nop 15
 v_max3_f32 v120, v0, v1, v2
 v_max3_f32 v120, v120, v3, v8
 v_max3_f32 v120, v120, v9, v10
 v_max_f32 v120, v120, v11
 v_mov_b32 v121, v120
 s_nop 1
 v_permlane16_swap_b32 v121, v120
 v_max_f32 v120, v120, v121
 v_mov_b32 v121, v120
 s_nop 1
 v_permlane32_swap_b32 v121, v120
 v_max_f32 v120, v120, v121
 v_max_f32 v120, 0, v120
 v_sub_f32 v121, 0, v120
 v_exp_f32 v121, v121
 v_sub_f32 v0, v0, v120
 v_sub_f32 v1, v1, v120
 v_sub_f32 v2, v2, v120
 v_sub_f32 v3, v3, v120
 v_sub_f32 v8, v8, v120
 v_sub_f32 v9, v9, v120
 v_sub_f32 v10, v10, v120
 v_sub_f32 v11, v11, v120
 v_sub_f32 v104, v104, v120
 v_sub_f32 v105, v105, v120
 v_sub_f32 v106, v106, v120
 v_sub_f32 v107, v107, v120
 v_mul_f32 v118, v118, v121
 v_mul_f32 v128, v128, v121
 v_mul_f32 v129, v129, v121
 v_mul_f32 v130, v130, v121
 v_mul_f32 v131, v131, v121
 v_mul_f32 v136, v136, v121
 v_mul_f32 v137, v137, v121
 v_mul_f32 v138, v138, v121
 v_mul_f32 v139, v139, v121
 v_mul_f32 v144, v144, v121
 v_mul_f32 v145, v145, v121
 v_mul_f32 v146, v146, v121
 v_mul_f32 v147, v147, v121
 v_mul_f32 v152, v152, v121
 v_mul_f32 v153, v153, v121
 v_mul_f32 v154, v154, v121
 v_mul_f32 v155, v155, v121
 v_mul_f32 v160, v160, v121
 v_mul_f32 v161, v161, v121
 v_mul_f32 v162, v162, v121
 v_mul_f32 v163, v163, v121
 v_mul_f32 v168, v168, v121
 v_mul_f32 v169, v169, v121
 v_mul_f32 v170, v170, v121
 v_mul_f32 v171, v171, v121
 v_mul_f32 v176, v176, v121
 v_mul_f32 v177, v177, v121
 v_mul_f32 v178, v178, v121
 v_mul_f32 v179, v179, v121
 v_mul_f32 v184, v184, v121
 v_mul_f32 v185, v185, v121
 v_mul_f32 v186, v186, v121
 v_mul_f32 v187, v187, v121
 v_mul_f32 v192, v192, v121
 v_mul_f32 v193, v193, v121
 v_mul_f32 v194, v194, v121
 v_mul_f32 v195, v195, v121
 v_mul_f32 v200, v200, v121
 v_mul_f32 v201, v201, v121
 v_mul_f32 v202, v202, v121
 v_mul_f32 v203, v203, v121
 v_mul_f32 v208, v208, v121
 v_mul_f32 v209, v209, v121
 v_mul_f32 v210, v210, v121
 v_mul_f32 v211, v211, v121
 v_mul_f32 v216, v216, v121
 v_mul_f32 v217, v217, v121
 v_mul_f32 v218, v218, v121
 v_mul_f32 v219, v219, v121
 v_mul_f32 v224, v224, v121
 v_mul_f32 v225, v225, v121
 v_mul_f32 v226, v226, v121
 v_mul_f32 v227, v227, v121
 v_mul_f32 v232, v232, v121
 v_mul_f32 v233, v233, v121
 v_mul_f32 v234, v234, v121
 v_mul_f32 v235, v235, v121
 v_mul_f32 v240, v240, v121
 v_mul_f32 v241, v241, v121
 v_mul_f32 v242, v242, v121
 v_mul_f32 v243, v243, v121
 v_mul_f32 v248, v248, v121
 v_mul_f32 v249, v249, v121
 v_mul_f32 v250, v250, v121
 v_mul_f32 v251, v251, v121
 RA v32, a128
 RA v33, a129
 RA v34, a130
 RA v35, a131
 v_mul_f32 v32, v32, v121
 v_mul_f32 v33, v33, v121
 v_mul_f32 v34, v34, v121
 v_mul_f32 v35, v35, v121
 WA a128, v32
 WA a129, v33
 WA a130, v34
 WA a131, v35
 RA v32, a136
 RA v33, a137
 RA v34, a138
 RA v35, a139
 v_mul_f32 v32, v32, v121
 v_mul_f32 v33, v33, v121
 v_mul_f32 v34, v34, v121
 v_mul_f32 v35, v35, v121
 WA a136, v32
 WA a137, v33
 WA a138, v34
 WA a139, v35
 RA v32, a144
 RA v33, a145
 RA v34, a146
 RA v35, a147
 v_mul_f32 v32, v32, v121
 v_mul_f32 v33, v33, v121
 v_mul_f32 v34, v34, v121
 v_mul_f32 v35, v35, v121
 WA a144, v32
 WA a145, v33
 WA a146, v34
 WA a147, v35
 RA v32, a152
 RA v33, a153
 RA v34, a154
 RA v35, a155
 v_mul_f32 v32, v32, v121
 v_mul_f32 v33, v33, v121
 v_mul_f32 v34, v34, v121
 v_mul_f32 v35, v35, v121
 WA a152, v32
 WA a153, v33
 WA a154, v34
 WA a155, v35
 RA v32, a160
 RA v33, a161
 RA v34, a162
 RA v35, a163
 v_mul_f32 v32, v32, v121
 v_mul_f32 v33, v33, v121
 v_mul_f32 v34, v34, v121
 v_mul_f32 v35, v35, v121
 WA a160, v32
 WA a161, v33
 WA a162, v34
 WA a163, v35
 RA v32, a168
 RA v33, a169
 RA v34, a170
 RA v35, a171
 v_mul_f32 v32, v32, v121
 v_mul_f32 v33, v33, v121
 v_mul_f32 v34, v34, v121
 v_mul_f32 v35, v35, v121
 WA a168, v32
 WA a169, v33
 WA a170, v34
 WA a171, v35
 RA v32, a176
 RA v33, a177
 RA v34, a178
 RA v35, a179
 v_mul_f32 v32, v32, v121
 v_mul_f32 v33, v33, v121
 v_mul_f32 v34, v34, v121
 v_mul_f32 v35, v35, v121
 WA a176, v32
 WA a177, v33
 WA a178, v34
 WA a179, v35
 RA v32, a184
 RA v33, a185
 RA v34, a186
 RA v35, a187
 v_mul_f32 v32, v32, v121
 v_mul_f32 v33, v33, v121
 v_mul_f32 v34, v34, v121
 v_mul_f32 v35, v35, v121
 WA a184, v32
 WA a185, v33
 WA a186, v34
 WA a187, v35
 RA v32, a192
 RA v33, a193
 RA v34, a194
 RA v35, a195
 v_mul_f32 v32, v32, v121
 v_mul_f32 v33, v33, v121
 v_mul_f32 v34, v34, v121
 v_mul_f32 v35, v35, v121
 WA a192, v32
 WA a193, v33
 WA a194, v34
 WA a195, v35
 RA v32, a200
 RA v33, a201
 RA v34, a202
 RA v35, a203
 v_mul_f32 v32, v32, v121
 v_mul_f32 v33, v33, v121
 v_mul_f32 v34, v34, v121
 v_mul_f32 v35, v35, v121
 WA a200, v32
 WA a201, v33
 WA a202, v34
 WA a203, v35
 RA v32, a208
 RA v33, a209
 RA v34, a210
 RA v35, a211
 v_mul_f32 v32, v32, v121
 v_mul_f32 v33, v33, v121
 v_mul_f32 v34, v34, v121
 v_mul_f32 v35, v35, v121
 WA a208, v32
 WA a209, v33
 WA a210, v34
 WA a211, v35
 RA v32, a216
 RA v33, a217
 RA v34, a218
 RA v35, a219
 v_mul_f32 v32, v32, v121
 v_mul_f32 v33, v33, v121
 v_mul_f32 v34, v34, v121
 v_mul_f32 v35, v35, v121
 WA a216, v32
 WA a217, v33
 WA a218, v34
 WA a219, v35
 RA v32, a224
 RA v33, a225
 RA v34, a226
 RA v35, a227
 v_mul_f32 v32, v32, v121
 v_mul_f32 v33, v33, v121
 v_mul_f32 v34, v34, v121
 v_mul_f32 v35, v35, v121
 WA a224, v32
 WA a225, v33
 WA a226, v34
 WA a227, v35
 RA v32, a232
 RA v33, a233
 RA v34, a234
 RA v35, a235
 v_mul_f32 v32, v32, v121
 v_mul_f32 v33, v33, v121
 v_mul_f32 v34, v34, v121
 v_mul_f32 v35, v35, v121
 WA a232, v32
 WA a233, v33
 WA a234, v34
 WA a235, v35
 RA v32, a240
 RA v33, a241
 RA v34, a242
 RA v35, a243
 v_mul_f32 v32, v32, v121
 v_mul_f32 v33, v33, v121
 v_mul_f32 v34, v34, v121
 v_mul_f32 v35, v35, v121
 WA a240, v32
 WA a241, v33
 WA a242, v34
 WA a243, v35
 RA v32, a248
 RA v33, a249
 RA v34, a250
 RA v35, a251
 v_mul_f32 v32, v32, v121
 v_mul_f32 v33, v33, v121
 v_mul_f32 v34, v34, v121
 v_mul_f32 v35, v35, v121
 WA a248, v32
 WA a249, v33
 WA a250, v34
 WA a251, v35
 v_max3_f32 v120, v4, v5, v6
 v_max3_f32 v120, v120, v7, v12
 v_max3_f32 v120, v120, v13, v14
 v_max_f32 v120, v120, v15
 v_mov_b32 v121, v120
 s_nop 1
 v_permlane16_swap_b32 v121, v120
 v_max_f32 v120, v120, v121
 v_mov_b32 v121, v120
 s_nop 1
 v_permlane32_swap_b32 v121, v120
 v_max_f32 v120, v120, v121
 v_max_f32 v120, 0, v120
 v_sub_f32 v121, 0, v120
 v_exp_f32 v121, v121
 v_sub_f32 v4, v4, v120
 v_sub_f32 v5, v5, v120
 v_sub_f32 v6, v6, v120
 v_sub_f32 v7, v7, v120
 v_sub_f32 v12, v12, v120
 v_sub_f32 v13, v13, v120
 v_sub_f32 v14, v14, v120
 v_sub_f32 v15, v15, v120
 v_sub_f32 v108, v108, v120
 v_sub_f32 v109, v109, v120
 v_sub_f32 v110, v110, v120
 v_sub_f32 v111, v111, v120
 v_mul_f32 v119, v119, v121
 v_mul_f32 v132, v132, v121
 v_mul_f32 v133, v133, v121
 v_mul_f32 v134, v134, v121
 v_mul_f32 v135, v135, v121
 v_mul_f32 v140, v140, v121
 v_mul_f32 v141, v141, v121
 v_mul_f32 v142, v142, v121
 v_mul_f32 v143, v143, v121
 v_mul_f32 v148, v148, v121
 v_mul_f32 v149, v149, v121
 v_mul_f32 v150, v150, v121
 v_mul_f32 v151, v151, v121
 v_mul_f32 v156, v156, v121
 v_mul_f32 v157, v157, v121
 v_mul_f32 v158, v158, v121
 v_mul_f32 v159, v159, v121
 v_mul_f32 v164, v164, v121
 v_mul_f32 v165, v165, v121
 v_mul_f32 v166, v166, v121
 v_mul_f32 v167, v167, v121
 v_mul_f32 v172, v172, v121
 v_mul_f32 v173, v173, v121
 v_mul_f32 v174, v174, v121
 v_mul_f32 v175, v175, v121
 v_mul_f32 v180, v180, v121
 v_mul_f32 v181, v181, v121
 v_mul_f32 v182, v182, v121
 v_mul_f32 v183, v183, v121
 v_mul_f32 v188, v188, v121
 v_mul_f32 v189, v189, v121
 v_mul_f32 v190, v190, v121
 v_mul_f32 v191, v191, v121
 v_mul_f32 v196, v196, v121
 v_mul_f32 v197, v197, v121
 v_mul_f32 v198, v198, v121
 v_mul_f32 v199, v199, v121
 v_mul_f32 v204, v204, v121
 v_mul_f32 v205, v205, v121
 v_mul_f32 v206, v206, v121
 v_mul_f32 v207, v207, v121
 v_mul_f32 v212, v212, v121
 v_mul_f32 v213, v213, v121
 v_mul_f32 v214, v214, v121
 v_mul_f32 v215, v215, v121
 v_mul_f32 v220, v220, v121
 v_mul_f32 v221, v221, v121
 v_mul_f32 v222, v222, v121
 v_mul_f32 v223, v223, v121
 v_mul_f32 v228, v228, v121
 v_mul_f32 v229, v229, v121
 v_mul_f32 v230, v230, v121
 v_mul_f32 v231, v231, v121
 v_mul_f32 v236, v236, v121
 v_mul_f32 v237, v237, v121
 v_mul_f32 v238, v238, v121
 v_mul_f32 v239, v239, v121
 v_mul_f32 v244, v244, v121
 v_mul_f32 v245, v245, v121
 v_mul_f32 v246, v246, v121
 v_mul_f32 v247, v247, v121
 v_mul_f32 v252, v252, v121
 v_mul_f32 v253, v253, v121
 v_mul_f32 v254, v254, v121
 v_mul_f32_e64 v255, v255, v121
 RA v32, a132
 RA v33, a133
 RA v34, a134
 RA v35, a135
 v_mul_f32 v32, v32, v121
 v_mul_f32 v33, v33, v121
 v_mul_f32 v34, v34, v121
 v_mul_f32 v35, v35, v121
 WA a132, v32
 WA a133, v33
 WA a134, v34
 WA a135, v35
 RA v32, a140
 RA v33, a141
 RA v34, a142
 RA v35, a143
 v_mul_f32 v32, v32, v121
 v_mul_f32 v33, v33, v121
 v_mul_f32 v34, v34, v121
 v_mul_f32 v35, v35, v121
 WA a140, v32
 WA a141, v33
 WA a142, v34
 WA a143, v35
 RA v32, a148
 RA v33, a149
 RA v34, a150
 RA v35, a151
 v_mul_f32 v32, v32, v121
 v_mul_f32 v33, v33, v121
 v_mul_f32 v34, v34, v121
 v_mul_f32 v35, v35, v121
 WA a148, v32
 WA a149, v33
 WA a150, v34
 WA a151, v35
 RA v32, a156
 RA v33, a157
 RA v34, a158
 RA v35, a159
 v_mul_f32 v32, v32, v121
 v_mul_f32 v33, v33, v121
 v_mul_f32 v34, v34, v121
 v_mul_f32 v35, v35, v121
 WA a156, v32
 WA a157, v33
 WA a158, v34
 WA a159, v35
 RA v32, a164
 RA v33, a165
 RA v34, a166
 RA v35, a167
 v_mul_f32 v32, v32, v121
 v_mul_f32 v33, v33, v121
 v_mul_f32 v34, v34, v121
 v_mul_f32 v35, v35, v121
 WA a164, v32
 WA a165, v33
 WA a166, v34
 WA a167, v35
 RA v32, a172
 RA v33, a173
 RA v34, a174
 RA v35, a175
 v_mul_f32 v32, v32, v121
 v_mul_f32 v33, v33, v121
 v_mul_f32 v34, v34, v121
 v_mul_f32 v35, v35, v121
 WA a172, v32
 WA a173, v33
 WA a174, v34
 WA a175, v35
 RA v32, a180
 RA v33, a181
 RA v34, a182
 RA v35, a183
 v_mul_f32 v32, v32, v121
 v_mul_f32 v33, v33, v121
 v_mul_f32 v34, v34, v121
 v_mul_f32 v35, v35, v121
 WA a180, v32
 WA a181, v33
 WA a182, v34
 WA a183, v35
 RA v32, a188
 RA v33, a189
 RA v34, a190
 RA v35, a191
 v_mul_f32 v32, v32, v121
 v_mul_f32 v33, v33, v121
 v_mul_f32 v34, v34, v121
 v_mul_f32 v35, v35, v121
 WA a188, v32
 WA a189, v33
 WA a190, v34
 WA a191, v35
 RA v32, a196
 RA v33, a197
 RA v34, a198
 RA v35, a199
 v_mul_f32 v32, v32, v121
 v_mul_f32 v33, v33, v121
 v_mul_f32 v34, v34, v121
 v_mul_f32 v35, v35, v121
 WA a196, v32
 WA a197, v33
 WA a198, v34
 WA a199, v35
 RA v32, a204
 RA v33, a205
 RA v34, a206
 RA v35, a207
 v_mul_f32 v32, v32, v121
 v_mul_f32 v33, v33, v121
 v_mul_f32 v34, v34, v121
 v_mul_f32 v35, v35, v121
 WA a204, v32
 WA a205, v33
 WA a206, v34
 WA a207, v35
 RA v32, a212
 RA v33, a213
 RA v34, a214
 RA v35, a215
 v_mul_f32 v32, v32, v121
 v_mul_f32 v33, v33, v121
 v_mul_f32 v34, v34, v121
 v_mul_f32 v35, v35, v121
 WA a212, v32
 WA a213, v33
 WA a214, v34
 WA a215, v35
 RA v32, a220
 RA v33, a221
 RA v34, a222
 RA v35, a223
 v_mul_f32 v32, v32, v121
 v_mul_f32 v33, v33, v121
 v_mul_f32 v34, v34, v121
 v_mul_f32 v35, v35, v121
 WA a220, v32
 WA a221, v33
 WA a222, v34
 WA a223, v35
 RA v32, a228
 RA v33, a229
 RA v34, a230
 RA v35, a231
 v_mul_f32 v32, v32, v121
 v_mul_f32 v33, v33, v121
 v_mul_f32 v34, v34, v121
 v_mul_f32 v35, v35, v121
 WA a228, v32
 WA a229, v33
 WA a230, v34
 WA a231, v35
 RA v32, a236
 RA v33, a237
 RA v34, a238
 RA v35, a239
 v_mul_f32 v32, v32, v121
 v_mul_f32 v33, v33, v121
 v_mul_f32 v34, v34, v121
 v_mul_f32 v35, v35, v121
 WA a236, v32
 WA a237, v33
 WA a238, v34
 WA a239, v35
 RA v32, a244
 RA v33, a245
 RA v34, a246
 RA v35, a247
 v_mul_f32 v32, v32, v121
 v_mul_f32 v33, v33, v121
 v_mul_f32 v34, v34, v121
 v_mul_f32 v35, v35, v121
 WA a244, v32
 WA a245, v33
 WA a246, v34
 WA a247, v35
 RA v32, a252
 RA v33, a253
 RA v34, a254
 RA v35, a255
 v_mul_f32 v32, v32, v121
 v_mul_f32 v33, v33, v121
 v_mul_f32 v34, v34, v121
 v_mul_f32 v35, v35, v121
 WA a252, v32
 WA a253, v33
 WA a254, v34
 WA a255, v35
 s_nop 3
 s_branch attn_kernel_back1
attn_kernel_rare2:
 s_nop 15
 v_max3_f32 v120, v16, v17, v18
 v_max3_f32 v120, v120, v19, v24
 v_max3_f32 v120, v120, v25, v26
 v_max_f32 v120, v120, v27
 v_mov_b32 v121, v120
 s_nop 1
 v_permlane16_swap_b32 v121, v120
 v_max_f32 v120, v120, v121
 v_mov_b32 v121, v120
 s_nop 1
 v_permlane32_swap_b32 v121, v120
 v_max_f32 v120, v120, v121
 v_max_f32 v120, 0, v120
 v_sub_f32 v121, 0, v120
 v_exp_f32 v121, v121
 v_sub_f32 v16, v16, v120
 v_sub_f32 v17, v17, v120
 v_sub_f32 v18, v18, v120
 v_sub_f32 v19, v19, v120
 v_sub_f32 v24, v24, v120
 v_sub_f32 v25, v25, v120
 v_sub_f32 v26, v26, v120
 v_sub_f32 v27, v27, v120
 v_sub_f32 v104, v104, v120
 v_sub_f32 v105, v105, v120
 v_sub_f32 v106, v106, v120
 v_sub_f32 v107, v107, v120
 v_mul_f32 v118, v118, v121
 v_mul_f32 v128, v128, v121
 v_mul_f32 v129, v129, v121
 v_mul_f32 v130, v130, v121
 v_mul_f32 v131, v131, v121
 v_mul_f32 v136, v136, v121
 v_mul_f32 v137, v137, v121
 v_mul_f32 v138, v138, v121
 v_mul_f32 v139, v139, v121
 v_mul_f32 v144, v144, v121
 v_mul_f32 v145, v145, v121
 v_mul_f32 v146, v146, v121
 v_mul_f32 v147, v147, v121
 v_mul_f32 v152, v152, v121
 v_mul_f32 v153, v153, v121
 v_mul_f32 v154, v154, v121
 v_mul_f32 v155, v155, v121
 v_mul_f32 v160, v160, v121
 v_mul_f32 v161, v161, v121
 v_mul_f32 v162, v162, v121
 v_mul_f32 v163, v163, v121
 v_mul_f32 v168, v168, v121
 v_mul_f32 v169, v169, v121
 v_mul_f32 v170, v170, v121
 v_mul_f32 v171, v171, v121
 v_mul_f32 v176, v176, v121
 v_mul_f32 v177, v177, v121
 v_mul_f32 v178, v178, v121
 v_mul_f32 v179, v179, v121
 v_mul_f32 v184, v184, v121
 v_mul_f32 v185, v185, v121
 v_mul_f32 v186, v186, v121
 v_mul_f32 v187, v187, v121
 v_mul_f32 v192, v192, v121
 v_mul_f32 v193, v193, v121
 v_mul_f32 v194, v194, v121
 v_mul_f32 v195, v195, v121
 v_mul_f32 v200, v200, v121
 v_mul_f32 v201, v201, v121
 v_mul_f32 v202, v202, v121
 v_mul_f32 v203, v203, v121
 v_mul_f32 v208, v208, v121
 v_mul_f32 v209, v209, v121
 v_mul_f32 v210, v210, v121
 v_mul_f32 v211, v211, v121
 v_mul_f32 v216, v216, v121
 v_mul_f32 v217, v217, v121
 v_mul_f32 v218, v218, v121
 v_mul_f32 v219, v219, v121
 v_mul_f32 v224, v224, v121
 v_mul_f32 v225, v225, v121
 v_mul_f32 v226, v226, v121
 v_mul_f32 v227, v227, v121
 v_mul_f32 v232, v232, v121
 v_mul_f32 v233, v233, v121
 v_mul_f32 v234, v234, v121
 v_mul_f32 v235, v235, v121
 v_mul_f32 v240, v240, v121
 v_mul_f32 v241, v241, v121
 v_mul_f32 v242, v242, v121
 v_mul_f32 v243, v243, v121
 v_mul_f32 v248, v248, v121
 v_mul_f32 v249, v249, v121
 v_mul_f32 v250, v250, v121
 v_mul_f32 v251, v251, v121
 RA v32, a128
 RA v33, a129
 RA v34, a130
 RA v35, a131
 v_mul_f32 v32, v32, v121
 v_mul_f32 v33, v33, v121
 v_mul_f32 v34, v34, v121
 v_mul_f32 v35, v35, v121
 WA a128, v32
 WA a129, v33
 WA a130, v34
 WA a131, v35
 RA v32, a136
 RA v33, a137
 RA v34, a138
 RA v35, a139
 v_mul_f32 v32, v32, v121
 v_mul_f32 v33, v33, v121
 v_mul_f32 v34, v34, v121
 v_mul_f32 v35, v35, v121
 WA a136, v32
 WA a137, v33
 WA a138, v34
 WA a139, v35
 RA v32, a144
 RA v33, a145
 RA v34, a146
 RA v35, a147
 v_mul_f32 v32, v32, v121
 v_mul_f32 v33, v33, v121
 v_mul_f32 v34, v34, v121
 v_mul_f32 v35, v35, v121
 WA a144, v32
 WA a145, v33
 WA a146, v34
 WA a147, v35
 RA v32, a152
 RA v33, a153
 RA v34, a154
 RA v35, a155
 v_mul_f32 v32, v32, v121
 v_mul_f32 v33, v33, v121
 v_mul_f32 v34, v34, v121
 v_mul_f32 v35, v35, v121
 WA a152, v32
 WA a153, v33
 WA a154, v34
 WA a155, v35
 RA v32, a160
 RA v33, a161
 RA v34, a162
 RA v35, a163
 v_mul_f32 v32, v32, v121
 v_mul_f32 v33, v33, v121
 v_mul_f32 v34, v34, v121
 v_mul_f32 v35, v35, v121
 WA a160, v32
 WA a161, v33
 WA a162, v34
 WA a163, v35
 RA v32, a168
 RA v33, a169
 RA v34, a170
 RA v35, a171
 v_mul_f32 v32, v32, v121
 v_mul_f32 v33, v33, v121
 v_mul_f32 v34, v34, v121
 v_mul_f32 v35, v35, v121
 WA a168, v32
 WA a169, v33
 WA a170, v34
 WA a171, v35
 RA v32, a176
 RA v33, a177
 RA v34, a178
 RA v35, a179
 v_mul_f32 v32, v32, v121
 v_mul_f32 v33, v33, v121
 v_mul_f32 v34, v34, v121
 v_mul_f32 v35, v35, v121
 WA a176, v32
 WA a177, v33
 WA a178, v34
 WA a179, v35
 RA v32, a184
 RA v33, a185
 RA v34, a186
 RA v35, a187
 v_mul_f32 v32, v32, v121
 v_mul_f32 v33, v33, v121
 v_mul_f32 v34, v34, v121
 v_mul_f32 v35, v35, v121
 WA a184, v32
 WA a185, v33
 WA a186, v34
 WA a187, v35
 RA v32, a192
 RA v33, a193
 RA v34, a194
 RA v35, a195
 v_mul_f32 v32, v32, v121
 v_mul_f32 v33, v33, v121
 v_mul_f32 v34, v34, v121
 v_mul_f32 v35, v35, v121
 WA a192, v32
 WA a193, v33
 WA a194, v34
 WA a195, v35
 RA v32, a200
 RA v33, a201
 RA v34, a202
 RA v35, a203
 v_mul_f32 v32, v32, v121
 v_mul_f32 v33, v33, v121
 v_mul_f32 v34, v34, v121
 v_mul_f32 v35, v35, v121
 WA a200, v32
 WA a201, v33
 WA a202, v34
 WA a203, v35
 RA v32, a208
 RA v33, a209
 RA v34, a210
 RA v35, a211
 v_mul_f32 v32, v32, v121
 v_mul_f32 v33, v33, v121
 v_mul_f32 v34, v34, v121
 v_mul_f32 v35, v35, v121
 WA a208, v32
 WA a209, v33
 WA a210, v34
 WA a211, v35
 RA v32, a216
 RA v33, a217
 RA v34, a218
 RA v35, a219
 v_mul_f32 v32, v32, v121
 v_mul_f32 v33, v33, v121
 v_mul_f32 v34, v34, v121
 v_mul_f32 v35, v35, v121
 WA a216, v32
 WA a217, v33
 WA a218, v34
 WA a219, v35
 RA v32, a224
 RA v33, a225
 RA v34, a226
 RA v35, a227
 v_mul_f32 v32, v32, v121
 v_mul_f32 v33, v33, v121
 v_mul_f32 v34, v34, v121
 v_mul_f32 v35, v35, v121
 WA a224, v32
 WA a225, v33
 WA a226, v34
 WA a227, v35
 RA v32, a232
 RA v33, a233
 RA v34, a234
 RA v35, a235
 v_mul_f32 v32, v32, v121
 v_mul_f32 v33, v33, v121
 v_mul_f32 v34, v34, v121
 v_mul_f32 v35, v35, v121
 WA a232, v32
 WA a233, v33
 WA a234, v34
 WA a235, v35
 RA v32, a240
 RA v33, a241
 RA v34, a242
 RA v35, a243
 v_mul_f32 v32, v32, v121
 v_mul_f32 v33, v33, v121
 v_mul_f32 v34, v34, v121
 v_mul_f32 v35, v35, v121
 WA a240, v32
 WA a241, v33
 WA a242, v34
 WA a243, v35
 RA v32, a248
 RA v33, a249
 RA v34, a250
 RA v35, a251
 v_mul_f32 v32, v32, v121
 v_mul_f32 v33, v33, v121
 v_mul_f32 v34, v34, v121
 v_mul_f32 v35, v35, v121
 WA a248, v32
 WA a249, v33
 WA a250, v34
 WA a251, v35
 v_max3_f32 v120, v20, v21, v22
 v_max3_f32 v120, v120, v23, v28
 v_max3_f32 v120, v120, v29, v30
 v_max_f32 v120, v120, v31
 v_mov_b32 v121, v120
 s_nop 1
 v_permlane16_swap_b32 v121, v120
 v_max_f32 v120, v120, v121
 v_mov_b32 v121, v120
 s_nop 1
 v_permlane32_swap_b32 v121, v120
 v_max_f32 v120, v120, v121
 v_max_f32 v120, 0, v120
 v_sub_f32 v121, 0, v120
 v_exp_f32 v121, v121
 v_sub_f32 v20, v20, v120
 v_sub_f32 v21, v21, v120
 v_sub_f32 v22, v22, v120
 v_sub_f32 v23, v23, v120
 v_sub_f32 v28, v28, v120
 v_sub_f32 v29, v29, v120
 v_sub_f32 v30, v30, v120
 v_sub_f32 v31, v31, v120
 v_sub_f32 v108, v108, v120
 v_sub_f32 v109, v109, v120
 v_sub_f32 v110, v110, v120
 v_sub_f32 v111, v111, v120
 v_mul_f32 v119, v119, v121
 v_mul_f32 v132, v132, v121
 v_mul_f32 v133, v133, v121
 v_mul_f32 v134, v134, v121
 v_mul_f32 v135, v135, v121
 v_mul_f32 v140, v140, v121
 v_mul_f32 v141, v141, v121
 v_mul_f32 v142, v142, v121
 v_mul_f32 v143, v143, v121
 v_mul_f32 v148, v148, v121
 v_mul_f32 v149, v149, v121
 v_mul_f32 v150, v150, v121
 v_mul_f32 v151, v151, v121
 v_mul_f32 v156, v156, v121
 v_mul_f32 v157, v157, v121
 v_mul_f32 v158, v158, v121
 v_mul_f32 v159, v159, v121
 v_mul_f32 v164, v164, v121
 v_mul_f32 v165, v165, v121
 v_mul_f32 v166, v166, v121
 v_mul_f32 v167, v167, v121
 v_mul_f32 v172, v172, v121
 v_mul_f32 v173, v173, v121
 v_mul_f32 v174, v174, v121
 v_mul_f32 v175, v175, v121
 v_mul_f32 v180, v180, v121
 v_mul_f32 v181, v181, v121
 v_mul_f32 v182, v182, v121
 v_mul_f32 v183, v183, v121
 v_mul_f32 v188, v188, v121
 v_mul_f32 v189, v189, v121
 v_mul_f32 v190, v190, v121
 v_mul_f32 v191, v191, v121
 v_mul_f32 v196, v196, v121
 v_mul_f32 v197, v197, v121
 v_mul_f32 v198, v198, v121
 v_mul_f32 v199, v199, v121
 v_mul_f32 v204, v204, v121
 v_mul_f32 v205, v205, v121
 v_mul_f32 v206, v206, v121
 v_mul_f32 v207, v207, v121
 v_mul_f32 v212, v212, v121
 v_mul_f32 v213, v213, v121
 v_mul_f32 v214, v214, v121
 v_mul_f32 v215, v215, v121
 v_mul_f32 v220, v220, v121
 v_mul_f32 v221, v221, v121
 v_mul_f32 v222, v222, v121
 v_mul_f32 v223, v223, v121
 v_mul_f32 v228, v228, v121
 v_mul_f32 v229, v229, v121
 v_mul_f32 v230, v230, v121
 v_mul_f32 v231, v231, v121
 v_mul_f32 v236, v236, v121
 v_mul_f32 v237, v237, v121
 v_mul_f32 v238, v238, v121
 v_mul_f32 v239, v239, v121
 v_mul_f32 v244, v244, v121
 v_mul_f32 v245, v245, v121
 v_mul_f32 v246, v246, v121
 v_mul_f32 v247, v247, v121
 v_mul_f32 v252, v252, v121
 v_mul_f32 v253, v253, v121
 v_mul_f32 v254, v254, v121
 v_mul_f32_e64 v255, v255, v121
 RA v32, a132
 RA v33, a133
 RA v34, a134
 RA v35, a135
 v_mul_f32 v32, v32, v121
 v_mul_f32 v33, v33, v121
 v_mul_f32 v34, v34, v121
 v_mul_f32 v35, v35, v121
 WA a132, v32
 WA a133, v33
 WA a134, v34
 WA a135, v35
 RA v32, a140
 RA v33, a141
 RA v34, a142
 RA v35, a143
 v_mul_f32 v32, v32, v121
 v_mul_f32 v33, v33, v121
 v_mul_f32 v34, v34, v121
 v_mul_f32 v35, v35, v121
 WA a140, v32
 WA a141, v33
 WA a142, v34
 WA a143, v35
 RA v32, a148
 RA v33, a149
 RA v34, a150
 RA v35, a151
 v_mul_f32 v32, v32, v121
 v_mul_f32 v33, v33, v121
 v_mul_f32 v34, v34, v121
 v_mul_f32 v35, v35, v121
 WA a148, v32
 WA a149, v33
 WA a150, v34
 WA a151, v35
 RA v32, a156
 RA v33, a157
 RA v34, a158
 RA v35, a159
 v_mul_f32 v32, v32, v121
 v_mul_f32 v33, v33, v121
 v_mul_f32 v34, v34, v121
 v_mul_f32 v35, v35, v121
 WA a156, v32
 WA a157, v33
 WA a158, v34
 WA a159, v35
 RA v32, a164
 RA v33, a165
 RA v34, a166
 RA v35, a167
 v_mul_f32 v32, v32, v121
 v_mul_f32 v33, v33, v121
 v_mul_f32 v34, v34, v121
 v_mul_f32 v35, v35, v121
 WA a164, v32
 WA a165, v33
 WA a166, v34
 WA a167, v35
 RA v32, a172
 RA v33, a173
 RA v34, a174
 RA v35, a175
 v_mul_f32 v32, v32, v121
 v_mul_f32 v33, v33, v121
 v_mul_f32 v34, v34, v121
 v_mul_f32 v35, v35, v121
 WA a172, v32
 WA a173, v33
 WA a174, v34
 WA a175, v35
 RA v32, a180
 RA v33, a181
 RA v34, a182
 RA v35, a183
 v_mul_f32 v32, v32, v121
 v_mul_f32 v33, v33, v121
 v_mul_f32 v34, v34, v121
 v_mul_f32 v35, v35, v121
 WA a180, v32
 WA a181, v33
 WA a182, v34
 WA a183, v35
 RA v32, a188
 RA v33, a189
 RA v34, a190
 RA v35, a191
 v_mul_f32 v32, v32, v121
 v_mul_f32 v33, v33, v121
 v_mul_f32 v34, v34, v121
 v_mul_f32 v35, v35, v121
 WA a188, v32
 WA a189, v33
 WA a190, v34
 WA a191, v35
 RA v32, a196
 RA v33, a197
 RA v34, a198
 RA v35, a199
 v_mul_f32 v32, v32, v121
 v_mul_f32 v33, v33, v121
 v_mul_f32 v34, v34, v121
 v_mul_f32 v35, v35, v121
 WA a196, v32
 WA a197, v33
 WA a198, v34
 WA a199, v35
 RA v32, a204
 RA v33, a205
 RA v34, a206
 RA v35, a207
 v_mul_f32 v32, v32, v121
 v_mul_f32 v33, v33, v121
 v_mul_f32 v34, v34, v121
 v_mul_f32 v35, v35, v121
 WA a204, v32
 WA a205, v33
 WA a206, v34
 WA a207, v35
 RA v32, a212
 RA v33, a213
 RA v34, a214
 RA v35, a215
 v_mul_f32 v32, v32, v121
 v_mul_f32 v33, v33, v121
 v_mul_f32 v34, v34, v121
 v_mul_f32 v35, v35, v121
 WA a212, v32
 WA a213, v33
 WA a214, v34
 WA a215, v35
 RA v32, a220
 RA v33, a221
 RA v34, a222
 RA v35, a223
 v_mul_f32 v32, v32, v121
 v_mul_f32 v33, v33, v121
 v_mul_f32 v34, v34, v121
 v_mul_f32 v35, v35, v121
 WA a220, v32
 WA a221, v33
 WA a222, v34
 WA a223, v35
 RA v32, a228
 RA v33, a229
 RA v34, a230
 RA v35, a231
 v_mul_f32 v32, v32, v121
 v_mul_f32 v33, v33, v121
 v_mul_f32 v34, v34, v121
 v_mul_f32 v35, v35, v121
 WA a228, v32
 WA a229, v33
 WA a230, v34
 WA a231, v35
 RA v32, a236
 RA v33, a237
 RA v34, a238
 RA v35, a239
 v_mul_f32 v32, v32, v121
 v_mul_f32 v33, v33, v121
 v_mul_f32 v34, v34, v121
 v_mul_f32 v35, v35, v121
 WA a236, v32
 WA a237, v33
 WA a238, v34
 WA a239, v35
 RA v32, a244
 RA v33, a245
 RA v34, a246
 RA v35, a247
 v_mul_f32 v32, v32, v121
 v_mul_f32 v33, v33, v121
 v_mul_f32 v34, v34, v121
 v_mul_f32 v35, v35, v121
 WA a244, v32
 WA a245, v33
 WA a246, v34
 WA a247, v35
 RA v32, a252
 RA v33, a253
 RA v34, a254
 RA v35, a255
 v_mul_f32 v32, v32, v121
 v_mul_f32 v33, v33, v121
 v_mul_f32 v34, v34, v121
 v_mul_f32 v35, v35, v121
 WA a252, v32
 WA a253, v33
 WA a254, v34
 WA a255, v35
 s_nop 3
 s_branch attn_kernel_back2
attn_kernel_rare3:
 s_nop 15
 v_max3_f32 v120, v0, v1, v2
 v_max3_f32 v120, v120, v3, v8
 v_max3_f32 v120, v120, v9, v10
 v_max_f32 v120, v120, v11
 v_mov_b32 v121, v120
 s_nop 1
 v_permlane16_swap_b32 v121, v120
 v_max_f32 v120, v120, v121
 v_mov_b32 v121, v120
 s_nop 1
 v_permlane32_swap_b32 v121, v120
 v_max_f32 v120, v120, v121
 v_max_f32 v120, 0, v120
 v_sub_f32 v121, 0, v120
 v_exp_f32 v121, v121
 v_sub_f32 v0, v0, v120
 v_sub_f32 v1, v1, v120
 v_sub_f32 v2, v2, v120
 v_sub_f32 v3, v3, v120
 v_sub_f32 v8, v8, v120
 v_sub_f32 v9, v9, v120
 v_sub_f32 v10, v10, v120
 v_sub_f32 v11, v11, v120
 v_sub_f32 v104, v104, v120
 v_sub_f32 v105, v105, v120
 v_sub_f32 v106, v106, v120
 v_sub_f32 v107, v107, v120
 v_mul_f32 v118, v118, v121
 v_mul_f32 v128, v128, v121
 v_mul_f32 v129, v129, v121
 v_mul_f32 v130, v130, v121
 v_mul_f32 v131, v131, v121
 v_mul_f32 v136, v136, v121
 v_mul_f32 v137, v137, v121
 v_mul_f32 v138, v138, v121
 v_mul_f32 v139, v139, v121
 v_mul_f32 v144, v144, v121
 v_mul_f32 v145, v145, v121
 v_mul_f32 v146, v146, v121
 v_mul_f32 v147, v147, v121
 v_mul_f32 v152, v152, v121
 v_mul_f32 v153, v153, v121
 v_mul_f32 v154, v154, v121
 v_mul_f32 v155, v155, v121
 v_mul_f32 v160, v160, v121
 v_mul_f32 v161, v161, v121
 v_mul_f32 v162, v162, v121
 v_mul_f32 v163, v163, v121
 v_mul_f32 v168, v168, v121
 v_mul_f32 v169, v169, v121
 v_mul_f32 v170, v170, v121
 v_mul_f32 v171, v171, v121
 v_mul_f32 v176, v176, v121
 v_mul_f32 v177, v177, v121
 v_mul_f32 v178, v178, v121
 v_mul_f32 v179, v179, v121
 v_mul_f32 v184, v184, v121
 v_mul_f32 v185, v185, v121
 v_mul_f32 v186, v186, v121
 v_mul_f32 v187, v187, v121
 v_mul_f32 v192, v192, v121
 v_mul_f32 v193, v193, v121
 v_mul_f32 v194, v194, v121
 v_mul_f32 v195, v195, v121
 v_mul_f32 v200, v200, v121
 v_mul_f32 v201, v201, v121
 v_mul_f32 v202, v202, v121
 v_mul_f32 v203, v203, v121
 v_mul_f32 v208, v208, v121
 v_mul_f32 v209, v209, v121
 v_mul_f32 v210, v210, v121
 v_mul_f32 v211, v211, v121
 v_mul_f32 v216, v216, v121
 v_mul_f32 v217, v217, v121
 v_mul_f32 v218, v218, v121
 v_mul_f32 v219, v219, v121
 v_mul_f32 v224, v224, v121
 v_mul_f32 v225, v225, v121
 v_mul_f32 v226, v226, v121
 v_mul_f32 v227, v227, v121
 v_mul_f32 v232, v232, v121
 v_mul_f32 v233, v233, v121
 v_mul_f32 v234, v234, v121
 v_mul_f32 v235, v235, v121
 v_mul_f32 v240, v240, v121
 v_mul_f32 v241, v241, v121
 v_mul_f32 v242, v242, v121
 v_mul_f32 v243, v243, v121
 v_mul_f32 v248, v248, v121
 v_mul_f32 v249, v249, v121
 v_mul_f32 v250, v250, v121
 v_mul_f32 v251, v251, v121
 RA v32, a128
 RA v33, a129
 RA v34, a130
 RA v35, a131
 v_mul_f32 v32, v32, v121
 v_mul_f32 v33, v33, v121
 v_mul_f32 v34, v34, v121
 v_mul_f32 v35, v35, v121
 WA a128, v32
 WA a129, v33
 WA a130, v34
 WA a131, v35
 RA v32, a136
 RA v33, a137
 RA v34, a138
 RA v35, a139
 v_mul_f32 v32, v32, v121
 v_mul_f32 v33, v33, v121
 v_mul_f32 v34, v34, v121
 v_mul_f32 v35, v35, v121
 WA a136, v32
 WA a137, v33
 WA a138, v34
 WA a139, v35
 RA v32, a144
 RA v33, a145
 RA v34, a146
 RA v35, a147
 v_mul_f32 v32, v32, v121
 v_mul_f32 v33, v33, v121
 v_mul_f32 v34, v34, v121
 v_mul_f32 v35, v35, v121
 WA a144, v32
 WA a145, v33
 WA a146, v34
 WA a147, v35
 RA v32, a152
 RA v33, a153
 RA v34, a154
 RA v35, a155
 v_mul_f32 v32, v32, v121
 v_mul_f32 v33, v33, v121
 v_mul_f32 v34, v34, v121
 v_mul_f32 v35, v35, v121
 WA a152, v32
 WA a153, v33
 WA a154, v34
 WA a155, v35
 RA v32, a160
 RA v33, a161
 RA v34, a162
 RA v35, a163
 v_mul_f32 v32, v32, v121
 v_mul_f32 v33, v33, v121
 v_mul_f32 v34, v34, v121
 v_mul_f32 v35, v35, v121
 WA a160, v32
 WA a161, v33
 WA a162, v34
 WA a163, v35
 RA v32, a168
 RA v33, a169
 RA v34, a170
 RA v35, a171
 v_mul_f32 v32, v32, v121
 v_mul_f32 v33, v33, v121
 v_mul_f32 v34, v34, v121
 v_mul_f32 v35, v35, v121
 WA a168, v32
 WA a169, v33
 WA a170, v34
 WA a171, v35
 RA v32, a176
 RA v33, a177
 RA v34, a178
 RA v35, a179
 v_mul_f32 v32, v32, v121
 v_mul_f32 v33, v33, v121
 v_mul_f32 v34, v34, v121
 v_mul_f32 v35, v35, v121
 WA a176, v32
 WA a177, v33
 WA a178, v34
 WA a179, v35
 RA v32, a184
 RA v33, a185
 RA v34, a186
 RA v35, a187
 v_mul_f32 v32, v32, v121
 v_mul_f32 v33, v33, v121
 v_mul_f32 v34, v34, v121
 v_mul_f32 v35, v35, v121
 WA a184, v32
 WA a185, v33
 WA a186, v34
 WA a187, v35
 RA v32, a192
 RA v33, a193
 RA v34, a194
 RA v35, a195
 v_mul_f32 v32, v32, v121
 v_mul_f32 v33, v33, v121
 v_mul_f32 v34, v34, v121
 v_mul_f32 v35, v35, v121
 WA a192, v32
 WA a193, v33
 WA a194, v34
 WA a195, v35
 RA v32, a200
 RA v33, a201
 RA v34, a202
 RA v35, a203
 v_mul_f32 v32, v32, v121
 v_mul_f32 v33, v33, v121
 v_mul_f32 v34, v34, v121
 v_mul_f32 v35, v35, v121
 WA a200, v32
 WA a201, v33
 WA a202, v34
 WA a203, v35
 RA v32, a208
 RA v33, a209
 RA v34, a210
 RA v35, a211
 v_mul_f32 v32, v32, v121
 v_mul_f32 v33, v33, v121
 v_mul_f32 v34, v34, v121
 v_mul_f32 v35, v35, v121
 WA a208, v32
 WA a209, v33
 WA a210, v34
 WA a211, v35
 RA v32, a216
 RA v33, a217
 RA v34, a218
 RA v35, a219
 v_mul_f32 v32, v32, v121
 v_mul_f32 v33, v33, v121
 v_mul_f32 v34, v34, v121
 v_mul_f32 v35, v35, v121
 WA a216, v32
 WA a217, v33
 WA a218, v34
 WA a219, v35
 RA v32, a224
 RA v33, a225
 RA v34, a226
 RA v35, a227
 v_mul_f32 v32, v32, v121
 v_mul_f32 v33, v33, v121
 v_mul_f32 v34, v34, v121
 v_mul_f32 v35, v35, v121
 WA a224, v32
 WA a225, v33
 WA a226, v34
 WA a227, v35
 RA v32, a232
 RA v33, a233
 RA v34, a234
 RA v35, a235
 v_mul_f32 v32, v32, v121
 v_mul_f32 v33, v33, v121
 v_mul_f32 v34, v34, v121
 v_mul_f32 v35, v35, v121
 WA a232, v32
 WA a233, v33
 WA a234, v34
 WA a235, v35
 RA v32, a240
 RA v33, a241
 RA v34, a242
 RA v35, a243
 v_mul_f32 v32, v32, v121
 v_mul_f32 v33, v33, v121
 v_mul_f32 v34, v34, v121
 v_mul_f32 v35, v35, v121
 WA a240, v32
 WA a241, v33
 WA a242, v34
 WA a243, v35
 RA v32, a248
 RA v33, a249
 RA v34, a250
 RA v35, a251
 v_mul_f32 v32, v32, v121
 v_mul_f32 v33, v33, v121
 v_mul_f32 v34, v34, v121
 v_mul_f32 v35, v35, v121
 WA a248, v32
 WA a249, v33
 WA a250, v34
 WA a251, v35
 v_max3_f32 v120, v4, v5, v6
 v_max3_f32 v120, v120, v7, v12
 v_max3_f32 v120, v120, v13, v14
 v_max_f32 v120, v120, v15
 v_mov_b32 v121, v120
 s_nop 1
 v_permlane16_swap_b32 v121, v120
 v_max_f32 v120, v120, v121
 v_mov_b32 v121, v120
 s_nop 1
 v_permlane32_swap_b32 v121, v120
 v_max_f32 v120, v120, v121
 v_max_f32 v120, 0, v120
 v_sub_f32 v121, 0, v120
 v_exp_f32 v121, v121
 v_sub_f32 v4, v4, v120
 v_sub_f32 v5, v5, v120
 v_sub_f32 v6, v6, v120
 v_sub_f32 v7, v7, v120
 v_sub_f32 v12, v12, v120
 v_sub_f32 v13, v13, v120
 v_sub_f32 v14, v14, v120
 v_sub_f32 v15, v15, v120
 v_sub_f32 v108, v108, v120
 v_sub_f32 v109, v109, v120
 v_sub_f32 v110, v110, v120
 v_sub_f32 v111, v111, v120
 v_mul_f32 v119, v119, v121
 v_mul_f32 v132, v132, v121
 v_mul_f32 v133, v133, v121
 v_mul_f32 v134, v134, v121
 v_mul_f32 v135, v135, v121
 v_mul_f32 v140, v140, v121
 v_mul_f32 v141, v141, v121
 v_mul_f32 v142, v142, v121
 v_mul_f32 v143, v143, v121
 v_mul_f32 v148, v148, v121
 v_mul_f32 v149, v149, v121
 v_mul_f32 v150, v150, v121
 v_mul_f32 v151, v151, v121
 v_mul_f32 v156, v156, v121
 v_mul_f32 v157, v157, v121
 v_mul_f32 v158, v158, v121
 v_mul_f32 v159, v159, v121
 v_mul_f32 v164, v164, v121
 v_mul_f32 v165, v165, v121
 v_mul_f32 v166, v166, v121
 v_mul_f32 v167, v167, v121
 v_mul_f32 v172, v172, v121
 v_mul_f32 v173, v173, v121
 v_mul_f32 v174, v174, v121
 v_mul_f32 v175, v175, v121
 v_mul_f32 v180, v180, v121
 v_mul_f32 v181, v181, v121
 v_mul_f32 v182, v182, v121
 v_mul_f32 v183, v183, v121
 v_mul_f32 v188, v188, v121
 v_mul_f32 v189, v189, v121
 v_mul_f32 v190, v190, v121
 v_mul_f32 v191, v191, v121
 v_mul_f32 v196, v196, v121
 v_mul_f32 v197, v197, v121
 v_mul_f32 v198, v198, v121
 v_mul_f32 v199, v199, v121
 v_mul_f32 v204, v204, v121
 v_mul_f32 v205, v205, v121
 v_mul_f32 v206, v206, v121
 v_mul_f32 v207, v207, v121
 v_mul_f32 v212, v212, v121
 v_mul_f32 v213, v213, v121
 v_mul_f32 v214, v214, v121
 v_mul_f32 v215, v215, v121
 v_mul_f32 v220, v220, v121
 v_mul_f32 v221, v221, v121
 v_mul_f32 v222, v222, v121
 v_mul_f32 v223, v223, v121
 v_mul_f32 v228, v228, v121
 v_mul_f32 v229, v229, v121
 v_mul_f32 v230, v230, v121
 v_mul_f32 v231, v231, v121
 v_mul_f32 v236, v236, v121
 v_mul_f32 v237, v237, v121
 v_mul_f32 v238, v238, v121
 v_mul_f32 v239, v239, v121
 v_mul_f32 v244, v244, v121
 v_mul_f32 v245, v245, v121
 v_mul_f32 v246, v246, v121
 v_mul_f32 v247, v247, v121
 v_mul_f32 v252, v252, v121
 v_mul_f32 v253, v253, v121
 v_mul_f32 v254, v254, v121
 v_mul_f32_e64 v255, v255, v121
 RA v32, a132
 RA v33, a133
 RA v34, a134
 RA v35, a135
 v_mul_f32 v32, v32, v121
 v_mul_f32 v33, v33, v121
 v_mul_f32 v34, v34, v121
 v_mul_f32 v35, v35, v121
 WA a132, v32
 WA a133, v33
 WA a134, v34
 WA a135, v35
 RA v32, a140
 RA v33, a141
 RA v34, a142
 RA v35, a143
 v_mul_f32 v32, v32, v121
 v_mul_f32 v33, v33, v121
 v_mul_f32 v34, v34, v121
 v_mul_f32 v35, v35, v121
 WA a140, v32
 WA a141, v33
 WA a142, v34
 WA a143, v35
 RA v32, a148
 RA v33, a149
 RA v34, a150
 RA v35, a151
 v_mul_f32 v32, v32, v121
 v_mul_f32 v33, v33, v121
 v_mul_f32 v34, v34, v121
 v_mul_f32 v35, v35, v121
 WA a148, v32
 WA a149, v33
 WA a150, v34
 WA a151, v35
 RA v32, a156
 RA v33, a157
 RA v34, a158
 RA v35, a159
 v_mul_f32 v32, v32, v121
 v_mul_f32 v33, v33, v121
 v_mul_f32 v34, v34, v121
 v_mul_f32 v35, v35, v121
 WA a156, v32
 WA a157, v33
 WA a158, v34
 WA a159, v35
 RA v32, a164
 RA v33, a165
 RA v34, a166
 RA v35, a167
 v_mul_f32 v32, v32, v121
 v_mul_f32 v33, v33, v121
 v_mul_f32 v34, v34, v121
 v_mul_f32 v35, v35, v121
 WA a164, v32
 WA a165, v33
 WA a166, v34
 WA a167, v35
 RA v32, a172
 RA v33, a173
 RA v34, a174
 RA v35, a175
 v_mul_f32 v32, v32, v121
 v_mul_f32 v33, v33, v121
 v_mul_f32 v34, v34, v121
 v_mul_f32 v35, v35, v121
 WA a172, v32
 WA a173, v33
 WA a174, v34
 WA a175, v35
 RA v32, a180
 RA v33, a181
 RA v34, a182
 RA v35, a183
 v_mul_f32 v32, v32, v121
 v_mul_f32 v33, v33, v121
 v_mul_f32 v34, v34, v121
 v_mul_f32 v35, v35, v121
 WA a180, v32
 WA a181, v33
 WA a182, v34
 WA a183, v35
 RA v32, a188
 RA v33, a189
 RA v34, a190
 RA v35, a191
 v_mul_f32 v32, v32, v121
 v_mul_f32 v33, v33, v121
 v_mul_f32 v34, v34, v121
 v_mul_f32 v35, v35, v121
 WA a188, v32
 WA a189, v33
 WA a190, v34
 WA a191, v35
 RA v32, a196
 RA v33, a197
 RA v34, a198
 RA v35, a199
 v_mul_f32 v32, v32, v121
 v_mul_f32 v33, v33, v121
 v_mul_f32 v34, v34, v121
 v_mul_f32 v35, v35, v121
 WA a196, v32
 WA a197, v33
 WA a198, v34
 WA a199, v35
 RA v32, a204
 RA v33, a205
 RA v34, a206
 RA v35, a207
 v_mul_f32 v32, v32, v121
 v_mul_f32 v33, v33, v121
 v_mul_f32 v34, v34, v121
 v_mul_f32 v35, v35, v121
 WA a204, v32
 WA a205, v33
 WA a206, v34
 WA a207, v35
 RA v32, a212
 RA v33, a213
 RA v34, a214
 RA v35, a215
 v_mul_f32 v32, v32, v121
 v_mul_f32 v33, v33, v121
 v_mul_f32 v34, v34, v121
 v_mul_f32 v35, v35, v121
 WA a212, v32
 WA a213, v33
 WA a214, v34
 WA a215, v35
 RA v32, a220
 RA v33, a221
 RA v34, a222
 RA v35, a223
 v_mul_f32 v32, v32, v121
 v_mul_f32 v33, v33, v121
 v_mul_f32 v34, v34, v121
 v_mul_f32 v35, v35, v121
 WA a220, v32
 WA a221, v33
 WA a222, v34
 WA a223, v35
 RA v32, a228
 RA v33, a229
 RA v34, a230
 RA v35, a231
 v_mul_f32 v32, v32, v121
 v_mul_f32 v33, v33, v121
 v_mul_f32 v34, v34, v121
 v_mul_f32 v35, v35, v121
 WA a228, v32
 WA a229, v33
 WA a230, v34
 WA a231, v35
 RA v32, a236
 RA v33, a237
 RA v34, a238
 RA v35, a239
 v_mul_f32 v32, v32, v121
 v_mul_f32 v33, v33, v121
 v_mul_f32 v34, v34, v121
 v_mul_f32 v35, v35, v121
 WA a236, v32
 WA a237, v33
 WA a238, v34
 WA a239, v35
 RA v32, a244
 RA v33, a245
 RA v34, a246
 RA v35, a247
 v_mul_f32 v32, v32, v121
 v_mul_f32 v33, v33, v121
 v_mul_f32 v34, v34, v121
 v_mul_f32 v35, v35, v121
 WA a244, v32
 WA a245, v33
 WA a246, v34
 WA a247, v35
 RA v32, a252
 RA v33, a253
 RA v34, a254
 RA v35, a255
 v_mul_f32 v32, v32, v121
 v_mul_f32 v33, v33, v121
 v_mul_f32 v34, v34, v121
 v_mul_f32 v35, v35, v121
 WA a252, v32
 WA a253, v33
 WA a254, v34
 WA a255, v35
 s_nop 3
 s_branch attn_kernel_back3
.p2align 8
tail_kernel:
tail_body:
 s_and_b32 s6, s2, 3
 s_lshl_b32 s6, s6, 4
 s_lshr_b32 s32, s2, 4
 s_add_u32 s6, s6, s32
 s_cmp_ge_u32 s6, 63
 s_cbranch_scc1 tail_kernel_out
 s_load_dwordx2 s[52:53], s[0:1], 0
 s_load_dwordx2 s[54:55], s[0:1], 64
 v_mov_b32 v70, 1
 v_mov_b32 v71, 0
 s_waitcnt vmcnt(0)
 s_mov_b64 exec, 1
 buffer_atomic_add v70, v71, s[8:11], s87 offen sc1
 s_mov_b64 exec, -1
 s_getpc_b64 s[60:61]
tail_kernel_pf9082:
 s_add_u32 s60, s60, tail_kernel-tail_kernel_pf9082
 s_addc_u32 s61, s61, -1
 v_lshlrev_b32 v60, 7, v0
 v_min_u32 v61, tail_kernel_end-tail_kernel, v60
 global_load_dword v61, v61, s[60:61]
 v_add_u32 v60, 0x8000, v60
 v_min_u32 v62, tail_kernel_end-tail_kernel, v60
 global_load_dword v62, v62, s[60:61]
 s_bfe_u32 s37, s2, 0x10003
 s_xor_b32 s37, s37, 1
 s_bfe_u32 s38, s2, 0x10002
 s_mov_b32 s90, 0xffff0000
 v_lshrrev_b32 v1, 6, v0
 v_and_b32 v244, 63, v0
 v_readfirstlane_b32 s3, v1
 v_lshlrev_b32 v245, 4, v244
 v_lshrrev_b32 v247, 4, v244
 v_and_b32_e64 v246, 15, v244
 s_lshl_b32 s7, s37, 2
 s_add_u32 s7, s7, s3
 s_mul_i32 s46, s7, 36864
 s_add_u32 s46, s46, 91996160
 s_lshl_b32 s7, s7, 17
 s_add_u32 s7, s7, 89653248
 s_lshl_b32 s36, s3, 14
 s_add_u32 s36, s36, 98304
 s_cmp_eq_u32 s6, 0
 s_cselect_b32 s41, 0x40000000, 0
 s_mul_i32 s47, s38, 4096000
 s_cmp_eq_u32 s37, 0
 s_cbranch_scc1 tail_kernel_glob
 s_add_u32 s32, s47, 25133056
 s_add_u32 s12, s4, s32
 s_addc_u32 s13, s5, 0
 s_and_b32 s13, s13, 0xffff
 s_mov_b32 s14, 4128768
 s_mov_b32 s15, 0x00020000
 v_lshrrev_b32 v8, 1, v246
 v_lshlrev_b32 v242, 14, v8
 v_lshl_add_u32 v242, v247, 5, v242
 v_and_b32_e64 v9, 1, v246
 v_lshl_add_u32 v242, v9, 4, v242
 v_cmp_gt_u32 vcc, 2, v8
 v_mov_b32 v9, s41
 s_nop 0
 v_cndmask_b32 v9, 0, v9, vcc
 v_or_b32 v242, v242, v9
 s_lshl_b32 s32, s6, 16
 s_lshl_b32 s33, s3, 10
 s_add_u32 s32, s32, s33
 s_mul_i32 s42, s3, 9216
 s_add_u32 s42, s42, 91848704
 s_add_u32 m0, s36, 0
 s_add_u32 s34, s32, 0
 buffer_load_dwordx4 v242, s[12:15], s34 offen sc1 lds
 s_add_u32 m0, s36, 1040
 s_add_u32 s34, s32, 128
 buffer_load_dwordx4 v242, s[12:15], s34 offen sc1 lds
 s_add_u32 m0, s36, 2080
 s_add_u32 s34, s32, 256
 buffer_load_dwordx4 v242, s[12:15], s34 offen sc1 lds
 s_add_u32 m0, s36, 3120
 s_add_u32 s34, s32, 384
 buffer_load_dwordx4 v242, s[12:15], s34 offen sc1 lds
 s_add_u32 m0, s36, 4160
 s_add_u32 s34, s32, 512
 buffer_load_dwordx4 v242, s[12:15], s34 offen sc1 lds
 s_add_u32 m0, s36, 5200
 s_add_u32 s34, s32, 640
 buffer_load_dwordx4 v242, s[12:15], s34 offen sc1 lds
 s_add_u32 m0, s36, 6240
 s_add_u32 s34, s32, 768
 buffer_load_dwordx4 v242, s[12:15], s34 offen sc1 lds
 s_add_u32 m0, s36, 7280
 s_add_u32 s34, s32, 896
 buffer_load_dwordx4 v242, s[12:15], s34 offen sc1 lds
 s_add_u32 m0, s36, 8320
 s_add_u32 s34, s32, 4096
 buffer_load_dwordx4 v242, s[12:15], s34 offen sc1 lds
 s_add_u32 m0, s36, 9360
 s_add_u32 s34, s32, 4224
 buffer_load_dwordx4 v242, s[12:15], s34 offen sc1 lds
 s_add_u32 m0, s36, 10400
 s_add_u32 s34, s32, 4352
 buffer_load_dwordx4 v242, s[12:15], s34 offen sc1 lds
 s_add_u32 m0, s36, 11440
 s_add_u32 s34, s32, 4480
 buffer_load_dwordx4 v242, s[12:15], s34 offen sc1 lds
 s_add_u32 s43, s42, 0
 buffer_load_dwordx4 a[136:139], v245, s[8:11], s43 offen offset:0
 s_add_u32 s35, s47, 16760832
 s_add_u32 s16, s4, s35
 s_addc_u32 s17, s5, 0
 s_and_b32 s17, s17, 0xffff
 s_mov_b32 s18, 4112384
 s_mov_b32 s19, 0x00020000
 v_and_b32 v8, 3, v244
 v_mul_u32_u24 v8, 3, v8
 v_lshrrev_b32 v9, 2, v244
 s_mul_i32 s44, s3, 6144
 v_add_u32_e64 v10, 0, v244
 v_mul_u32_u24 v12, 0x1556, v10
 v_lshrrev_b32 v12, 16, v12
 v_mul_u32_u24 v11, 12, v12
 v_sub_u32 v10, v10, v11
 v_lshrrev_b32 v11, 1, v10
 v_lshlrev_b32_e64 v253, 14, v11
 v_lshl_add_u32 v253, v12, 5, v253
 v_and_b32_e64 v10, 1, v10
 v_lshl_add_u32 v253, v10, 4, v253
 v_cmp_eq_u32 vcc, 0, v11
 v_mov_b32 v10, s41
 s_nop 0
 v_cndmask_b32 v10, 0, v10, vcc
 v_or_b32 v253, v253, v10
 v_add_u32 v10, 64, v244
 v_mul_u32_u24 v12, 0x1556, v10
 v_lshrrev_b32 v12, 16, v12
 v_mul_u32_u24 v11, 12, v12
 v_sub_u32 v10, v10, v11
 v_lshrrev_b32 v11, 1, v10
 v_lshlrev_b32_e64 v255, 14, v11
 v_lshl_add_u32 v255, v12, 5, v255
 v_and_b32_e64 v10, 1, v10
 v_lshl_add_u32 v255, v10, 4, v255
 v_cmp_eq_u32 vcc, 0, v11
 v_mov_b32 v10, s41
 s_nop 0
 v_cndmask_b32 v10, 0, v10, vcc
 v_or_b32_e64 v255, v255, v10
 v_add_u32 v10, 128, v244
 v_mul_u32_u24 v12, 0x1556, v10
 v_lshrrev_b32 v12, 16, v12
 v_mul_u32_u24 v11, 12, v12
 v_sub_u32 v10, v10, v11
 v_lshrrev_b32 v11, 1, v10
 v_lshlrev_b32_e64 v250, 14, v11
 v_lshl_add_u32 v250, v12, 5, v250
 v_and_b32_e64 v10, 1, v10
 v_lshl_add_u32 v250, v10, 4, v250
 v_cmp_eq_u32 vcc, 0, v11
 v_mov_b32 v10, s41
 s_nop 0
 v_cndmask_b32 v10, 0, v10, vcc
 v_or_b32 v250, v250, v10
 v_lshlrev_b32 v8, 4, v8
 v_lshl_add_u32 v243, v9, 8, v8
 v_lshl_add_u32 v243, v247, 4, v243
 v_add_u32_e64 v243, s36, v243
 v_mul_u32_u24 v254, 192, v9
 v_add_u32_e64 v254, v8, v254
 s_mul_i32 s33, s3, 6144
 v_add_u32_e64 v254, s33, v254
 v_bfe_u32 v8, v244, 2, 2
 v_lshl_add_u32 v8, v247, 3, v8
 v_mul_u32_u24 v251, 192, v8
 v_and_b32_e64 v8, 3, v244
 v_lshl_add_u32 v251, v8, 4, v251
 v_add_u32 v252, 49152, v251
 s_waitcnt lgkmcnt(0)
 s_add_u32 s24, s52, s47
 s_addc_u32 s25, s53, 0
 s_and_b32 s25, s25, 0xffff
 s_mov_b32 s26, 4096000
 s_mov_b32 s27, 0x00020000
 s_lshl_b32 s49, s6, 16
 s_lshl_b32 s50, s3, 8
 s_add_u32 s49, s49, s50
 s_lshl_b32 s50, s37, 7
 s_add_u32 s49, s49, s50
 v_lshlrev_b32_e64 v248, 10, v246
 v_lshl_add_u32 v248, v247, 4, v248
 buffer_load_dwordx4 a[140:143], v245, s[8:11], s43 offen offset:1024
 buffer_load_dwordx4 a[144:147], v245, s[8:11], s43 offen offset:2048
 buffer_load_dwordx4 a[148:151], v245, s[8:11], s43 offen offset:3072
 s_add_u32 s43, s42, 4096
 buffer_load_dwordx4 a[152:155], v245, s[8:11], s43 offen offset:0
 s_add_u32 m0, s44, 0
 s_add_u32 s45, s32, 0
 buffer_load_dwordx4 v253, s[16:19], s45 offen sc1 lds
 s_add_u32 m0, s44, 1024
 s_add_u32 s45, s32, 0
 buffer_load_dwordx4 v255, s[16:19], s45 offen sc1 lds
 s_add_u32 m0, s44, 2048
 s_add_u32 s45, s32, 0
 buffer_load_dwordx4 v250, s[16:19], s45 offen sc1 lds
 buffer_load_dwordx4 a[156:159], v245, s[8:11], s43 offen offset:1024
 buffer_load_dwordx4 a[160:163], v245, s[8:11], s43 offen offset:2048
 buffer_load_dwordx4 a[164:167], v245, s[8:11], s43 offen offset:3072
 s_add_u32 s43, s42, 8192
 buffer_load_dwordx4 a[168:171], v245, s[8:11], s43 offen offset:0
 s_add_u32 m0, s44, 3072
 s_add_u32 s45, s32, 512
 buffer_load_dwordx4 v253, s[16:19], s45 offen sc1 lds
 s_waitcnt vmcnt(21)
 s_nop 0
 ds_read_b128 a[108:111], v243 offset:0
 ds_read_b128 a[112:115], v243 offset:16
 ds_read_b128 a[116:119], v243 offset:32
 ds_read_b128 a[120:123], v243 offset:48
 ds_read_b128 a[124:127], v243 offset:64
 ds_read_b128 a[128:131], v243 offset:80
 ds_read_b128 a[132:135], v243 offset:96
 s_waitcnt vmcnt(8)
 s_waitcnt lgkmcnt(0)
 M4 v[192:195], a[136:137], a[108:109], 0
 s_add_u32 m0, s44, 4096
 M4 v[196:199], a[136:137], a[110:111], 0
 s_add_u32 s45, s32, 512
 M4 v[200:203], a[136:137], a[112:113], 0
 s_waitcnt vmcnt(5)
 s_nop 0
 M4 v[192:195], a[138:139], a[110:111], v[192:195]
 buffer_load_dwordx4 v255, s[16:19], s45 offen sc1 lds
 M4 v[196:199], a[138:139], a[112:113], v[196:199]
 ds_read_b128 v[216:219], v254 offset:0
 M4 v[200:203], a[138:139], a[114:115], v[200:203]
 ds_read_b128 v[220:223], v254 offset:16
 M4 v[192:195], a[140:141], a[112:113], v[192:195]
 ds_read_b128 v[224:227], v254 offset:32
 M4 v[196:199], a[140:141], a[114:115], v[196:199]
 M4 v[200:203], a[140:141], a[116:117], v[200:203]
 s_add_u32 m0, s44, 5120
 M4 v[192:195], a[142:143], a[114:115], v[192:195]
 s_add_u32 s45, s32, 512
 M4 v[196:199], a[142:143], a[116:117], v[196:199]
 M4 v[200:203], a[142:143], a[118:119], v[200:203]
 buffer_load_dwordx4 v250, s[16:19], s45 offen sc1 lds
 M4 v[192:195], a[144:145], a[116:117], v[192:195]
 M4 v[196:199], a[144:145], a[118:119], v[196:199]
 M4 v[200:203], a[144:145], a[120:121], v[200:203]
 M4 v[192:195], a[146:147], a[118:119], v[192:195]
 M4 v[196:199], a[146:147], a[120:121], v[196:199]
 s_add_u32 m0, s36, 0
 s_nop 0
 M4 v[200:203], a[146:147], a[122:123], v[200:203]
 s_add_u32 s34, s32, 4608
 M4 v[192:195], a[148:149], a[120:121], v[192:195]
 M4 v[196:199], a[148:149], a[122:123], v[196:199]
 M4 v[200:203], a[148:149], a[124:125], v[200:203]
 buffer_load_dwordx4 v242, s[12:15], s34 offen sc1 lds
 M4 v[192:195], a[150:151], a[122:123], v[192:195]
 M4 v[196:199], a[150:151], a[124:125], v[196:199]
 M4 v[200:203], a[150:151], a[126:127], v[200:203]
 M4 v[192:195], a[152:153], a[124:125], v[192:195]
 s_add_u32 m0, s36, 1040
 M4 v[196:199], a[152:153], a[126:127], v[196:199]
 s_add_u32 s34, s32, 4736
 M4 v[200:203], a[152:153], a[128:129], v[200:203]
 M4 v[204:207], a[136:137], a[114:115], 0
 M4 v[208:211], a[136:137], a[116:117], 0
 buffer_load_dwordx4 v242, s[12:15], s34 offen sc1 lds
 M4 v[212:215], a[136:137], a[118:119], 0
 M4 v[204:207], a[138:139], a[116:117], v[204:207]
 s_waitcnt lgkmcnt(0)
 s_nop 0
 M4 v[208:211], a[138:139], a[118:119], v[208:211]
 v_lshlrev_b32_e64 v240, 16, v216
 M4 v[212:215], a[138:139], a[120:121], v[212:215]
 v_and_b32_e64 v241, s90, v216
 M4 v[204:207], a[140:141], a[118:119], v[204:207]
 s_add_u32 m0, s36, 2080
 M4 v[208:211], a[140:141], a[120:121], v[208:211]
 s_add_u32 s34, s32, 4864
 M4 v[212:215], a[140:141], a[122:123], v[212:215]
 v_mul_f32_e64 v240, v240, v192
 M4 v[204:207], a[142:143], a[120:121], v[204:207]
 buffer_load_dwordx4 v242, s[12:15], s34 offen sc1 lds
 M4 v[208:211], a[142:143], a[122:123], v[208:211]
 v_mul_f32_e64 v241, v241, v193
 M4 v[212:215], a[142:143], a[124:125], v[212:215]
 CB v228, v240, v241
 M4 v[204:207], a[144:145], a[122:123], v[204:207]
 v_lshlrev_b32_e64 v240, 16, v217
 M4 v[208:211], a[144:145], a[124:125], v[208:211]
 v_and_b32_e64 v241, s90, v217
 M4 v[212:215], a[144:145], a[126:127], v[212:215]
 s_add_u32 m0, s36, 3120
 M4 v[204:207], a[146:147], a[124:125], v[204:207]
 s_add_u32 s34, s32, 4992
 M4 v[208:211], a[146:147], a[126:127], v[208:211]
 v_mul_f32_e64 v240, v240, v194
 M4 v[212:215], a[146:147], a[128:129], v[212:215]
 buffer_load_dwordx4 v242, s[12:15], s34 offen sc1 lds
 M4 v[204:207], a[148:149], a[126:127], v[204:207]
 v_mul_f32_e64 v241, v241, v195
 M4 v[208:211], a[148:149], a[128:129], v[208:211]
 CB v229, v240, v241
 M4 v[212:215], a[148:149], a[130:131], v[212:215]
 v_lshlrev_b32_e64 v240, 16, v218
 M4 v[204:207], a[150:151], a[128:129], v[204:207]
 v_and_b32_e64 v241, s90, v218
 M4 v[208:211], a[150:151], a[130:131], v[208:211]
 s_add_u32 s43, s42, 36864
 M4 v[212:215], a[150:151], a[132:133], v[212:215]
 v_mul_f32_e64 v240, v240, v196
 M4 v[204:207], a[152:153], a[130:131], v[204:207]
 v_mul_f32_e64 v241, v241, v197
 M4 v[208:211], a[152:153], a[132:133], v[208:211]
 CB v230, v240, v241
 M4 v[212:215], a[152:153], a[134:135], v[212:215]
 buffer_load_dwordx4 a[172:175], v245, s[8:11], s43 offen offset:0
 v_lshlrev_b32 v240, 16, v219
 v_and_b32 v241, s90, v219
 v_mul_f32 v240, v240, v198
 v_mul_f32 v241, v241, v199
 CB v231, v240, v241
 ds_write_b128 v254, v[228:231] offset:0
 ds_read_b128 a[108:111], v243 offset:4160
 ds_read_b128 a[112:115], v243 offset:4176
 ds_read_b128 a[116:119], v243 offset:4192
 ds_read_b128 a[120:123], v243 offset:4208
 ds_read_b128 a[124:127], v243 offset:4224
 ds_read_b128 a[128:131], v243 offset:4240
 ds_read_b128 a[132:135], v243 offset:4256
 v_lshlrev_b32 v240, 16, v220
 v_and_b32 v241, s90, v220
 v_mul_f32 v240, v240, v200
 v_mul_f32 v241, v241, v201
 buffer_load_dwordx4 a[176:179], v245, s[8:11], s43 offen offset:1024
 CB v232, v240, v241
 v_lshlrev_b32 v240, 16, v221
 v_and_b32 v241, s90, v221
 v_mul_f32 v240, v240, v202
 v_mul_f32 v241, v241, v203
 CB v233, v240, v241
 v_lshlrev_b32 v240, 16, v222
 v_and_b32 v241, s90, v222
 v_mul_f32 v240, v240, v204
 v_mul_f32 v241, v241, v205
 buffer_load_dwordx4 a[180:183], v245, s[8:11], s43 offen offset:2048
 CB v234, v240, v241
 v_lshlrev_b32 v240, 16, v223
 v_and_b32 v241, s90, v223
 v_mul_f32 v240, v240, v206
 v_mul_f32 v241, v241, v207
 CB v235, v240, v241
 v_lshlrev_b32 v240, 16, v224
 v_and_b32 v241, s90, v224
 v_mul_f32 v240, v240, v208
 v_mul_f32 v241, v241, v209
 ds_write_b128 v254, v[232:235] offset:16
 CB v236, v240, v241
 v_lshlrev_b32 v240, 16, v225
 v_and_b32 v241, s90, v225
 v_mul_f32 v240, v240, v210
 v_mul_f32 v241, v241, v211
 buffer_load_dwordx4 a[184:187], v245, s[8:11], s43 offen offset:3072
 CB v237, v240, v241
 s_add_u32 s43, s42, 40960
 v_lshlrev_b32 v240, 16, v226
 v_and_b32 v241, s90, v226
 v_mul_f32 v240, v240, v212
 v_mul_f32 v241, v241, v213
 CB v238, v240, v241
 v_lshlrev_b32 v240, 16, v227
 v_and_b32 v241, s90, v227
 v_mul_f32_e64 v240, v240, v214
 buffer_load_dwordx4 a[188:191], v245, s[8:11], s43 offen offset:0
 v_mul_f32_e64 v241, v241, v215
 CB v239, v240, v241
 ds_write_b128 v254, v[236:239] offset:32
 s_add_u32 m0, s44, 24576
 s_add_u32 s45, s32, 4096
 s_waitcnt vmcnt(12)
 s_waitcnt lgkmcnt(2)
 M4 v[192:195], a[154:155], a[108:109], 0
 s_waitcnt vmcnt(9)
 s_nop 0
 M4 v[196:199], a[154:155], a[110:111], 0
 buffer_load_dwordx4 v253, s[16:19], s45 offen sc1 lds
 M4 v[200:203], a[154:155], a[112:113], 0
 ds_read_b128 v[216:219], v254 offset:3072
 M4 v[192:195], a[156:157], a[110:111], v[192:195]
 ds_read_b128 v[220:223], v254 offset:3088
 M4 v[196:199], a[156:157], a[112:113], v[196:199]
 ds_read_b128 v[224:227], v254 offset:3104
 M4 v[200:203], a[156:157], a[114:115], v[200:203]
 M4 v[192:195], a[158:159], a[112:113], v[192:195]
 s_add_u32 m0, s44, 25600
 M4 v[196:199], a[158:159], a[114:115], v[196:199]
 s_add_u32 s45, s32, 4096
 M4 v[200:203], a[158:159], a[116:117], v[200:203]
 M4 v[192:195], a[160:161], a[114:115], v[192:195]
 buffer_load_dwordx4 v255, s[16:19], s45 offen sc1 lds
 M4 v[196:199], a[160:161], a[116:117], v[196:199]
 M4 v[200:203], a[160:161], a[118:119], v[200:203]
 M4 v[192:195], a[162:163], a[116:117], v[192:195]
 M4 v[196:199], a[162:163], a[118:119], v[196:199]
 M4 v[200:203], a[162:163], a[120:121], v[200:203]
 s_add_u32 m0, s44, 26624
 M4 v[192:195], a[164:165], a[118:119], v[192:195]
 s_add_u32 s45, s32, 4096
 M4 v[196:199], a[164:165], a[120:121], v[196:199]
 M4 v[200:203], a[164:165], a[122:123], v[200:203]
 buffer_load_dwordx4 v250, s[16:19], s45 offen sc1 lds
 M4 v[192:195], a[166:167], a[120:121], v[192:195]
 M4 v[196:199], a[166:167], a[122:123], v[196:199]
 M4 v[200:203], a[166:167], a[124:125], v[200:203]
 M4 v[192:195], a[168:169], a[122:123], v[192:195]
 M4 v[196:199], a[168:169], a[124:125], v[196:199]
 M4 v[200:203], a[168:169], a[126:127], v[200:203]
 M4 v[192:195], a[170:171], a[124:125], v[192:195]
 M4 v[196:199], a[170:171], a[126:127], v[196:199]
 M4 v[200:203], a[170:171], a[128:129], v[200:203]
 buffer_load_dwordx4 a[0:3], v245, s[8:11], s7 offen offset:0
 M4 v[204:207], a[154:155], a[114:115], 0
 M4 v[208:211], a[154:155], a[116:117], 0
 M4 v[212:215], a[154:155], a[118:119], 0
 M4 v[204:207], a[156:157], a[116:117], v[204:207]
 s_waitcnt lgkmcnt(0)
 s_nop 0
 M4 v[208:211], a[156:157], a[118:119], v[208:211]
 v_lshlrev_b32_e64 v240, 16, v216
 M4 v[212:215], a[156:157], a[120:121], v[212:215]
 v_and_b32_e64 v241, s90, v216
 M4 v[204:207], a[158:159], a[118:119], v[204:207]
 v_mul_f32_e64 v240, v240, v192
 M4 v[208:211], a[158:159], a[120:121], v[208:211]
 buffer_load_dwordx4 a[4:7], v245, s[8:11], s7 offen offset:1024
 M4 v[212:215], a[158:159], a[122:123], v[212:215]
 v_mul_f32_e64 v241, v241, v193
 M4 v[204:207], a[160:161], a[120:121], v[204:207]
 CB v228, v240, v241
 M4 v[208:211], a[160:161], a[122:123], v[208:211]
 v_lshlrev_b32_e64 v240, 16, v217
 M4 v[212:215], a[160:161], a[124:125], v[212:215]
 v_and_b32_e64 v241, s90, v217
 M4 v[204:207], a[162:163], a[122:123], v[204:207]
 v_mul_f32_e64 v240, v240, v194
 M4 v[208:211], a[162:163], a[124:125], v[208:211]
 v_mul_f32_e64 v241, v241, v195
 M4 v[212:215], a[162:163], a[126:127], v[212:215]
 CB v229, v240, v241
 M4 v[204:207], a[164:165], a[124:125], v[204:207]
 buffer_load_dwordx4 a[8:11], v245, s[8:11], s7 offen offset:2048
 M4 v[208:211], a[164:165], a[126:127], v[208:211]
 v_lshlrev_b32_e64 v240, 16, v218
 M4 v[212:215], a[164:165], a[128:129], v[212:215]
 v_and_b32_e64 v241, s90, v218
 M4 v[204:207], a[166:167], a[126:127], v[204:207]
 v_mul_f32_e64 v240, v240, v196
 M4 v[208:211], a[166:167], a[128:129], v[208:211]
 v_mul_f32_e64 v241, v241, v197
 M4 v[212:215], a[166:167], a[130:131], v[212:215]
 CB v230, v240, v241
 M4 v[204:207], a[168:169], a[128:129], v[204:207]
 v_lshlrev_b32_e64 v240, 16, v219
 M4 v[208:211], a[168:169], a[130:131], v[208:211]
 v_and_b32_e64 v241, s90, v219
 M4 v[212:215], a[168:169], a[132:133], v[212:215]
 buffer_load_dwordx4 a[12:15], v245, s[8:11], s7 offen offset:3072
 M4 v[204:207], a[170:171], a[130:131], v[204:207]
 v_mul_f32_e64 v240, v240, v198
 M4 v[208:211], a[170:171], a[132:133], v[208:211]
 v_mul_f32_e64 v241, v241, v199
 M4 v[212:215], a[170:171], a[134:135], v[212:215]
 CB v231, v240, v241
 ds_write_b128 v254, v[228:231] offset:3072
 s_add_u32 s7, s7, 0x1000
 ds_read_b128 a[108:111], v243 offset:8320
 ds_read_b128 a[112:115], v243 offset:8336
 ds_read_b128 a[116:119], v243 offset:8352
 ds_read_b128 a[120:123], v243 offset:8368
 ds_read_b128 a[124:127], v243 offset:8384
 ds_read_b128 a[128:131], v243 offset:8400
 ds_read_b128 a[132:135], v243 offset:8416
 v_lshlrev_b32 v240, 16, v220
 v_and_b32 v241, s90, v220
 v_mul_f32_e64 v240, v240, v200
 buffer_load_dwordx4 a[16:19], v245, s[8:11], s7 offen offset:0
 v_mul_f32_e64 v241, v241, v201
 CB v232, v240, v241
 v_lshlrev_b32 v240, 16, v221
 v_and_b32 v241, s90, v221
 v_mul_f32 v240, v240, v202
 v_mul_f32 v241, v241, v203
 CB v233, v240, v241
 v_lshlrev_b32 v240, 16, v222
 v_and_b32 v241, s90, v222
 v_mul_f32_e64 v240, v240, v204
 buffer_load_dwordx4 a[20:23], v245, s[8:11], s7 offen offset:1024
 v_mul_f32_e64 v241, v241, v205
 CB v234, v240, v241
 v_lshlrev_b32 v240, 16, v223
 v_and_b32 v241, s90, v223
 v_mul_f32 v240, v240, v206
 v_mul_f32 v241, v241, v207
 CB v235, v240, v241
 v_lshlrev_b32 v240, 16, v224
 v_and_b32 v241, s90, v224
 v_mul_f32_e64 v240, v240, v208
 ds_write_b128 v254, v[232:235] offset:3088
 v_mul_f32_e64 v241, v241, v209
 CB v236, v240, v241
 v_lshlrev_b32 v240, 16, v225
 v_and_b32 v241, s90, v225
 v_mul_f32_e64 v240, v240, v210
 buffer_load_dwordx4 a[24:27], v245, s[8:11], s7 offen offset:2048
 v_mul_f32_e64 v241, v241, v211
 CB v237, v240, v241
 v_lshlrev_b32 v240, 16, v226
 v_and_b32 v241, s90, v226
 v_mul_f32 v240, v240, v212
 v_mul_f32 v241, v241, v213
 CB v238, v240, v241
 v_lshlrev_b32 v240, 16, v227
 v_and_b32 v241, s90, v227
 v_mul_f32_e64 v240, v240, v214
 buffer_load_dwordx4 a[28:31], v245, s[8:11], s7 offen offset:3072
 v_mul_f32_e64 v241, v241, v215
 CB v239, v240, v241
 ds_write_b128 v254, v[236:239] offset:3104
 s_add_u32 m0, s36, 4160
 s_add_u32 s34, s32, 8192
 buffer_load_dwordx4 v242, s[12:15], s34 offen sc1 lds
 s_waitcnt lgkmcnt(0)
 s_barrier
 ds_read_b64_tr_b16 a[208:209], v251 offset:0
 ds_read_b64_tr_b16 a[210:211], v251 offset:768
 ds_read_b64_tr_b16 a[212:213], v251 offset:8
 ds_read_b64_tr_b16 a[214:215], v251 offset:776
 ds_read_b64_tr_b16 a[216:217], v251 offset:64
 ds_read_b64_tr_b16 a[218:219], v251 offset:832
 ds_read_b64_tr_b16 a[220:221], v251 offset:72
 ds_read_b64_tr_b16 a[222:223], v251 offset:840
 ds_read_b64_tr_b16 a[224:225], v251 offset:128
 ds_read_b64_tr_b16 a[226:227], v251 offset:896
 ds_read_b64_tr_b16 a[228:229], v251 offset:136
 ds_read_b64_tr_b16 a[230:231], v251 offset:904
 s_waitcnt vmcnt(12)
 M4 v[192:195], a[172:173], a[108:109], 0
 s_add_u32 m0, s36, 5200
 M4 v[196:199], a[172:173], a[110:111], 0
 s_add_u32 s34, s32, 8320
 M4 v[200:203], a[172:173], a[112:113], 0
 buffer_load_dwordx4 v242, s[12:15], s34 offen sc1 lds
 M4 v[192:195], a[174:175], a[110:111], v[192:195]
 s_waitcnt vmcnt(10)
 M4 v[196:199], a[174:175], a[112:113], v[196:199]
 ds_read_b128 v[216:219], v254 offset:24576
 M4 v[200:203], a[174:175], a[114:115], v[200:203]
 ds_read_b128 v[220:223], v254 offset:24592
 M4 v[192:195], a[176:177], a[112:113], v[192:195]
 ds_read_b128 v[224:227], v254 offset:24608
 M4 v[196:199], a[176:177], a[114:115], v[196:199]
 s_add_u32 m0, s36, 6240
 M4 v[200:203], a[176:177], a[116:117], v[200:203]
 s_add_u32 s34, s32, 8448
 M4 v[192:195], a[178:179], a[114:115], v[192:195]
 buffer_load_dwordx4 v242, s[12:15], s34 offen sc1 lds
 M4 v[196:199], a[178:179], a[116:117], v[196:199]
 M4 v[200:203], a[178:179], a[118:119], v[200:203]
 M4 v[192:195], a[180:181], a[116:117], v[192:195]
 M4 v[196:199], a[180:181], a[118:119], v[196:199]
 M4 v[200:203], a[180:181], a[120:121], v[200:203]
 s_add_u32 m0, s36, 7280
 M4 v[192:195], a[182:183], a[118:119], v[192:195]
 s_add_u32 s34, s32, 8576
 M4 v[196:199], a[182:183], a[120:121], v[196:199]
 M4 v[200:203], a[182:183], a[122:123], v[200:203]
 buffer_load_dwordx4 v242, s[12:15], s34 offen sc1 lds
 M4 v[192:195], a[184:185], a[120:121], v[192:195]
 M4 v[196:199], a[184:185], a[122:123], v[196:199]
 M4 v[200:203], a[184:185], a[124:125], v[200:203]
 M4 v[192:195], a[186:187], a[122:123], v[192:195]
 M4 v[196:199], a[186:187], a[124:125], v[196:199]
 M4 v[200:203], a[186:187], a[126:127], v[200:203]
 M4 v[192:195], a[188:189], a[124:125], v[192:195]
 M4 v[196:199], a[188:189], a[126:127], v[196:199]
 buffer_load_dwordx4 a[192:195], v245, s[8:11], s43 offen offset:1024
 M4 v[200:203], a[188:189], a[128:129], v[200:203]
 M4 v[204:207], a[172:173], a[114:115], 0
 M4 v[208:211], a[172:173], a[116:117], 0
 M4 v[212:215], a[172:173], a[118:119], 0
 M4 v[204:207], a[174:175], a[116:117], v[204:207]
 s_waitcnt lgkmcnt(0)
 M4 v[208:211], a[174:175], a[118:119], v[208:211]
 v_lshlrev_b32 v240, 16, v216
 M4 v[212:215], a[174:175], a[120:121], v[212:215]
 v_and_b32_e64 v241, s90, v216
 M4 v[204:207], a[176:177], a[118:119], v[204:207]
 v_mul_f32_e64 v240, v240, v192
 M4 v[208:211], a[176:177], a[120:121], v[208:211]
 buffer_load_dwordx4 a[196:199], v245, s[8:11], s43 offen offset:2048
 M4 v[212:215], a[176:177], a[122:123], v[212:215]
 v_mul_f32_e64 v241, v241, v193
 M4 v[204:207], a[178:179], a[120:121], v[204:207]
 CB v228, v240, v241
 M4 v[208:211], a[178:179], a[122:123], v[208:211]
 v_lshlrev_b32_e64 v240, 16, v217
 M4 v[212:215], a[178:179], a[124:125], v[212:215]
 v_and_b32_e64 v241, s90, v217
 M4 v[204:207], a[180:181], a[122:123], v[204:207]
 v_mul_f32_e64 v240, v240, v194
 M4 v[208:211], a[180:181], a[124:125], v[208:211]
 v_mul_f32_e64 v241, v241, v195
 M4 v[212:215], a[180:181], a[126:127], v[212:215]
 CB v229, v240, v241
 M4 v[204:207], a[182:183], a[124:125], v[204:207]
 buffer_load_dwordx4 a[200:203], v245, s[8:11], s43 offen offset:3072
 M4 v[208:211], a[182:183], a[126:127], v[208:211]
 v_lshlrev_b32_e64 v240, 16, v218
 M4 v[212:215], a[182:183], a[128:129], v[212:215]
 v_and_b32_e64 v241, s90, v218
 M4 v[204:207], a[184:185], a[126:127], v[204:207]
 v_mul_f32_e64 v240, v240, v196
 M4 v[208:211], a[184:185], a[128:129], v[208:211]
 v_mul_f32_e64 v241, v241, v197
 M4 v[212:215], a[184:185], a[130:131], v[212:215]
 s_add_u32 s43, s42, 45056
 M4 v[204:207], a[186:187], a[128:129], v[204:207]
 CB v230, v240, v241
 M4 v[208:211], a[186:187], a[130:131], v[208:211]
 v_lshlrev_b32_e64 v240, 16, v219
 M4 v[212:215], a[186:187], a[132:133], v[212:215]
 buffer_load_dwordx4 a[204:207], v245, s[8:11], s43 offen offset:0
 M4 v[204:207], a[188:189], a[130:131], v[204:207]
 v_and_b32_e64 v241, s90, v219
 M4 v[208:211], a[188:189], a[132:133], v[208:211]
 v_mul_f32_e64 v240, v240, v198
 M4 v[212:215], a[188:189], a[134:135], v[212:215]
 v_mul_f32 v241, v241, v199
 s_waitcnt vmcnt(14)
 MM v[0:3], a[208:211], a[0:3], 0
 ds_read_b64_tr_b16 a[232:233], v251 offset:6144
 s_add_u32 s7, s7, 0x1000
 MM v[4:7], a[212:215], a[0:3], 0
 ds_read_b64_tr_b16 a[234:235], v251 offset:6912
 CB v231, v240, v241
 MM v[8:11], a[216:219], a[0:3], 0
 buffer_load_dwordx4 a[32:35], v245, s[8:11], s7 offen offset:0
 MM v[12:15], a[220:223], a[0:3], 0
 ds_write_b128 v254, v[228:231] offset:24576
 v_lshlrev_b32_e64 v240, 16, v220
 MM v[16:19], a[224:227], a[0:3], 0
 ds_read_b64_tr_b16 a[236:237], v251 offset:6152
 s_add_u32 m0, s44, 27648
 MM v[20:23], a[228:231], a[0:3], 0
 ds_read_b64_tr_b16 a[238:239], v251 offset:6920
 s_add_u32 s45, s32, 4608
 MM v[44:47], a[228:231], a[4:7], 0
 buffer_load_dwordx4 v253, s[16:19], s45 offen sc1 lds
 MM v[40:43], a[224:227], a[4:7], 0
 ds_read_b64_tr_b16 a[240:241], v251 offset:6208
 v_and_b32_e64 v241, s90, v220
 MM v[36:39], a[220:223], a[4:7], 0
 ds_read_b64_tr_b16 a[242:243], v251 offset:6976
 v_mul_f32_e64 v240, v240, v200
 MM v[32:35], a[216:219], a[4:7], 0
 s_add_u32 m0, s44, 28672
 s_add_u32 s45, s32, 4608
 MM v[28:31], a[212:215], a[4:7], 0
 ds_read_b64_tr_b16 a[244:245], v251 offset:6216
 v_mul_f32_e64 v241, v241, v201
 MM v[24:27], a[208:211], a[4:7], 0
 CB v232, v240, v241
 s_waitcnt vmcnt(14)
 MM v[48:51], a[208:211], a[8:11], 0
 buffer_load_dwordx4 v255, s[16:19], s45 offen sc1 lds
 MM v[52:55], a[212:215], a[8:11], 0
 ds_read_b64_tr_b16 a[246:247], v251 offset:6984
 s_add_u32 m0, s44, 29696
 MM v[56:59], a[216:219], a[8:11], 0
 s_add_u32 s45, s32, 4608
 v_lshlrev_b32 v240, 16, v221
 MM v[60:63], a[220:223], a[8:11], 0
 buffer_load_dwordx4 v250, s[16:19], s45 offen sc1 lds
 MM v[64:67], a[224:227], a[8:11], 0
 ds_read_b64_tr_b16 a[248:249], v251 offset:6272
 v_and_b32_e64 v241, s90, v221
 MM v[68:71], a[228:231], a[8:11], 0
 ds_read_b64_tr_b16 a[250:251], v251 offset:7040
 v_mul_f32_e64 v240, v240, v202
 MM v[92:95], a[228:231], a[12:15], 0
 ds_read_b64_tr_b16 a[252:253], v251 offset:6280
 v_mul_f32_e64 v241, v241, v203
 MM v[88:91], a[224:227], a[12:15], 0
 buffer_load_dwordx4 a[36:39], v245, s[8:11], s7 offen offset:1024
 MM v[84:87], a[220:223], a[12:15], 0
 ds_read_b64_tr_b16 a[254:255], v251 offset:7048
 CB v233, v240, v241
 MM v[80:83], a[216:219], a[12:15], 0
 v_lshlrev_b32 v240, 16, v222
 v_and_b32 v241, s90, v222
 MM v[76:79], a[212:215], a[12:15], 0
 v_mul_f32 v240, v240, v204
 v_mul_f32 v241, v241, v205
 MM v[72:75], a[208:211], a[12:15], 0
 CB v234, v240, v241
 s_waitcnt vmcnt(15)
 MM v[96:99], a[208:211], a[16:19], 0
 buffer_load_dwordx4 a[40:43], v245, s[8:11], s7 offen offset:2048
 MM v[100:103], a[212:215], a[16:19], 0
 v_lshlrev_b32 v240, 16, v223
 v_and_b32_e64 v241, s90, v223
 MM v[104:107], a[216:219], a[16:19], 0
 v_mul_f32 v240, v240, v206
 v_mul_f32 v241, v241, v207
 MM v[108:111], a[220:223], a[16:19], 0
 CB v235, v240, v241
 v_lshlrev_b32_e64 v240, 16, v224
 MM v[112:115], a[224:227], a[16:19], 0
 buffer_load_dwordx4 a[44:47], v245, s[8:11], s7 offen offset:3072
 MM v[116:119], a[228:231], a[16:19], 0
 ds_write_b128 v254, v[232:235] offset:24592
 v_and_b32_e64 v241, s90, v224
 MM v[140:143], a[228:231], a[20:23], 0
 v_mul_f32 v240, v240, v208
 v_mul_f32 v241, v241, v209
 MM v[136:139], a[224:227], a[20:23], 0
 s_add_u32 s7, s7, 0x1000
 CB v236, v240, v241
 MM v[132:135], a[220:223], a[20:23], 0
 v_lshlrev_b32 v240, 16, v225
 v_and_b32 v241, s90, v225
 MM v[128:131], a[216:219], a[20:23], 0
 buffer_load_dwordx4 a[48:51], v245, s[8:11], s7 offen offset:0
 MM v[124:127], a[212:215], a[20:23], 0
 v_mul_f32 v240, v240, v210
 v_mul_f32 v241, v241, v211
 MM v[120:123], a[208:211], a[20:23], 0
 CB v237, v240, v241
 s_waitcnt vmcnt(16)
 MM v[144:147], a[208:211], a[24:27], 0
 v_lshlrev_b32 v240, 16, v226
 v_and_b32_e64 v241, s90, v226
 MM v[148:151], a[212:215], a[24:27], 0
 buffer_load_dwordx4 a[52:55], v245, s[8:11], s7 offen offset:1024
 MM v[152:155], a[216:219], a[24:27], 0
 v_mul_f32 v240, v240, v212
 v_mul_f32 v241, v241, v213
 MM v[156:159], a[220:223], a[24:27], 0
 CB v238, v240, v241
 v_lshlrev_b32_e64 v240, 16, v227
 MM v[160:163], a[224:227], a[24:27], 0
 v_and_b32 v241, s90, v227
 v_mul_f32 v240, v240, v214
 MM v[164:167], a[228:231], a[24:27], 0
 buffer_load_dwordx4 a[56:59], v245, s[8:11], s7 offen offset:2048
 MM v[188:191], a[228:231], a[28:31], 0
 v_mul_f32_e64 v241, v241, v215
 CB v239, v240, v241
 MM v[184:187], a[224:227], a[28:31], 0
 ds_write_b128 v254, v[236:239] offset:24608
 MM v[180:183], a[220:223], a[28:31], 0
 MM v[176:179], a[216:219], a[28:31], 0
 MM v[172:175], a[212:215], a[28:31], 0
 buffer_load_dwordx4 a[60:63], v245, s[8:11], s7 offen offset:3072
 MM v[168:171], a[208:211], a[28:31], 0
 s_waitcnt lgkmcnt(2)
 s_waitcnt vmcnt(6)
 MM v[0:3], a[232:235], a[32:35], v[0:3]
 ds_read_b64_tr_b16 a[208:209], v251 offset:12288
 s_add_u32 s7, s7, 0x1000
 MM v[4:7], a[236:239], a[32:35], v[4:7]
 ds_read_b64_tr_b16 a[210:211], v251 offset:13056
 MM v[8:11], a[240:243], a[32:35], v[8:11]
 buffer_load_dwordx4 a[64:67], v245, s[8:11], s7 offen offset:0
 MM v[12:15], a[244:247], a[32:35], v[12:15]
 ds_read_b128 a[108:111], v243 offset:0
 MM v[16:19], a[248:251], a[32:35], v[16:19]
 ds_read_b64_tr_b16 a[212:213], v251 offset:12296
 MM v[20:23], a[252:255], a[32:35], v[20:23]
 ds_read_b128 a[112:115], v243 offset:16
 MM v[44:47], a[252:255], a[36:39], v[44:47]
 buffer_load_dwordx4 a[68:71], v245, s[8:11], s7 offen offset:1024
 MM v[40:43], a[248:251], a[36:39], v[40:43]
 ds_read_b64_tr_b16 a[214:215], v251 offset:13064
 MM v[36:39], a[244:247], a[36:39], v[36:39]
 ds_read_b128 a[116:119], v243 offset:32
 MM v[32:35], a[240:243], a[36:39], v[32:35]
 ds_read_b64_tr_b16 a[216:217], v251 offset:12352
 MM v[28:31], a[236:239], a[36:39], v[28:31]
 ds_read_b128 a[120:123], v243 offset:48
 MM v[24:27], a[232:235], a[36:39], v[24:27]
 ds_read_b64_tr_b16 a[218:219], v251 offset:13120
 s_waitcnt vmcnt(6)
 MM v[48:51], a[232:235], a[40:43], v[48:51]
 buffer_load_dwordx4 a[72:75], v245, s[8:11], s7 offen offset:2048
 MM v[52:55], a[236:239], a[40:43], v[52:55]
 ds_read_b128 a[124:127], v243 offset:64
 MM v[56:59], a[240:243], a[40:43], v[56:59]
 ds_read_b64_tr_b16 a[220:221], v251 offset:12360
 MM v[60:63], a[244:247], a[40:43], v[60:63]
 buffer_load_dwordx4 a[76:79], v245, s[8:11], s7 offen offset:3072
 MM v[64:67], a[248:251], a[40:43], v[64:67]
 ds_read_b128 a[128:131], v243 offset:80
 MM v[68:71], a[252:255], a[40:43], v[68:71]
 ds_read_b64_tr_b16 a[222:223], v251 offset:13128
 MM v[92:95], a[252:255], a[44:47], v[92:95]
 ds_read_b128 a[132:135], v243 offset:96
 s_add_u32 s7, s7, 0x1000
 MM v[88:91], a[248:251], a[44:47], v[88:91]
 ds_read_b64_tr_b16 a[224:225], v251 offset:12416
 MM v[84:87], a[244:247], a[44:47], v[84:87]
 buffer_load_dwordx4 a[80:83], v245, s[8:11], s7 offen offset:0
 MM v[80:83], a[240:243], a[44:47], v[80:83]
 ds_read_b64_tr_b16 a[226:227], v251 offset:13184
 MM v[76:79], a[236:239], a[44:47], v[76:79]
 ds_read_b64_tr_b16 a[228:229], v251 offset:12424
 MM v[72:75], a[232:235], a[44:47], v[72:75]
 ds_read_b64_tr_b16 a[230:231], v251 offset:13192
 s_waitcnt vmcnt(7)
 MM v[96:99], a[232:235], a[48:51], v[96:99]
 buffer_load_dwordx4 a[84:87], v245, s[8:11], s7 offen offset:1024
 MM v[100:103], a[236:239], a[48:51], v[100:103]
 MM v[104:107], a[240:243], a[48:51], v[104:107]
 MM v[108:111], a[244:247], a[48:51], v[108:111]
 MM v[112:115], a[248:251], a[48:51], v[112:115]
 buffer_load_dwordx4 a[88:91], v245, s[8:11], s7 offen offset:2048
 MM v[116:119], a[252:255], a[48:51], v[116:119]
 MM v[140:143], a[252:255], a[52:55], v[140:143]
 MM v[136:139], a[248:251], a[52:55], v[136:139]
 MM v[132:135], a[244:247], a[52:55], v[132:135]
 MM v[128:131], a[240:243], a[52:55], v[128:131]
 buffer_load_dwordx4 a[92:95], v245, s[8:11], s7 offen offset:3072
 MM v[124:127], a[236:239], a[52:55], v[124:127]
 MM v[120:123], a[232:235], a[52:55], v[120:123]
 s_add_u32 m0, s36, 8320
 s_waitcnt vmcnt(8)
 MM v[144:147], a[232:235], a[56:59], v[144:147]
 s_add_u32 s34, s32, 8704
 MM v[148:151], a[236:239], a[56:59], v[148:151]
 buffer_load_dwordx4 v242, s[12:15], s34 offen sc1 lds
 MM v[152:155], a[240:243], a[56:59], v[152:155]
 MM v[156:159], a[244:247], a[56:59], v[156:159]
 MM v[160:163], a[248:251], a[56:59], v[160:163]
 s_add_u32 m0, s36, 9360
 s_add_u32 s34, s32, 8832
 MM v[164:167], a[252:255], a[56:59], v[164:167]
 buffer_load_dwordx4 v242, s[12:15], s34 offen sc1 lds
 MM v[188:191], a[252:255], a[60:63], v[188:191]
 MM v[184:187], a[248:251], a[60:63], v[184:187]
 MM v[180:183], a[244:247], a[60:63], v[180:183]
 s_add_u32 m0, s36, 10400
 s_add_u32 s34, s32, 8960
 MM v[176:179], a[240:243], a[60:63], v[176:179]
 MM v[172:175], a[236:239], a[60:63], v[172:175]
 buffer_load_dwordx4 v242, s[12:15], s34 offen sc1 lds
 MM v[168:171], a[232:235], a[60:63], v[168:171]
 s_waitcnt lgkmcnt(4)
 M4 v[192:195], a[190:191], a[108:109], 0
 ds_read_b128 v[216:219], v254 offset:27648
 M4 v[196:199], a[190:191], a[110:111], 0
 ds_read_b128 v[220:223], v254 offset:27664
 M4 v[200:203], a[190:191], a[112:113], 0
 ds_read_b128 v[224:227], v254 offset:27680
 M4 v[192:195], a[192:193], a[110:111], v[192:195]
 s_add_u32 m0, s36, 11440
 M4 v[196:199], a[192:193], a[112:113], v[196:199]
 s_add_u32 s34, s32, 9088
 M4 v[200:203], a[192:193], a[114:115], v[200:203]
 buffer_load_dwordx4 v242, s[12:15], s34 offen sc1 lds
 M4 v[192:195], a[194:195], a[112:113], v[192:195]
 M4 v[196:199], a[194:195], a[114:115], v[196:199]
 M4 v[200:203], a[194:195], a[116:117], v[200:203]
 M4 v[192:195], a[196:197], a[114:115], v[192:195]
 s_add_u32 s43, s42, 73728
 M4 v[196:199], a[196:197], a[116:117], v[196:199]
 M4 v[200:203], a[196:197], a[118:119], v[200:203]
 M4 v[192:195], a[198:199], a[116:117], v[192:195]
 M4 v[196:199], a[198:199], a[118:119], v[196:199]
 buffer_load_dwordx4 a[136:139], v245, s[8:11], s43 offen offset:0
 M4 v[200:203], a[198:199], a[120:121], v[200:203]
 M4 v[192:195], a[200:201], a[118:119], v[192:195]
 M4 v[196:199], a[200:201], a[120:121], v[196:199]
 M4 v[200:203], a[200:201], a[122:123], v[200:203]
 M4 v[192:195], a[202:203], a[120:121], v[192:195]
 M4 v[196:199], a[202:203], a[122:123], v[196:199]
 M4 v[200:203], a[202:203], a[124:125], v[200:203]
 M4 v[192:195], a[204:205], a[122:123], v[192:195]
 buffer_load_dwordx4 a[140:143], v245, s[8:11], s43 offen offset:1024
 M4 v[196:199], a[204:205], a[124:125], v[196:199]
 M4 v[200:203], a[204:205], a[126:127], v[200:203]
 M4 v[192:195], a[206:207], a[124:125], v[192:195]
 M4 v[196:199], a[206:207], a[126:127], v[196:199]
 M4 v[200:203], a[206:207], a[128:129], v[200:203]
 M4 v[204:207], a[190:191], a[114:115], 0
 M4 v[208:211], a[190:191], a[116:117], 0
 M4 v[212:215], a[190:191], a[118:119], 0
 buffer_load_dwordx4 a[144:147], v245, s[8:11], s43 offen offset:2048
 M4 v[204:207], a[192:193], a[116:117], v[204:207]
 s_waitcnt lgkmcnt(0)
 M4 v[208:211], a[192:193], a[118:119], v[208:211]
 v_lshlrev_b32 v240, 16, v216
 M4 v[212:215], a[192:193], a[120:121], v[212:215]
 v_and_b32_e64 v241, s90, v216
 M4 v[204:207], a[194:195], a[118:119], v[204:207]
 v_mul_f32_e64 v240, v240, v192
 M4 v[208:211], a[194:195], a[120:121], v[208:211]
 v_mul_f32_e64 v241, v241, v193
 M4 v[212:215], a[194:195], a[122:123], v[212:215]
 CB v228, v240, v241
 M4 v[204:207], a[196:197], a[120:121], v[204:207]
 v_lshlrev_b32_e64 v240, 16, v217
 M4 v[208:211], a[196:197], a[122:123], v[208:211]
 buffer_load_dwordx4 a[148:151], v245, s[8:11], s43 offen offset:3072
 M4 v[212:215], a[196:197], a[124:125], v[212:215]
 v_and_b32_e64 v241, s90, v217
 M4 v[204:207], a[198:199], a[122:123], v[204:207]
 v_mul_f32_e64 v240, v240, v194
 M4 v[208:211], a[198:199], a[124:125], v[208:211]
 v_mul_f32_e64 v241, v241, v195
 M4 v[212:215], a[198:199], a[126:127], v[212:215]
 CB v229, v240, v241
 M4 v[204:207], a[200:201], a[124:125], v[204:207]
 s_add_u32 s43, s42, 77824
 M4 v[208:211], a[200:201], a[126:127], v[208:211]
 v_lshlrev_b32_e64 v240, 16, v218
 M4 v[212:215], a[200:201], a[128:129], v[212:215]
 v_and_b32_e64 v241, s90, v218
 M4 v[204:207], a[202:203], a[126:127], v[204:207]
 v_mul_f32_e64 v240, v240, v196
 M4 v[208:211], a[202:203], a[128:129], v[208:211]
 buffer_load_dwordx4 a[152:155], v245, s[8:11], s43 offen offset:0
 M4 v[212:215], a[202:203], a[130:131], v[212:215]
 v_mul_f32_e64 v241, v241, v197
 M4 v[204:207], a[204:205], a[128:129], v[204:207]
 CB v230, v240, v241
 M4 v[208:211], a[204:205], a[130:131], v[208:211]
 v_lshlrev_b32_e64 v240, 16, v219
 M4 v[212:215], a[204:205], a[132:133], v[212:215]
 s_add_u32 s7, s7, 0x1000
 M4 v[204:207], a[206:207], a[130:131], v[204:207]
 v_and_b32_e64 v241, s90, v219
 M4 v[208:211], a[206:207], a[132:133], v[208:211]
 v_mul_f32_e64 v240, v240, v198
 M4 v[212:215], a[206:207], a[134:135], v[212:215]
 v_mul_f32 v241, v241, v199
 s_waitcnt vmcnt(15)
 MM v[0:3], a[208:211], a[64:67], v[0:3]
 buffer_load_dwordx4 a[96:99], v245, s[8:11], s7 offen offset:0
 MM v[4:7], a[212:215], a[64:67], v[4:7]
 ds_read_b64_tr_b16 a[232:233], v251 offset:18432
 CB v231, v240, v241
 MM v[8:11], a[216:219], a[64:67], v[8:11]
 ds_read_b64_tr_b16 a[234:235], v251 offset:19200
 s_add_u32 m0, s44, 49152
 MM v[12:15], a[220:223], a[64:67], v[12:15]
 ds_write_b128 v254, v[228:231] offset:27648
 s_add_u32 s45, s32, 8192
 MM v[16:19], a[224:227], a[64:67], v[16:19]
 buffer_load_dwordx4 v253, s[16:19], s45 offen sc1 lds
 MM v[20:23], a[228:231], a[64:67], v[20:23]
 ds_read_b64_tr_b16 a[236:237], v251 offset:18440
 v_lshlrev_b32_e64 v240, 16, v220
 MM v[44:47], a[228:231], a[68:71], v[44:47]
 ds_read_b64_tr_b16 a[238:239], v251 offset:19208
 s_add_u32 m0, s44, 50176
 MM v[40:43], a[224:227], a[68:71], v[40:43]
 s_add_u32 s45, s32, 8192
 v_and_b32_e64 v241, s90, v220
 MM v[36:39], a[220:223], a[68:71], v[36:39]
 buffer_load_dwordx4 v255, s[16:19], s45 offen sc1 lds
 MM v[32:35], a[216:219], a[68:71], v[32:35]
 ds_read_b64_tr_b16 a[240:241], v251 offset:18496
 v_mul_f32_e64 v240, v240, v200
 MM v[28:31], a[212:215], a[68:71], v[28:31]
 ds_read_b64_tr_b16 a[242:243], v251 offset:19264
 v_mul_f32_e64 v241, v241, v201
 MM v[24:27], a[208:211], a[68:71], v[24:27]
 ds_read_b64_tr_b16 a[244:245], v251 offset:18504
 s_waitcnt vmcnt(16)
 MM v[48:51], a[208:211], a[72:75], v[48:51]
 s_add_u32 m0, s44, 51200
 s_add_u32 s45, s32, 8192
 MM v[52:55], a[212:215], a[72:75], v[52:55]
 buffer_load_dwordx4 v250, s[16:19], s45 offen sc1 lds
 MM v[56:59], a[216:219], a[72:75], v[56:59]
 ds_read_b64_tr_b16 a[246:247], v251 offset:19272
 CB v232, v240, v241
 MM v[60:63], a[220:223], a[72:75], v[60:63]
 ds_read_b64_tr_b16 a[248:249], v251 offset:18560
 v_lshlrev_b32 v240, 16, v221
 MM v[64:67], a[224:227], a[72:75], v[64:67]
 ds_read_b64_tr_b16 a[250:251], v251 offset:19328
 v_and_b32_e64 v241, s90, v221
 MM v[68:71], a[228:231], a[72:75], v[68:71]
 buffer_load_dwordx4 a[100:103], v245, s[8:11], s7 offen offset:1024
 MM v[92:95], a[228:231], a[76:79], v[92:95]
 ds_read_b64_tr_b16 a[252:253], v251 offset:18568
 v_mul_f32_e64 v240, v240, v202
 MM v[88:91], a[224:227], a[76:79], v[88:91]
 ds_read_b64_tr_b16 a[254:255], v251 offset:19336
 v_mul_f32_e64 v241, v241, v203
 MM v[84:87], a[220:223], a[76:79], v[84:87]
 CB v233, v240, v241
 v_lshlrev_b32_e64 v240, 16, v222
 MM v[80:83], a[216:219], a[76:79], v[80:83]
 v_and_b32 v241, s90, v222
 v_mul_f32 v240, v240, v204
 MM v[76:79], a[212:215], a[76:79], v[76:79]
 buffer_load_dwordx4 a[104:107], v245, s[8:11], s7 offen offset:2048
 MM v[72:75], a[208:211], a[76:79], v[72:75]
 v_mul_f32 v241, v241, v205
 s_waitcnt vmcnt(17)
 MM v[96:99], a[208:211], a[80:83], v[96:99]
 CB v234, v240, v241
 v_lshlrev_b32_e64 v240, 16, v223
 MM v[100:103], a[212:215], a[80:83], v[100:103]
 v_and_b32 v241, s90, v223
 v_mul_f32 v240, v240, v206
 MM v[104:107], a[216:219], a[80:83], v[104:107]
 buffer_load_dwordx4 a[0:3], v245, s[8:11], s7 offen offset:3072
 MM v[108:111], a[220:223], a[80:83], v[108:111]
 v_mul_f32_e64 v241, v241, v207
 CB v235, v240, v241
 MM v[112:115], a[224:227], a[80:83], v[112:115]
 ds_write_b128 v254, v[232:235] offset:27664
 s_add_u32 s7, s7, 0x1000
 MM v[116:119], a[228:231], a[80:83], v[116:119]
 v_lshlrev_b32 v240, 16, v224
 v_and_b32 v241, s90, v224
 MM v[140:143], a[228:231], a[84:87], v[140:143]
 buffer_load_dwordx4 a[4:7], v245, s[8:11], s7 offen offset:0
 MM v[136:139], a[224:227], a[84:87], v[136:139]
 v_mul_f32 v240, v240, v208
 v_mul_f32 v241, v241, v209
 MM v[132:135], a[220:223], a[84:87], v[132:135]
 CB v236, v240, v241
 v_lshlrev_b32_e64 v240, 16, v225
 MM v[128:131], a[216:219], a[84:87], v[128:131]
 v_and_b32 v241, s90, v225
 v_mul_f32 v240, v240, v210
 MM v[124:127], a[212:215], a[84:87], v[124:127]
 v_mul_f32_e64 v241, v241, v211
 CB v237, v240, v241
 MM v[120:123], a[208:211], a[84:87], v[120:123]
 v_lshlrev_b32 v240, 16, v226
 s_waitcnt vmcnt(17)
 MM v[144:147], a[208:211], a[88:91], v[144:147]
 buffer_load_dwordx4 a[8:11], v245, s[8:11], s7 offen offset:1024
 MM v[148:151], a[212:215], a[88:91], v[148:151]
 v_and_b32 v241, s90, v226
 v_mul_f32 v240, v240, v212
 MM v[152:155], a[216:219], a[88:91], v[152:155]
 v_mul_f32_e64 v241, v241, v213
 CB v238, v240, v241
 MM v[156:159], a[220:223], a[88:91], v[156:159]
 buffer_load_dwordx4 a[12:15], v245, s[8:11], s7 offen offset:2048
 MM v[160:163], a[224:227], a[88:91], v[160:163]
 v_lshlrev_b32 v240, 16, v227
 v_and_b32 v241, s90, v227
 MM v[164:167], a[228:231], a[88:91], v[164:167]
 v_mul_f32 v240, v240, v214
 v_mul_f32 v241, v241, v215
 MM v[188:191], a[228:231], a[92:95], v[188:191]
 CB v239, v240, v241
 MM v[184:187], a[224:227], a[92:95], v[184:187]
 buffer_load_dwordx4 a[16:19], v245, s[8:11], s7 offen offset:3072
 MM v[180:183], a[220:223], a[92:95], v[180:183]
 ds_write_b128 v254, v[236:239] offset:27680
 MM v[176:179], a[216:219], a[92:95], v[176:179]
 ds_read_b128 a[108:111], v243 offset:4160
 MM v[172:175], a[212:215], a[92:95], v[172:175]
 ds_read_b128 a[112:115], v243 offset:4176
 s_add_u32 s7, s7, 0x1000
 MM v[168:171], a[208:211], a[92:95], v[168:171]
 s_waitcnt lgkmcnt(4)
 s_waitcnt vmcnt(6)
 MM v[0:3], a[232:235], a[96:99], v[0:3]
 buffer_load_dwordx4 a[20:23], v245, s[8:11], s7 offen offset:0
 MM v[4:7], a[236:239], a[96:99], v[4:7]
 ds_read_b128 a[116:119], v243 offset:4192
 MM v[8:11], a[240:243], a[96:99], v[8:11]
 ds_read_b128 a[120:123], v243 offset:4208
 MM v[12:15], a[244:247], a[96:99], v[12:15]
 ds_read_b128 a[124:127], v243 offset:4224
 MM v[16:19], a[248:251], a[96:99], v[16:19]
 buffer_load_dwordx4 a[24:27], v245, s[8:11], s7 offen offset:1024
 MM v[20:23], a[252:255], a[96:99], v[20:23]
 ds_read_b128 a[128:131], v243 offset:4240
 MM v[44:47], a[252:255], a[100:103], v[44:47]
 ds_read_b128 a[132:135], v243 offset:4256
 MM v[40:43], a[248:251], a[100:103], v[40:43]
 MM v[36:39], a[244:247], a[100:103], v[36:39]
 MM v[32:35], a[240:243], a[100:103], v[32:35]
 buffer_load_dwordx4 a[28:31], v245, s[8:11], s7 offen offset:2048
 MM v[28:31], a[236:239], a[100:103], v[28:31]
 MM v[24:27], a[232:235], a[100:103], v[24:27]
 s_waitcnt vmcnt(7)
 MM v[48:51], a[232:235], a[104:107], v[48:51]
 MM v[52:55], a[236:239], a[104:107], v[52:55]
 buffer_load_dwordx4 a[32:35], v245, s[8:11], s7 offen offset:3072
 MM v[56:59], a[240:243], a[104:107], v[56:59]
 MM v[60:63], a[244:247], a[104:107], v[60:63]
 MM v[64:67], a[248:251], a[104:107], v[64:67]
 s_add_u32 s7, s7, 0x1000
 MM v[68:71], a[252:255], a[104:107], v[68:71]
 buffer_load_dwordx4 a[36:39], v245, s[8:11], s7 offen offset:0
 s_waitcnt lgkmcnt(0)
 s_barrier
 MM v[92:95], a[252:255], a[0:3], v[92:95]
 ds_read_b64_tr_b16 a[208:209], v251 offset:24576
 MM v[88:91], a[248:251], a[0:3], v[88:91]
 ds_read_b64_tr_b16 a[210:211], v251 offset:25344
 MM v[84:87], a[244:247], a[0:3], v[84:87]
 ds_read_b64_tr_b16 a[212:213], v251 offset:24584
 MM v[80:83], a[240:243], a[0:3], v[80:83]
 buffer_load_dwordx4 a[40:43], v245, s[8:11], s7 offen offset:1024
 MM v[76:79], a[236:239], a[0:3], v[76:79]
 ds_read_b64_tr_b16 a[214:215], v251 offset:25352
 MM v[72:75], a[232:235], a[0:3], v[72:75]
 ds_read_b64_tr_b16 a[216:217], v251 offset:24640
 s_waitcnt vmcnt(8)
 MM v[96:99], a[232:235], a[4:7], v[96:99]
 ds_read_b64_tr_b16 a[218:219], v251 offset:25408
 MM v[100:103], a[236:239], a[4:7], v[100:103]
 ds_read_b64_tr_b16 a[220:221], v251 offset:24648
 MM v[104:107], a[240:243], a[4:7], v[104:107]
 buffer_load_dwordx4 a[44:47], v245, s[8:11], s7 offen offset:2048
 MM v[108:111], a[244:247], a[4:7], v[108:111]
 ds_read_b64_tr_b16 a[222:223], v251 offset:25416
 MM v[112:115], a[248:251], a[4:7], v[112:115]
 ds_read_b64_tr_b16 a[224:225], v251 offset:24704
 MM v[116:119], a[252:255], a[4:7], v[116:119]
 ds_read_b64_tr_b16 a[226:227], v251 offset:25472
 MM v[140:143], a[252:255], a[8:11], v[140:143]
 buffer_load_dwordx4 a[48:51], v245, s[8:11], s7 offen offset:3072
 MM v[136:139], a[248:251], a[8:11], v[136:139]
 ds_read_b64_tr_b16 a[228:229], v251 offset:24712
 MM v[132:135], a[244:247], a[8:11], v[132:135]
 ds_read_b64_tr_b16 a[230:231], v251 offset:25480
 s_add_u32 m0, s36, 0
 MM v[128:131], a[240:243], a[8:11], v[128:131]
 s_add_u32 s34, s32, 12288
 MM v[124:127], a[236:239], a[8:11], v[124:127]
 buffer_load_dwordx4 v242, s[12:15], s34 offen sc1 lds
 MM v[120:123], a[232:235], a[8:11], v[120:123]
 s_waitcnt vmcnt(9)
 MM v[144:147], a[232:235], a[12:15], v[144:147]
 MM v[148:151], a[236:239], a[12:15], v[148:151]
 s_add_u32 m0, s36, 1040
 s_add_u32 s34, s32, 12416
 MM v[152:155], a[240:243], a[12:15], v[152:155]
 MM v[156:159], a[244:247], a[12:15], v[156:159]
 buffer_load_dwordx4 v242, s[12:15], s34 offen sc1 lds
 MM v[160:163], a[248:251], a[12:15], v[160:163]
 MM v[164:167], a[252:255], a[12:15], v[164:167]
 s_add_u32 m0, s36, 2080
 s_add_u32 s34, s32, 12544
 MM v[188:191], a[252:255], a[16:19], v[188:191]
 MM v[184:187], a[248:251], a[16:19], v[184:187]
 buffer_load_dwordx4 v242, s[12:15], s34 offen sc1 lds
 MM v[180:183], a[244:247], a[16:19], v[180:183]
 MM v[176:179], a[240:243], a[16:19], v[176:179]
 MM v[172:175], a[236:239], a[16:19], v[172:175]
 s_add_u32 m0, s36, 3120
 s_add_u32 s34, s32, 12672
 MM v[168:171], a[232:235], a[16:19], v[168:171]
 M4 v[192:195], a[136:137], a[108:109], 0
 buffer_load_dwordx4 v242, s[12:15], s34 offen sc1 lds
 M4 v[196:199], a[136:137], a[110:111], 0
 v_add_u32 v254, 49152, v254
 M4 v[200:203], a[136:137], a[112:113], 0
 ds_read_b128 v[216:219], v254 offset:0
 M4 v[192:195], a[138:139], a[110:111], v[192:195]
 ds_read_b128 v[220:223], v254 offset:16
 M4 v[196:199], a[138:139], a[112:113], v[196:199]
 ds_read_b128 v[224:227], v254 offset:32
 M4 v[200:203], a[138:139], a[114:115], v[200:203]
 M4 v[192:195], a[140:141], a[112:113], v[192:195]
 M4 v[196:199], a[140:141], a[114:115], v[196:199]
 buffer_load_dwordx4 a[156:159], v245, s[8:11], s43 offen offset:1024
 M4 v[200:203], a[140:141], a[116:117], v[200:203]
 M4 v[192:195], a[142:143], a[114:115], v[192:195]
 M4 v[196:199], a[142:143], a[116:117], v[196:199]
 M4 v[200:203], a[142:143], a[118:119], v[200:203]
 M4 v[192:195], a[144:145], a[116:117], v[192:195]
 M4 v[196:199], a[144:145], a[118:119], v[196:199]
 M4 v[200:203], a[144:145], a[120:121], v[200:203]
 M4 v[192:195], a[146:147], a[118:119], v[192:195]
 buffer_load_dwordx4 a[160:163], v245, s[8:11], s43 offen offset:2048
 M4 v[196:199], a[146:147], a[120:121], v[196:199]
 M4 v[200:203], a[146:147], a[122:123], v[200:203]
 M4 v[192:195], a[148:149], a[120:121], v[192:195]
 M4 v[196:199], a[148:149], a[122:123], v[196:199]
 M4 v[200:203], a[148:149], a[124:125], v[200:203]
 M4 v[192:195], a[150:151], a[122:123], v[192:195]
 M4 v[196:199], a[150:151], a[124:125], v[196:199]
 M4 v[200:203], a[150:151], a[126:127], v[200:203]
 M4 v[192:195], a[152:153], a[124:125], v[192:195]
 buffer_load_dwordx4 a[164:167], v245, s[8:11], s43 offen offset:3072
 M4 v[196:199], a[152:153], a[126:127], v[196:199]
 M4 v[200:203], a[152:153], a[128:129], v[200:203]
 M4 v[204:207], a[136:137], a[114:115], 0
 M4 v[208:211], a[136:137], a[116:117], 0
 s_add_u32 s43, s42, 81920
 M4 v[212:215], a[136:137], a[118:119], 0
 M4 v[204:207], a[138:139], a[116:117], v[204:207]
 s_waitcnt lgkmcnt(0)
 M4 v[208:211], a[138:139], a[118:119], v[208:211]
 v_lshlrev_b32 v240, 16, v216
 M4 v[212:215], a[138:139], a[120:121], v[212:215]
 buffer_load_dwordx4 a[168:171], v245, s[8:11], s43 offen offset:0
 M4 v[204:207], a[140:141], a[118:119], v[204:207]
 v_and_b32_e64 v241, s90, v216
 M4 v[208:211], a[140:141], a[120:121], v[208:211]
 v_mul_f32_e64 v240, v240, v192
 M4 v[212:215], a[140:141], a[122:123], v[212:215]
 v_mul_f32_e64 v241, v241, v193
 M4 v[204:207], a[142:143], a[120:121], v[204:207]
 CB v228, v240, v241
 M4 v[208:211], a[142:143], a[122:123], v[208:211]
 s_add_u32 s7, s7, 0x1000
 M4 v[212:215], a[142:143], a[124:125], v[212:215]
 v_lshlrev_b32_e64 v240, 16, v217
 M4 v[204:207], a[144:145], a[122:123], v[204:207]
 v_and_b32_e64 v241, s90, v217
 M4 v[208:211], a[144:145], a[124:125], v[208:211]
 buffer_load_dwordx4 a[52:55], v245, s[8:11], s7 offen offset:0
 M4 v[212:215], a[144:145], a[126:127], v[212:215]
 v_mul_f32_e64 v240, v240, v194
 M4 v[204:207], a[146:147], a[124:125], v[204:207]
 v_mul_f32_e64 v241, v241, v195
 M4 v[208:211], a[146:147], a[126:127], v[208:211]
 CB v229, v240, v241
 M4 v[212:215], a[146:147], a[128:129], v[212:215]
 v_lshlrev_b32_e64 v240, 16, v218
 M4 v[204:207], a[148:149], a[126:127], v[204:207]
 s_add_u32 m0, s44, 52224
 M4 v[208:211], a[148:149], a[128:129], v[208:211]
 s_add_u32 s45, s32, 8704
 M4 v[212:215], a[148:149], a[130:131], v[212:215]
 v_and_b32_e64 v241, s90, v218
 M4 v[204:207], a[150:151], a[128:129], v[204:207]
 buffer_load_dwordx4 v253, s[16:19], s45 offen sc1 lds
 M4 v[208:211], a[150:151], a[130:131], v[208:211]
 v_mul_f32_e64 v240, v240, v196
 M4 v[212:215], a[150:151], a[132:133], v[212:215]
 v_mul_f32_e64 v241, v241, v197
 M4 v[204:207], a[152:153], a[130:131], v[204:207]
 CB v230, v240, v241
 M4 v[208:211], a[152:153], a[132:133], v[208:211]
 v_lshlrev_b32_e64 v240, 16, v219
 M4 v[212:215], a[152:153], a[134:135], v[212:215]
 s_add_u32 m0, s44, 53248
 s_waitcnt vmcnt(16)
 MM v[0:3], a[208:211], a[20:23], v[0:3]
 ds_read_b64_tr_b16 a[232:233], v251 offset:30720
 s_add_u32 s45, s32, 8704
 MM v[4:7], a[212:215], a[20:23], v[4:7]
 buffer_load_dwordx4 v255, s[16:19], s45 offen sc1 lds
 MM v[8:11], a[216:219], a[20:23], v[8:11]
 ds_read_b64_tr_b16 a[234:235], v251 offset:31488
 v_and_b32 v241, s90, v219
 MM v[12:15], a[220:223], a[20:23], v[12:15]
 ds_read_b64_tr_b16 a[236:237], v251 offset:30728
 s_add_u32 m0, s44, 54272
 MM v[16:19], a[224:227], a[20:23], v[16:19]
 s_add_u32 s45, s32, 8704
 v_mul_f32_e64 v240, v240, v198
 MM v[20:23], a[228:231], a[20:23], v[20:23]
 buffer_load_dwordx4 v250, s[16:19], s45 offen sc1 lds
 MM v[44:47], a[228:231], a[24:27], v[44:47]
 ds_read_b64_tr_b16 a[238:239], v251 offset:31496
 v_mul_f32_e64 v241, v241, v199
 MM v[40:43], a[224:227], a[24:27], v[40:43]
 ds_read_b64_tr_b16 a[240:241], v251 offset:30784
 CB v231, v240, v241
 MM v[36:39], a[220:223], a[24:27], v[36:39]
 ds_write_b128 v254, v[228:231] offset:0
 v_lshlrev_b32_e64 v240, 16, v220
 MM v[32:35], a[216:219], a[24:27], v[32:35]
 ds_read_b64_tr_b16 a[242:243], v251 offset:31552
 v_and_b32_e64 v241, s90, v220
 MM v[28:31], a[212:215], a[24:27], v[28:31]
 buffer_load_dwordx4 a[56:59], v245, s[8:11], s7 offen offset:1024
 MM v[24:27], a[208:211], a[24:27], v[24:27]
 ds_read_b64_tr_b16 a[244:245], v251 offset:30792
 s_waitcnt vmcnt(17)
 MM v[48:51], a[208:211], a[28:31], v[48:51]
 ds_read_b64_tr_b16 a[246:247], v251 offset:31560
 v_mul_f32 v240, v240, v200
 MM v[52:55], a[212:215], a[28:31], v[52:55]
 ds_read_b64_tr_b16 a[248:249], v251 offset:30848
 v_mul_f32_e64 v241, v241, v201
 MM v[56:59], a[216:219], a[28:31], v[56:59]
 buffer_load_dwordx4 a[60:63], v245, s[8:11], s7 offen offset:2048
 MM v[60:63], a[220:223], a[28:31], v[60:63]
 ds_read_b64_tr_b16 a[250:251], v251 offset:31616
 CB v232, v240, v241
 MM v[64:67], a[224:227], a[28:31], v[64:67]
 ds_read_b64_tr_b16 a[252:253], v251 offset:30856
 v_lshlrev_b32_e64 v240, 16, v221
 MM v[68:71], a[228:231], a[28:31], v[68:71]
 ds_read_b64_tr_b16 a[254:255], v251 offset:31624
 v_and_b32_e64 v241, s90, v221
 MM v[92:95], a[228:231], a[32:35], v[92:95]
 v_mul_f32 v240, v240, v202
 v_mul_f32 v241, v241, v203
 MM v[88:91], a[224:227], a[32:35], v[88:91]
 buffer_load_dwordx4 a[64:67], v245, s[8:11], s7 offen offset:3072
 MM v[84:87], a[220:223], a[32:35], v[84:87]
 CB v233, v240, v241
 v_lshlrev_b32_e64 v240, 16, v222
 MM v[80:83], a[216:219], a[32:35], v[80:83]
 s_add_u32 s7, s7, 0x1000
 v_and_b32_e64 v241, s90, v222
 MM v[76:79], a[212:215], a[32:35], v[76:79]
 v_mul_f32 v240, v240, v204
 v_mul_f32 v241, v241, v205
 MM v[72:75], a[208:211], a[32:35], v[72:75]
 CB v234, v240, v241
 s_waitcnt vmcnt(17)
 MM v[96:99], a[208:211], a[36:39], v[96:99]
 buffer_load_dwordx4 a[68:71], v245, s[8:11], s7 offen offset:0
 MM v[100:103], a[212:215], a[36:39], v[100:103]
 v_lshlrev_b32 v240, 16, v223
 v_and_b32_e64 v241, s90, v223
 MM v[104:107], a[216:219], a[36:39], v[104:107]
 v_mul_f32 v240, v240, v206
 v_mul_f32 v241, v241, v207
 MM v[108:111], a[220:223], a[36:39], v[108:111]
 buffer_load_dwordx4 a[72:75], v245, s[8:11], s7 offen offset:1024
 MM v[112:115], a[224:227], a[36:39], v[112:115]
 CB v235, v240, v241
 v_lshlrev_b32_e64 v240, 16, v224
 MM v[116:119], a[228:231], a[36:39], v[116:119]
 ds_write_b128 v254, v[232:235] offset:16
 v_and_b32_e64 v241, s90, v224
 MM v[140:143], a[228:231], a[40:43], v[140:143]
 v_mul_f32 v240, v240, v208
 v_mul_f32 v241, v241, v209
 MM v[136:139], a[224:227], a[40:43], v[136:139]
 CB v236, v240, v241
 v_lshlrev_b32_e64 v240, 16, v225
 MM v[132:135], a[220:223], a[40:43], v[132:135]
 buffer_load_dwordx4 a[76:79], v245, s[8:11], s7 offen offset:2048
 MM v[128:131], a[216:219], a[40:43], v[128:131]
 v_and_b32 v241, s90, v225
 v_mul_f32 v240, v240, v210
 MM v[124:127], a[212:215], a[40:43], v[124:127]
 v_mul_f32_e64 v241, v241, v211
 CB v237, v240, v241
 MM v[120:123], a[208:211], a[40:43], v[120:123]
 v_lshlrev_b32 v240, 16, v226
 s_waitcnt vmcnt(18)
 MM v[144:147], a[208:211], a[44:47], v[144:147]
 buffer_load_dwordx4 a[80:83], v245, s[8:11], s7 offen offset:3072
 MM v[148:151], a[212:215], a[44:47], v[148:151]
 v_and_b32 v241, s90, v226
 v_mul_f32 v240, v240, v212
 MM v[152:155], a[216:219], a[44:47], v[152:155]
 v_mul_f32_e64 v241, v241, v213
 s_add_u32 s7, s7, 0x1000
 MM v[156:159], a[220:223], a[44:47], v[156:159]
 CB v238, v240, v241
 v_lshlrev_b32_e64 v240, 16, v227
 MM v[160:163], a[224:227], a[44:47], v[160:163]
 buffer_load_dwordx4 a[84:87], v245, s[8:11], s7 offen offset:0
 MM v[164:167], a[228:231], a[44:47], v[164:167]
 v_and_b32 v241, s90, v227
 v_mul_f32 v240, v240, v214
 MM v[188:191], a[228:231], a[48:51], v[188:191]
 v_mul_f32_e64 v241, v241, v215
 CB v239, v240, v241
 MM v[184:187], a[224:227], a[48:51], v[184:187]
 ds_write_b128 v254, v[236:239] offset:32
 MM v[180:183], a[220:223], a[48:51], v[180:183]
 MM v[176:179], a[216:219], a[48:51], v[176:179]
 buffer_load_dwordx4 a[88:91], v245, s[8:11], s7 offen offset:1024
 MM v[172:175], a[212:215], a[48:51], v[172:175]
 MM v[168:171], a[208:211], a[48:51], v[168:171]
 s_waitcnt lgkmcnt(2)
 s_waitcnt vmcnt(8)
 MM v[0:3], a[232:235], a[52:55], v[0:3]
 ds_read_b64_tr_b16 a[208:209], v251 offset:36864
 MM v[4:7], a[236:239], a[52:55], v[4:7]
 buffer_load_dwordx4 a[92:95], v245, s[8:11], s7 offen offset:2048
 MM v[8:11], a[240:243], a[52:55], v[8:11]
 ds_read_b64_tr_b16 a[210:211], v251 offset:37632
 MM v[12:15], a[244:247], a[52:55], v[12:15]
 ds_read_b128 a[108:111], v243 offset:8320
 MM v[16:19], a[248:251], a[52:55], v[16:19]
 ds_read_b64_tr_b16 a[212:213], v251 offset:36872
 MM v[20:23], a[252:255], a[52:55], v[20:23]
 ds_read_b128 a[112:115], v243 offset:8336
 MM v[44:47], a[252:255], a[56:59], v[44:47]
 buffer_load_dwordx4 a[96:99], v245, s[8:11], s7 offen offset:3072
 MM v[40:43], a[248:251], a[56:59], v[40:43]
 ds_read_b64_tr_b16 a[214:215], v251 offset:37640
 MM v[36:39], a[244:247], a[56:59], v[36:39]
 ds_read_b128 a[116:119], v243 offset:8352
 s_add_u32 s7, s7, 0x1000
 MM v[32:35], a[240:243], a[56:59], v[32:35]
 ds_read_b64_tr_b16 a[216:217], v251 offset:36928
 MM v[28:31], a[236:239], a[56:59], v[28:31]
 buffer_load_dwordx4 a[100:103], v245, s[8:11], s7 offen offset:0
 MM v[24:27], a[232:235], a[56:59], v[24:27]
 ds_read_b128 a[120:123], v243 offset:8368
 s_waitcnt vmcnt(9)
 MM v[48:51], a[232:235], a[60:63], v[48:51]
 ds_read_b64_tr_b16 a[218:219], v251 offset:37696
 MM v[52:55], a[236:239], a[60:63], v[52:55]
 ds_read_b128 a[124:127], v243 offset:8384
 MM v[56:59], a[240:243], a[60:63], v[56:59]
 buffer_load_dwordx4 a[104:107], v245, s[8:11], s7 offen offset:1024
 MM v[60:63], a[244:247], a[60:63], v[60:63]
 ds_read_b64_tr_b16 a[220:221], v251 offset:36936
 MM v[64:67], a[248:251], a[60:63], v[64:67]
 ds_read_b128 a[128:131], v243 offset:8400
 MM v[68:71], a[252:255], a[60:63], v[68:71]
 ds_read_b64_tr_b16 a[222:223], v251 offset:37704
 MM v[92:95], a[252:255], a[64:67], v[92:95]
 ds_read_b128 a[132:135], v243 offset:8416
 MM v[88:91], a[248:251], a[64:67], v[88:91]
 buffer_load_dwordx4 a[0:3], v245, s[8:11], s7 offen offset:2048
 MM v[84:87], a[244:247], a[64:67], v[84:87]
 ds_read_b64_tr_b16 a[224:225], v251 offset:36992
 MM v[80:83], a[240:243], a[64:67], v[80:83]
 ds_read_b64_tr_b16 a[226:227], v251 offset:37760
 MM v[76:79], a[236:239], a[64:67], v[76:79]
 ds_read_b64_tr_b16 a[228:229], v251 offset:37000
 MM v[72:75], a[232:235], a[64:67], v[72:75]
 ds_read_b64_tr_b16 a[230:231], v251 offset:37768
 s_waitcnt vmcnt(9)
 MM v[96:99], a[232:235], a[68:71], v[96:99]
 buffer_load_dwordx4 a[4:7], v245, s[8:11], s7 offen offset:3072
 MM v[100:103], a[236:239], a[68:71], v[100:103]
 MM v[104:107], a[240:243], a[68:71], v[104:107]
 s_add_u32 m0, s36, 4160
 s_add_u32 s34, s32, 12800
 MM v[108:111], a[244:247], a[68:71], v[108:111]
 buffer_load_dwordx4 v242, s[12:15], s34 offen sc1 lds
 MM v[112:115], a[248:251], a[68:71], v[112:115]
 MM v[116:119], a[252:255], a[68:71], v[116:119]
 MM v[140:143], a[252:255], a[72:75], v[140:143]
 s_add_u32 m0, s36, 5200
 s_add_u32 s34, s32, 12928
 MM v[136:139], a[248:251], a[72:75], v[136:139]
 MM v[132:135], a[244:247], a[72:75], v[132:135]
 buffer_load_dwordx4 v242, s[12:15], s34 offen sc1 lds
 MM v[128:131], a[240:243], a[72:75], v[128:131]
 MM v[124:127], a[236:239], a[72:75], v[124:127]
 s_add_u32 m0, s36, 6240
 s_add_u32 s34, s32, 13056
 MM v[120:123], a[232:235], a[72:75], v[120:123]
 s_waitcnt vmcnt(10)
 MM v[144:147], a[232:235], a[76:79], v[144:147]
 buffer_load_dwordx4 v242, s[12:15], s34 offen sc1 lds
 MM v[148:151], a[236:239], a[76:79], v[148:151]
 MM v[152:155], a[240:243], a[76:79], v[152:155]
 MM v[156:159], a[244:247], a[76:79], v[156:159]
 s_add_u32 m0, s36, 7280
 s_add_u32 s34, s32, 13184
 MM v[160:163], a[248:251], a[76:79], v[160:163]
 MM v[164:167], a[252:255], a[76:79], v[164:167]
 buffer_load_dwordx4 v242, s[12:15], s34 offen sc1 lds
 MM v[188:191], a[252:255], a[80:83], v[188:191]
 MM v[184:187], a[248:251], a[80:83], v[184:187]
 s_add_u32 s43, s42, 110592
 MM v[180:183], a[244:247], a[80:83], v[180:183]
 MM v[176:179], a[240:243], a[80:83], v[176:179]
 buffer_load_dwordx4 a[172:175], v245, s[8:11], s43 offen offset:0
 MM v[172:175], a[236:239], a[80:83], v[172:175]
 MM v[168:171], a[232:235], a[80:83], v[168:171]
 s_waitcnt lgkmcnt(4)
 M4 v[192:195], a[154:155], a[108:109], 0
 ds_read_b128 v[216:219], v254 offset:3072
 M4 v[196:199], a[154:155], a[110:111], 0
 ds_read_b128 v[220:223], v254 offset:3088
 M4 v[200:203], a[154:155], a[112:113], 0
 ds_read_b128 v[224:227], v254 offset:3104
 M4 v[192:195], a[156:157], a[110:111], v[192:195]
 buffer_load_dwordx4 a[176:179], v245, s[8:11], s43 offen offset:1024
 M4 v[196:199], a[156:157], a[112:113], v[196:199]
 M4 v[200:203], a[156:157], a[114:115], v[200:203]
 M4 v[192:195], a[158:159], a[112:113], v[192:195]
 M4 v[196:199], a[158:159], a[114:115], v[196:199]
 M4 v[200:203], a[158:159], a[116:117], v[200:203]
 M4 v[192:195], a[160:161], a[114:115], v[192:195]
 M4 v[196:199], a[160:161], a[116:117], v[196:199]
 M4 v[200:203], a[160:161], a[118:119], v[200:203]
 buffer_load_dwordx4 a[180:183], v245, s[8:11], s43 offen offset:2048
 M4 v[192:195], a[162:163], a[116:117], v[192:195]
 M4 v[196:199], a[162:163], a[118:119], v[196:199]
 M4 v[200:203], a[162:163], a[120:121], v[200:203]
 M4 v[192:195], a[164:165], a[118:119], v[192:195]
 M4 v[196:199], a[164:165], a[120:121], v[196:199]
 M4 v[200:203], a[164:165], a[122:123], v[200:203]
 M4 v[192:195], a[166:167], a[120:121], v[192:195]
 M4 v[196:199], a[166:167], a[122:123], v[196:199]
 buffer_load_dwordx4 a[184:187], v245, s[8:11], s43 offen offset:3072
 M4 v[200:203], a[166:167], a[124:125], v[200:203]
 M4 v[192:195], a[168:169], a[122:123], v[192:195]
 M4 v[196:199], a[168:169], a[124:125], v[196:199]
 M4 v[200:203], a[168:169], a[126:127], v[200:203]
 M4 v[192:195], a[170:171], a[124:125], v[192:195]
 s_add_u32 s43, s42, 114688
 M4 v[196:199], a[170:171], a[126:127], v[196:199]
 M4 v[200:203], a[170:171], a[128:129], v[200:203]
 M4 v[204:207], a[154:155], a[114:115], 0
 buffer_load_dwordx4 a[188:191], v245, s[8:11], s43 offen offset:0
 M4 v[208:211], a[154:155], a[116:117], 0
 M4 v[212:215], a[154:155], a[118:119], 0
 M4 v[204:207], a[156:157], a[116:117], v[204:207]
 s_waitcnt lgkmcnt(0)
 M4 v[208:211], a[156:157], a[118:119], v[208:211]
 v_lshlrev_b32 v240, 16, v216
 M4 v[212:215], a[156:157], a[120:121], v[212:215]
 s_add_u32 s7, s7, 0x1000
 M4 v[204:207], a[158:159], a[118:119], v[204:207]
 v_and_b32_e64 v241, s90, v216
 M4 v[208:211], a[158:159], a[120:121], v[208:211]
 v_mul_f32_e64 v240, v240, v192
 M4 v[212:215], a[158:159], a[122:123], v[212:215]
 v_mul_f32_e64 v241, v241, v193
 M4 v[204:207], a[160:161], a[120:121], v[204:207]
 buffer_load_dwordx4 a[8:11], v245, s[8:11], s7 offen offset:0
 M4 v[208:211], a[160:161], a[122:123], v[208:211]
 CB v228, v240, v241
 M4 v[212:215], a[160:161], a[124:125], v[212:215]
 v_lshlrev_b32_e64 v240, 16, v217
 M4 v[204:207], a[162:163], a[122:123], v[204:207]
 v_and_b32_e64 v241, s90, v217
 M4 v[208:211], a[162:163], a[124:125], v[208:211]
 s_add_u32 m0, s44, 73728
 M4 v[212:215], a[162:163], a[126:127], v[212:215]
 s_add_u32 s45, s32, 12288
 M4 v[204:207], a[164:165], a[124:125], v[204:207]
 v_mul_f32_e64 v240, v240, v194
 M4 v[208:211], a[164:165], a[126:127], v[208:211]
 v_mul_f32_e64 v241, v241, v195
 M4 v[212:215], a[164:165], a[128:129], v[212:215]
 buffer_load_dwordx4 v253, s[16:19], s45 offen sc1 lds
 M4 v[204:207], a[166:167], a[126:127], v[204:207]
 CB v229, v240, v241
 M4 v[208:211], a[166:167], a[128:129], v[208:211]
 v_lshlrev_b32_e64 v240, 16, v218
 M4 v[212:215], a[166:167], a[130:131], v[212:215]
 v_and_b32_e64 v241, s90, v218
 M4 v[204:207], a[168:169], a[128:129], v[204:207]
 v_mul_f32_e64 v240, v240, v196
 M4 v[208:211], a[168:169], a[130:131], v[208:211]
 s_add_u32 m0, s44, 74752
 M4 v[212:215], a[168:169], a[132:133], v[212:215]
 s_add_u32 s45, s32, 12288
 M4 v[204:207], a[170:171], a[130:131], v[204:207]
 v_mul_f32_e64 v241, v241, v197
 M4 v[208:211], a[170:171], a[132:133], v[208:211]
 buffer_load_dwordx4 v255, s[16:19], s45 offen sc1 lds
 M4 v[212:215], a[170:171], a[134:135], v[212:215]
 CB v230, v240, v241
 s_waitcnt vmcnt(18)
 MM v[0:3], a[208:211], a[84:87], v[0:3]
 ds_read_b64_tr_b16 a[232:233], v251 offset:43008
 v_lshlrev_b32 v240, 16, v219
 MM v[4:7], a[212:215], a[84:87], v[4:7]
 ds_read_b64_tr_b16 a[234:235], v251 offset:43776
 s_add_u32 m0, s44, 75776
 MM v[8:11], a[216:219], a[84:87], v[8:11]
 s_add_u32 s45, s32, 12288
 v_and_b32_e64 v241, s90, v219
 MM v[12:15], a[220:223], a[84:87], v[12:15]
 buffer_load_dwordx4 v250, s[16:19], s45 offen sc1 lds
 MM v[16:19], a[224:227], a[84:87], v[16:19]
 ds_read_b64_tr_b16 a[236:237], v251 offset:43016
 v_mul_f32_e64 v240, v240, v198
 MM v[20:23], a[228:231], a[84:87], v[20:23]
 ds_read_b64_tr_b16 a[238:239], v251 offset:43784
 v_mul_f32_e64 v241, v241, v199
 MM v[44:47], a[228:231], a[88:91], v[44:47]
 ds_read_b64_tr_b16 a[240:241], v251 offset:43072
 CB v231, v240, v241
 MM v[40:43], a[224:227], a[88:91], v[40:43]
 buffer_load_dwordx4 a[12:15], v245, s[8:11], s7 offen offset:1024
 MM v[36:39], a[220:223], a[88:91], v[36:39]
 ds_read_b64_tr_b16 a[242:243], v251 offset:43840
 v_lshlrev_b32_e64 v240, 16, v220
 MM v[32:35], a[216:219], a[88:91], v[32:35]
 ds_write_b128 v254, v[228:231] offset:3072
 v_and_b32_e64 v241, s90, v220
 MM v[28:31], a[212:215], a[88:91], v[28:31]
 ds_read_b64_tr_b16 a[244:245], v251 offset:43080
 v_mul_f32_e64 v240, v240, v200
 MM v[24:27], a[208:211], a[88:91], v[24:27]
 ds_read_b64_tr_b16 a[246:247], v251 offset:43848
 s_waitcnt vmcnt(18)
 MM v[48:51], a[208:211], a[92:95], v[48:51]
 buffer_load_dwordx4 a[16:19], v245, s[8:11], s7 offen offset:2048
 MM v[52:55], a[212:215], a[92:95], v[52:55]
 ds_read_b64_tr_b16 a[248:249], v251 offset:43136
 v_mul_f32 v241, v241, v201
 MM v[56:59], a[216:219], a[92:95], v[56:59]
 ds_read_b64_tr_b16 a[250:251], v251 offset:43904
 CB v232, v240, v241
 MM v[60:63], a[220:223], a[92:95], v[60:63]
 ds_read_b64_tr_b16 a[252:253], v251 offset:43144
 v_lshlrev_b32_e64 v240, 16, v221
 MM v[64:67], a[224:227], a[92:95], v[64:67]
 buffer_load_dwordx4 a[20:23], v245, s[8:11], s7 offen offset:3072
 MM v[68:71], a[228:231], a[92:95], v[68:71]
 ds_read_b64_tr_b16 a[254:255], v251 offset:43912
 v_and_b32_e64 v241, s90, v221
 MM v[92:95], a[228:231], a[96:99], v[92:95]
 v_mul_f32_e64 v240, v240, v202
 s_add_u32 s7, s7, 0x1000
 MM v[88:91], a[224:227], a[96:99], v[88:91]
 v_mul_f32_e64 v241, v241, v203
 CB v233, v240, v241
 MM v[84:87], a[220:223], a[96:99], v[84:87]
 buffer_load_dwordx4 a[24:27], v245, s[8:11], s7 offen offset:0
 MM v[80:83], a[216:219], a[96:99], v[80:83]
 v_lshlrev_b32 v240, 16, v222
 v_and_b32 v241, s90, v222
 MM v[76:79], a[212:215], a[96:99], v[76:79]
 v_mul_f32 v240, v240, v204
 v_mul_f32 v241, v241, v205
 MM v[72:75], a[208:211], a[96:99], v[72:75]
 CB v234, v240, v241
 s_waitcnt vmcnt(19)
 MM v[96:99], a[208:211], a[100:103], v[96:99]
 v_lshlrev_b32 v240, 16, v223
 v_and_b32_e64 v241, s90, v223
 MM v[100:103], a[212:215], a[100:103], v[100:103]
 buffer_load_dwordx4 a[28:31], v245, s[8:11], s7 offen offset:1024
 MM v[104:107], a[216:219], a[100:103], v[104:107]
 v_mul_f32 v240, v240, v206
 v_mul_f32 v241, v241, v207
 MM v[108:111], a[220:223], a[100:103], v[108:111]
 CB v235, v240, v241
 v_lshlrev_b32_e64 v240, 16, v224
 MM v[112:115], a[224:227], a[100:103], v[112:115]
 ds_write_b128 v254, v[232:235] offset:3088
 v_and_b32_e64 v241, s90, v224
 MM v[116:119], a[228:231], a[100:103], v[116:119]
 buffer_load_dwordx4 a[32:35], v245, s[8:11], s7 offen offset:2048
 MM v[140:143], a[228:231], a[104:107], v[140:143]
 v_mul_f32 v240, v240, v208
 v_mul_f32 v241, v241, v209
 MM v[136:139], a[224:227], a[104:107], v[136:139]
 CB v236, v240, v241
 v_lshlrev_b32_e64 v240, 16, v225
 MM v[132:135], a[220:223], a[104:107], v[132:135]
 v_and_b32 v241, s90, v225
 v_mul_f32 v240, v240, v210
 MM v[128:131], a[216:219], a[104:107], v[128:131]
 v_mul_f32_e64 v241, v241, v211
 CB v237, v240, v241
 MM v[124:127], a[212:215], a[104:107], v[124:127]
 buffer_load_dwordx4 a[36:39], v245, s[8:11], s7 offen offset:3072
 MM v[120:123], a[208:211], a[104:107], v[120:123]
 v_lshlrev_b32 v240, 16, v226
 s_waitcnt vmcnt(20)
 MM v[144:147], a[208:211], a[0:3], v[144:147]
 s_add_u32 s7, s7, 0x1000
 v_and_b32_e64 v241, s90, v226
 MM v[148:151], a[212:215], a[0:3], v[148:151]
 v_mul_f32 v240, v240, v212
 v_mul_f32 v241, v241, v213
 MM v[152:155], a[216:219], a[0:3], v[152:155]
 buffer_load_dwordx4 a[40:43], v245, s[8:11], s7 offen offset:0
 MM v[156:159], a[220:223], a[0:3], v[156:159]
 CB v238, v240, v241
 v_lshlrev_b32_e64 v240, 16, v227
 MM v[160:163], a[224:227], a[0:3], v[160:163]
 v_and_b32 v241, s90, v227
 v_mul_f32 v240, v240, v214
 MM v[164:167], a[228:231], a[0:3], v[164:167]
 v_mul_f32_e64 v241, v241, v215
 CB v239, v240, v241
 MM v[188:191], a[228:231], a[4:7], v[188:191]
 buffer_load_dwordx4 a[44:47], v245, s[8:11], s7 offen offset:1024
 MM v[184:187], a[224:227], a[4:7], v[184:187]
 ds_write_b128 v254, v[236:239] offset:3104
 MM v[180:183], a[220:223], a[4:7], v[180:183]
 ds_read_b128 a[108:111], v243 offset:0
 MM v[176:179], a[216:219], a[4:7], v[176:179]
 ds_read_b128 a[112:115], v243 offset:16
 MM v[172:175], a[212:215], a[4:7], v[172:175]
 ds_read_b128 a[116:119], v243 offset:32
 MM v[168:171], a[208:211], a[4:7], v[168:171]
 s_waitcnt lgkmcnt(5)
 s_waitcnt vmcnt(8)
 MM v[0:3], a[232:235], a[8:11], v[0:3]
 buffer_load_dwordx4 a[48:51], v245, s[8:11], s7 offen offset:2048
 MM v[4:7], a[236:239], a[8:11], v[4:7]
 ds_read_b128 a[120:123], v243 offset:48
 MM v[8:11], a[240:243], a[8:11], v[8:11]
 ds_read_b128 a[124:127], v243 offset:64
 MM v[12:15], a[244:247], a[8:11], v[12:15]
 buffer_load_dwordx4 a[52:55], v245, s[8:11], s7 offen offset:3072
 MM v[16:19], a[248:251], a[8:11], v[16:19]
 ds_read_b128 a[128:131], v243 offset:80
 MM v[20:23], a[252:255], a[8:11], v[20:23]
 ds_read_b128 a[132:135], v243 offset:96
 s_add_u32 s7, s7, 0x1000
 MM v[44:47], a[252:255], a[12:15], v[44:47]
 MM v[40:43], a[248:251], a[12:15], v[40:43]
 buffer_load_dwordx4 a[56:59], v245, s[8:11], s7 offen offset:0
 MM v[36:39], a[244:247], a[12:15], v[36:39]
 MM v[32:35], a[240:243], a[12:15], v[32:35]
 MM v[28:31], a[236:239], a[12:15], v[28:31]
 MM v[24:27], a[232:235], a[12:15], v[24:27]
 s_waitcnt vmcnt(9)
 MM v[48:51], a[232:235], a[16:19], v[48:51]
 buffer_load_dwordx4 a[60:63], v245, s[8:11], s7 offen offset:1024
 MM v[52:55], a[236:239], a[16:19], v[52:55]
 MM v[56:59], a[240:243], a[16:19], v[56:59]
 MM v[60:63], a[244:247], a[16:19], v[60:63]
 MM v[64:67], a[248:251], a[16:19], v[64:67]
 buffer_load_dwordx4 a[64:67], v245, s[8:11], s7 offen offset:2048
 MM v[68:71], a[252:255], a[16:19], v[68:71]
 s_waitcnt lgkmcnt(0)
 s_barrier
 MM v[92:95], a[252:255], a[20:23], v[92:95]
 ds_read_b64_tr_b16 a[208:209], v252 offset:0
 MM v[88:91], a[248:251], a[20:23], v[88:91]
 ds_read_b64_tr_b16 a[210:211], v252 offset:768
 MM v[84:87], a[244:247], a[20:23], v[84:87]
 ds_read_b64_tr_b16 a[212:213], v252 offset:8
 MM v[80:83], a[240:243], a[20:23], v[80:83]
 buffer_load_dwordx4 a[68:71], v245, s[8:11], s7 offen offset:3072
 MM v[76:79], a[236:239], a[20:23], v[76:79]
 ds_read_b64_tr_b16 a[214:215], v252 offset:776
 MM v[72:75], a[232:235], a[20:23], v[72:75]
 ds_read_b64_tr_b16 a[216:217], v252 offset:64
 s_waitcnt vmcnt(10)
 MM v[96:99], a[232:235], a[24:27], v[96:99]
 ds_read_b64_tr_b16 a[218:219], v252 offset:832
 MM v[100:103], a[236:239], a[24:27], v[100:103]
 buffer_load_dwordx4 a[192:195], v245, s[8:11], s43 offen offset:1024
 MM v[104:107], a[240:243], a[24:27], v[104:107]
 ds_read_b64_tr_b16 a[220:221], v252 offset:72
 MM v[108:111], a[244:247], a[24:27], v[108:111]
 ds_read_b64_tr_b16 a[222:223], v252 offset:840
 MM v[112:115], a[248:251], a[24:27], v[112:115]
 ds_read_b64_tr_b16 a[224:225], v252 offset:128
 MM v[116:119], a[252:255], a[24:27], v[116:119]
 buffer_load_dwordx4 a[196:199], v245, s[8:11], s43 offen offset:2048
 MM v[140:143], a[252:255], a[28:31], v[140:143]
 ds_read_b64_tr_b16 a[226:227], v252 offset:896
 MM v[136:139], a[248:251], a[28:31], v[136:139]
 ds_read_b64_tr_b16 a[228:229], v252 offset:136
 MM v[132:135], a[244:247], a[28:31], v[132:135]
 ds_read_b64_tr_b16 a[230:231], v252 offset:904
 MM v[128:131], a[240:243], a[28:31], v[128:131]
 MM v[124:127], a[236:239], a[28:31], v[124:127]
 buffer_load_dwordx4 a[200:203], v245, s[8:11], s43 offen offset:3072
 MM v[120:123], a[232:235], a[28:31], v[120:123]
 s_waitcnt vmcnt(11)
 MM v[144:147], a[232:235], a[32:35], v[144:147]
 s_add_u32 s43, s42, 118784
 MM v[148:151], a[236:239], a[32:35], v[148:151]
 MM v[152:155], a[240:243], a[32:35], v[152:155]
 buffer_load_dwordx4 a[204:207], v245, s[8:11], s43 offen offset:0
 MM v[156:159], a[244:247], a[32:35], v[156:159]
 MM v[160:163], a[248:251], a[32:35], v[160:163]
 MM v[164:167], a[252:255], a[32:35], v[164:167]
 s_add_u32 s7, s7, 0x1000
 MM v[188:191], a[252:255], a[36:39], v[188:191]
 buffer_load_dwordx4 a[72:75], v245, s[8:11], s7 offen offset:0
 MM v[184:187], a[248:251], a[36:39], v[184:187]
 MM v[180:183], a[244:247], a[36:39], v[180:183]
 MM v[176:179], a[240:243], a[36:39], v[176:179]
 s_add_u32 m0, s44, 76800
 s_add_u32 s45, s32, 12800
 MM v[172:175], a[236:239], a[36:39], v[172:175]
 MM v[168:171], a[232:235], a[36:39], v[168:171]
 M4 v[192:195], a[172:173], a[108:109], 0
 buffer_load_dwordx4 v253, s[16:19], s45 offen sc1 lds
 M4 v[196:199], a[172:173], a[110:111], 0
 ds_read_b128 v[216:219], v254 offset:24576
 M4 v[200:203], a[172:173], a[112:113], 0
 ds_read_b128 v[220:223], v254 offset:24592
 M4 v[192:195], a[174:175], a[110:111], v[192:195]
 ds_read_b128 v[224:227], v254 offset:24608
 M4 v[196:199], a[174:175], a[112:113], v[196:199]
 s_add_u32 m0, s44, 77824
 M4 v[200:203], a[174:175], a[114:115], v[200:203]
 s_add_u32 s45, s32, 12800
 M4 v[192:195], a[176:177], a[112:113], v[192:195]
 buffer_load_dwordx4 v255, s[16:19], s45 offen sc1 lds
 M4 v[196:199], a[176:177], a[114:115], v[196:199]
 M4 v[200:203], a[176:177], a[116:117], v[200:203]
 M4 v[192:195], a[178:179], a[114:115], v[192:195]
 M4 v[196:199], a[178:179], a[116:117], v[196:199]
 M4 v[200:203], a[178:179], a[118:119], v[200:203]
 s_add_u32 m0, s44, 78848
 M4 v[192:195], a[180:181], a[116:117], v[192:195]
 s_add_u32 s45, s32, 12800
 M4 v[196:199], a[180:181], a[118:119], v[196:199]
 M4 v[200:203], a[180:181], a[120:121], v[200:203]
 buffer_load_dwordx4 v250, s[16:19], s45 offen sc1 lds
 M4 v[192:195], a[182:183], a[118:119], v[192:195]
 M4 v[196:199], a[182:183], a[120:121], v[196:199]
 M4 v[200:203], a[182:183], a[122:123], v[200:203]
 M4 v[192:195], a[184:185], a[120:121], v[192:195]
 M4 v[196:199], a[184:185], a[122:123], v[196:199]
 M4 v[200:203], a[184:185], a[124:125], v[200:203]
 M4 v[192:195], a[186:187], a[122:123], v[192:195]
 M4 v[196:199], a[186:187], a[124:125], v[196:199]
 buffer_load_dwordx4 a[76:79], v245, s[8:11], s7 offen offset:1024
 M4 v[200:203], a[186:187], a[126:127], v[200:203]
 M4 v[192:195], a[188:189], a[124:125], v[192:195]
 M4 v[196:199], a[188:189], a[126:127], v[196:199]
 M4 v[200:203], a[188:189], a[128:129], v[200:203]
 M4 v[204:207], a[172:173], a[114:115], 0
 M4 v[208:211], a[172:173], a[116:117], 0
 M4 v[212:215], a[172:173], a[118:119], 0
 M4 v[204:207], a[174:175], a[116:117], v[204:207]
 s_waitcnt lgkmcnt(0)
 M4 v[208:211], a[174:175], a[118:119], v[208:211]
 buffer_load_dwordx4 a[80:83], v245, s[8:11], s7 offen offset:2048
 M4 v[212:215], a[174:175], a[120:121], v[212:215]
 v_lshlrev_b32_e64 v240, 16, v216
 M4 v[204:207], a[176:177], a[118:119], v[204:207]
 v_and_b32_e64 v241, s90, v216
 M4 v[208:211], a[176:177], a[120:121], v[208:211]
 v_mul_f32_e64 v240, v240, v192
 M4 v[212:215], a[176:177], a[122:123], v[212:215]
 v_mul_f32_e64 v241, v241, v193
 M4 v[204:207], a[178:179], a[120:121], v[204:207]
 CB v228, v240, v241
 M4 v[208:211], a[178:179], a[122:123], v[208:211]
 v_lshlrev_b32_e64 v240, 16, v217
 M4 v[212:215], a[178:179], a[124:125], v[212:215]
 v_and_b32_e64 v241, s90, v217
 M4 v[204:207], a[180:181], a[122:123], v[204:207]
 buffer_load_dwordx4 a[84:87], v245, s[8:11], s7 offen offset:3072
 M4 v[208:211], a[180:181], a[124:125], v[208:211]
 v_mul_f32_e64 v240, v240, v194
 M4 v[212:215], a[180:181], a[126:127], v[212:215]
 v_mul_f32_e64 v241, v241, v195
 M4 v[204:207], a[182:183], a[124:125], v[204:207]
 CB v229, v240, v241
 M4 v[208:211], a[182:183], a[126:127], v[208:211]
 v_lshlrev_b32_e64 v240, 16, v218
 M4 v[212:215], a[182:183], a[128:129], v[212:215]
 s_add_u32 s7, s7, 0x1000
 M4 v[204:207], a[184:185], a[126:127], v[204:207]
 v_and_b32_e64 v241, s90, v218
 M4 v[208:211], a[184:185], a[128:129], v[208:211]
 v_mul_f32_e64 v240, v240, v196
 M4 v[212:215], a[184:185], a[130:131], v[212:215]
 buffer_load_dwordx4 a[88:91], v245, s[8:11], s7 offen offset:0
 M4 v[204:207], a[186:187], a[128:129], v[204:207]
 v_mul_f32_e64 v241, v241, v197
 M4 v[208:211], a[186:187], a[130:131], v[208:211]
 CB v230, v240, v241
 M4 v[212:215], a[186:187], a[132:133], v[212:215]
 v_lshlrev_b32_e64 v240, 16, v219
 M4 v[204:207], a[188:189], a[130:131], v[204:207]
 v_and_b32_e64 v241, s90, v219
 M4 v[208:211], a[188:189], a[132:133], v[208:211]
 v_mul_f32_e64 v240, v240, v198
 M4 v[212:215], a[188:189], a[134:135], v[212:215]
 v_mul_f32 v241, v241, v199
 s_waitcnt vmcnt(18)
 MM v[0:3], a[208:211], a[40:43], v[0:3]
 buffer_load_dwordx4 a[92:95], v245, s[8:11], s7 offen offset:1024
 MM v[4:7], a[212:215], a[40:43], v[4:7]
 ds_read_b64_tr_b16 a[232:233], v252 offset:6144
 CB v231, v240, v241
 MM v[8:11], a[216:219], a[40:43], v[8:11]
 ds_read_b64_tr_b16 a[234:235], v252 offset:6912
 v_lshlrev_b32_e64 v240, 16, v220
 MM v[12:15], a[220:223], a[40:43], v[12:15]
 ds_write_b128 v254, v[228:231] offset:24576
 v_and_b32_e64 v241, s90, v220
 MM v[16:19], a[224:227], a[40:43], v[16:19]
 ds_read_b64_tr_b16 a[236:237], v252 offset:6152
 v_mul_f32_e64 v240, v240, v200
 MM v[20:23], a[228:231], a[40:43], v[20:23]
 buffer_load_dwordx4 a[96:99], v245, s[8:11], s7 offen offset:2048
 MM v[44:47], a[228:231], a[44:47], v[44:47]
 ds_read_b64_tr_b16 a[238:239], v252 offset:6920
 v_mul_f32_e64 v241, v241, v201
 MM v[40:43], a[224:227], a[44:47], v[40:43]
 ds_read_b64_tr_b16 a[240:241], v252 offset:6208
 CB v232, v240, v241
 MM v[36:39], a[220:223], a[44:47], v[36:39]
 ds_read_b64_tr_b16 a[242:243], v252 offset:6976
 v_lshlrev_b32_e64 v240, 16, v221
 MM v[32:35], a[216:219], a[44:47], v[32:35]
 buffer_load_dwordx4 a[100:103], v245, s[8:11], s7 offen offset:3072
 MM v[28:31], a[212:215], a[44:47], v[28:31]
 ds_read_b64_tr_b16 a[244:245], v252 offset:6216
 v_and_b32_e64 v241, s90, v221
 MM v[24:27], a[208:211], a[44:47], v[24:27]
 ds_read_b64_tr_b16 a[246:247], v252 offset:6984
 s_waitcnt vmcnt(19)
 MM v[48:51], a[208:211], a[48:51], v[48:51]
 ds_read_b64_tr_b16 a[248:249], v252 offset:6272
 s_add_u32 s7, s7, 0x1000
 MM v[52:55], a[212:215], a[48:51], v[52:55]
 ds_read_b64_tr_b16 a[250:251], v252 offset:7040
 v_mul_f32 v240, v240, v202
 MM v[56:59], a[216:219], a[48:51], v[56:59]
 buffer_load_dwordx4 a[104:107], v245, s[8:11], s7 offen offset:0
 MM v[60:63], a[220:223], a[48:51], v[60:63]
 ds_read_b64_tr_b16 a[252:253], v252 offset:6280
 v_mul_f32_e64 v241, v241, v203
 MM v[64:67], a[224:227], a[48:51], v[64:67]
 ds_read_b64_tr_b16 a[254:255], v252 offset:7048
 CB v233, v240, v241
 MM v[68:71], a[228:231], a[48:51], v[68:71]
 v_lshlrev_b32 v240, 16, v222
 v_and_b32 v241, s90, v222
 MM v[92:95], a[228:231], a[52:55], v[92:95]
 buffer_load_dwordx4 a[0:3], v245, s[8:11], s7 offen offset:1024
 MM v[88:91], a[224:227], a[52:55], v[88:91]
 v_mul_f32 v240, v240, v204
 v_mul_f32 v241, v241, v205
 MM v[84:87], a[220:223], a[52:55], v[84:87]
 CB v234, v240, v241
 v_lshlrev_b32_e64 v240, 16, v223
 MM v[80:83], a[216:219], a[52:55], v[80:83]
 v_and_b32 v241, s90, v223
 v_mul_f32 v240, v240, v206
 MM v[76:79], a[212:215], a[52:55], v[76:79]
 buffer_load_dwordx4 a[4:7], v245, s[8:11], s7 offen offset:2048
 MM v[72:75], a[208:211], a[52:55], v[72:75]
 v_mul_f32 v241, v241, v207
 s_waitcnt vmcnt(20)
 MM v[96:99], a[208:211], a[56:59], v[96:99]
 CB v235, v240, v241
 v_lshlrev_b32_e64 v240, 16, v224
 MM v[100:103], a[212:215], a[56:59], v[100:103]
 ds_write_b128 v254, v[232:235] offset:24592
 v_and_b32_e64 v241, s90, v224
 MM v[104:107], a[216:219], a[56:59], v[104:107]
 v_mul_f32 v240, v240, v208
 v_mul_f32 v241, v241, v209
 MM v[108:111], a[220:223], a[56:59], v[108:111]
 buffer_load_dwordx4 a[8:11], v245, s[8:11], s7 offen offset:3072
 MM v[112:115], a[224:227], a[56:59], v[112:115]
 CB v236, v240, v241
 v_lshlrev_b32_e64 v240, 16, v225
 MM v[116:119], a[228:231], a[56:59], v[116:119]
 s_add_u32 s7, s7, 0x1000
 v_and_b32_e64 v241, s90, v225
 MM v[140:143], a[228:231], a[60:63], v[140:143]
 v_mul_f32 v240, v240, v210
 v_mul_f32 v241, v241, v211
 MM v[136:139], a[224:227], a[60:63], v[136:139]
 buffer_load_dwordx4 a[12:15], v245, s[8:11], s7 offen offset:0
 MM v[132:135], a[220:223], a[60:63], v[132:135]
 CB v237, v240, v241
 v_lshlrev_b32_e64 v240, 16, v226
 MM v[128:131], a[216:219], a[60:63], v[128:131]
 v_and_b32 v241, s90, v226
 v_mul_f32 v240, v240, v212
 MM v[124:127], a[212:215], a[60:63], v[124:127]
 v_mul_f32_e64 v241, v241, v213
 CB v238, v240, v241
 MM v[120:123], a[208:211], a[60:63], v[120:123]
 v_lshlrev_b32 v240, 16, v227
 s_waitcnt vmcnt(20)
 MM v[144:147], a[208:211], a[64:67], v[144:147]
 buffer_load_dwordx4 a[16:19], v245, s[8:11], s7 offen offset:1024
 MM v[148:151], a[212:215], a[64:67], v[148:151]
 v_and_b32 v241, s90, v227
 v_mul_f32 v240, v240, v214
 MM v[152:155], a[216:219], a[64:67], v[152:155]
 v_mul_f32_e64 v241, v241, v215
 CB v239, v240, v241
 MM v[156:159], a[220:223], a[64:67], v[156:159]
 ds_write_b128 v254, v[236:239] offset:24608
 MM v[160:163], a[224:227], a[64:67], v[160:163]
 buffer_load_dwordx4 a[20:23], v245, s[8:11], s7 offen offset:2048
 MM v[164:167], a[228:231], a[64:67], v[164:167]
 MM v[188:191], a[228:231], a[68:71], v[188:191]
 MM v[184:187], a[224:227], a[68:71], v[184:187]
 MM v[180:183], a[220:223], a[68:71], v[180:183]
 buffer_load_dwordx4 a[24:27], v245, s[8:11], s7 offen offset:3072
 MM v[176:179], a[216:219], a[68:71], v[176:179]
 MM v[172:175], a[212:215], a[68:71], v[172:175]
 MM v[168:171], a[208:211], a[68:71], v[168:171]
 s_waitcnt lgkmcnt(2)
 s_waitcnt vmcnt(14)
 MM v[0:3], a[232:235], a[72:75], v[0:3]
 ds_read_b64_tr_b16 a[208:209], v252 offset:12288
 s_add_u32 s7, s7, 0x1000
 MM v[4:7], a[236:239], a[72:75], v[4:7]
 buffer_load_dwordx4 a[28:31], v245, s[8:11], s7 offen offset:0
 MM v[8:11], a[240:243], a[72:75], v[8:11]
 ds_read_b64_tr_b16 a[210:211], v252 offset:13056
 MM v[12:15], a[244:247], a[72:75], v[12:15]
 ds_read_b128 a[108:111], v243 offset:4160
 MM v[16:19], a[248:251], a[72:75], v[16:19]
 ds_read_b64_tr_b16 a[212:213], v252 offset:12296
 MM v[20:23], a[252:255], a[72:75], v[20:23]
 buffer_load_dwordx4 a[32:35], v245, s[8:11], s7 offen offset:1024
 MM v[44:47], a[252:255], a[76:79], v[44:47]
 ds_read_b128 a[112:115], v243 offset:4176
 MM v[40:43], a[248:251], a[76:79], v[40:43]
 ds_read_b64_tr_b16 a[214:215], v252 offset:13064
 MM v[36:39], a[244:247], a[76:79], v[36:39]
 ds_read_b128 a[116:119], v243 offset:4192
 MM v[32:35], a[240:243], a[76:79], v[32:35]
 buffer_load_dwordx4 a[36:39], v245, s[8:11], s7 offen offset:2048
 MM v[28:31], a[236:239], a[76:79], v[28:31]
 ds_read_b64_tr_b16 a[216:217], v252 offset:12352
 MM v[24:27], a[232:235], a[76:79], v[24:27]
 ds_read_b128 a[120:123], v243 offset:4208
 s_waitcnt vmcnt(15)
 MM v[48:51], a[232:235], a[80:83], v[48:51]
 ds_read_b64_tr_b16 a[218:219], v252 offset:13120
 MM v[52:55], a[236:239], a[80:83], v[52:55]
 ds_read_b128 a[124:127], v243 offset:4224
 MM v[56:59], a[240:243], a[80:83], v[56:59]
 buffer_load_dwordx4 a[40:43], v245, s[8:11], s7 offen offset:3072
 MM v[60:63], a[244:247], a[80:83], v[60:63]
 ds_read_b64_tr_b16 a[220:221], v252 offset:12360
 MM v[64:67], a[248:251], a[80:83], v[64:67]
 ds_read_b128 a[128:131], v243 offset:4240
 s_add_u32 s7, s7, 0x1000
 MM v[68:71], a[252:255], a[80:83], v[68:71]
 ds_read_b64_tr_b16 a[222:223], v252 offset:13128
 MM v[92:95], a[252:255], a[84:87], v[92:95]
 buffer_load_dwordx4 a[44:47], v245, s[8:11], s7 offen offset:0
 MM v[88:91], a[248:251], a[84:87], v[88:91]
 ds_read_b128 a[132:135], v243 offset:4256
 MM v[84:87], a[244:247], a[84:87], v[84:87]
 ds_read_b64_tr_b16 a[224:225], v252 offset:12416
 MM v[80:83], a[240:243], a[84:87], v[80:83]
 ds_read_b64_tr_b16 a[226:227], v252 offset:13184
 MM v[76:79], a[236:239], a[84:87], v[76:79]
 buffer_load_dwordx4 a[48:51], v245, s[8:11], s7 offen offset:1024
 MM v[72:75], a[232:235], a[84:87], v[72:75]
 ds_read_b64_tr_b16 a[228:229], v252 offset:12424
 s_waitcnt vmcnt(16)
 MM v[96:99], a[232:235], a[88:91], v[96:99]
 ds_read_b64_tr_b16 a[230:231], v252 offset:13192
 MM v[100:103], a[236:239], a[88:91], v[100:103]
 MM v[104:107], a[240:243], a[88:91], v[104:107]
 MM v[108:111], a[244:247], a[88:91], v[108:111]
 buffer_load_dwordx4 a[52:55], v245, s[8:11], s7 offen offset:2048
 MM v[112:115], a[248:251], a[88:91], v[112:115]
 MM v[116:119], a[252:255], a[88:91], v[116:119]
 MM v[140:143], a[252:255], a[92:95], v[140:143]
 MM v[136:139], a[248:251], a[92:95], v[136:139]
 buffer_load_dwordx4 a[56:59], v245, s[8:11], s7 offen offset:3072
 MM v[132:135], a[244:247], a[92:95], v[132:135]
 MM v[128:131], a[240:243], a[92:95], v[128:131]
 MM v[124:127], a[236:239], a[92:95], v[124:127]
 s_add_u32 s7, s7, 0x1000
 MM v[120:123], a[232:235], a[92:95], v[120:123]
 s_waitcnt vmcnt(16)
 MM v[144:147], a[232:235], a[96:99], v[144:147]
 buffer_load_dwordx4 a[60:63], v245, s[8:11], s7 offen offset:0
 MM v[148:151], a[236:239], a[96:99], v[148:151]
 MM v[152:155], a[240:243], a[96:99], v[152:155]
 MM v[156:159], a[244:247], a[96:99], v[156:159]
 MM v[160:163], a[248:251], a[96:99], v[160:163]
 buffer_load_dwordx4 a[64:67], v245, s[8:11], s7 offen offset:1024
 MM v[164:167], a[252:255], a[96:99], v[164:167]
 MM v[188:191], a[252:255], a[100:103], v[188:191]
 MM v[184:187], a[248:251], a[100:103], v[184:187]
 MM v[180:183], a[244:247], a[100:103], v[180:183]
 buffer_load_dwordx4 a[68:71], v245, s[8:11], s7 offen offset:2048
 MM v[176:179], a[240:243], a[100:103], v[176:179]
 MM v[172:175], a[236:239], a[100:103], v[172:175]
 MM v[168:171], a[232:235], a[100:103], v[168:171]
 s_waitcnt lgkmcnt(4)
 M4 v[192:195], a[190:191], a[108:109], 0
 ds_read_b128 v[216:219], v254 offset:27648
 M4 v[196:199], a[190:191], a[110:111], 0
 buffer_load_dwordx4 a[72:75], v245, s[8:11], s7 offen offset:3072
 M4 v[200:203], a[190:191], a[112:113], 0
 ds_read_b128 v[220:223], v254 offset:27664
 M4 v[192:195], a[192:193], a[110:111], v[192:195]
 ds_read_b128 v[224:227], v254 offset:27680
 M4 v[196:199], a[192:193], a[112:113], v[196:199]
 M4 v[200:203], a[192:193], a[114:115], v[200:203]
 M4 v[192:195], a[194:195], a[112:113], v[192:195]
 s_add_u32 s7, s7, 0x1000
 M4 v[196:199], a[194:195], a[114:115], v[196:199]
 M4 v[200:203], a[194:195], a[116:117], v[200:203]
 M4 v[192:195], a[196:197], a[114:115], v[192:195]
 M4 v[196:199], a[196:197], a[116:117], v[196:199]
 buffer_load_dwordx4 a[76:79], v245, s[8:11], s7 offen offset:0
 M4 v[200:203], a[196:197], a[118:119], v[200:203]
 M4 v[192:195], a[198:199], a[116:117], v[192:195]
 M4 v[196:199], a[198:199], a[118:119], v[196:199]
 M4 v[200:203], a[198:199], a[120:121], v[200:203]
 M4 v[192:195], a[200:201], a[118:119], v[192:195]
 M4 v[196:199], a[200:201], a[120:121], v[196:199]
 M4 v[200:203], a[200:201], a[122:123], v[200:203]
 M4 v[192:195], a[202:203], a[120:121], v[192:195]
 buffer_load_dwordx4 a[80:83], v245, s[8:11], s7 offen offset:1024
 M4 v[196:199], a[202:203], a[122:123], v[196:199]
 M4 v[200:203], a[202:203], a[124:125], v[200:203]
 M4 v[192:195], a[204:205], a[122:123], v[192:195]
 M4 v[196:199], a[204:205], a[124:125], v[196:199]
 M4 v[200:203], a[204:205], a[126:127], v[200:203]
 M4 v[192:195], a[206:207], a[124:125], v[192:195]
 M4 v[196:199], a[206:207], a[126:127], v[196:199]
 M4 v[200:203], a[206:207], a[128:129], v[200:203]
 buffer_load_dwordx4 a[84:87], v245, s[8:11], s7 offen offset:2048
 M4 v[204:207], a[190:191], a[114:115], 0
 M4 v[208:211], a[190:191], a[116:117], 0
 M4 v[212:215], a[190:191], a[118:119], 0
 M4 v[204:207], a[192:193], a[116:117], v[204:207]
 s_waitcnt lgkmcnt(0)
 M4 v[208:211], a[192:193], a[118:119], v[208:211]
 v_lshlrev_b32 v240, 16, v216
 M4 v[212:215], a[192:193], a[120:121], v[212:215]
 v_and_b32_e64 v241, s90, v216
 M4 v[204:207], a[194:195], a[118:119], v[204:207]
 v_mul_f32_e64 v240, v240, v192
 M4 v[208:211], a[194:195], a[120:121], v[208:211]
 buffer_load_dwordx4 a[88:91], v245, s[8:11], s7 offen offset:3072
 M4 v[212:215], a[194:195], a[122:123], v[212:215]
 v_mul_f32_e64 v241, v241, v193
 M4 v[204:207], a[196:197], a[120:121], v[204:207]
 CB v228, v240, v241
 M4 v[208:211], a[196:197], a[122:123], v[208:211]
 v_lshlrev_b32_e64 v240, 16, v217
 M4 v[212:215], a[196:197], a[124:125], v[212:215]
 v_and_b32_e64 v241, s90, v217
 M4 v[204:207], a[198:199], a[122:123], v[204:207]
 s_add_u32 s7, s7, 0x1000
 M4 v[208:211], a[198:199], a[124:125], v[208:211]
 v_mul_f32_e64 v240, v240, v194
 M4 v[212:215], a[198:199], a[126:127], v[212:215]
 v_mul_f32_e64 v241, v241, v195
 M4 v[204:207], a[200:201], a[124:125], v[204:207]
 CB v229, v240, v241
 M4 v[208:211], a[200:201], a[126:127], v[208:211]
 buffer_load_dwordx4 a[92:95], v245, s[8:11], s7 offen offset:0
 M4 v[212:215], a[200:201], a[128:129], v[212:215]
 v_lshlrev_b32_e64 v240, 16, v218
 M4 v[204:207], a[202:203], a[126:127], v[204:207]
 v_and_b32_e64 v241, s90, v218
 M4 v[208:211], a[202:203], a[128:129], v[208:211]
 v_mul_f32_e64 v240, v240, v196
 M4 v[212:215], a[202:203], a[130:131], v[212:215]
 v_mul_f32_e64 v241, v241, v197
 M4 v[204:207], a[204:205], a[128:129], v[204:207]
 CB v230, v240, v241
 M4 v[208:211], a[204:205], a[130:131], v[208:211]
 v_lshlrev_b32_e64 v240, 16, v219
 M4 v[212:215], a[204:205], a[132:133], v[212:215]
 v_and_b32_e64 v241, s90, v219
 M4 v[204:207], a[206:207], a[130:131], v[204:207]
 buffer_load_dwordx4 a[96:99], v245, s[8:11], s7 offen offset:1024
 M4 v[208:211], a[206:207], a[132:133], v[208:211]
 v_mul_f32_e64 v240, v240, v198
 M4 v[212:215], a[206:207], a[134:135], v[212:215]
 v_mul_f32 v241, v241, v199
 s_waitcnt vmcnt(24)
 MM v[0:3], a[208:211], a[104:107], v[0:3]
 ds_read_b64_tr_b16 a[232:233], v252 offset:18432
 CB v231, v240, v241
 MM v[4:7], a[212:215], a[104:107], v[4:7]
 ds_read_b64_tr_b16 a[234:235], v252 offset:19200
 v_lshlrev_b32_e64 v240, 16, v220
 MM v[8:11], a[216:219], a[104:107], v[8:11]
 buffer_load_dwordx4 a[100:103], v245, s[8:11], s7 offen offset:2048
 MM v[12:15], a[220:223], a[104:107], v[12:15]
 ds_write_b128 v254, v[228:231] offset:27648
 v_and_b32_e64 v241, s90, v220
 MM v[16:19], a[224:227], a[104:107], v[16:19]
 ds_read_b64_tr_b16 a[236:237], v252 offset:18440
 v_mul_f32_e64 v240, v240, v200
 MM v[20:23], a[228:231], a[104:107], v[20:23]
 ds_read_b64_tr_b16 a[238:239], v252 offset:19208
 v_mul_f32_e64 v241, v241, v201
 MM v[44:47], a[228:231], a[0:3], v[44:47]
 ds_read_b64_tr_b16 a[240:241], v252 offset:18496
 CB v232, v240, v241
 MM v[40:43], a[224:227], a[0:3], v[40:43]
 buffer_load_dwordx4 a[104:107], v245, s[8:11], s7 offen offset:3072
 MM v[36:39], a[220:223], a[0:3], v[36:39]
 ds_read_b64_tr_b16 a[242:243], v252 offset:19264
 v_lshlrev_b32_e64 v240, 16, v221
 MM v[32:35], a[216:219], a[0:3], v[32:35]
 ds_read_b64_tr_b16 a[244:245], v252 offset:18504
 v_and_b32_e64 v241, s90, v221
 MM v[28:31], a[212:215], a[0:3], v[28:31]
 ds_read_b64_tr_b16 a[246:247], v252 offset:19272
 v_mul_f32_e64 v240, v240, v202
 MM v[24:27], a[208:211], a[0:3], v[24:27]
 ds_read_b64_tr_b16 a[248:249], v252 offset:18560
 s_waitcnt vmcnt(24)
 MM v[48:51], a[208:211], a[4:7], v[48:51]
 ds_read_b64_tr_b16 a[250:251], v252 offset:19328
 s_add_u32 s7, s7, 0x1000
 MM v[52:55], a[212:215], a[4:7], v[52:55]
 buffer_load_dwordx4 a[0:3], v245, s[8:11], s7 offen offset:0
 MM v[56:59], a[216:219], a[4:7], v[56:59]
 ds_read_b64_tr_b16 a[252:253], v252 offset:18568
 v_mul_f32 v241, v241, v203
 MM v[60:63], a[220:223], a[4:7], v[60:63]
 ds_read_b64_tr_b16 a[254:255], v252 offset:19336
 CB v233, v240, v241
 MM v[64:67], a[224:227], a[4:7], v[64:67]
 v_lshlrev_b32 v240, 16, v222
 v_and_b32 v241, s90, v222
 MM v[68:71], a[228:231], a[4:7], v[68:71]
 buffer_load_dwordx4 a[4:7], v245, s[8:11], s7 offen offset:1024
 MM v[92:95], a[228:231], a[8:11], v[92:95]
 v_mul_f32 v240, v240, v204
 v_mul_f32 v241, v241, v205
 MM v[88:91], a[224:227], a[8:11], v[88:91]
 CB v234, v240, v241
 v_lshlrev_b32_e64 v240, 16, v223
 MM v[84:87], a[220:223], a[8:11], v[84:87]
 v_and_b32 v241, s90, v223
 v_mul_f32 v240, v240, v206
 MM v[80:83], a[216:219], a[8:11], v[80:83]
 v_mul_f32_e64 v241, v241, v207
 CB v235, v240, v241
 MM v[76:79], a[212:215], a[8:11], v[76:79]
 ds_write_b128 v254, v[232:235] offset:27664
 v_lshlrev_b32_e64 v240, 16, v224
 MM v[72:75], a[208:211], a[8:11], v[72:75]
 v_and_b32 v241, s90, v224
 s_waitcnt vmcnt(24)
 MM v[96:99], a[208:211], a[12:15], v[96:99]
 buffer_load_dwordx4 a[8:11], v245, s[8:11], s7 offen offset:2048
 MM v[100:103], a[212:215], a[12:15], v[100:103]
 v_mul_f32 v240, v240, v208
 v_mul_f32 v241, v241, v209
 MM v[104:107], a[216:219], a[12:15], v[104:107]
 CB v236, v240, v241
 v_lshlrev_b32_e64 v240, 16, v225
 MM v[108:111], a[220:223], a[12:15], v[108:111]
 v_and_b32 v241, s90, v225
 v_mul_f32 v240, v240, v210
 MM v[112:115], a[224:227], a[12:15], v[112:115]
 v_mul_f32_e64 v241, v241, v211
 CB v237, v240, v241
 MM v[116:119], a[228:231], a[12:15], v[116:119]
 buffer_load_dwordx4 a[12:15], v245, s[8:11], s7 offen offset:3072
 MM v[140:143], a[228:231], a[16:19], v[140:143]
 v_lshlrev_b32 v240, 16, v226
 v_and_b32 v241, s90, v226
 MM v[136:139], a[224:227], a[16:19], v[136:139]
 v_mul_f32 v240, v240, v212
 v_mul_f32 v241, v241, v213
 MM v[132:135], a[220:223], a[16:19], v[132:135]
 CB v238, v240, v241
 v_lshlrev_b32_e64 v240, 16, v227
 MM v[128:131], a[216:219], a[16:19], v[128:131]
 v_and_b32 v241, s90, v227
 v_mul_f32 v240, v240, v214
 MM v[124:127], a[212:215], a[16:19], v[124:127]
 v_mul_f32_e64 v241, v241, v215
 CB v239, v240, v241
 MM v[120:123], a[208:211], a[16:19], v[120:123]
 ds_write_b128 v254, v[236:239] offset:27680
 s_waitcnt vmcnt(24)
 MM v[144:147], a[208:211], a[20:23], v[144:147]
 s_add_u32 s7, s7, 0x1000
 MM v[148:151], a[212:215], a[20:23], v[148:151]
 buffer_load_dwordx4 a[16:19], v245, s[8:11], s7 offen offset:0
 MM v[152:155], a[216:219], a[20:23], v[152:155]
 MM v[156:159], a[220:223], a[20:23], v[156:159]
 MM v[160:163], a[224:227], a[20:23], v[160:163]
 MM v[164:167], a[228:231], a[20:23], v[164:167]
 buffer_load_dwordx4 a[20:23], v245, s[8:11], s7 offen offset:1024
 MM v[188:191], a[228:231], a[24:27], v[188:191]
 MM v[184:187], a[224:227], a[24:27], v[184:187]
 MM v[180:183], a[220:223], a[24:27], v[180:183]
 MM v[176:179], a[216:219], a[24:27], v[176:179]
 MM v[172:175], a[212:215], a[24:27], v[172:175]
 MM v[168:171], a[208:211], a[24:27], v[168:171]
 s_waitcnt lgkmcnt(2)
 s_waitcnt vmcnt(24)
 MM v[0:3], a[232:235], a[28:31], v[0:3]
 buffer_load_dwordx4 a[24:27], v245, s[8:11], s7 offen offset:2048
 MM v[4:7], a[236:239], a[28:31], v[4:7]
 MM v[8:11], a[240:243], a[28:31], v[8:11]
 MM v[12:15], a[244:247], a[28:31], v[12:15]
 MM v[16:19], a[248:251], a[28:31], v[16:19]
 MM v[20:23], a[252:255], a[28:31], v[20:23]
 buffer_load_dwordx4 a[28:31], v245, s[8:11], s7 offen offset:3072
 MM v[44:47], a[252:255], a[32:35], v[44:47]
 MM v[40:43], a[248:251], a[32:35], v[40:43]
 MM v[36:39], a[244:247], a[32:35], v[36:39]
 MM v[32:35], a[240:243], a[32:35], v[32:35]
 MM v[28:31], a[236:239], a[32:35], v[28:31]
 MM v[24:27], a[232:235], a[32:35], v[24:27]
 s_add_u32 s7, s7, 0x1000
 s_waitcnt vmcnt(24)
 MM v[48:51], a[232:235], a[36:39], v[48:51]
 buffer_load_dwordx4 a[32:35], v245, s[8:11], s7 offen offset:0
 MM v[52:55], a[236:239], a[36:39], v[52:55]
 MM v[56:59], a[240:243], a[36:39], v[56:59]
 MM v[60:63], a[244:247], a[36:39], v[60:63]
 MM v[64:67], a[248:251], a[36:39], v[64:67]
 MM v[68:71], a[252:255], a[36:39], v[68:71]
 buffer_load_dwordx4 a[36:39], v245, s[8:11], s7 offen offset:1024
 s_waitcnt lgkmcnt(0)
 s_barrier
 MM v[92:95], a[252:255], a[40:43], v[92:95]
 ds_read_b64_tr_b16 a[208:209], v252 offset:24576
 MM v[88:91], a[248:251], a[40:43], v[88:91]
 ds_read_b64_tr_b16 a[210:211], v252 offset:25344
 MM v[84:87], a[244:247], a[40:43], v[84:87]
 ds_read_b64_tr_b16 a[212:213], v252 offset:24584
 MM v[80:83], a[240:243], a[40:43], v[80:83]
 ds_read_b64_tr_b16 a[214:215], v252 offset:25352
 MM v[76:79], a[236:239], a[40:43], v[76:79]
 ds_read_b64_tr_b16 a[216:217], v252 offset:24640
 MM v[72:75], a[232:235], a[40:43], v[72:75]
 ds_read_b64_tr_b16 a[218:219], v252 offset:25408
 s_waitcnt vmcnt(24)
 MM v[96:99], a[232:235], a[44:47], v[96:99]
 buffer_load_dwordx4 a[40:43], v245, s[8:11], s7 offen offset:2048
 MM v[100:103], a[236:239], a[44:47], v[100:103]
 ds_read_b64_tr_b16 a[220:221], v252 offset:24648
 MM v[104:107], a[240:243], a[44:47], v[104:107]
 ds_read_b64_tr_b16 a[222:223], v252 offset:25416
 MM v[108:111], a[244:247], a[44:47], v[108:111]
 ds_read_b64_tr_b16 a[224:225], v252 offset:24704
 MM v[112:115], a[248:251], a[44:47], v[112:115]
 ds_read_b64_tr_b16 a[226:227], v252 offset:25472
 MM v[116:119], a[252:255], a[44:47], v[116:119]
 buffer_load_dwordx4 a[44:47], v245, s[8:11], s7 offen offset:3072
 MM v[140:143], a[252:255], a[48:51], v[140:143]
 ds_read_b64_tr_b16 a[228:229], v252 offset:24712
 MM v[136:139], a[248:251], a[48:51], v[136:139]
 ds_read_b64_tr_b16 a[230:231], v252 offset:25480
 MM v[132:135], a[244:247], a[48:51], v[132:135]
 MM v[128:131], a[240:243], a[48:51], v[128:131]
 MM v[124:127], a[236:239], a[48:51], v[124:127]
 MM v[120:123], a[232:235], a[48:51], v[120:123]
 s_add_u32 s7, s7, 0x1000
 s_waitcnt vmcnt(24)
 MM v[144:147], a[232:235], a[52:55], v[144:147]
 buffer_load_dwordx4 a[48:51], v245, s[8:11], s7 offen offset:0
 MM v[148:151], a[236:239], a[52:55], v[148:151]
 MM v[152:155], a[240:243], a[52:55], v[152:155]
 MM v[156:159], a[244:247], a[52:55], v[156:159]
 MM v[160:163], a[248:251], a[52:55], v[160:163]
 MM v[164:167], a[252:255], a[52:55], v[164:167]
 buffer_load_dwordx4 a[52:55], v245, s[8:11], s7 offen offset:1024
 MM v[188:191], a[252:255], a[56:59], v[188:191]
 MM v[184:187], a[248:251], a[56:59], v[184:187]
 MM v[180:183], a[244:247], a[56:59], v[180:183]
 MM v[176:179], a[240:243], a[56:59], v[176:179]
 MM v[172:175], a[236:239], a[56:59], v[172:175]
 MM v[168:171], a[232:235], a[56:59], v[168:171]
 s_waitcnt lgkmcnt(0)
 s_waitcnt vmcnt(24)
 MM v[0:3], a[208:211], a[60:63], v[0:3]
 buffer_load_dwordx4 a[56:59], v245, s[8:11], s7 offen offset:2048
 MM v[4:7], a[212:215], a[60:63], v[4:7]
 ds_read_b64_tr_b16 a[232:233], v252 offset:30720
 s_add_u32 m0, s36, 0
 MM v[8:11], a[216:219], a[60:63], v[8:11]
 ds_read_b64_tr_b16 a[234:235], v252 offset:31488
 s_add_u32 s50, s49, 0
 MM v[12:15], a[220:223], a[60:63], v[12:15]
 buffer_load_dwordx4 v248, s[24:27], s50 offen lds
 MM v[16:19], a[224:227], a[60:63], v[16:19]
 ds_read_b64_tr_b16 a[236:237], v252 offset:30728
 s_add_u32 m0, s36, 1024
 MM v[20:23], a[228:231], a[60:63], v[20:23]
 ds_read_b64_tr_b16 a[238:239], v252 offset:31496
 s_add_u32 s50, s49, 64
 MM v[44:47], a[228:231], a[64:67], v[44:47]
 buffer_load_dwordx4 v248, s[24:27], s50 offen lds
 MM v[40:43], a[224:227], a[64:67], v[40:43]
 ds_read_b64_tr_b16 a[240:241], v252 offset:30784
 MM v[36:39], a[220:223], a[64:67], v[36:39]
 ds_read_b64_tr_b16 a[242:243], v252 offset:31552
 MM v[32:35], a[216:219], a[64:67], v[32:35]
 buffer_load_dwordx4 a[60:63], v245, s[8:11], s7 offen offset:3072
 MM v[28:31], a[212:215], a[64:67], v[28:31]
 ds_read_b64_tr_b16 a[244:245], v252 offset:30792
 MM v[24:27], a[208:211], a[64:67], v[24:27]
 ds_read_b64_tr_b16 a[246:247], v252 offset:31560
 s_waitcnt vmcnt(26)
 MM v[48:51], a[208:211], a[68:71], v[48:51]
 ds_read_b64_tr_b16 a[248:249], v252 offset:30848
 s_add_u32 s7, s7, 0x1000
 MM v[52:55], a[212:215], a[68:71], v[52:55]
 ds_read_b64_tr_b16 a[250:251], v252 offset:31616
 MM v[56:59], a[216:219], a[68:71], v[56:59]
 buffer_load_dwordx4 a[64:67], v245, s[8:11], s7 offen offset:0
 MM v[60:63], a[220:223], a[68:71], v[60:63]
 ds_read_b64_tr_b16 a[252:253], v252 offset:30856
 MM v[64:67], a[224:227], a[68:71], v[64:67]
 ds_read_b64_tr_b16 a[254:255], v252 offset:31624
 s_add_u32 m0, s36, 2048
 MM v[68:71], a[228:231], a[68:71], v[68:71]
 s_add_u32 s50, s49, 16384
 MM v[92:95], a[228:231], a[72:75], v[92:95]
 buffer_load_dwordx4 v248, s[24:27], s50 offen lds
 MM v[88:91], a[224:227], a[72:75], v[88:91]
 MM v[84:87], a[220:223], a[72:75], v[84:87]
 MM v[80:83], a[216:219], a[72:75], v[80:83]
 MM v[76:79], a[212:215], a[72:75], v[76:79]
 MM v[72:75], a[208:211], a[72:75], v[72:75]
 s_waitcnt vmcnt(26)
 MM v[96:99], a[208:211], a[76:79], v[96:99]
 buffer_load_dwordx4 a[68:71], v245, s[8:11], s7 offen offset:1024
 MM v[100:103], a[212:215], a[76:79], v[100:103]
 MM v[104:107], a[216:219], a[76:79], v[104:107]
 MM v[108:111], a[220:223], a[76:79], v[108:111]
 buffer_load_dwordx4 a[72:75], v245, s[8:11], s7 offen offset:2048
 MM v[112:115], a[224:227], a[76:79], v[112:115]
 MM v[116:119], a[228:231], a[76:79], v[116:119]
 MM v[140:143], a[228:231], a[80:83], v[140:143]
 MM v[136:139], a[224:227], a[80:83], v[136:139]
 buffer_load_dwordx4 a[76:79], v245, s[8:11], s7 offen offset:3072
 MM v[132:135], a[220:223], a[80:83], v[132:135]
 MM v[128:131], a[216:219], a[80:83], v[128:131]
 MM v[124:127], a[212:215], a[80:83], v[124:127]
 s_add_u32 m0, s36, 3072
 s_add_u32 s50, s49, 16448
 MM v[120:123], a[208:211], a[80:83], v[120:123]
 s_waitcnt vmcnt(27)
 MM v[144:147], a[208:211], a[84:87], v[144:147]
 buffer_load_dwordx4 v248, s[24:27], s50 offen lds
 MM v[148:151], a[212:215], a[84:87], v[148:151]
 MM v[152:155], a[216:219], a[84:87], v[152:155]
 s_add_u32 m0, s36, 4096
 s_add_u32 s50, s49, 32768
 MM v[156:159], a[220:223], a[84:87], v[156:159]
 MM v[160:163], a[224:227], a[84:87], v[160:163]
 buffer_load_dwordx4 v248, s[24:27], s50 offen lds
 MM v[164:167], a[228:231], a[84:87], v[164:167]
 MM v[188:191], a[228:231], a[88:91], v[188:191]
 MM v[184:187], a[224:227], a[88:91], v[184:187]
 s_add_u32 m0, s36, 5120
 s_add_u32 s50, s49, 32832
 MM v[180:183], a[220:223], a[88:91], v[180:183]
 buffer_load_dwordx4 v248, s[24:27], s50 offen lds
 MM v[176:179], a[216:219], a[88:91], v[176:179]
 MM v[172:175], a[212:215], a[88:91], v[172:175]
 MM v[168:171], a[208:211], a[88:91], v[168:171]
 s_waitcnt lgkmcnt(0)
 s_waitcnt vmcnt(28)
 MM v[0:3], a[232:235], a[92:95], v[0:3]
 ds_read_b64_tr_b16 a[208:209], v252 offset:36864
 s_add_u32 m0, s36, 6144
 MM v[4:7], a[236:239], a[92:95], v[4:7]
 ds_read_b64_tr_b16 a[210:211], v252 offset:37632
 s_add_u32 s50, s49, 49152
 MM v[8:11], a[240:243], a[92:95], v[8:11]
 buffer_load_dwordx4 v248, s[24:27], s50 offen lds
 MM v[12:15], a[244:247], a[92:95], v[12:15]
 ds_read_b64_tr_b16 a[212:213], v252 offset:36872
 s_add_u32 m0, s36, 7168
 MM v[16:19], a[248:251], a[92:95], v[16:19]
 ds_read_b64_tr_b16 a[214:215], v252 offset:37640
 s_add_u32 s50, s49, 49216
 MM v[20:23], a[252:255], a[92:95], v[20:23]
 buffer_load_dwordx4 v248, s[24:27], s50 offen lds
 MM v[44:47], a[252:255], a[96:99], v[44:47]
 ds_read_b64_tr_b16 a[216:217], v252 offset:36928
 MM v[40:43], a[248:251], a[96:99], v[40:43]
 ds_read_b64_tr_b16 a[218:219], v252 offset:37696
 MM v[36:39], a[244:247], a[96:99], v[36:39]
 ds_read_b64_tr_b16 a[220:221], v252 offset:36936
 s_add_u32 s43, s46, 0
 MM v[32:35], a[240:243], a[96:99], v[32:35]
 ds_read_b64_tr_b16 a[222:223], v252 offset:37704
 MM v[28:31], a[236:239], a[96:99], v[28:31]
 buffer_load_dwordx4 a[136:139], v245, s[8:11], s43 offen offset:0
 MM v[24:27], a[232:235], a[96:99], v[24:27]
 ds_read_b64_tr_b16 a[224:225], v252 offset:36992
 s_waitcnt vmcnt(29)
 MM v[48:51], a[232:235], a[100:103], v[48:51]
 ds_read_b64_tr_b16 a[226:227], v252 offset:37760
 MM v[52:55], a[236:239], a[100:103], v[52:55]
 ds_read_b64_tr_b16 a[228:229], v252 offset:37000
 MM v[56:59], a[240:243], a[100:103], v[56:59]
 buffer_load_dwordx4 a[140:143], v245, s[8:11], s43 offen offset:1024
 MM v[60:63], a[244:247], a[100:103], v[60:63]
 ds_read_b64_tr_b16 a[230:231], v252 offset:37768
 MM v[64:67], a[248:251], a[100:103], v[64:67]
 MM v[68:71], a[252:255], a[100:103], v[68:71]
 MM v[92:95], a[252:255], a[104:107], v[92:95]
 buffer_load_dwordx4 a[144:147], v245, s[8:11], s43 offen offset:2048
 MM v[88:91], a[248:251], a[104:107], v[88:91]
 MM v[84:87], a[244:247], a[104:107], v[84:87]
 MM v[80:83], a[240:243], a[104:107], v[80:83]
 MM v[76:79], a[236:239], a[104:107], v[76:79]
 MM v[72:75], a[232:235], a[104:107], v[72:75]
 s_waitcnt vmcnt(29)
 MM v[96:99], a[232:235], a[0:3], v[96:99]
 buffer_load_dwordx4 a[148:151], v245, s[8:11], s43 offen offset:3072
 MM v[100:103], a[236:239], a[0:3], v[100:103]
 s_add_u32 s43, s46, 4096
 MM v[104:107], a[240:243], a[0:3], v[104:107]
 MM v[108:111], a[244:247], a[0:3], v[108:111]
 buffer_load_dwordx4 a[152:155], v245, s[8:11], s43 offen offset:0
 MM v[112:115], a[248:251], a[0:3], v[112:115]
 MM v[116:119], a[252:255], a[0:3], v[116:119]
 MM v[140:143], a[252:255], a[4:7], v[140:143]
 MM v[136:139], a[248:251], a[4:7], v[136:139]
 buffer_load_dwordx4 a[156:159], v245, s[8:11], s43 offen offset:1024
 MM v[132:135], a[244:247], a[4:7], v[132:135]
 MM v[128:131], a[240:243], a[4:7], v[128:131]
 MM v[124:127], a[236:239], a[4:7], v[124:127]
 MM v[120:123], a[232:235], a[4:7], v[120:123]
 s_waitcnt vmcnt(30)
 MM v[144:147], a[232:235], a[8:11], v[144:147]
 buffer_load_dwordx4 a[160:163], v245, s[8:11], s43 offen offset:2048
 MM v[148:151], a[236:239], a[8:11], v[148:151]
 MM v[152:155], a[240:243], a[8:11], v[152:155]
 MM v[156:159], a[244:247], a[8:11], v[156:159]
 MM v[160:163], a[248:251], a[8:11], v[160:163]
 buffer_load_dwordx4 a[164:167], v245, s[8:11], s43 offen offset:3072
 MM v[164:167], a[252:255], a[8:11], v[164:167]
 MM v[188:191], a[252:255], a[12:15], v[188:191]
 MM v[184:187], a[248:251], a[12:15], v[184:187]
 s_add_u32 s43, s46, 8192
 MM v[180:183], a[244:247], a[12:15], v[180:183]
 MM v[176:179], a[240:243], a[12:15], v[176:179]
 buffer_load_dwordx4 a[168:171], v245, s[8:11], s43 offen offset:0
 MM v[172:175], a[236:239], a[12:15], v[172:175]
 MM v[168:171], a[232:235], a[12:15], v[168:171]
 s_waitcnt lgkmcnt(0)
 s_waitcnt vmcnt(31)
 MM v[0:3], a[208:211], a[16:19], v[0:3]
 ds_read_b64_tr_b16 a[232:233], v252 offset:43008
 s_add_u32 s43, s46, 9216
 MM v[4:7], a[212:215], a[16:19], v[4:7]
 buffer_load_dwordx4 a[172:175], v245, s[8:11], s43 offen offset:0
 MM v[8:11], a[216:219], a[16:19], v[8:11]
 ds_read_b64_tr_b16 a[234:235], v252 offset:43776
 MM v[12:15], a[220:223], a[16:19], v[12:15]
 ds_read_b64_tr_b16 a[236:237], v252 offset:43016
 MM v[16:19], a[224:227], a[16:19], v[16:19]
 ds_read_b64_tr_b16 a[238:239], v252 offset:43784
 MM v[20:23], a[228:231], a[16:19], v[20:23]
 buffer_load_dwordx4 a[176:179], v245, s[8:11], s43 offen offset:1024
 MM v[44:47], a[228:231], a[20:23], v[44:47]
 ds_read_b64_tr_b16 a[240:241], v252 offset:43072
 MM v[40:43], a[224:227], a[20:23], v[40:43]
 ds_read_b64_tr_b16 a[242:243], v252 offset:43840
 MM v[36:39], a[220:223], a[20:23], v[36:39]
 ds_read_b64_tr_b16 a[244:245], v252 offset:43080
 MM v[32:35], a[216:219], a[20:23], v[32:35]
 ds_read_b64_tr_b16 a[246:247], v252 offset:43848
 MM v[28:31], a[212:215], a[20:23], v[28:31]
 buffer_load_dwordx4 a[180:183], v245, s[8:11], s43 offen offset:2048
 MM v[24:27], a[208:211], a[20:23], v[24:27]
 ds_read_b64_tr_b16 a[248:249], v252 offset:43136
 s_waitcnt vmcnt(32)
 MM v[48:51], a[208:211], a[24:27], v[48:51]
 ds_read_b64_tr_b16 a[250:251], v252 offset:43904
 MM v[52:55], a[212:215], a[24:27], v[52:55]
 ds_read_b64_tr_b16 a[252:253], v252 offset:43144
 MM v[56:59], a[216:219], a[24:27], v[56:59]
 buffer_load_dwordx4 a[184:187], v245, s[8:11], s43 offen offset:3072
 MM v[60:63], a[220:223], a[24:27], v[60:63]
 ds_read_b64_tr_b16 a[254:255], v252 offset:43912
 MM v[64:67], a[224:227], a[24:27], v[64:67]
 MM v[68:71], a[228:231], a[24:27], v[68:71]
 s_add_u32 s43, s46, 13312
 MM v[92:95], a[228:231], a[28:31], v[92:95]
 buffer_load_dwordx4 a[188:191], v245, s[8:11], s43 offen offset:0
 MM v[88:91], a[224:227], a[28:31], v[88:91]
 MM v[84:87], a[220:223], a[28:31], v[84:87]
 MM v[80:83], a[216:219], a[28:31], v[80:83]
 MM v[76:79], a[212:215], a[28:31], v[76:79]
 MM v[72:75], a[208:211], a[28:31], v[72:75]
 s_waitcnt vmcnt(32)
 MM v[96:99], a[208:211], a[32:35], v[96:99]
 buffer_load_dwordx4 a[192:195], v245, s[8:11], s43 offen offset:1024
 MM v[100:103], a[212:215], a[32:35], v[100:103]
 MM v[104:107], a[216:219], a[32:35], v[104:107]
 MM v[108:111], a[220:223], a[32:35], v[108:111]
 buffer_load_dwordx4 a[196:199], v245, s[8:11], s43 offen offset:2048
 MM v[112:115], a[224:227], a[32:35], v[112:115]
 MM v[116:119], a[228:231], a[32:35], v[116:119]
 MM v[140:143], a[228:231], a[36:39], v[140:143]
 MM v[136:139], a[224:227], a[36:39], v[136:139]
 MM v[132:135], a[220:223], a[36:39], v[132:135]
 buffer_load_dwordx4 a[200:203], v245, s[8:11], s43 offen offset:3072
 MM v[128:131], a[216:219], a[36:39], v[128:131]
 MM v[124:127], a[212:215], a[36:39], v[124:127]
 s_add_u32 s43, s46, 17408
 MM v[120:123], a[208:211], a[36:39], v[120:123]
 s_waitcnt vmcnt(33)
 MM v[144:147], a[208:211], a[40:43], v[144:147]
 buffer_load_dwordx4 a[204:207], v245, s[8:11], s43 offen offset:0
 MM v[148:151], a[212:215], a[40:43], v[148:151]
 MM v[152:155], a[216:219], a[40:43], v[152:155]
 MM v[156:159], a[220:223], a[40:43], v[156:159]
 s_add_u32 s7, s7, 921600
 MM v[160:163], a[224:227], a[40:43], v[160:163]
 buffer_load_dwordx4 a[80:83], v245, s[8:11], s7 offen offset:0
 MM v[164:167], a[228:231], a[40:43], v[164:167]
 MM v[188:191], a[228:231], a[44:47], v[188:191]
 MM v[184:187], a[224:227], a[44:47], v[184:187]
 MM v[180:183], a[220:223], a[44:47], v[180:183]
 MM v[176:179], a[216:219], a[44:47], v[176:179]
 buffer_load_dwordx4 a[84:87], v245, s[8:11], s7 offen offset:1024
 MM v[172:175], a[212:215], a[44:47], v[172:175]
 MM v[168:171], a[208:211], a[44:47], v[168:171]
 s_waitcnt lgkmcnt(0)
 s_waitcnt vmcnt(34)
 MM v[0:3], a[232:235], a[48:51], v[0:3]
 MM v[4:7], a[236:239], a[48:51], v[4:7]
 buffer_load_dwordx4 a[88:91], v245, s[8:11], s7 offen offset:2048
 MM v[8:11], a[240:243], a[48:51], v[8:11]
 MM v[12:15], a[244:247], a[48:51], v[12:15]
 MM v[16:19], a[248:251], a[48:51], v[16:19]
 MM v[20:23], a[252:255], a[48:51], v[20:23]
 buffer_load_dwordx4 a[92:95], v245, s[8:11], s7 offen offset:3072
 MM v[44:47], a[252:255], a[52:55], v[44:47]
 MM v[40:43], a[248:251], a[52:55], v[40:43]
 MM v[36:39], a[244:247], a[52:55], v[36:39]
 s_add_u32 s7, s7, 0x1000
 MM v[32:35], a[240:243], a[52:55], v[32:35]
 MM v[28:31], a[236:239], a[52:55], v[28:31]
 buffer_load_dwordx4 a[96:99], v245, s[8:11], s7 offen offset:0
 MM v[24:27], a[232:235], a[52:55], v[24:27]
 s_waitcnt vmcnt(33)
 MM v[48:51], a[232:235], a[56:59], v[48:51]
 MM v[52:55], a[236:239], a[56:59], v[52:55]
 MM v[56:59], a[240:243], a[56:59], v[56:59]
 buffer_load_dwordx4 a[100:103], v245, s[8:11], s7 offen offset:1024
 MM v[60:63], a[244:247], a[56:59], v[60:63]
 MM v[64:67], a[248:251], a[56:59], v[64:67]
 MM v[68:71], a[252:255], a[56:59], v[68:71]
 MM v[92:95], a[252:255], a[60:63], v[92:95]
 MM v[88:91], a[248:251], a[60:63], v[88:91]
 buffer_load_dwordx4 a[104:107], v245, s[8:11], s7 offen offset:2048
 MM v[84:87], a[244:247], a[60:63], v[84:87]
 MM v[80:83], a[240:243], a[60:63], v[80:83]
 MM v[76:79], a[236:239], a[60:63], v[76:79]
 MM v[72:75], a[232:235], a[60:63], v[72:75]
 s_waitcnt vmcnt(32)
 MM v[96:99], a[232:235], a[64:67], v[96:99]
 buffer_load_dwordx4 a[108:111], v245, s[8:11], s7 offen offset:3072
 MM v[100:103], a[236:239], a[64:67], v[100:103]
 MM v[104:107], a[240:243], a[64:67], v[104:107]
 s_add_u32 s7, s7, 0x1000
 MM v[108:111], a[244:247], a[64:67], v[108:111]
 buffer_load_dwordx4 a[112:115], v245, s[8:11], s7 offen offset:0
 MM v[112:115], a[248:251], a[64:67], v[112:115]
 MM v[116:119], a[252:255], a[64:67], v[116:119]
 MM v[140:143], a[252:255], a[68:71], v[140:143]
 MM v[136:139], a[248:251], a[68:71], v[136:139]
 MM v[132:135], a[244:247], a[68:71], v[132:135]
 buffer_load_dwordx4 a[116:119], v245, s[8:11], s7 offen offset:1024
 MM v[128:131], a[240:243], a[68:71], v[128:131]
 MM v[124:127], a[236:239], a[68:71], v[124:127]
 MM v[120:123], a[232:235], a[68:71], v[120:123]
 s_waitcnt vmcnt(33)
 MM v[144:147], a[232:235], a[72:75], v[144:147]
 buffer_load_dwordx4 a[120:123], v245, s[8:11], s7 offen offset:2048
 MM v[148:151], a[236:239], a[72:75], v[148:151]
 MM v[152:155], a[240:243], a[72:75], v[152:155]
 MM v[156:159], a[244:247], a[72:75], v[156:159]
 MM v[160:163], a[248:251], a[72:75], v[160:163]
 buffer_load_dwordx4 a[124:127], v245, s[8:11], s7 offen offset:3072
 MM v[164:167], a[252:255], a[72:75], v[164:167]
 MM v[188:191], a[252:255], a[76:79], v[188:191]
 MM v[184:187], a[248:251], a[76:79], v[184:187]
 s_add_u32 s7, s7, 0x1000
 MM v[180:183], a[244:247], a[76:79], v[180:183]
 MM v[176:179], a[240:243], a[76:79], v[176:179]
 buffer_load_dwordx4 a[128:131], v245, s[8:11], s7 offen offset:0
 MM v[172:175], a[236:239], a[76:79], v[172:175]
 MM v[168:171], a[232:235], a[76:79], v[168:171]
 buffer_load_dwordx4 a[132:135], v245, s[8:11], s7 offen offset:1024
 s_branch tail_kernel_s2
tail_kernel_glob:
 s_mul_i32 s39, s38, 4000
 s_lshl_b32 s32, s6, 6
 s_add_u32 s39, s39, s32
 v_lshlrev_b32_e64 v248, 2, v246
 s_lshl_b32 s32, s39, 4
 s_add_u32 s32, s32, 67108352
 s_lshl_b32 s40, s39, 12
 s_lshl_b32 s33, s3, 13
 s_add_u32 s40, s40, s33
 s_add_u32 s40, s40, 33423360
 s_mov_b32 s12, s4
 s_and_b32 s13, s5, 0xffff
 s_mov_b32 s14, 0
 s_mov_b32 s15, 0x00020000
 s_cmp_eq_u32 s6, 0
 s_cselect_b32 s14, 0, 268435456
 s_mov_b32 s16, s4
 s_and_b32 s17, s5, 0xffff
 s_mov_b32 s18, 0
 s_mov_b32 s19, 0x00020000
 s_cmp_eq_u32 s6, 62
 s_cselect_b32 s18, 0, 268435456
 s_mul_i32 s44, s3, 6144
 buffer_load_dwordx4 a[0:3], v245, s[8:11], s7 offen offset:0
 buffer_load_dwordx4 a[4:7], v245, s[8:11], s7 offen offset:1024
 buffer_load_dwordx4 a[8:11], v245, s[8:11], s7 offen offset:2048
 buffer_load_dwordx4 a[12:15], v245, s[8:11], s7 offen offset:3072
 s_add_u32 s7, s7, 0x1000
 buffer_load_dwordx4 a[16:19], v245, s[8:11], s7 offen offset:0
 buffer_load_dwordx4 a[20:23], v245, s[8:11], s7 offen offset:1024
 buffer_load_dwordx4 a[24:27], v245, s[8:11], s7 offen offset:2048
 buffer_load_dwordx4 a[28:31], v245, s[8:11], s7 offen offset:3072
 s_add_u32 s7, s7, 0x1000
 buffer_load_dwordx4 a[32:35], v245, s[8:11], s7 offen offset:0
 buffer_load_dwordx4 a[36:39], v245, s[8:11], s7 offen offset:1024
 buffer_load_dwordx4 a[40:43], v245, s[8:11], s7 offen offset:2048
 buffer_load_dwordx4 a[44:47], v245, s[8:11], s7 offen offset:3072
 s_add_u32 s7, s7, 0x1000
 buffer_load_dwordx4 a[48:51], v245, s[8:11], s7 offen offset:0
 buffer_load_dwordx4 a[52:55], v245, s[8:11], s7 offen offset:1024
 buffer_load_dwordx4 a[56:59], v245, s[8:11], s7 offen offset:2048
 buffer_load_dwordx4 a[60:63], v245, s[8:11], s7 offen offset:3072
 s_add_u32 s7, s7, 0x1000
 buffer_load_dwordx4 a[64:67], v245, s[8:11], s7 offen offset:0
 buffer_load_dwordx4 a[68:71], v245, s[8:11], s7 offen offset:1024
 buffer_load_dwordx4 a[72:75], v245, s[8:11], s7 offen offset:2048
 buffer_load_dwordx4 a[76:79], v245, s[8:11], s7 offen offset:3072
 s_add_u32 s7, s7, 0x1000
 buffer_load_dwordx4 a[80:83], v245, s[8:11], s7 offen offset:0
 buffer_load_dwordx4 a[84:87], v245, s[8:11], s7 offen offset:1024
 buffer_load_dwordx4 a[88:91], v245, s[8:11], s7 offen offset:2048
 buffer_load_dwordx4 a[92:95], v245, s[8:11], s7 offen offset:3072
 s_lshr_b32 s62, s6, 1
 s_and_b32 s63, s6, 1
 s_lshl_b32 s63, s63, 1
 s_add_u32 s63, s63, s62
 s_max_u32 s63, s63, 1
 s_sub_u32 s63, s63, 1
 s_min_u32 s63, s63, 31
 s_lshl_b32 s59, s38, 5
 s_add_u32 s62, s62, s59
 s_add_u32 s63, s63, s59
 s_lshl_b32 s62, s62, 7
 s_lshl_b32 s63, s63, 7
 s_add_u32 s62, s62, 92291072
 s_add_u32 s63, s63, 92291072
 v_mov_b32 v64, s62
 v_mov_b32 v65, s63
 s_mov_b32 s59, 0
tail_kernel_wait:
 global_load_dword v66, v64, s[4:5] sc1
 global_load_dword v67, v65, s[4:5] sc1
 s_waitcnt vmcnt(0)
 v_min_u32_e64 v66, v66, v67
 s_nop 0
 v_readfirstlane_b32 s62, v66
 s_nop 0
 s_cmp_ge_u32 s62, 16
 s_cbranch_scc1 tail_kernel_ready
 s_sleep 1
 s_add_u32 s59, s59, 1
 s_cmp_lt_u32 s59, 0x80000
 s_cbranch_scc1 tail_kernel_wait
tail_kernel_ready:
 s_barrier
 buffer_load_dword v192, v248, s[12:15], s32 offen offset:64 sc1
 buffer_load_dword v193, v248, s[12:15], s32 offen offset:192 sc1
 buffer_load_dword v194, v248, s[12:15], s32 offen offset:320 sc1
 buffer_load_dword v195, v248, s[12:15], s32 offen offset:448 sc1
 s_add_u32 m0, s36, -1024
 s_add_u32 s34, s40, 4096
 buffer_load_dwordx4 v245, s[12:15], s34 offen offset:1024 sc1 lds
 buffer_load_dwordx4 v245, s[12:15], s34 offen offset:2048 sc1 lds
 buffer_load_dwordx4 v245, s[12:15], s34 offen offset:3072 sc1 lds
 s_add_u32 m0, s44, 0
 s_add_u32 s45, s40, 4096
 buffer_load_dwordx4 v245, s[12:15], s45 offen sc1 lds
 buffer_load_dword v196, v248, s[8:11], s32 offen offset:512 sc1
 buffer_load_dword v197, v248, s[8:11], s32 offen offset:640 sc1
 buffer_load_dword v198, v248, s[8:11], s32 offen offset:768 sc1
 buffer_load_dword v199, v248, s[8:11], s32 offen offset:896 sc1
 buffer_load_dword v200, v248, s[8:11], s32 offen offset:576 sc1
 buffer_load_dword v201, v248, s[8:11], s32 offen offset:704 sc1
 buffer_load_dword v202, v248, s[8:11], s32 offen offset:832 sc1
 buffer_load_dword v203, v248, s[8:11], s32 offen offset:960 sc1
 buffer_load_dword v204, v248, s[16:19], s32 offen offset:1024 sc1
 buffer_load_dword v205, v248, s[16:19], s32 offen offset:1152 sc1
 buffer_load_dword v206, v248, s[16:19], s32 offen offset:1280 sc1
 buffer_load_dword v207, v248, s[16:19], s32 offen offset:1408 sc1
 buffer_load_dword v208, v248, s[16:19], s32 offen offset:1088 sc1
 buffer_load_dword v209, v248, s[16:19], s32 offen offset:1216 sc1
 buffer_load_dword v210, v248, s[16:19], s32 offen offset:1344 sc1
 buffer_load_dword v211, v248, s[16:19], s32 offen offset:1472 sc1
 buffer_load_dword v212, v248, s[16:19], s32 offen offset:1536 sc1
 buffer_load_dword v213, v248, s[16:19], s32 offen offset:1664 sc1
 buffer_load_dword v214, v248, s[16:19], s32 offen offset:1792 sc1
 buffer_load_dword v215, v248, s[16:19], s32 offen offset:1920 sc1
 s_add_u32 m0, s36, 2048
 s_add_u32 s34, s40, 131072
 buffer_load_dwordx4 v245, s[8:11], s34 offen offset:1024 sc1 lds
 buffer_load_dwordx4 v245, s[8:11], s34 offen offset:2048 sc1 lds
 buffer_load_dwordx4 v245, s[8:11], s34 offen offset:3072 sc1 lds
 s_add_u32 m0, s44, 1024
 s_add_u32 s45, s40, 131072
 buffer_load_dwordx4 v245, s[8:11], s45 offen sc1 lds
 s_add_u32 m0, s36, 5120
 s_add_u32 s34, s40, 135168
 buffer_load_dwordx4 v245, s[8:11], s34 offen offset:1024 sc1 lds
 buffer_load_dwordx4 v245, s[8:11], s34 offen offset:2048 sc1 lds
 buffer_load_dwordx4 v245, s[8:11], s34 offen offset:3072 sc1 lds
 s_add_u32 m0, s44, 2048
 s_add_u32 s45, s40, 135168
 buffer_load_dwordx4 v245, s[8:11], s45 offen sc1 lds
 s_add_u32 m0, s36, 8192
 s_add_u32 s34, s40, 262144
 buffer_load_dwordx4 v245, s[16:19], s34 offen offset:1024 sc1 lds
 buffer_load_dwordx4 v245, s[16:19], s34 offen offset:2048 sc1 lds
 buffer_load_dwordx4 v245, s[16:19], s34 offen offset:3072 sc1 lds
 s_add_u32 m0, s44, 3072
 s_add_u32 s45, s40, 262144
 buffer_load_dwordx4 v245, s[16:19], s45 offen sc1 lds
 s_add_u32 m0, s36, 11264
 s_add_u32 s34, s40, 266240
 buffer_load_dwordx4 v245, s[16:19], s34 offen offset:1024 sc1 lds
 buffer_load_dwordx4 v245, s[16:19], s34 offen offset:2048 sc1 lds
 buffer_load_dwordx4 v245, s[16:19], s34 offen offset:3072 sc1 lds
 s_add_u32 m0, s44, 4096
 s_add_u32 s45, s40, 266240
 buffer_load_dwordx4 v245, s[16:19], s45 offen sc1 lds
 s_add_u32 m0, s44, 48128
 s_add_u32 s34, s40, 393216
 buffer_load_dwordx4 v245, s[16:19], s34 offen offset:1024 sc1 lds
 buffer_load_dwordx4 v245, s[16:19], s34 offen offset:2048 sc1 lds
 buffer_load_dwordx4 v245, s[16:19], s34 offen offset:3072 sc1 lds
 s_add_u32 m0, s44, 5120
 s_add_u32 s45, s40, 393216
 buffer_load_dwordx4 v245, s[16:19], s45 offen sc1 lds
 v_lshrrev_b32 v64, 2, v246
 v_lshlrev_b32 v64, 3, v64
 v_and_b32 v65, 3, v246
 v_add_u32 v64, v64, v65
 v_lshrrev_b32 v65, 4, v64
 v_and_b32 v64, 15, v64
 v_xor_b32 v64, v64, v247
 v_lshl_add_u32 v64, v247, 4, v64
 v_lshlrev_b32_e64 v64, 4, v64
 v_lshl_add_u32 v251, v65, 10, v64
 v_xor_b32_e64 v252, 64, v251
 v_add_u32 v253, 49152, v251
 v_add_u32 v254, 49152, v252
 v_lshrrev_b32 v66, 4, v244
 v_xor_b32 v64, v66, v244
 v_lshlrev_b32 v64, 4, v64
 v_xor_b32_e64 v65, 64, v64
 s_bitcmp1_b32 s3, 0
 s_cselect_b64 vcc, -1, 0
 v_cndmask_b32 v255, v64, v65, vcc
 s_mul_i32 s33, s3, 6144
 v_add_u32 v255, s33, v255
 v_add_u32 v250, s36, v245
 v_add_u32 v249, s33, v245
 s_waitcnt lgkmcnt(0)
 s_add_u32 s24, s52, s47
 s_addc_u32 s25, s53, 0
 s_and_b32 s25, s25, 0xffff
 s_mov_b32 s26, 4096000
 s_mov_b32 s27, 0x00020000
 s_lshl_b32 s49, s6, 16
 s_lshl_b32 s50, s3, 8
 s_add_u32 s49, s49, s50
 s_lshl_b32 s50, s37, 7
 s_add_u32 s49, s49, s50
 v_lshlrev_b32 v248, 10, v246
 v_lshl_add_u32 v248, v247, 4, v248
 s_waitcnt vmcnt(20)
 s_nop 0
 v_max3_f32 v64, v192, v193, v194
 v_max_f32 v64, v64, v195
 v_sub_f32 v192, v192, v64
 v_sub_f32 v193, v193, v64
 v_sub_f32 v194, v194, v64
 v_sub_f32 v195, v195, v64
 v_exp_f32 v192, v192
 v_exp_f32 v193, v193
 v_exp_f32 v194, v194
 v_exp_f32 v195, v195
 v_add_f32 v64, v192, v193
 v_add_f32 v64, v64, v194
 v_add_f32 v64, v64, v195
 v_rcp_f32 v64, v64
 s_nop 0
 v_mul_f32 v192, v192, v64
 v_mul_f32 v193, v193, v64
 v_mul_f32 v194, v194, v64
 v_mul_f32 v195, v195, v64
 v_max3_f32 v64, v196, v197, v198
 v_max_f32 v64, v64, v199
 v_sub_f32 v196, v196, v64
 v_sub_f32 v197, v197, v64
 v_sub_f32 v198, v198, v64
 v_sub_f32 v199, v199, v64
 v_exp_f32 v196, v196
 v_exp_f32 v197, v197
 v_exp_f32 v198, v198
 v_exp_f32 v199, v199
 v_add_f32 v64, v196, v197
 v_add_f32 v64, v64, v198
 v_add_f32 v64, v64, v199
 v_rcp_f32 v64, v64
 s_nop 0
 v_mul_f32 v196, v196, v64
 v_mul_f32 v197, v197, v64
 v_mul_f32 v198, v198, v64
 v_mul_f32 v199, v199, v64
 v_max3_f32 v64, v200, v201, v202
 v_max_f32 v64, v64, v203
 v_sub_f32 v200, v200, v64
 v_sub_f32 v201, v201, v64
 v_sub_f32 v202, v202, v64
 v_sub_f32 v203, v203, v64
 v_exp_f32 v200, v200
 v_exp_f32 v201, v201
 v_exp_f32 v202, v202
 v_exp_f32 v203, v203
 v_add_f32 v64, v200, v201
 v_add_f32 v64, v64, v202
 v_add_f32 v64, v64, v203
 v_rcp_f32 v64, v64
 s_nop 0
 v_mul_f32 v200, v200, v64
 v_mul_f32 v201, v201, v64
 v_mul_f32 v202, v202, v64
 v_mul_f32 v203, v203, v64
 v_max3_f32 v64, v204, v205, v206
 v_max_f32 v64, v64, v207
 v_sub_f32 v204, v204, v64
 v_sub_f32 v205, v205, v64
 v_sub_f32 v206, v206, v64
 v_sub_f32 v207, v207, v64
 v_exp_f32 v204, v204
 v_exp_f32 v205, v205
 v_exp_f32 v206, v206
 v_exp_f32 v207, v207
 v_add_f32 v64, v204, v205
 v_add_f32 v64, v64, v206
 v_add_f32 v64, v64, v207
 v_rcp_f32 v64, v64
 s_nop 0
 v_mul_f32 v204, v204, v64
 v_mul_f32 v205, v205, v64
 v_mul_f32 v206, v206, v64
 v_mul_f32 v207, v207, v64
 v_max3_f32 v64, v208, v209, v210
 v_max_f32 v64, v64, v211
 v_sub_f32 v208, v208, v64
 v_sub_f32 v209, v209, v64
 v_sub_f32 v210, v210, v64
 v_sub_f32 v211, v211, v64
 v_exp_f32 v208, v208
 v_exp_f32 v209, v209
 v_exp_f32 v210, v210
 v_exp_f32 v211, v211
 v_add_f32 v64, v208, v209
 v_add_f32 v64, v64, v210
 v_add_f32 v64, v64, v211
 v_rcp_f32 v64, v64
 s_nop 0
 v_mul_f32 v208, v208, v64
 v_mul_f32 v209, v209, v64
 v_mul_f32 v210, v210, v64
 v_mul_f32 v211, v211, v64
 v_max3_f32 v64, v212, v213, v214
 v_max_f32 v64, v64, v215
 v_sub_f32 v212, v212, v64
 v_sub_f32 v213, v213, v64
 v_sub_f32 v214, v214, v64
 v_sub_f32 v215, v215, v64
 v_exp_f32 v212, v212
 v_exp_f32 v213, v213
 v_exp_f32 v214, v214
 v_exp_f32 v215, v215
 v_add_f32 v64, v212, v213
 v_add_f32 v64, v64, v214
 v_add_f32 v64, v64, v215
 v_rcp_f32 v64, v64
 s_nop 0
 v_mul_f32 v212, v212, v64
 v_mul_f32 v213, v213, v64
 v_mul_f32 v214, v214, v64
 v_mul_f32 v215, v215, v64
 s_add_u32 m0, s44, 51200
 s_add_u32 s34, s40, 36864
 ds_read_b128 v[216:219], v249 offset:0
 ds_read_b128 v[220:223], v250 offset:0
 ds_read_b128 v[224:227], v250 offset:1024
 ds_read_b128 v[228:231], v250 offset:2048
 buffer_load_dwordx4 v245, s[12:15], s34 offen offset:1024 sc1 lds
 s_waitcnt lgkmcnt(2)
 s_nop 0
 v_fma_mix_f32 v232, v216, v192, 0 op_sel:[0,0,0] op_sel_hi:[1,0,0]
 v_fma_mix_f32 v233, v216, v192, 0 op_sel:[1,0,0] op_sel_hi:[1,0,0]
 buffer_load_dwordx4 v245, s[12:15], s34 offen offset:2048 sc1 lds
 v_fma_mix_f32 v234, v217, v192, 0 op_sel:[0,0,0] op_sel_hi:[1,0,0]
 v_fma_mix_f32 v235, v217, v192, 0 op_sel:[1,0,0] op_sel_hi:[1,0,0]
 v_fma_mix_f32 v236, v218, v192, 0 op_sel:[0,0,0] op_sel_hi:[1,0,0]
 v_fma_mix_f32 v237, v218, v192, 0 op_sel:[1,0,0] op_sel_hi:[1,0,0]
 v_fma_mix_f32 v238, v219, v192, 0 op_sel:[0,0,0] op_sel_hi:[1,0,0]
 v_fma_mix_f32 v239, v219, v192, 0 op_sel:[1,0,0] op_sel_hi:[1,0,0]
 s_waitcnt vmcnt(18)
 s_nop 0
 ds_read_b128 v[216:219], v249 offset:1024
 v_fma_mix_f32 v232, v220, v193, v232 op_sel:[0,0,0] op_sel_hi:[1,0,0]
 v_fma_mix_f32 v233, v220, v193, v233 op_sel:[1,0,0] op_sel_hi:[1,0,0]
 v_fma_mix_f32 v234, v221, v193, v234 op_sel:[0,0,0] op_sel_hi:[1,0,0]
 v_fma_mix_f32 v235, v221, v193, v235 op_sel:[1,0,0] op_sel_hi:[1,0,0]
 v_fma_mix_f32 v236, v222, v193, v236 op_sel:[0,0,0] op_sel_hi:[1,0,0]
 v_fma_mix_f32 v237, v222, v193, v237 op_sel:[1,0,0] op_sel_hi:[1,0,0]
 v_fma_mix_f32 v238, v223, v193, v238 op_sel:[0,0,0] op_sel_hi:[1,0,0]
 buffer_load_dwordx4 v245, s[12:15], s34 offen offset:3072 sc1 lds
 v_fma_mix_f32 v239, v223, v193, v239 op_sel:[1,0,0] op_sel_hi:[1,0,0]
 s_add_u32 m0, s44, 24576
 ds_read_b128 v[220:223], v250 offset:3072
 s_add_u32 s45, s40, 36864
 s_waitcnt lgkmcnt(2)
 s_nop 0
 v_fma_mix_f32 v232, v224, v194, v232 op_sel:[0,0,0] op_sel_hi:[1,0,0]
 v_fma_mix_f32 v233, v224, v194, v233 op_sel:[1,0,0] op_sel_hi:[1,0,0]
 v_fma_mix_f32 v234, v225, v194, v234 op_sel:[0,0,0] op_sel_hi:[1,0,0]
 v_fma_mix_f32 v235, v225, v194, v235 op_sel:[1,0,0] op_sel_hi:[1,0,0]
 buffer_load_dwordx4 v245, s[12:15], s45 offen sc1 lds
 v_fma_mix_f32 v236, v226, v194, v236 op_sel:[0,0,0] op_sel_hi:[1,0,0]
 v_fma_mix_f32 v237, v226, v194, v237 op_sel:[1,0,0] op_sel_hi:[1,0,0]
 v_fma_mix_f32 v238, v227, v194, v238 op_sel:[0,0,0] op_sel_hi:[1,0,0]
 v_fma_mix_f32 v239, v227, v194, v239 op_sel:[1,0,0] op_sel_hi:[1,0,0]
 ds_read_b128 v[224:227], v250 offset:4096
 s_add_u32 m0, s36, -1024
 s_add_u32 s34, s40, 163840
 v_fma_mix_f32 v232, v228, v195, v232 op_sel:[0,0,0] op_sel_hi:[1,0,0]
 v_fma_mix_f32 v233, v228, v195, v233 op_sel:[1,0,0] op_sel_hi:[1,0,0]
 v_fma_mix_f32 v234, v229, v195, v234 op_sel:[0,0,0] op_sel_hi:[1,0,0]
 v_fma_mix_f32 v235, v229, v195, v235 op_sel:[1,0,0] op_sel_hi:[1,0,0]
 v_fma_mix_f32 v236, v230, v195, v236 op_sel:[0,0,0] op_sel_hi:[1,0,0]
 v_fma_mix_f32 v237, v230, v195, v237 op_sel:[1,0,0] op_sel_hi:[1,0,0]
 v_fma_mix_f32 v238, v231, v195, v238 op_sel:[0,0,0] op_sel_hi:[1,0,0]
 v_fma_mix_f32 v239, v231, v195, v239 op_sel:[1,0,0] op_sel_hi:[1,0,0]
 CB v240, v232, v233
 buffer_load_dwordx4 v245, s[8:11], s34 offen offset:1024 sc1 lds
 ds_read_b128 v[228:231], v250 offset:5120
 CB v241, v234, v235
 CB v242, v236, v237
 CB v243, v238, v239
 ds_write_b128 v255, v[240:243] offset:0
 s_waitcnt lgkmcnt(3)
 s_nop 0
 v_fma_mix_f32 v232, v216, v196, 0 op_sel:[0,0,0] op_sel_hi:[1,0,0]
 v_fma_mix_f32 v233, v216, v196, 0 op_sel:[1,0,0] op_sel_hi:[1,0,0]
 v_fma_mix_f32 v234, v217, v196, 0 op_sel:[0,0,0] op_sel_hi:[1,0,0]
 buffer_load_dwordx4 v245, s[8:11], s34 offen offset:2048 sc1 lds
 v_fma_mix_f32 v235, v217, v196, 0 op_sel:[1,0,0] op_sel_hi:[1,0,0]
 v_fma_mix_f32 v236, v218, v196, 0 op_sel:[0,0,0] op_sel_hi:[1,0,0]
 v_fma_mix_f32 v237, v218, v196, 0 op_sel:[1,0,0] op_sel_hi:[1,0,0]
 v_fma_mix_f32 v238, v219, v196, 0 op_sel:[0,0,0] op_sel_hi:[1,0,0]
 v_fma_mix_f32 v239, v219, v196, 0 op_sel:[1,0,0] op_sel_hi:[1,0,0]
 s_waitcnt vmcnt(18)
 s_nop 0
 ds_read_b128 v[216:219], v249 offset:2048
 v_fma_mix_f32 v232, v220, v197, v232 op_sel:[0,0,0] op_sel_hi:[1,0,0]
 v_fma_mix_f32 v233, v220, v197, v233 op_sel:[1,0,0] op_sel_hi:[1,0,0]
 v_fma_mix_f32 v234, v221, v197, v234 op_sel:[0,0,0] op_sel_hi:[1,0,0]
 v_fma_mix_f32 v235, v221, v197, v235 op_sel:[1,0,0] op_sel_hi:[1,0,0]
 v_fma_mix_f32 v236, v222, v197, v236 op_sel:[0,0,0] op_sel_hi:[1,0,0]
 v_fma_mix_f32 v237, v222, v197, v237 op_sel:[1,0,0] op_sel_hi:[1,0,0]
 v_fma_mix_f32 v238, v223, v197, v238 op_sel:[0,0,0] op_sel_hi:[1,0,0]
 v_fma_mix_f32 v239, v223, v197, v239 op_sel:[1,0,0] op_sel_hi:[1,0,0]
 buffer_load_dwordx4 v245, s[8:11], s34 offen offset:3072 sc1 lds
 ds_read_b128 v[220:223], v250 offset:6144
 s_waitcnt lgkmcnt(3)
 s_nop 0
 s_add_u32 m0, s44, 25600
 s_add_u32 s45, s40, 163840
 v_fma_mix_f32 v232, v224, v198, v232 op_sel:[0,0,0] op_sel_hi:[1,0,0]
 v_fma_mix_f32 v233, v224, v198, v233 op_sel:[1,0,0] op_sel_hi:[1,0,0]
 v_fma_mix_f32 v234, v225, v198, v234 op_sel:[0,0,0] op_sel_hi:[1,0,0]
 v_fma_mix_f32 v235, v225, v198, v235 op_sel:[1,0,0] op_sel_hi:[1,0,0]
 v_fma_mix_f32 v236, v226, v198, v236 op_sel:[0,0,0] op_sel_hi:[1,0,0]
 v_fma_mix_f32 v237, v226, v198, v237 op_sel:[1,0,0] op_sel_hi:[1,0,0]
 buffer_load_dwordx4 v245, s[8:11], s45 offen sc1 lds
 v_fma_mix_f32 v238, v227, v198, v238 op_sel:[0,0,0] op_sel_hi:[1,0,0]
 v_fma_mix_f32 v239, v227, v198, v239 op_sel:[1,0,0] op_sel_hi:[1,0,0]
 v_fma_mix_f32 v232, v228, v199, v232 op_sel:[0,0,0] op_sel_hi:[1,0,0]
 v_fma_mix_f32 v233, v228, v199, v233 op_sel:[1,0,0] op_sel_hi:[1,0,0]
 ds_read_b128 v[224:227], v250 offset:7168
 s_add_u32 m0, s36, 2048
 s_add_u32 s34, s40, 167936
 v_fma_mix_f32 v234, v229, v199, v234 op_sel:[0,0,0] op_sel_hi:[1,0,0]
 v_fma_mix_f32 v235, v229, v199, v235 op_sel:[1,0,0] op_sel_hi:[1,0,0]
 v_fma_mix_f32 v236, v230, v199, v236 op_sel:[0,0,0] op_sel_hi:[1,0,0]
 v_fma_mix_f32 v237, v230, v199, v237 op_sel:[1,0,0] op_sel_hi:[1,0,0]
 v_fma_mix_f32 v238, v231, v199, v238 op_sel:[0,0,0] op_sel_hi:[1,0,0]
 v_fma_mix_f32 v239, v231, v199, v239 op_sel:[1,0,0] op_sel_hi:[1,0,0]
 CB v240, v232, v233
 CB v241, v234, v235
 CB v242, v236, v237
 buffer_load_dwordx4 v245, s[8:11], s34 offen offset:1024 sc1 lds
 ds_read_b128 v[228:231], v250 offset:8192
 CB v243, v238, v239
 ds_write_b128 v255, v[240:243] offset:1024
 s_waitcnt lgkmcnt(3)
 s_nop 0
 v_fma_mix_f32 v232, v216, v200, 0 op_sel:[0,0,0] op_sel_hi:[1,0,0]
 v_fma_mix_f32 v233, v216, v200, 0 op_sel:[1,0,0] op_sel_hi:[1,0,0]
 v_fma_mix_f32 v234, v217, v200, 0 op_sel:[0,0,0] op_sel_hi:[1,0,0]
 buffer_load_dwordx4 v245, s[8:11], s34 offen offset:2048 sc1 lds
 v_fma_mix_f32 v235, v217, v200, 0 op_sel:[1,0,0] op_sel_hi:[1,0,0]
 v_fma_mix_f32 v236, v218, v200, 0 op_sel:[0,0,0] op_sel_hi:[1,0,0]
 v_fma_mix_f32 v237, v218, v200, 0 op_sel:[1,0,0] op_sel_hi:[1,0,0]
 v_fma_mix_f32 v238, v219, v200, 0 op_sel:[0,0,0] op_sel_hi:[1,0,0]
 v_fma_mix_f32 v239, v219, v200, 0 op_sel:[1,0,0] op_sel_hi:[1,0,0]
 s_waitcnt vmcnt(18)
 s_nop 0
 ds_read_b128 v[216:219], v249 offset:3072
 v_fma_mix_f32 v232, v220, v201, v232 op_sel:[0,0,0] op_sel_hi:[1,0,0]
 v_fma_mix_f32 v233, v220, v201, v233 op_sel:[1,0,0] op_sel_hi:[1,0,0]
 v_fma_mix_f32 v234, v221, v201, v234 op_sel:[0,0,0] op_sel_hi:[1,0,0]
 v_fma_mix_f32 v235, v221, v201, v235 op_sel:[1,0,0] op_sel_hi:[1,0,0]
 v_fma_mix_f32 v236, v222, v201, v236 op_sel:[0,0,0] op_sel_hi:[1,0,0]
 v_fma_mix_f32 v237, v222, v201, v237 op_sel:[1,0,0] op_sel_hi:[1,0,0]
 v_fma_mix_f32 v238, v223, v201, v238 op_sel:[0,0,0] op_sel_hi:[1,0,0]
 v_fma_mix_f32 v239, v223, v201, v239 op_sel:[1,0,0] op_sel_hi:[1,0,0]
 buffer_load_dwordx4 v245, s[8:11], s34 offen offset:3072 sc1 lds
 ds_read_b128 v[220:223], v250 offset:9216
 s_waitcnt lgkmcnt(3)
 s_nop 0
 v_fma_mix_f32 v232, v224, v202, v232 op_sel:[0,0,0] op_sel_hi:[1,0,0]
 v_fma_mix_f32 v233, v224, v202, v233 op_sel:[1,0,0] op_sel_hi:[1,0,0]
 s_add_u32 m0, s44, 26624
 s_add_u32 s45, s40, 167936
 v_fma_mix_f32 v234, v225, v202, v234 op_sel:[0,0,0] op_sel_hi:[1,0,0]
 v_fma_mix_f32 v235, v225, v202, v235 op_sel:[1,0,0] op_sel_hi:[1,0,0]
 v_fma_mix_f32 v236, v226, v202, v236 op_sel:[0,0,0] op_sel_hi:[1,0,0]
 v_fma_mix_f32 v237, v226, v202, v237 op_sel:[1,0,0] op_sel_hi:[1,0,0]
 v_fma_mix_f32 v238, v227, v202, v238 op_sel:[0,0,0] op_sel_hi:[1,0,0]
 v_fma_mix_f32 v239, v227, v202, v239 op_sel:[1,0,0] op_sel_hi:[1,0,0]
 v_fma_mix_f32 v232, v228, v203, v232 op_sel:[0,0,0] op_sel_hi:[1,0,0]
 v_fma_mix_f32 v233, v228, v203, v233 op_sel:[1,0,0] op_sel_hi:[1,0,0]
 v_fma_mix_f32 v234, v229, v203, v234 op_sel:[0,0,0] op_sel_hi:[1,0,0]
 buffer_load_dwordx4 v245, s[8:11], s45 offen sc1 lds
 ds_read_b128 v[224:227], v250 offset:10240
 v_fma_mix_f32 v235, v229, v203, v235 op_sel:[1,0,0] op_sel_hi:[1,0,0]
 v_fma_mix_f32 v236, v230, v203, v236 op_sel:[0,0,0] op_sel_hi:[1,0,0]
 s_add_u32 m0, s36, 5120
 s_add_u32 s34, s40, 294912
 v_fma_mix_f32 v237, v230, v203, v237 op_sel:[1,0,0] op_sel_hi:[1,0,0]
 v_fma_mix_f32 v238, v231, v203, v238 op_sel:[0,0,0] op_sel_hi:[1,0,0]
 v_fma_mix_f32 v239, v231, v203, v239 op_sel:[1,0,0] op_sel_hi:[1,0,0]
 CB v240, v232, v233
 CB v241, v234, v235
 buffer_load_dwordx4 v245, s[16:19], s34 offen offset:1024 sc1 lds
 ds_read_b128 v[228:231], v250 offset:11264
 CB v242, v236, v237
 CB v243, v238, v239
 ds_write_b128 v255, v[240:243] offset:2048
 s_waitcnt lgkmcnt(3)
 s_nop 0
 v_fma_mix_f32 v232, v216, v204, 0 op_sel:[0,0,0] op_sel_hi:[1,0,0]
 v_fma_mix_f32 v233, v216, v204, 0 op_sel:[1,0,0] op_sel_hi:[1,0,0]
 v_fma_mix_f32 v234, v217, v204, 0 op_sel:[0,0,0] op_sel_hi:[1,0,0]
 v_fma_mix_f32 v235, v217, v204, 0 op_sel:[1,0,0] op_sel_hi:[1,0,0]
 v_fma_mix_f32 v236, v218, v204, 0 op_sel:[0,0,0] op_sel_hi:[1,0,0]
 v_fma_mix_f32 v237, v218, v204, 0 op_sel:[1,0,0] op_sel_hi:[1,0,0]
 v_fma_mix_f32 v238, v219, v204, 0 op_sel:[0,0,0] op_sel_hi:[1,0,0]
 v_fma_mix_f32 v239, v219, v204, 0 op_sel:[1,0,0] op_sel_hi:[1,0,0]
 s_waitcnt vmcnt(17)
 s_nop 0
 buffer_load_dwordx4 v245, s[16:19], s34 offen offset:2048 sc1 lds
 ds_read_b128 v[216:219], v249 offset:4096
 v_fma_mix_f32 v232, v220, v205, v232 op_sel:[0,0,0] op_sel_hi:[1,0,0]
 v_fma_mix_f32 v233, v220, v205, v233 op_sel:[1,0,0] op_sel_hi:[1,0,0]
 v_fma_mix_f32 v234, v221, v205, v234 op_sel:[0,0,0] op_sel_hi:[1,0,0]
 v_fma_mix_f32 v235, v221, v205, v235 op_sel:[1,0,0] op_sel_hi:[1,0,0]
 v_fma_mix_f32 v236, v222, v205, v236 op_sel:[0,0,0] op_sel_hi:[1,0,0]
 v_fma_mix_f32 v237, v222, v205, v237 op_sel:[1,0,0] op_sel_hi:[1,0,0]
 v_fma_mix_f32 v238, v223, v205, v238 op_sel:[0,0,0] op_sel_hi:[1,0,0]
 v_fma_mix_f32 v239, v223, v205, v239 op_sel:[1,0,0] op_sel_hi:[1,0,0]
 ds_read_b128 v[220:223], v250 offset:12288
 s_waitcnt lgkmcnt(3)
 s_nop 0
 v_fma_mix_f32 v232, v224, v206, v232 op_sel:[0,0,0] op_sel_hi:[1,0,0]
 v_fma_mix_f32 v233, v224, v206, v233 op_sel:[1,0,0] op_sel_hi:[1,0,0]
 v_fma_mix_f32 v234, v225, v206, v234 op_sel:[0,0,0] op_sel_hi:[1,0,0]
 buffer_load_dwordx4 v245, s[16:19], s34 offen offset:3072 sc1 lds
 v_fma_mix_f32 v235, v225, v206, v235 op_sel:[1,0,0] op_sel_hi:[1,0,0]
 v_fma_mix_f32 v236, v226, v206, v236 op_sel:[0,0,0] op_sel_hi:[1,0,0]
 v_fma_mix_f32 v237, v226, v206, v237 op_sel:[1,0,0] op_sel_hi:[1,0,0]
 s_add_u32 m0, s44, 27648
 s_add_u32 s45, s40, 294912
 v_fma_mix_f32 v238, v227, v206, v238 op_sel:[0,0,0] op_sel_hi:[1,0,0]
 v_fma_mix_f32 v239, v227, v206, v239 op_sel:[1,0,0] op_sel_hi:[1,0,0]
 v_fma_mix_f32 v232, v228, v207, v232 op_sel:[0,0,0] op_sel_hi:[1,0,0]
 v_fma_mix_f32 v233, v228, v207, v233 op_sel:[1,0,0] op_sel_hi:[1,0,0]
 v_fma_mix_f32 v234, v229, v207, v234 op_sel:[0,0,0] op_sel_hi:[1,0,0]
 buffer_load_dwordx4 v245, s[16:19], s45 offen sc1 lds
 ds_read_b128 v[224:227], v250 offset:13312
 v_fma_mix_f32 v235, v229, v207, v235 op_sel:[1,0,0] op_sel_hi:[1,0,0]
 v_fma_mix_f32 v236, v230, v207, v236 op_sel:[0,0,0] op_sel_hi:[1,0,0]
 v_fma_mix_f32 v237, v230, v207, v237 op_sel:[1,0,0] op_sel_hi:[1,0,0]
 v_fma_mix_f32 v238, v231, v207, v238 op_sel:[0,0,0] op_sel_hi:[1,0,0]
 v_fma_mix_f32 v239, v231, v207, v239 op_sel:[1,0,0] op_sel_hi:[1,0,0]
 CB v240, v232, v233
 s_add_u32 m0, s36, 8192
 ds_read_b128 v[228:231], v250 offset:14336
 s_add_u32 s34, s40, 299008
 CB v241, v234, v235
 CB v242, v236, v237
 CB v243, v238, v239
 ds_write_b128 v255, v[240:243] offset:3072
 s_waitcnt lgkmcnt(3)
 s_nop 0
 v_fma_mix_f32 v232, v216, v208, 0 op_sel:[0,0,0] op_sel_hi:[1,0,0]
 v_fma_mix_f32 v233, v216, v208, 0 op_sel:[1,0,0] op_sel_hi:[1,0,0]
 v_fma_mix_f32 v234, v217, v208, 0 op_sel:[0,0,0] op_sel_hi:[1,0,0]
 buffer_load_dwordx4 v245, s[16:19], s34 offen offset:1024 sc1 lds
 v_fma_mix_f32 v235, v217, v208, 0 op_sel:[1,0,0] op_sel_hi:[1,0,0]
 v_fma_mix_f32 v236, v218, v208, 0 op_sel:[0,0,0] op_sel_hi:[1,0,0]
 v_fma_mix_f32 v237, v218, v208, 0 op_sel:[1,0,0] op_sel_hi:[1,0,0]
 v_fma_mix_f32 v238, v219, v208, 0 op_sel:[0,0,0] op_sel_hi:[1,0,0]
 v_fma_mix_f32 v239, v219, v208, 0 op_sel:[1,0,0] op_sel_hi:[1,0,0]
 s_waitcnt vmcnt(17)
 s_nop 0
 ds_read_b128 v[216:219], v249 offset:5120
 v_fma_mix_f32 v232, v220, v209, v232 op_sel:[0,0,0] op_sel_hi:[1,0,0]
 v_fma_mix_f32 v233, v220, v209, v233 op_sel:[1,0,0] op_sel_hi:[1,0,0]
 buffer_load_dwordx4 v245, s[16:19], s34 offen offset:2048 sc1 lds
 v_fma_mix_f32 v234, v221, v209, v234 op_sel:[0,0,0] op_sel_hi:[1,0,0]
 v_fma_mix_f32 v235, v221, v209, v235 op_sel:[1,0,0] op_sel_hi:[1,0,0]
 v_fma_mix_f32 v236, v222, v209, v236 op_sel:[0,0,0] op_sel_hi:[1,0,0]
 v_fma_mix_f32 v237, v222, v209, v237 op_sel:[1,0,0] op_sel_hi:[1,0,0]
 v_fma_mix_f32 v238, v223, v209, v238 op_sel:[0,0,0] op_sel_hi:[1,0,0]
 v_fma_mix_f32 v239, v223, v209, v239 op_sel:[1,0,0] op_sel_hi:[1,0,0]
 ds_read_b128 v[220:223], v249 offset:49152
 s_waitcnt lgkmcnt(3)
 s_nop 0
 v_fma_mix_f32 v232, v224, v210, v232 op_sel:[0,0,0] op_sel_hi:[1,0,0]
 v_fma_mix_f32 v233, v224, v210, v233 op_sel:[1,0,0] op_sel_hi:[1,0,0]
 v_fma_mix_f32 v234, v225, v210, v234 op_sel:[0,0,0] op_sel_hi:[1,0,0]
 buffer_load_dwordx4 v245, s[16:19], s34 offen offset:3072 sc1 lds
 v_fma_mix_f32 v235, v225, v210, v235 op_sel:[1,0,0] op_sel_hi:[1,0,0]
 v_fma_mix_f32 v236, v226, v210, v236 op_sel:[0,0,0] op_sel_hi:[1,0,0]
 v_fma_mix_f32 v237, v226, v210, v237 op_sel:[1,0,0] op_sel_hi:[1,0,0]
 v_fma_mix_f32 v238, v227, v210, v238 op_sel:[0,0,0] op_sel_hi:[1,0,0]
 v_fma_mix_f32 v239, v227, v210, v239 op_sel:[1,0,0] op_sel_hi:[1,0,0]
 s_add_u32 m0, s44, 28672
 ds_read_b128 v[224:227], v249 offset:50176
 s_add_u32 s45, s40, 299008
 v_fma_mix_f32 v232, v228, v211, v232 op_sel:[0,0,0] op_sel_hi:[1,0,0]
 v_fma_mix_f32 v233, v228, v211, v233 op_sel:[1,0,0] op_sel_hi:[1,0,0]
 v_fma_mix_f32 v234, v229, v211, v234 op_sel:[0,0,0] op_sel_hi:[1,0,0]
 v_fma_mix_f32 v235, v229, v211, v235 op_sel:[1,0,0] op_sel_hi:[1,0,0]
 v_fma_mix_f32 v236, v230, v211, v236 op_sel:[0,0,0] op_sel_hi:[1,0,0]
 v_fma_mix_f32 v237, v230, v211, v237 op_sel:[1,0,0] op_sel_hi:[1,0,0]
 v_fma_mix_f32 v238, v231, v211, v238 op_sel:[0,0,0] op_sel_hi:[1,0,0]
 v_fma_mix_f32 v239, v231, v211, v239 op_sel:[1,0,0] op_sel_hi:[1,0,0]
 buffer_load_dwordx4 v245, s[16:19], s45 offen sc1 lds
 ds_read_b128 v[228:231], v249 offset:51200
 CB v240, v232, v233
 CB v241, v234, v235
 s_add_u32 m0, s36, 11264
 s_add_u32 s34, s40, 425984
 CB v242, v236, v237
 CB v243, v238, v239
 ds_write_b128 v255, v[240:243] offset:4096
 s_waitcnt lgkmcnt(3)
 s_nop 0
 v_fma_mix_f32 v232, v216, v212, 0 op_sel:[0,0,0] op_sel_hi:[1,0,0]
 v_fma_mix_f32 v233, v216, v212, 0 op_sel:[1,0,0] op_sel_hi:[1,0,0]
 v_fma_mix_f32 v234, v217, v212, 0 op_sel:[0,0,0] op_sel_hi:[1,0,0]
 buffer_load_dwordx4 v245, s[16:19], s34 offen offset:1024 sc1 lds
 v_fma_mix_f32 v235, v217, v212, 0 op_sel:[1,0,0] op_sel_hi:[1,0,0]
 v_fma_mix_f32 v236, v218, v212, 0 op_sel:[0,0,0] op_sel_hi:[1,0,0]
 v_fma_mix_f32 v237, v218, v212, 0 op_sel:[1,0,0] op_sel_hi:[1,0,0]
 v_fma_mix_f32 v238, v219, v212, 0 op_sel:[0,0,0] op_sel_hi:[1,0,0]
 v_fma_mix_f32 v239, v219, v212, 0 op_sel:[1,0,0] op_sel_hi:[1,0,0]
 s_waitcnt vmcnt(17)
 s_nop 0
 ds_read_b128 v[216:219], v249 offset:24576
 v_fma_mix_f32 v232, v220, v213, v232 op_sel:[0,0,0] op_sel_hi:[1,0,0]
 v_fma_mix_f32 v233, v220, v213, v233 op_sel:[1,0,0] op_sel_hi:[1,0,0]
 buffer_load_dwordx4 v245, s[16:19], s34 offen offset:2048 sc1 lds
 v_fma_mix_f32 v234, v221, v213, v234 op_sel:[0,0,0] op_sel_hi:[1,0,0]
 v_fma_mix_f32 v235, v221, v213, v235 op_sel:[1,0,0] op_sel_hi:[1,0,0]
 v_fma_mix_f32 v236, v222, v213, v236 op_sel:[0,0,0] op_sel_hi:[1,0,0]
 v_fma_mix_f32 v237, v222, v213, v237 op_sel:[1,0,0] op_sel_hi:[1,0,0]
 v_fma_mix_f32 v238, v223, v213, v238 op_sel:[0,0,0] op_sel_hi:[1,0,0]
 v_fma_mix_f32 v239, v223, v213, v239 op_sel:[1,0,0] op_sel_hi:[1,0,0]
 ds_read_b128 v[220:223], v249 offset:52224
 s_waitcnt lgkmcnt(3)
 s_nop 0
 v_fma_mix_f32 v232, v224, v214, v232 op_sel:[0,0,0] op_sel_hi:[1,0,0]
 v_fma_mix_f32 v233, v224, v214, v233 op_sel:[1,0,0] op_sel_hi:[1,0,0]
 v_fma_mix_f32 v234, v225, v214, v234 op_sel:[0,0,0] op_sel_hi:[1,0,0]
 v_fma_mix_f32 v235, v225, v214, v235 op_sel:[1,0,0] op_sel_hi:[1,0,0]
 v_fma_mix_f32 v236, v226, v214, v236 op_sel:[0,0,0] op_sel_hi:[1,0,0]
 v_fma_mix_f32 v237, v226, v214, v237 op_sel:[1,0,0] op_sel_hi:[1,0,0]
 v_fma_mix_f32 v238, v227, v214, v238 op_sel:[0,0,0] op_sel_hi:[1,0,0]
 v_fma_mix_f32 v239, v227, v214, v239 op_sel:[1,0,0] op_sel_hi:[1,0,0]
 v_fma_mix_f32 v232, v228, v215, v232 op_sel:[0,0,0] op_sel_hi:[1,0,0]
 buffer_load_dwordx4 v245, s[16:19], s34 offen offset:3072 sc1 lds
 ds_read_b128 v[224:227], v249 offset:53248
 s_add_u32 m0, s44, 29696
 s_add_u32 s45, s40, 425984
 v_fma_mix_f32 v233, v228, v215, v233 op_sel:[1,0,0] op_sel_hi:[1,0,0]
 v_fma_mix_f32 v234, v229, v215, v234 op_sel:[0,0,0] op_sel_hi:[1,0,0]
 v_fma_mix_f32 v235, v229, v215, v235 op_sel:[1,0,0] op_sel_hi:[1,0,0]
 v_fma_mix_f32 v236, v230, v215, v236 op_sel:[0,0,0] op_sel_hi:[1,0,0]
 v_fma_mix_f32 v237, v230, v215, v237 op_sel:[1,0,0] op_sel_hi:[1,0,0]
 v_fma_mix_f32 v238, v231, v215, v238 op_sel:[0,0,0] op_sel_hi:[1,0,0]
 v_fma_mix_f32 v239, v231, v215, v239 op_sel:[1,0,0] op_sel_hi:[1,0,0]
 buffer_load_dwordx4 v245, s[16:19], s45 offen sc1 lds
 ds_read_b128 v[228:231], v249 offset:54272
 CB v240, v232, v233
 CB v241, v234, v235
 CB v242, v236, v237
 CB v243, v238, v239
 s_add_u32 s7, s7, 0x1000
 ds_write_b128 v255, v[240:243] offset:5120
 buffer_load_dwordx4 a[96:99], v245, s[8:11], s7 offen offset:0
 s_waitcnt lgkmcnt(0)
 s_barrier
 ds_read_b128 a[208:211], v251 offset:0
 ds_read_b128 a[212:215], v252 offset:0
 ds_read_b128 a[216:219], v251 offset:2048
 ds_read_b128 a[220:223], v252 offset:2048
 ds_read_b128 a[224:227], v251 offset:4096
 ds_read_b128 a[228:231], v252 offset:4096
 s_waitcnt lgkmcnt(0)
 MM v[0:3], a[208:211], a[0:3], 0
 ds_read_b128 a[232:235], v252 offset:6144
 ds_read_b128 a[236:239], v251 offset:6144
 v_fma_mix_f32 v232, v216, v192, 0 op_sel:[0,0,0] op_sel_hi:[1,0,0]
 MM v[4:7], a[212:215], a[0:3], 0
 buffer_load_dwordx4 a[100:103], v245, s[8:11], s7 offen offset:1024
 ds_read_b128 a[240:243], v252 offset:8192
 MM v[8:11], a[216:219], a[0:3], 0
 ds_read_b128 a[244:247], v251 offset:8192
 v_fma_mix_f32 v233, v216, v192, 0 op_sel:[1,0,0] op_sel_hi:[1,0,0]
 v_fma_mix_f32 v234, v217, v192, 0 op_sel:[0,0,0] op_sel_hi:[1,0,0]
 MM v[12:15], a[220:223], a[0:3], 0
 ds_read_b128 a[248:251], v252 offset:10240
 v_fma_mix_f32 v235, v217, v192, 0 op_sel:[1,0,0] op_sel_hi:[1,0,0]
 v_fma_mix_f32 v236, v218, v192, 0 op_sel:[0,0,0] op_sel_hi:[1,0,0]
 MM v[16:19], a[224:227], a[0:3], 0
 buffer_load_dwordx4 a[104:107], v245, s[8:11], s7 offen offset:2048
 ds_read_b128 a[252:255], v251 offset:10240
 MM v[20:23], a[228:231], a[0:3], 0
 v_fma_mix_f32 v237, v218, v192, 0 op_sel:[1,0,0] op_sel_hi:[1,0,0]
 v_fma_mix_f32 v238, v219, v192, 0 op_sel:[0,0,0] op_sel_hi:[1,0,0]
 v_fma_mix_f32 v239, v219, v192, 0 op_sel:[1,0,0] op_sel_hi:[1,0,0]
 MM v[44:47], a[228:231], a[4:7], 0
 s_waitcnt vmcnt(19)
 ds_read_b128 v[216:219], v249 offset:25600
 v_fma_mix_f32 v232, v220, v193, v232 op_sel:[0,0,0] op_sel_hi:[1,0,0]
 MM v[40:43], a[224:227], a[4:7], 0
 v_fma_mix_f32 v233, v220, v193, v233 op_sel:[1,0,0] op_sel_hi:[1,0,0]
 v_fma_mix_f32 v234, v221, v193, v234 op_sel:[0,0,0] op_sel_hi:[1,0,0]
 v_fma_mix_f32 v235, v221, v193, v235 op_sel:[1,0,0] op_sel_hi:[1,0,0]
 MM v[36:39], a[220:223], a[4:7], 0
 buffer_load_dwordx4 a[108:111], v245, s[8:11], s7 offen offset:3072
 v_fma_mix_f32 v236, v222, v193, v236 op_sel:[0,0,0] op_sel_hi:[1,0,0]
 MM v[32:35], a[216:219], a[4:7], 0
 s_add_u32 s7, s7, 0x1000
 v_fma_mix_f32 v237, v222, v193, v237 op_sel:[1,0,0] op_sel_hi:[1,0,0]
 v_fma_mix_f32 v238, v223, v193, v238 op_sel:[0,0,0] op_sel_hi:[1,0,0]
 MM v[28:31], a[212:215], a[4:7], 0
 v_fma_mix_f32 v239, v223, v193, v239 op_sel:[1,0,0] op_sel_hi:[1,0,0]
 MM v[24:27], a[208:211], a[4:7], 0
 buffer_load_dwordx4 a[112:115], v245, s[8:11], s7 offen offset:0
 MM v[48:51], a[208:211], a[8:11], 0
 ds_read_b128 v[220:223], v250 offset:0
 v_fma_mix_f32 v232, v224, v194, v232 op_sel:[0,0,0] op_sel_hi:[1,0,0]
 v_fma_mix_f32 v233, v224, v194, v233 op_sel:[1,0,0] op_sel_hi:[1,0,0]
 MM v[52:55], a[212:215], a[8:11], 0
 s_add_u32 m0, s44, 49152
 s_add_u32 s45, s40, 69632
 v_fma_mix_f32 v234, v225, v194, v234 op_sel:[0,0,0] op_sel_hi:[1,0,0]
 MM v[56:59], a[216:219], a[8:11], 0
 buffer_load_dwordx4 v245, s[12:15], s45 offen sc1 lds
 v_fma_mix_f32 v235, v225, v194, v235 op_sel:[1,0,0] op_sel_hi:[1,0,0]
 MM v[60:63], a[220:223], a[8:11], 0
 v_fma_mix_f32 v236, v226, v194, v236 op_sel:[0,0,0] op_sel_hi:[1,0,0]
 v_fma_mix_f32 v237, v226, v194, v237 op_sel:[1,0,0] op_sel_hi:[1,0,0]
 v_fma_mix_f32 v238, v227, v194, v238 op_sel:[0,0,0] op_sel_hi:[1,0,0]
 MM v[64:67], a[224:227], a[8:11], 0
 s_add_u32 m0, s44, 50176
 s_add_u32 s45, s40, 196608
 v_fma_mix_f32 v239, v227, v194, v239 op_sel:[1,0,0] op_sel_hi:[1,0,0]
 MM v[68:71], a[228:231], a[8:11], 0
 ds_read_b128 v[224:227], v250 offset:1024
 v_fma_mix_f32 v232, v228, v195, v232 op_sel:[0,0,0] op_sel_hi:[1,0,0]
 v_fma_mix_f32 v233, v228, v195, v233 op_sel:[1,0,0] op_sel_hi:[1,0,0]
 MM v[92:95], a[228:231], a[12:15], 0
 buffer_load_dwordx4 v245, s[8:11], s45 offen sc1 lds
 v_fma_mix_f32 v234, v229, v195, v234 op_sel:[0,0,0] op_sel_hi:[1,0,0]
 MM v[88:91], a[224:227], a[12:15], 0
 s_add_u32 m0, s44, 51200
 s_add_u32 s45, s40, 200704
 v_fma_mix_f32 v235, v229, v195, v235 op_sel:[1,0,0] op_sel_hi:[1,0,0]
 MM v[84:87], a[220:223], a[12:15], 0
 v_fma_mix_f32 v236, v230, v195, v236 op_sel:[0,0,0] op_sel_hi:[1,0,0]
 v_fma_mix_f32 v237, v230, v195, v237 op_sel:[1,0,0] op_sel_hi:[1,0,0]
 v_fma_mix_f32 v238, v231, v195, v238 op_sel:[0,0,0] op_sel_hi:[1,0,0]
 MM v[80:83], a[216:219], a[12:15], 0
 buffer_load_dwordx4 v245, s[8:11], s45 offen sc1 lds
 v_fma_mix_f32 v239, v231, v195, v239 op_sel:[1,0,0] op_sel_hi:[1,0,0]
 MM v[76:79], a[212:215], a[12:15], 0
 ds_read_b128 v[228:231], v250 offset:2048
 s_add_u32 m0, s44, 52224
 s_add_u32 s45, s40, 327680
 MM v[72:75], a[208:211], a[12:15], 0
 CB v240, v232, v233
 CB v241, v234, v235
 MM v[96:99], a[208:211], a[16:19], 0
 buffer_load_dwordx4 v245, s[16:19], s45 offen sc1 lds
 CB v242, v236, v237
 MM v[100:103], a[212:215], a[16:19], 0
 CB v243, v238, v239
 MM v[104:107], a[216:219], a[16:19], 0
 ds_write_b128 v255, v[240:243] offset:24576
 s_add_u32 m0, s44, 53248
 s_add_u32 s45, s40, 331776
 MM v[108:111], a[220:223], a[16:19], 0
 s_waitcnt lgkmcnt(3)
 v_fma_mix_f32 v232, v216, v196, 0 op_sel:[0,0,0] op_sel_hi:[1,0,0]
 v_fma_mix_f32 v233, v216, v196, 0 op_sel:[1,0,0] op_sel_hi:[1,0,0]
 MM v[112:115], a[224:227], a[16:19], 0
 buffer_load_dwordx4 v245, s[16:19], s45 offen sc1 lds
 v_fma_mix_f32 v234, v217, v196, 0 op_sel:[0,0,0] op_sel_hi:[1,0,0]
 MM v[116:119], a[228:231], a[16:19], 0
 v_fma_mix_f32 v235, v217, v196, 0 op_sel:[1,0,0] op_sel_hi:[1,0,0]
 v_fma_mix_f32 v236, v218, v196, 0 op_sel:[0,0,0] op_sel_hi:[1,0,0]
 v_fma_mix_f32 v237, v218, v196, 0 op_sel:[1,0,0] op_sel_hi:[1,0,0]
 MM v[140:143], a[228:231], a[20:23], 0
 v_fma_mix_f32 v238, v219, v196, 0 op_sel:[0,0,0] op_sel_hi:[1,0,0]
 v_fma_mix_f32 v239, v219, v196, 0 op_sel:[1,0,0] op_sel_hi:[1,0,0]
 s_waitcnt vmcnt(22)
 MM v[136:139], a[224:227], a[20:23], 0
 buffer_load_dwordx4 a[116:119], v245, s[8:11], s7 offen offset:1024
 ds_read_b128 v[216:219], v249 offset:26624
 MM v[132:135], a[220:223], a[20:23], 0
 v_fma_mix_f32 v232, v220, v197, v232 op_sel:[0,0,0] op_sel_hi:[1,0,0]
 v_fma_mix_f32 v233, v220, v197, v233 op_sel:[1,0,0] op_sel_hi:[1,0,0]
 v_fma_mix_f32 v234, v221, v197, v234 op_sel:[0,0,0] op_sel_hi:[1,0,0]
 MM v[128:131], a[216:219], a[20:23], 0
 v_fma_mix_f32 v235, v221, v197, v235 op_sel:[1,0,0] op_sel_hi:[1,0,0]
 v_fma_mix_f32 v236, v222, v197, v236 op_sel:[0,0,0] op_sel_hi:[1,0,0]
 v_fma_mix_f32 v237, v222, v197, v237 op_sel:[1,0,0] op_sel_hi:[1,0,0]
 MM v[124:127], a[212:215], a[20:23], 0
 buffer_load_dwordx4 a[120:123], v245, s[8:11], s7 offen offset:2048
 v_fma_mix_f32 v238, v223, v197, v238 op_sel:[0,0,0] op_sel_hi:[1,0,0]
 MM v[120:123], a[208:211], a[20:23], 0
 v_fma_mix_f32 v239, v223, v197, v239 op_sel:[1,0,0] op_sel_hi:[1,0,0]
 MM v[144:147], a[208:211], a[24:27], 0
 ds_read_b128 v[220:223], v250 offset:3072
 s_waitcnt lgkmcnt(3)
 v_fma_mix_f32 v232, v224, v198, v232 op_sel:[0,0,0] op_sel_hi:[1,0,0]
 MM v[148:151], a[212:215], a[24:27], 0
 buffer_load_dwordx4 a[124:127], v245, s[8:11], s7 offen offset:3072
 v_fma_mix_f32 v233, v224, v198, v233 op_sel:[1,0,0] op_sel_hi:[1,0,0]
 MM v[152:155], a[216:219], a[24:27], 0
 v_fma_mix_f32 v234, v225, v198, v234 op_sel:[0,0,0] op_sel_hi:[1,0,0]
 v_fma_mix_f32 v235, v225, v198, v235 op_sel:[1,0,0] op_sel_hi:[1,0,0]
 v_fma_mix_f32 v236, v226, v198, v236 op_sel:[0,0,0] op_sel_hi:[1,0,0]
 MM v[156:159], a[220:223], a[24:27], 0
 s_add_u32 m0, s36, -1024
 s_add_u32 s34, s40, 69632
 v_fma_mix_f32 v237, v226, v198, v237 op_sel:[1,0,0] op_sel_hi:[1,0,0]
 MM v[160:163], a[224:227], a[24:27], 0
 v_fma_mix_f32 v238, v227, v198, v238 op_sel:[0,0,0] op_sel_hi:[1,0,0]
 v_fma_mix_f32 v239, v227, v198, v239 op_sel:[1,0,0] op_sel_hi:[1,0,0]
 v_fma_mix_f32 v232, v228, v199, v232 op_sel:[0,0,0] op_sel_hi:[1,0,0]
 MM v[164:167], a[228:231], a[24:27], 0
 buffer_load_dwordx4 v245, s[12:15], s34 offen offset:1024 sc1 lds
 ds_read_b128 v[224:227], v250 offset:4096
 MM v[188:191], a[228:231], a[28:31], 0
 v_fma_mix_f32 v233, v228, v199, v233 op_sel:[1,0,0] op_sel_hi:[1,0,0]
 v_fma_mix_f32 v234, v229, v199, v234 op_sel:[0,0,0] op_sel_hi:[1,0,0]
 v_fma_mix_f32 v235, v229, v199, v235 op_sel:[1,0,0] op_sel_hi:[1,0,0]
 MM v[184:187], a[224:227], a[28:31], 0
 v_fma_mix_f32 v236, v230, v199, v236 op_sel:[0,0,0] op_sel_hi:[1,0,0]
 v_fma_mix_f32 v237, v230, v199, v237 op_sel:[1,0,0] op_sel_hi:[1,0,0]
 v_fma_mix_f32 v238, v231, v199, v238 op_sel:[0,0,0] op_sel_hi:[1,0,0]
 MM v[180:183], a[220:223], a[28:31], 0
 buffer_load_dwordx4 v245, s[12:15], s34 offen offset:2048 sc1 lds
 v_fma_mix_f32 v239, v231, v199, v239 op_sel:[1,0,0] op_sel_hi:[1,0,0]
 MM v[176:179], a[216:219], a[28:31], 0
 ds_read_b128 v[228:231], v250 offset:5120
 CB v240, v232, v233
 CB v241, v234, v235
 MM v[172:175], a[212:215], a[28:31], 0
 CB v242, v236, v237
 CB v243, v238, v239
 MM v[168:171], a[208:211], a[28:31], 0
 ds_write_b128 v255, v[240:243] offset:25600
 MM v[0:3], a[232:235], a[32:35], v[0:3]
 buffer_load_dwordx4 v245, s[12:15], s34 offen offset:3072 sc1 lds
 ds_read_b128 a[208:211], v251 offset:12288
 MM v[4:7], a[236:239], a[32:35], v[4:7]
 s_add_u32 s7, s7, 0x1000
 s_waitcnt lgkmcnt(4)
 ds_read_b128 a[212:215], v252 offset:12288
 MM v[8:11], a[240:243], a[32:35], v[8:11]
 ds_read_b128 a[216:219], v251 offset:14336
 v_fma_mix_f32 v232, v216, v200, 0 op_sel:[0,0,0] op_sel_hi:[1,0,0]
 v_fma_mix_f32 v233, v216, v200, 0 op_sel:[1,0,0] op_sel_hi:[1,0,0]
 MM v[12:15], a[244:247], a[32:35], v[12:15]
 buffer_load_dwordx4 a[128:131], v245, s[8:11], s7 offen offset:0
 ds_read_b128 a[220:223], v252 offset:14336
 MM v[16:19], a[248:251], a[32:35], v[16:19]
 s_add_u32 m0, s44, 54272
 s_add_u32 s45, s40, 458752
 v_fma_mix_f32 v234, v217, v200, 0 op_sel:[0,0,0] op_sel_hi:[1,0,0]
 MM v[20:23], a[252:255], a[32:35], v[20:23]
 ds_read_b128 a[224:227], v251 offset:16384
 v_fma_mix_f32 v235, v217, v200, 0 op_sel:[1,0,0] op_sel_hi:[1,0,0]
 v_fma_mix_f32 v236, v218, v200, 0 op_sel:[0,0,0] op_sel_hi:[1,0,0]
 MM v[44:47], a[252:255], a[36:39], v[44:47]
 buffer_load_dwordx4 v245, s[16:19], s45 offen sc1 lds
 ds_read_b128 a[228:231], v252 offset:16384
 MM v[40:43], a[248:251], a[36:39], v[40:43]
 v_fma_mix_f32 v237, v218, v200, 0 op_sel:[1,0,0] op_sel_hi:[1,0,0]
 v_fma_mix_f32 v238, v219, v200, 0 op_sel:[0,0,0] op_sel_hi:[1,0,0]
 v_fma_mix_f32 v239, v219, v200, 0 op_sel:[1,0,0] op_sel_hi:[1,0,0]
 MM v[36:39], a[244:247], a[36:39], v[36:39]
 s_waitcnt vmcnt(26)
 ds_read_b128 v[216:219], v249 offset:27648
 v_fma_mix_f32 v232, v220, v201, v232 op_sel:[0,0,0] op_sel_hi:[1,0,0]
 MM v[32:35], a[240:243], a[36:39], v[32:35]
 buffer_load_dwordx4 a[132:135], v245, s[8:11], s7 offen offset:1024
 v_fma_mix_f32 v233, v220, v201, v233 op_sel:[1,0,0] op_sel_hi:[1,0,0]
 MM v[28:31], a[236:239], a[36:39], v[28:31]
 v_fma_mix_f32 v234, v221, v201, v234 op_sel:[0,0,0] op_sel_hi:[1,0,0]
 v_fma_mix_f32 v235, v221, v201, v235 op_sel:[1,0,0] op_sel_hi:[1,0,0]
 v_fma_mix_f32 v236, v222, v201, v236 op_sel:[0,0,0] op_sel_hi:[1,0,0]
 MM v[24:27], a[232:235], a[36:39], v[24:27]
 v_fma_mix_f32 v237, v222, v201, v237 op_sel:[1,0,0] op_sel_hi:[1,0,0]
 v_fma_mix_f32 v238, v223, v201, v238 op_sel:[0,0,0] op_sel_hi:[1,0,0]
 MM v[48:51], a[232:235], a[40:43], v[48:51]
 buffer_load_dwordx4 a[0:3], v245, s[8:11], s7 offen offset:2048
 v_fma_mix_f32 v239, v223, v201, v239 op_sel:[1,0,0] op_sel_hi:[1,0,0]
 MM v[52:55], a[236:239], a[40:43], v[52:55]
 ds_read_b128 v[220:223], v250 offset:6144
 s_waitcnt lgkmcnt(9)
 v_fma_mix_f32 v232, v224, v202, v232 op_sel:[0,0,0] op_sel_hi:[1,0,0]
 MM v[56:59], a[240:243], a[40:43], v[56:59]
 s_add_u32 m0, s36, 2048
 s_add_u32 s34, s40, 196608
 v_fma_mix_f32 v233, v224, v202, v233 op_sel:[1,0,0] op_sel_hi:[1,0,0]
 MM v[60:63], a[244:247], a[40:43], v[60:63]
 v_fma_mix_f32 v234, v225, v202, v234 op_sel:[0,0,0] op_sel_hi:[1,0,0]
 v_fma_mix_f32 v235, v225, v202, v235 op_sel:[1,0,0] op_sel_hi:[1,0,0]
 v_fma_mix_f32 v236, v226, v202, v236 op_sel:[0,0,0] op_sel_hi:[1,0,0]
 MM v[64:67], a[248:251], a[40:43], v[64:67]
 buffer_load_dwordx4 v245, s[8:11], s34 offen offset:1024 sc1 lds
 v_fma_mix_f32 v237, v226, v202, v237 op_sel:[1,0,0] op_sel_hi:[1,0,0]
 MM v[68:71], a[252:255], a[40:43], v[68:71]
 v_fma_mix_f32 v238, v227, v202, v238 op_sel:[0,0,0] op_sel_hi:[1,0,0]
 v_fma_mix_f32 v239, v227, v202, v239 op_sel:[1,0,0] op_sel_hi:[1,0,0]
 v_fma_mix_f32 v232, v228, v203, v232 op_sel:[0,0,0] op_sel_hi:[1,0,0]
 MM v[92:95], a[252:255], a[44:47], v[92:95]
 ds_read_b128 v[224:227], v250 offset:7168
 v_fma_mix_f32 v233, v228, v203, v233 op_sel:[1,0,0] op_sel_hi:[1,0,0]
 v_fma_mix_f32 v234, v229, v203, v234 op_sel:[0,0,0] op_sel_hi:[1,0,0]
 MM v[88:91], a[248:251], a[44:47], v[88:91]
 buffer_load_dwordx4 v245, s[8:11], s34 offen offset:2048 sc1 lds
 v_fma_mix_f32 v235, v229, v203, v235 op_sel:[1,0,0] op_sel_hi:[1,0,0]
 MM v[84:87], a[244:247], a[44:47], v[84:87]
 v_fma_mix_f32 v236, v230, v203, v236 op_sel:[0,0,0] op_sel_hi:[1,0,0]
 v_fma_mix_f32 v237, v230, v203, v237 op_sel:[1,0,0] op_sel_hi:[1,0,0]
 v_fma_mix_f32 v238, v231, v203, v238 op_sel:[0,0,0] op_sel_hi:[1,0,0]
 MM v[80:83], a[240:243], a[44:47], v[80:83]
 v_fma_mix_f32 v239, v231, v203, v239 op_sel:[1,0,0] op_sel_hi:[1,0,0]
 CB v240, v232, v233
 CB v241, v234, v235
 MM v[76:79], a[236:239], a[44:47], v[76:79]
 buffer_load_dwordx4 v245, s[8:11], s34 offen offset:3072 sc1 lds
 ds_read_b128 v[228:231], v250 offset:8192
 MM v[72:75], a[232:235], a[44:47], v[72:75]
 CB v242, v236, v237
 CB v243, v238, v239
 MM v[96:99], a[232:235], a[48:51], v[96:99]
 ds_write_b128 v255, v[240:243] offset:26624
 s_waitcnt lgkmcnt(3)
 v_fma_mix_f32 v232, v216, v204, 0 op_sel:[0,0,0] op_sel_hi:[1,0,0]
 MM v[100:103], a[236:239], a[48:51], v[100:103]
 buffer_load_dwordx4 a[4:7], v245, s[8:11], s7 offen offset:3072
 v_fma_mix_f32 v233, v216, v204, 0 op_sel:[1,0,0] op_sel_hi:[1,0,0]
 MM v[104:107], a[240:243], a[48:51], v[104:107]
 v_fma_mix_f32 v234, v217, v204, 0 op_sel:[0,0,0] op_sel_hi:[1,0,0]
 v_fma_mix_f32 v235, v217, v204, 0 op_sel:[1,0,0] op_sel_hi:[1,0,0]
 v_fma_mix_f32 v236, v218, v204, 0 op_sel:[0,0,0] op_sel_hi:[1,0,0]
 MM v[108:111], a[244:247], a[48:51], v[108:111]
 s_add_u32 s7, s7, 0x1000
 v_fma_mix_f32 v237, v218, v204, 0 op_sel:[1,0,0] op_sel_hi:[1,0,0]
 v_fma_mix_f32 v238, v219, v204, 0 op_sel:[0,0,0] op_sel_hi:[1,0,0]
 MM v[112:115], a[248:251], a[48:51], v[112:115]
 v_fma_mix_f32 v239, v219, v204, 0 op_sel:[1,0,0] op_sel_hi:[1,0,0]
 s_waitcnt vmcnt(28)
 ds_read_b128 v[216:219], v249 offset:28672
 MM v[116:119], a[252:255], a[48:51], v[116:119]
 buffer_load_dwordx4 a[8:11], v245, s[8:11], s7 offen offset:0
 v_fma_mix_f32 v232, v220, v205, v232 op_sel:[0,0,0] op_sel_hi:[1,0,0]
 MM v[140:143], a[252:255], a[52:55], v[140:143]
 v_fma_mix_f32 v233, v220, v205, v233 op_sel:[1,0,0] op_sel_hi:[1,0,0]
 v_fma_mix_f32 v234, v221, v205, v234 op_sel:[0,0,0] op_sel_hi:[1,0,0]
 v_fma_mix_f32 v235, v221, v205, v235 op_sel:[1,0,0] op_sel_hi:[1,0,0]
 MM v[136:139], a[248:251], a[52:55], v[136:139]
 v_fma_mix_f32 v236, v222, v205, v236 op_sel:[0,0,0] op_sel_hi:[1,0,0]
 v_fma_mix_f32 v237, v222, v205, v237 op_sel:[1,0,0] op_sel_hi:[1,0,0]
 MM v[132:135], a[244:247], a[52:55], v[132:135]
 buffer_load_dwordx4 a[12:15], v245, s[8:11], s7 offen offset:1024
 MM v[128:131], a[240:243], a[52:55], v[128:131]
 v_fma_mix_f32 v238, v223, v205, v238 op_sel:[0,0,0] op_sel_hi:[1,0,0]
 v_fma_mix_f32 v239, v223, v205, v239 op_sel:[1,0,0] op_sel_hi:[1,0,0]
 MM v[124:127], a[236:239], a[52:55], v[124:127]
 ds_read_b128 v[220:223], v250 offset:9216
 s_waitcnt lgkmcnt(3)
 MM v[120:123], a[232:235], a[52:55], v[120:123]
 v_fma_mix_f32 v232, v224, v206, v232 op_sel:[0,0,0] op_sel_hi:[1,0,0]
 MM v[144:147], a[232:235], a[56:59], v[144:147]
 buffer_load_dwordx4 a[16:19], v245, s[8:11], s7 offen offset:2048
 MM v[148:151], a[236:239], a[56:59], v[148:151]
 v_fma_mix_f32 v233, v224, v206, v233 op_sel:[1,0,0] op_sel_hi:[1,0,0]
 v_fma_mix_f32 v234, v225, v206, v234 op_sel:[0,0,0] op_sel_hi:[1,0,0]
 v_fma_mix_f32 v235, v225, v206, v235 op_sel:[1,0,0] op_sel_hi:[1,0,0]
 MM v[152:155], a[240:243], a[56:59], v[152:155]
 s_add_u32 m0, s36, 5120
 s_add_u32 s34, s40, 200704
 MM v[156:159], a[244:247], a[56:59], v[156:159]
 v_fma_mix_f32 v236, v226, v206, v236 op_sel:[0,0,0] op_sel_hi:[1,0,0]
 v_fma_mix_f32 v237, v226, v206, v237 op_sel:[1,0,0] op_sel_hi:[1,0,0]
 v_fma_mix_f32 v238, v227, v206, v238 op_sel:[0,0,0] op_sel_hi:[1,0,0]
 MM v[160:163], a[248:251], a[56:59], v[160:163]
 buffer_load_dwordx4 v245, s[8:11], s34 offen offset:1024 sc1 lds
 MM v[164:167], a[252:255], a[56:59], v[164:167]
 v_fma_mix_f32 v239, v227, v206, v239 op_sel:[1,0,0] op_sel_hi:[1,0,0]
 v_fma_mix_f32 v232, v228, v207, v232 op_sel:[0,0,0] op_sel_hi:[1,0,0]
 v_fma_mix_f32 v233, v228, v207, v233 op_sel:[1,0,0] op_sel_hi:[1,0,0]
 MM v[188:191], a[252:255], a[60:63], v[188:191]
 ds_read_b128 v[224:227], v250 offset:10240
 v_fma_mix_f32 v234, v229, v207, v234 op_sel:[0,0,0] op_sel_hi:[1,0,0]
 MM v[184:187], a[248:251], a[60:63], v[184:187]
 buffer_load_dwordx4 v245, s[8:11], s34 offen offset:2048 sc1 lds
 MM v[180:183], a[244:247], a[60:63], v[180:183]
 v_fma_mix_f32 v235, v229, v207, v235 op_sel:[1,0,0] op_sel_hi:[1,0,0]
 v_fma_mix_f32 v236, v230, v207, v236 op_sel:[0,0,0] op_sel_hi:[1,0,0]
 MM v[176:179], a[240:243], a[60:63], v[176:179]
 v_fma_mix_f32 v237, v230, v207, v237 op_sel:[1,0,0] op_sel_hi:[1,0,0]
 v_fma_mix_f32 v238, v231, v207, v238 op_sel:[0,0,0] op_sel_hi:[1,0,0]
 MM v[172:175], a[236:239], a[60:63], v[172:175]
 v_fma_mix_f32 v239, v231, v207, v239 op_sel:[1,0,0] op_sel_hi:[1,0,0]
 CB v240, v232, v233
 MM v[168:171], a[232:235], a[60:63], v[168:171]
 MM v[0:3], a[208:211], a[64:67], v[0:3]
 buffer_load_dwordx4 v245, s[8:11], s34 offen offset:3072 sc1 lds
 ds_read_b128 a[232:235], v252 offset:18432
 MM v[4:7], a[212:215], a[64:67], v[4:7]
 ds_read_b128 v[228:231], v250 offset:11264
 ds_read_b128 a[236:239], v251 offset:18432
 CB v241, v234, v235
 MM v[8:11], a[216:219], a[64:67], v[8:11]
 ds_read_b128 a[240:243], v252 offset:20480
 CB v242, v236, v237
 CB v243, v238, v239
 MM v[12:15], a[220:223], a[64:67], v[12:15]
 buffer_load_dwordx4 a[20:23], v245, s[8:11], s7 offen offset:3072
 ds_read_b128 a[244:247], v251 offset:20480
 MM v[16:19], a[224:227], a[64:67], v[16:19]
 ds_read_b128 a[248:251], v252 offset:22528
 ds_write_b128 v255, v[240:243] offset:27648
 ds_read_b128 a[252:255], v251 offset:22528
 MM v[20:23], a[228:231], a[64:67], v[20:23]
 s_add_u32 s7, s7, 0x1000
 s_waitcnt lgkmcnt(9)
 v_fma_mix_f32 v232, v216, v208, 0 op_sel:[0,0,0] op_sel_hi:[1,0,0]
 MM v[44:47], a[228:231], a[68:71], v[44:47]
 buffer_load_dwordx4 a[24:27], v245, s[8:11], s7 offen offset:0
 v_fma_mix_f32 v233, v216, v208, 0 op_sel:[1,0,0] op_sel_hi:[1,0,0]
 MM v[40:43], a[224:227], a[68:71], v[40:43]
 v_fma_mix_f32 v234, v217, v208, 0 op_sel:[0,0,0] op_sel_hi:[1,0,0]
 v_fma_mix_f32 v235, v217, v208, 0 op_sel:[1,0,0] op_sel_hi:[1,0,0]
 v_fma_mix_f32 v236, v218, v208, 0 op_sel:[0,0,0] op_sel_hi:[1,0,0]
 MM v[36:39], a[220:223], a[68:71], v[36:39]
 v_fma_mix_f32 v237, v218, v208, 0 op_sel:[1,0,0] op_sel_hi:[1,0,0]
 v_fma_mix_f32 v238, v219, v208, 0 op_sel:[0,0,0] op_sel_hi:[1,0,0]
 v_fma_mix_f32 v239, v219, v208, 0 op_sel:[1,0,0] op_sel_hi:[1,0,0]
 MM v[32:35], a[216:219], a[68:71], v[32:35]
 buffer_load_dwordx4 a[28:31], v245, s[8:11], s7 offen offset:1024
 MM v[28:31], a[212:215], a[68:71], v[28:31]
 s_waitcnt vmcnt(33)
 ds_read_b128 v[216:219], v249 offset:29696
 v_fma_mix_f32 v232, v220, v209, v232 op_sel:[0,0,0] op_sel_hi:[1,0,0]
 MM v[24:27], a[208:211], a[68:71], v[24:27]
 v_fma_mix_f32 v233, v220, v209, v233 op_sel:[1,0,0] op_sel_hi:[1,0,0]
 MM v[48:51], a[208:211], a[72:75], v[48:51]
 v_fma_mix_f32 v234, v221, v209, v234 op_sel:[0,0,0] op_sel_hi:[1,0,0]
 v_fma_mix_f32 v235, v221, v209, v235 op_sel:[1,0,0] op_sel_hi:[1,0,0]
 MM v[52:55], a[212:215], a[72:75], v[52:55]
 buffer_load_dwordx4 a[32:35], v245, s[8:11], s7 offen offset:2048
 MM v[56:59], a[216:219], a[72:75], v[56:59]
 v_fma_mix_f32 v236, v222, v209, v236 op_sel:[0,0,0] op_sel_hi:[1,0,0]
 v_fma_mix_f32 v237, v222, v209, v237 op_sel:[1,0,0] op_sel_hi:[1,0,0]
 v_fma_mix_f32 v238, v223, v209, v238 op_sel:[0,0,0] op_sel_hi:[1,0,0]
 MM v[60:63], a[220:223], a[72:75], v[60:63]
 v_fma_mix_f32 v239, v223, v209, v239 op_sel:[1,0,0] op_sel_hi:[1,0,0]
 MM v[64:67], a[224:227], a[72:75], v[64:67]
 buffer_load_dwordx4 a[36:39], v245, s[8:11], s7 offen offset:3072
 MM v[68:71], a[228:231], a[72:75], v[68:71]
 ds_read_b128 v[220:223], v250 offset:12288
 s_waitcnt lgkmcnt(8)
 v_fma_mix_f32 v232, v224, v210, v232 op_sel:[0,0,0] op_sel_hi:[1,0,0]
 MM v[92:95], a[228:231], a[76:79], v[92:95]
 s_add_u32 m0, s36, 8192
 s_add_u32 s34, s40, 327680
 MM v[88:91], a[224:227], a[76:79], v[88:91]
 v_fma_mix_f32 v233, v224, v210, v233 op_sel:[1,0,0] op_sel_hi:[1,0,0]
 v_fma_mix_f32 v234, v225, v210, v234 op_sel:[0,0,0] op_sel_hi:[1,0,0]
 v_fma_mix_f32 v235, v225, v210, v235 op_sel:[1,0,0] op_sel_hi:[1,0,0]
 MM v[84:87], a[220:223], a[76:79], v[84:87]
 buffer_load_dwordx4 v245, s[16:19], s34 offen offset:1024 sc1 lds
 MM v[80:83], a[216:219], a[76:79], v[80:83]
 v_fma_mix_f32 v236, v226, v210, v236 op_sel:[0,0,0] op_sel_hi:[1,0,0]
 v_fma_mix_f32 v237, v226, v210, v237 op_sel:[1,0,0] op_sel_hi:[1,0,0]
 v_fma_mix_f32 v238, v227, v210, v238 op_sel:[0,0,0] op_sel_hi:[1,0,0]
 MM v[76:79], a[212:215], a[76:79], v[76:79]
 v_fma_mix_f32 v239, v227, v210, v239 op_sel:[1,0,0] op_sel_hi:[1,0,0]
 v_fma_mix_f32 v232, v228, v211, v232 op_sel:[0,0,0] op_sel_hi:[1,0,0]
 MM v[72:75], a[208:211], a[76:79], v[72:75]
 ds_read_b128 v[224:227], v250 offset:13312
 MM v[96:99], a[208:211], a[80:83], v[96:99]
 buffer_load_dwordx4 v245, s[16:19], s34 offen offset:2048 sc1 lds
 MM v[100:103], a[212:215], a[80:83], v[100:103]
 v_fma_mix_f32 v233, v228, v211, v233 op_sel:[1,0,0] op_sel_hi:[1,0,0]
 v_fma_mix_f32 v234, v229, v211, v234 op_sel:[0,0,0] op_sel_hi:[1,0,0]
 MM v[104:107], a[216:219], a[80:83], v[104:107]
 v_fma_mix_f32 v235, v229, v211, v235 op_sel:[1,0,0] op_sel_hi:[1,0,0]
 v_fma_mix_f32 v236, v230, v211, v236 op_sel:[0,0,0] op_sel_hi:[1,0,0]
 MM v[108:111], a[220:223], a[80:83], v[108:111]
 v_fma_mix_f32 v237, v230, v211, v237 op_sel:[1,0,0] op_sel_hi:[1,0,0]
 v_fma_mix_f32 v238, v231, v211, v238 op_sel:[0,0,0] op_sel_hi:[1,0,0]
 MM v[112:115], a[224:227], a[80:83], v[112:115]
 buffer_load_dwordx4 v245, s[16:19], s34 offen offset:3072 sc1 lds
 MM v[116:119], a[228:231], a[80:83], v[116:119]
 v_fma_mix_f32 v239, v231, v211, v239 op_sel:[1,0,0] op_sel_hi:[1,0,0]
 CB v240, v232, v233
 MM v[140:143], a[228:231], a[84:87], v[140:143]
 ds_read_b128 v[228:231], v250 offset:14336
 s_add_u32 s7, s7, 0x1000
 MM v[136:139], a[224:227], a[84:87], v[136:139]
 CB v241, v234, v235
 CB v242, v236, v237
 MM v[132:135], a[220:223], a[84:87], v[132:135]
 buffer_load_dwordx4 a[40:43], v245, s[8:11], s7 offen offset:0
 MM v[128:131], a[216:219], a[84:87], v[128:131]
 CB v243, v238, v239
 MM v[124:127], a[212:215], a[84:87], v[124:127]
 ds_write_b128 v255, v[240:243] offset:28672
 s_add_u32 m0, s44, 73728
 s_add_u32 s45, s40, 102400
 MM v[120:123], a[208:211], a[84:87], v[120:123]
 buffer_load_dwordx4 v245, s[12:15], s45 offen sc1 lds
 MM v[144:147], a[208:211], a[88:91], v[144:147]
 s_waitcnt lgkmcnt(3)
 v_fma_mix_f32 v232, v216, v212, 0 op_sel:[0,0,0] op_sel_hi:[1,0,0]
 v_fma_mix_f32 v233, v216, v212, 0 op_sel:[1,0,0] op_sel_hi:[1,0,0]
 MM v[148:151], a[212:215], a[88:91], v[148:151]
 v_fma_mix_f32 v234, v217, v212, 0 op_sel:[0,0,0] op_sel_hi:[1,0,0]
 v_fma_mix_f32 v235, v217, v212, 0 op_sel:[1,0,0] op_sel_hi:[1,0,0]
 v_fma_mix_f32 v236, v218, v212, 0 op_sel:[0,0,0] op_sel_hi:[1,0,0]
 MM v[152:155], a[216:219], a[88:91], v[152:155]
 v_fma_mix_f32 v237, v218, v212, 0 op_sel:[1,0,0] op_sel_hi:[1,0,0]
 v_fma_mix_f32 v238, v219, v212, 0 op_sel:[0,0,0] op_sel_hi:[1,0,0]
 MM v[156:159], a[220:223], a[88:91], v[156:159]
 buffer_load_dwordx4 a[44:47], v245, s[8:11], s7 offen offset:1024
 MM v[160:163], a[224:227], a[88:91], v[160:163]
 v_fma_mix_f32 v239, v219, v212, 0 op_sel:[1,0,0] op_sel_hi:[1,0,0]
 s_waitcnt vmcnt(35)
 s_waitcnt vmcnt(25)
 MM v[164:167], a[228:231], a[88:91], v[164:167]
 v_add_u32 v249, 49152, v249
 v_fma_mix_f32 v232, v220, v213, v232 op_sel:[0,0,0] op_sel_hi:[1,0,0]
 v_fma_mix_f32 v233, v220, v213, v233 op_sel:[1,0,0] op_sel_hi:[1,0,0]
 MM v[188:191], a[228:231], a[92:95], v[188:191]
 buffer_load_dwordx4 a[48:51], v245, s[8:11], s7 offen offset:2048
 MM v[184:187], a[224:227], a[92:95], v[184:187]
 ds_read_b128 v[216:219], v249 offset:0
 v_fma_mix_f32 v234, v221, v213, v234 op_sel:[0,0,0] op_sel_hi:[1,0,0]
 v_fma_mix_f32 v235, v221, v213, v235 op_sel:[1,0,0] op_sel_hi:[1,0,0]
 MM v[180:183], a[220:223], a[92:95], v[180:183]
 v_fma_mix_f32 v236, v222, v213, v236 op_sel:[0,0,0] op_sel_hi:[1,0,0]
 v_fma_mix_f32 v237, v222, v213, v237 op_sel:[1,0,0] op_sel_hi:[1,0,0]
 MM v[176:179], a[216:219], a[92:95], v[176:179]
 v_fma_mix_f32 v238, v223, v213, v238 op_sel:[0,0,0] op_sel_hi:[1,0,0]
 v_fma_mix_f32 v239, v223, v213, v239 op_sel:[1,0,0] op_sel_hi:[1,0,0]
 MM v[172:175], a[212:215], a[92:95], v[172:175]
 buffer_load_dwordx4 a[52:55], v245, s[8:11], s7 offen offset:3072
 MM v[168:171], a[208:211], a[92:95], v[168:171]
 MM v[0:3], a[232:235], a[96:99], v[0:3]
 ds_read_b128 v[220:223], v250 offset:0
 s_add_u32 s7, s7, 0x1000
 s_waitcnt lgkmcnt(3)
 MM v[4:7], a[236:239], a[96:99], v[4:7]
 v_fma_mix_f32 v232, v224, v214, v232 op_sel:[0,0,0] op_sel_hi:[1,0,0]
 v_fma_mix_f32 v233, v224, v214, v233 op_sel:[1,0,0] op_sel_hi:[1,0,0]
 MM v[8:11], a[240:243], a[96:99], v[8:11]
 buffer_load_dwordx4 a[56:59], v245, s[8:11], s7 offen offset:0
 MM v[12:15], a[244:247], a[96:99], v[12:15]
 v_fma_mix_f32 v234, v225, v214, v234 op_sel:[0,0,0] op_sel_hi:[1,0,0]
 v_fma_mix_f32 v235, v225, v214, v235 op_sel:[1,0,0] op_sel_hi:[1,0,0]
 v_fma_mix_f32 v236, v226, v214, v236 op_sel:[0,0,0] op_sel_hi:[1,0,0]
 MM v[16:19], a[248:251], a[96:99], v[16:19]
 s_add_u32 m0, s36, 11264
 s_add_u32 s34, s40, 331776
 MM v[20:23], a[252:255], a[96:99], v[20:23]
 v_fma_mix_f32 v237, v226, v214, v237 op_sel:[1,0,0] op_sel_hi:[1,0,0]
 v_fma_mix_f32 v238, v227, v214, v238 op_sel:[0,0,0] op_sel_hi:[1,0,0]
 v_fma_mix_f32 v239, v227, v214, v239 op_sel:[1,0,0] op_sel_hi:[1,0,0]
 MM v[44:47], a[252:255], a[100:103], v[44:47]
 buffer_load_dwordx4 v245, s[16:19], s34 offen offset:1024 sc1 lds
 MM v[40:43], a[248:251], a[100:103], v[40:43]
 ds_read_b128 v[224:227], v250 offset:1024
 v_fma_mix_f32 v232, v228, v215, v232 op_sel:[0,0,0] op_sel_hi:[1,0,0]
 v_fma_mix_f32 v233, v228, v215, v233 op_sel:[1,0,0] op_sel_hi:[1,0,0]
 MM v[36:39], a[244:247], a[100:103], v[36:39]
 v_fma_mix_f32 v234, v229, v215, v234 op_sel:[0,0,0] op_sel_hi:[1,0,0]
 v_fma_mix_f32 v235, v229, v215, v235 op_sel:[1,0,0] op_sel_hi:[1,0,0]
 MM v[32:35], a[240:243], a[100:103], v[32:35]
 buffer_load_dwordx4 v245, s[16:19], s34 offen offset:2048 sc1 lds
 MM v[28:31], a[236:239], a[100:103], v[28:31]
 v_fma_mix_f32 v236, v230, v215, v236 op_sel:[0,0,0] op_sel_hi:[1,0,0]
 v_fma_mix_f32 v237, v230, v215, v237 op_sel:[1,0,0] op_sel_hi:[1,0,0]
 MM v[24:27], a[232:235], a[100:103], v[24:27]
 v_fma_mix_f32 v238, v231, v215, v238 op_sel:[0,0,0] op_sel_hi:[1,0,0]
 MM v[48:51], a[232:235], a[104:107], v[48:51]
 v_fma_mix_f32 v239, v231, v215, v239 op_sel:[1,0,0] op_sel_hi:[1,0,0]
 CB v240, v232, v233
 MM v[52:55], a[236:239], a[104:107], v[52:55]
 buffer_load_dwordx4 v245, s[16:19], s34 offen offset:3072 sc1 lds
 MM v[56:59], a[240:243], a[104:107], v[56:59]
 ds_read_b128 v[228:231], v250 offset:2048
 CB v241, v234, v235
 CB v242, v236, v237
 MM v[60:63], a[244:247], a[104:107], v[60:63]
 s_add_u32 m0, s44, 74752
 s_add_u32 s45, s40, 229376
 MM v[64:67], a[248:251], a[104:107], v[64:67]
 CB v243, v238, v239
 MM v[68:71], a[252:255], a[104:107], v[68:71]
 buffer_load_dwordx4 v245, s[8:11], s45 offen sc1 lds
 ds_write_b128 v255, v[240:243] offset:29696
 s_waitcnt lgkmcnt(0)
 s_barrier
 MM v[92:95], a[252:255], a[108:111], v[92:95]
 ds_read_b128 a[208:211], v251 offset:24576
 MM v[88:91], a[248:251], a[108:111], v[88:91]
 ds_read_b128 a[212:215], v252 offset:24576
 MM v[84:87], a[244:247], a[108:111], v[84:87]
 buffer_load_dwordx4 a[60:63], v245, s[8:11], s7 offen offset:1024
 MM v[80:83], a[240:243], a[108:111], v[80:83]
 ds_read_b128 a[216:219], v251 offset:26624
 MM v[76:79], a[236:239], a[108:111], v[76:79]
 ds_read_b128 a[220:223], v252 offset:26624
 MM v[72:75], a[232:235], a[108:111], v[72:75]
 ds_read_b128 a[224:227], v251 offset:28672
 MM v[96:99], a[232:235], a[112:115], v[96:99]
 buffer_load_dwordx4 a[64:67], v245, s[8:11], s7 offen offset:2048
 MM v[100:103], a[236:239], a[112:115], v[100:103]
 ds_read_b128 a[228:231], v252 offset:28672
 MM v[104:107], a[240:243], a[112:115], v[104:107]
 MM v[108:111], a[244:247], a[112:115], v[108:111]
 MM v[112:115], a[248:251], a[112:115], v[112:115]
 buffer_load_dwordx4 a[68:71], v245, s[8:11], s7 offen offset:3072
 MM v[116:119], a[252:255], a[112:115], v[116:119]
 MM v[140:143], a[252:255], a[116:119], v[140:143]
 s_add_u32 s7, s7, 0x1000
 MM v[136:139], a[248:251], a[116:119], v[136:139]
 MM v[132:135], a[244:247], a[116:119], v[132:135]
 buffer_load_dwordx4 a[72:75], v245, s[8:11], s7 offen offset:0
 MM v[128:131], a[240:243], a[116:119], v[128:131]
 MM v[124:127], a[236:239], a[116:119], v[124:127]
 s_add_u32 m0, s44, 75776
 s_add_u32 s45, s40, 233472
 MM v[120:123], a[232:235], a[116:119], v[120:123]
 MM v[144:147], a[232:235], a[120:123], v[144:147]
 buffer_load_dwordx4 v245, s[8:11], s45 offen sc1 lds
 MM v[148:151], a[236:239], a[120:123], v[148:151]
 MM v[152:155], a[240:243], a[120:123], v[152:155]
 MM v[156:159], a[244:247], a[120:123], v[156:159]
 MM v[160:163], a[248:251], a[120:123], v[160:163]
 buffer_load_dwordx4 a[76:79], v245, s[8:11], s7 offen offset:1024
 MM v[164:167], a[252:255], a[120:123], v[164:167]
 MM v[188:191], a[252:255], a[124:127], v[188:191]
 MM v[184:187], a[248:251], a[124:127], v[184:187]
 MM v[180:183], a[244:247], a[124:127], v[180:183]
 buffer_load_dwordx4 a[80:83], v245, s[8:11], s7 offen offset:2048
 MM v[176:179], a[240:243], a[124:127], v[176:179]
 MM v[172:175], a[236:239], a[124:127], v[172:175]
 MM v[168:171], a[232:235], a[124:127], v[168:171]
 s_waitcnt lgkmcnt(0)
 s_waitcnt vmcnt(36)
 MM v[0:3], a[208:211], a[128:131], v[0:3]
 buffer_load_dwordx4 a[84:87], v245, s[8:11], s7 offen offset:3072
 ds_read_b128 a[232:235], v252 offset:30720
 MM v[4:7], a[212:215], a[128:131], v[4:7]
 ds_read_b128 a[236:239], v251 offset:30720
 v_fma_mix_f32 v232, v216, v192, 0 op_sel:[0,0,0] op_sel_hi:[1,0,0]
 v_fma_mix_f32 v233, v216, v192, 0 op_sel:[1,0,0] op_sel_hi:[1,0,0]
 MM v[8:11], a[216:219], a[128:131], v[8:11]
 ds_read_b128 a[240:243], v252 offset:32768
 ds_read_b128 a[244:247], v251 offset:32768
 s_add_u32 s7, s7, 0x1000
 MM v[12:15], a[220:223], a[128:131], v[12:15]
 buffer_load_dwordx4 a[88:91], v245, s[8:11], s7 offen offset:0
 v_fma_mix_f32 v234, v217, v192, 0 op_sel:[0,0,0] op_sel_hi:[1,0,0]
 MM v[16:19], a[224:227], a[128:131], v[16:19]
 ds_read_b128 a[248:251], v252 offset:34816
 v_fma_mix_f32 v235, v217, v192, 0 op_sel:[1,0,0] op_sel_hi:[1,0,0]
 v_fma_mix_f32 v236, v218, v192, 0 op_sel:[0,0,0] op_sel_hi:[1,0,0]
 MM v[20:23], a[228:231], a[128:131], v[20:23]
 ds_read_b128 a[252:255], v251 offset:34816
 s_add_u32 m0, s44, 76800
 s_add_u32 s45, s40, 360448
 MM v[44:47], a[228:231], a[132:135], v[44:47]
 v_fma_mix_f32 v237, v218, v192, 0 op_sel:[1,0,0] op_sel_hi:[1,0,0]
 v_fma_mix_f32 v238, v219, v192, 0 op_sel:[0,0,0] op_sel_hi:[1,0,0]
 v_fma_mix_f32 v239, v219, v192, 0 op_sel:[1,0,0] op_sel_hi:[1,0,0]
 MM v[40:43], a[224:227], a[132:135], v[40:43]
 buffer_load_dwordx4 v245, s[16:19], s45 offen sc1 lds
 s_waitcnt vmcnt(35)
 MM v[36:39], a[220:223], a[132:135], v[36:39]
 ds_read_b128 v[216:219], v249 offset:1024
 v_fma_mix_f32 v232, v220, v193, v232 op_sel:[0,0,0] op_sel_hi:[1,0,0]
 v_fma_mix_f32 v233, v220, v193, v233 op_sel:[1,0,0] op_sel_hi:[1,0,0]
 MM v[32:35], a[216:219], a[132:135], v[32:35]
 v_fma_mix_f32 v234, v221, v193, v234 op_sel:[0,0,0] op_sel_hi:[1,0,0]
 v_fma_mix_f32 v235, v221, v193, v235 op_sel:[1,0,0] op_sel_hi:[1,0,0]
 v_fma_mix_f32 v236, v222, v193, v236 op_sel:[0,0,0] op_sel_hi:[1,0,0]
 MM v[28:31], a[212:215], a[132:135], v[28:31]
 buffer_load_dwordx4 a[92:95], v245, s[8:11], s7 offen offset:1024
 v_fma_mix_f32 v237, v222, v193, v237 op_sel:[1,0,0] op_sel_hi:[1,0,0]
 MM v[24:27], a[208:211], a[132:135], v[24:27]
 v_fma_mix_f32 v238, v223, v193, v238 op_sel:[0,0,0] op_sel_hi:[1,0,0]
 v_fma_mix_f32 v239, v223, v193, v239 op_sel:[1,0,0] op_sel_hi:[1,0,0]
 s_waitcnt vmcnt(35)
 MM v[48:51], a[208:211], a[0:3], v[48:51]
 ds_read_b128 v[220:223], v250 offset:3072
 v_fma_mix_f32 v232, v224, v194, v232 op_sel:[0,0,0] op_sel_hi:[1,0,0]
 v_fma_mix_f32 v233, v224, v194, v233 op_sel:[1,0,0] op_sel_hi:[1,0,0]
 MM v[52:55], a[212:215], a[0:3], v[52:55]
 buffer_load_dwordx4 a[96:99], v245, s[8:11], s7 offen offset:2048
 v_fma_mix_f32 v234, v225, v194, v234 op_sel:[0,0,0] op_sel_hi:[1,0,0]
 MM v[56:59], a[216:219], a[0:3], v[56:59]
 v_fma_mix_f32 v235, v225, v194, v235 op_sel:[1,0,0] op_sel_hi:[1,0,0]
 v_fma_mix_f32 v236, v226, v194, v236 op_sel:[0,0,0] op_sel_hi:[1,0,0]
 s_add_u32 m0, s36, -1024
 MM v[60:63], a[220:223], a[0:3], v[60:63]
 s_add_u32 s34, s40, 458752
 v_fma_mix_f32 v237, v226, v194, v237 op_sel:[1,0,0] op_sel_hi:[1,0,0]
 v_fma_mix_f32 v238, v227, v194, v238 op_sel:[0,0,0] op_sel_hi:[1,0,0]
 MM v[64:67], a[224:227], a[0:3], v[64:67]
 buffer_load_dwordx4 v245, s[16:19], s34 offen offset:1024 sc1 lds
 v_fma_mix_f32 v239, v227, v194, v239 op_sel:[1,0,0] op_sel_hi:[1,0,0]
 MM v[68:71], a[228:231], a[0:3], v[68:71]
 ds_read_b128 v[224:227], v250 offset:4096
 v_fma_mix_f32 v232, v228, v195, v232 op_sel:[0,0,0] op_sel_hi:[1,0,0]
 v_fma_mix_f32 v233, v228, v195, v233 op_sel:[1,0,0] op_sel_hi:[1,0,0]
 MM v[92:95], a[228:231], a[4:7], v[92:95]
 v_fma_mix_f32 v234, v229, v195, v234 op_sel:[0,0,0] op_sel_hi:[1,0,0]
 v_fma_mix_f32 v235, v229, v195, v235 op_sel:[1,0,0] op_sel_hi:[1,0,0]
 v_fma_mix_f32 v236, v230, v195, v236 op_sel:[0,0,0] op_sel_hi:[1,0,0]
 MM v[88:91], a[224:227], a[4:7], v[88:91]
 buffer_load_dwordx4 v245, s[16:19], s34 offen offset:2048 sc1 lds
 v_fma_mix_f32 v237, v230, v195, v237 op_sel:[1,0,0] op_sel_hi:[1,0,0]
 MM v[84:87], a[220:223], a[4:7], v[84:87]
 v_fma_mix_f32 v238, v231, v195, v238 op_sel:[0,0,0] op_sel_hi:[1,0,0]
 v_fma_mix_f32 v239, v231, v195, v239 op_sel:[1,0,0] op_sel_hi:[1,0,0]
 CB v240, v232, v233
 MM v[80:83], a[216:219], a[4:7], v[80:83]
 ds_read_b128 v[228:231], v250 offset:5120
 CB v241, v234, v235
 CB v242, v236, v237
 MM v[76:79], a[212:215], a[4:7], v[76:79]
 CB v243, v238, v239
 v_add_u32 v255, 49152, v255
 MM v[72:75], a[208:211], a[4:7], v[72:75]
 buffer_load_dwordx4 v245, s[16:19], s34 offen offset:3072 sc1 lds
 s_waitcnt vmcnt(37)
 MM v[96:99], a[208:211], a[8:11], v[96:99]
 ds_write_b128 v255, v[240:243] offset:0
 s_waitcnt lgkmcnt(3)
 v_fma_mix_f32 v232, v216, v196, 0 op_sel:[0,0,0] op_sel_hi:[1,0,0]
 MM v[100:103], a[212:215], a[8:11], v[100:103]
 v_fma_mix_f32 v233, v216, v196, 0 op_sel:[1,0,0] op_sel_hi:[1,0,0]
 v_fma_mix_f32 v234, v217, v196, 0 op_sel:[0,0,0] op_sel_hi:[1,0,0]
 v_fma_mix_f32 v235, v217, v196, 0 op_sel:[1,0,0] op_sel_hi:[1,0,0]
 MM v[104:107], a[216:219], a[8:11], v[104:107]
 buffer_load_dwordx4 a[100:103], v245, s[8:11], s7 offen offset:3072
 v_fma_mix_f32 v236, v218, v196, 0 op_sel:[0,0,0] op_sel_hi:[1,0,0]
 MM v[108:111], a[220:223], a[8:11], v[108:111]
 v_fma_mix_f32 v237, v218, v196, 0 op_sel:[1,0,0] op_sel_hi:[1,0,0]
 v_fma_mix_f32 v238, v219, v196, 0 op_sel:[0,0,0] op_sel_hi:[1,0,0]
 s_add_u32 s7, s7, 0x1000
 MM v[112:115], a[224:227], a[8:11], v[112:115]
 v_fma_mix_f32 v239, v219, v196, 0 op_sel:[1,0,0] op_sel_hi:[1,0,0]
 s_waitcnt vmcnt(34)
 ds_read_b128 v[216:219], v249 offset:2048
 MM v[116:119], a[228:231], a[8:11], v[116:119]
 buffer_load_dwordx4 a[104:107], v245, s[8:11], s7 offen offset:0
 v_fma_mix_f32 v232, v220, v197, v232 op_sel:[0,0,0] op_sel_hi:[1,0,0]
 MM v[140:143], a[228:231], a[12:15], v[140:143]
 v_fma_mix_f32 v233, v220, v197, v233 op_sel:[1,0,0] op_sel_hi:[1,0,0]
 v_fma_mix_f32 v234, v221, v197, v234 op_sel:[0,0,0] op_sel_hi:[1,0,0]
 v_fma_mix_f32 v235, v221, v197, v235 op_sel:[1,0,0] op_sel_hi:[1,0,0]
 MM v[136:139], a[224:227], a[12:15], v[136:139]
 s_add_u32 m0, s44, 77824
 s_add_u32 s45, s40, 364544
 v_fma_mix_f32 v236, v222, v197, v236 op_sel:[0,0,0] op_sel_hi:[1,0,0]
 MM v[132:135], a[220:223], a[12:15], v[132:135]
 buffer_load_dwordx4 v245, s[16:19], s45 offen sc1 lds
 v_fma_mix_f32 v237, v222, v197, v237 op_sel:[1,0,0] op_sel_hi:[1,0,0]
 MM v[128:131], a[216:219], a[12:15], v[128:131]
 v_fma_mix_f32 v238, v223, v197, v238 op_sel:[0,0,0] op_sel_hi:[1,0,0]
 v_fma_mix_f32 v239, v223, v197, v239 op_sel:[1,0,0] op_sel_hi:[1,0,0]
 MM v[124:127], a[212:215], a[12:15], v[124:127]
 ds_read_b128 v[220:223], v250 offset:6144
 s_waitcnt lgkmcnt(3)
 v_fma_mix_f32 v232, v224, v198, v232 op_sel:[0,0,0] op_sel_hi:[1,0,0]
 MM v[120:123], a[208:211], a[12:15], v[120:123]
 v_fma_mix_f32 v233, v224, v198, v233 op_sel:[1,0,0] op_sel_hi:[1,0,0]
 v_fma_mix_f32 v234, v225, v198, v234 op_sel:[0,0,0] op_sel_hi:[1,0,0]
 s_waitcnt vmcnt(35)
 MM v[144:147], a[208:211], a[16:19], v[144:147]
 buffer_load_dwordx4 a[108:111], v245, s[8:11], s7 offen offset:1024
 v_fma_mix_f32 v235, v225, v198, v235 op_sel:[1,0,0] op_sel_hi:[1,0,0]
 MM v[148:151], a[212:215], a[16:19], v[148:151]
 v_fma_mix_f32 v236, v226, v198, v236 op_sel:[0,0,0] op_sel_hi:[1,0,0]
 s_add_u32 m0, s36, 2048
 s_add_u32 s34, s40, 102400
 MM v[152:155], a[216:219], a[16:19], v[152:155]
 v_fma_mix_f32 v237, v226, v198, v237 op_sel:[1,0,0] op_sel_hi:[1,0,0]
 v_fma_mix_f32 v238, v227, v198, v238 op_sel:[0,0,0] op_sel_hi:[1,0,0]
 v_fma_mix_f32 v239, v227, v198, v239 op_sel:[1,0,0] op_sel_hi:[1,0,0]
 MM v[156:159], a[220:223], a[16:19], v[156:159]
 buffer_load_dwordx4 v245, s[12:15], s34 offen offset:1024 sc1 lds
 ds_read_b128 v[224:227], v250 offset:7168
 MM v[160:163], a[224:227], a[16:19], v[160:163]
 v_fma_mix_f32 v232, v228, v199, v232 op_sel:[0,0,0] op_sel_hi:[1,0,0]
 v_fma_mix_f32 v233, v228, v199, v233 op_sel:[1,0,0] op_sel_hi:[1,0,0]
 v_fma_mix_f32 v234, v229, v199, v234 op_sel:[0,0,0] op_sel_hi:[1,0,0]
 MM v[164:167], a[228:231], a[16:19], v[164:167]
 v_fma_mix_f32 v235, v229, v199, v235 op_sel:[1,0,0] op_sel_hi:[1,0,0]
 v_fma_mix_f32 v236, v230, v199, v236 op_sel:[0,0,0] op_sel_hi:[1,0,0]
 v_fma_mix_f32 v237, v230, v199, v237 op_sel:[1,0,0] op_sel_hi:[1,0,0]
 MM v[188:191], a[228:231], a[20:23], v[188:191]
 buffer_load_dwordx4 v245, s[12:15], s34 offen offset:2048 sc1 lds
 v_fma_mix_f32 v238, v231, v199, v238 op_sel:[0,0,0] op_sel_hi:[1,0,0]
 MM v[184:187], a[224:227], a[20:23], v[184:187]
 v_fma_mix_f32 v239, v231, v199, v239 op_sel:[1,0,0] op_sel_hi:[1,0,0]
 CB v240, v232, v233
 CB v241, v234, v235
 MM v[180:183], a[220:223], a[20:23], v[180:183]
 ds_read_b128 v[228:231], v250 offset:8192
 CB v242, v236, v237
 CB v243, v238, v239
 MM v[176:179], a[216:219], a[20:23], v[176:179]
 buffer_load_dwordx4 v245, s[12:15], s34 offen offset:3072 sc1 lds
 ds_write_b128 v255, v[240:243] offset:1024
 MM v[172:175], a[212:215], a[20:23], v[172:175]
 s_waitcnt lgkmcnt(3)
 v_fma_mix_f32 v232, v216, v200, 0 op_sel:[0,0,0] op_sel_hi:[1,0,0]
 v_fma_mix_f32 v233, v216, v200, 0 op_sel:[1,0,0] op_sel_hi:[1,0,0]
 MM v[168:171], a[208:211], a[20:23], v[168:171]
 v_fma_mix_f32 v234, v217, v200, 0 op_sel:[0,0,0] op_sel_hi:[1,0,0]
 s_waitcnt vmcnt(37)
 MM v[0:3], a[232:235], a[24:27], v[0:3]
 ds_read_b128 a[208:211], v251 offset:36864
 v_fma_mix_f32 v235, v217, v200, 0 op_sel:[1,0,0] op_sel_hi:[1,0,0]
 v_fma_mix_f32 v236, v218, v200, 0 op_sel:[0,0,0] op_sel_hi:[1,0,0]
 MM v[4:7], a[236:239], a[24:27], v[4:7]
 buffer_load_dwordx4 a[112:115], v245, s[8:11], s7 offen offset:2048
 ds_read_b128 a[212:215], v252 offset:36864
 MM v[8:11], a[240:243], a[24:27], v[8:11]
 ds_read_b128 a[216:219], v251 offset:38912
 v_fma_mix_f32 v237, v218, v200, 0 op_sel:[1,0,0] op_sel_hi:[1,0,0]
 v_fma_mix_f32 v238, v219, v200, 0 op_sel:[0,0,0] op_sel_hi:[1,0,0]
 MM v[12:15], a[244:247], a[24:27], v[12:15]
 ds_read_b128 a[220:223], v252 offset:38912
 ds_read_b128 a[224:227], v251 offset:40960
 v_fma_mix_f32 v239, v219, v200, 0 op_sel:[1,0,0] op_sel_hi:[1,0,0]
 MM v[16:19], a[248:251], a[24:27], v[16:19]
 buffer_load_dwordx4 a[116:119], v245, s[8:11], s7 offen offset:3072
 ds_read_b128 a[228:231], v252 offset:40960
 MM v[20:23], a[252:255], a[24:27], v[20:23]
 s_waitcnt vmcnt(34)
 ds_read_b128 v[216:219], v249 offset:3072
 s_add_u32 s7, s7, 0x1000
 MM v[44:47], a[252:255], a[28:31], v[44:47]
 v_fma_mix_f32 v232, v220, v201, v232 op_sel:[0,0,0] op_sel_hi:[1,0,0]
 v_fma_mix_f32 v233, v220, v201, v233 op_sel:[1,0,0] op_sel_hi:[1,0,0]
 v_fma_mix_f32 v234, v221, v201, v234 op_sel:[0,0,0] op_sel_hi:[1,0,0]
 MM v[40:43], a[248:251], a[28:31], v[40:43]
 buffer_load_dwordx4 a[120:123], v245, s[8:11], s7 offen offset:0
 v_fma_mix_f32 v235, v221, v201, v235 op_sel:[1,0,0] op_sel_hi:[1,0,0]
 MM v[36:39], a[244:247], a[28:31], v[36:39]
 v_fma_mix_f32 v236, v222, v201, v236 op_sel:[0,0,0] op_sel_hi:[1,0,0]
 v_fma_mix_f32 v237, v222, v201, v237 op_sel:[1,0,0] op_sel_hi:[1,0,0]
 v_fma_mix_f32 v238, v223, v201, v238 op_sel:[0,0,0] op_sel_hi:[1,0,0]
 MM v[32:35], a[240:243], a[28:31], v[32:35]
 s_add_u32 m0, s44, 78848
 s_add_u32 s45, s40, 491520
 v_fma_mix_f32 v239, v223, v201, v239 op_sel:[1,0,0] op_sel_hi:[1,0,0]
 MM v[28:31], a[236:239], a[28:31], v[28:31]
 buffer_load_dwordx4 v245, s[16:19], s45 offen sc1 lds
 ds_read_b128 v[220:223], v250 offset:9216
 MM v[24:27], a[232:235], a[28:31], v[24:27]
 s_waitcnt lgkmcnt(9)
 v_fma_mix_f32 v232, v224, v202, v232 op_sel:[0,0,0] op_sel_hi:[1,0,0]
 MM v[48:51], a[232:235], a[32:35], v[48:51]
 s_add_u32 m0, s36, 5120
 s_add_u32 s34, s40, 229376
 v_fma_mix_f32 v233, v224, v202, v233 op_sel:[1,0,0] op_sel_hi:[1,0,0]
 MM v[52:55], a[236:239], a[32:35], v[52:55]
 v_fma_mix_f32 v234, v225, v202, v234 op_sel:[0,0,0] op_sel_hi:[1,0,0]
 v_fma_mix_f32 v235, v225, v202, v235 op_sel:[1,0,0] op_sel_hi:[1,0,0]
 v_fma_mix_f32 v236, v226, v202, v236 op_sel:[0,0,0] op_sel_hi:[1,0,0]
 MM v[56:59], a[240:243], a[32:35], v[56:59]
 buffer_load_dwordx4 v245, s[8:11], s34 offen offset:1024 sc1 lds
 v_fma_mix_f32 v237, v226, v202, v237 op_sel:[1,0,0] op_sel_hi:[1,0,0]
 MM v[60:63], a[244:247], a[32:35], v[60:63]
 v_fma_mix_f32 v238, v227, v202, v238 op_sel:[0,0,0] op_sel_hi:[1,0,0]
 v_fma_mix_f32 v239, v227, v202, v239 op_sel:[1,0,0] op_sel_hi:[1,0,0]
 v_fma_mix_f32 v232, v228, v203, v232 op_sel:[0,0,0] op_sel_hi:[1,0,0]
 MM v[64:67], a[248:251], a[32:35], v[64:67]
 ds_read_b128 v[224:227], v250 offset:10240
 v_fma_mix_f32 v233, v228, v203, v233 op_sel:[1,0,0] op_sel_hi:[1,0,0]
 v_fma_mix_f32 v234, v229, v203, v234 op_sel:[0,0,0] op_sel_hi:[1,0,0]
 MM v[68:71], a[252:255], a[32:35], v[68:71]
 buffer_load_dwordx4 v245, s[8:11], s34 offen offset:2048 sc1 lds
 v_fma_mix_f32 v235, v229, v203, v235 op_sel:[1,0,0] op_sel_hi:[1,0,0]
 MM v[92:95], a[252:255], a[36:39], v[92:95]
 v_fma_mix_f32 v236, v230, v203, v236 op_sel:[0,0,0] op_sel_hi:[1,0,0]
 v_fma_mix_f32 v237, v230, v203, v237 op_sel:[1,0,0] op_sel_hi:[1,0,0]
 v_fma_mix_f32 v238, v231, v203, v238 op_sel:[0,0,0] op_sel_hi:[1,0,0]
 MM v[88:91], a[248:251], a[36:39], v[88:91]
 v_fma_mix_f32 v239, v231, v203, v239 op_sel:[1,0,0] op_sel_hi:[1,0,0]
 CB v240, v232, v233
 CB v241, v234, v235
 MM v[84:87], a[244:247], a[36:39], v[84:87]
 buffer_load_dwordx4 v245, s[8:11], s34 offen offset:3072 sc1 lds
 ds_read_b128 v[228:231], v250 offset:11264
 MM v[80:83], a[240:243], a[36:39], v[80:83]
 CB v242, v236, v237
 CB v243, v238, v239
 MM v[76:79], a[236:239], a[36:39], v[76:79]
 ds_write_b128 v255, v[240:243] offset:2048
 s_waitcnt lgkmcnt(3)
 v_fma_mix_f32 v232, v216, v204, 0 op_sel:[0,0,0] op_sel_hi:[1,0,0]
 MM v[72:75], a[232:235], a[36:39], v[72:75]
 v_fma_mix_f32 v233, v216, v204, 0 op_sel:[1,0,0] op_sel_hi:[1,0,0]
 s_waitcnt vmcnt(36)
 MM v[96:99], a[232:235], a[40:43], v[96:99]
 buffer_load_dwordx4 a[124:127], v245, s[8:11], s7 offen offset:1024
 MM v[100:103], a[236:239], a[40:43], v[100:103]
 v_fma_mix_f32 v234, v217, v204, 0 op_sel:[0,0,0] op_sel_hi:[1,0,0]
 v_fma_mix_f32 v235, v217, v204, 0 op_sel:[1,0,0] op_sel_hi:[1,0,0]
 v_fma_mix_f32 v236, v218, v204, 0 op_sel:[0,0,0] op_sel_hi:[1,0,0]
 MM v[104:107], a[240:243], a[40:43], v[104:107]
 v_fma_mix_f32 v237, v218, v204, 0 op_sel:[1,0,0] op_sel_hi:[1,0,0]
 v_fma_mix_f32 v238, v219, v204, 0 op_sel:[0,0,0] op_sel_hi:[1,0,0]
 MM v[108:111], a[244:247], a[40:43], v[108:111]
 buffer_load_dwordx4 a[128:131], v245, s[8:11], s7 offen offset:2048
 MM v[112:115], a[248:251], a[40:43], v[112:115]
 v_fma_mix_f32 v239, v219, v204, 0 op_sel:[1,0,0] op_sel_hi:[1,0,0]
 s_waitcnt vmcnt(32)
 ds_read_b128 v[216:219], v249 offset:4096
 MM v[116:119], a[252:255], a[40:43], v[116:119]
 v_fma_mix_f32 v232, v220, v205, v232 op_sel:[0,0,0] op_sel_hi:[1,0,0]
 v_fma_mix_f32 v233, v220, v205, v233 op_sel:[1,0,0] op_sel_hi:[1,0,0]
 MM v[140:143], a[252:255], a[44:47], v[140:143]
 v_fma_mix_f32 v234, v221, v205, v234 op_sel:[0,0,0] op_sel_hi:[1,0,0]
 v_fma_mix_f32 v235, v221, v205, v235 op_sel:[1,0,0] op_sel_hi:[1,0,0]
 MM v[136:139], a[248:251], a[44:47], v[136:139]
 buffer_load_dwordx4 a[132:135], v245, s[8:11], s7 offen offset:3072
 MM v[132:135], a[244:247], a[44:47], v[132:135]
 v_fma_mix_f32 v236, v222, v205, v236 op_sel:[0,0,0] op_sel_hi:[1,0,0]
 v_fma_mix_f32 v237, v222, v205, v237 op_sel:[1,0,0] op_sel_hi:[1,0,0]
 MM v[128:131], a[240:243], a[44:47], v[128:131]
 s_add_u32 s7, s7, 0x1000
 v_fma_mix_f32 v238, v223, v205, v238 op_sel:[0,0,0] op_sel_hi:[1,0,0]
 MM v[124:127], a[236:239], a[44:47], v[124:127]
 v_fma_mix_f32 v239, v223, v205, v239 op_sel:[1,0,0] op_sel_hi:[1,0,0]
 MM v[120:123], a[232:235], a[44:47], v[120:123]
 ds_read_b128 v[220:223], v250 offset:12288
 MM v[144:147], a[232:235], a[48:51], v[144:147]
 buffer_load_dwordx4 a[0:3], v245, s[8:11], s7 offen offset:0
 s_waitcnt lgkmcnt(3)
 MM v[148:151], a[236:239], a[48:51], v[148:151]
 s_add_u32 m0, s36, 8192
 s_add_u32 s34, s40, 233472
 v_fma_mix_f32 v232, v224, v206, v232 op_sel:[0,0,0] op_sel_hi:[1,0,0]
 MM v[152:155], a[240:243], a[48:51], v[152:155]
 v_fma_mix_f32 v233, v224, v206, v233 op_sel:[1,0,0] op_sel_hi:[1,0,0]
 v_fma_mix_f32 v234, v225, v206, v234 op_sel:[0,0,0] op_sel_hi:[1,0,0]
 v_fma_mix_f32 v235, v225, v206, v235 op_sel:[1,0,0] op_sel_hi:[1,0,0]
 MM v[156:159], a[244:247], a[48:51], v[156:159]
 buffer_load_dwordx4 v245, s[8:11], s34 offen offset:1024 sc1 lds
 MM v[160:163], a[248:251], a[48:51], v[160:163]
 v_fma_mix_f32 v236, v226, v206, v236 op_sel:[0,0,0] op_sel_hi:[1,0,0]
 v_fma_mix_f32 v237, v226, v206, v237 op_sel:[1,0,0] op_sel_hi:[1,0,0]
 v_fma_mix_f32 v238, v227, v206, v238 op_sel:[0,0,0] op_sel_hi:[1,0,0]
 MM v[164:167], a[252:255], a[48:51], v[164:167]
 v_fma_mix_f32 v239, v227, v206, v239 op_sel:[1,0,0] op_sel_hi:[1,0,0]
 v_fma_mix_f32 v232, v228, v207, v232 op_sel:[0,0,0] op_sel_hi:[1,0,0]
 MM v[188:191], a[252:255], a[52:55], v[188:191]
 buffer_load_dwordx4 v245, s[8:11], s34 offen offset:2048 sc1 lds
 MM v[184:187], a[248:251], a[52:55], v[184:187]
 ds_read_b128 v[224:227], v250 offset:13312
 v_fma_mix_f32 v233, v228, v207, v233 op_sel:[1,0,0] op_sel_hi:[1,0,0]
 v_fma_mix_f32 v234, v229, v207, v234 op_sel:[0,0,0] op_sel_hi:[1,0,0]
 MM v[180:183], a[244:247], a[52:55], v[180:183]
 v_fma_mix_f32 v235, v229, v207, v235 op_sel:[1,0,0] op_sel_hi:[1,0,0]
 v_fma_mix_f32 v236, v230, v207, v236 op_sel:[0,0,0] op_sel_hi:[1,0,0]
 MM v[176:179], a[240:243], a[52:55], v[176:179]
 v_fma_mix_f32 v237, v230, v207, v237 op_sel:[1,0,0] op_sel_hi:[1,0,0]
 v_fma_mix_f32 v238, v231, v207, v238 op_sel:[0,0,0] op_sel_hi:[1,0,0]
 MM v[172:175], a[236:239], a[52:55], v[172:175]
 buffer_load_dwordx4 v245, s[8:11], s34 offen offset:3072 sc1 lds
 MM v[168:171], a[232:235], a[52:55], v[168:171]
 s_waitcnt vmcnt(35)
 MM v[0:3], a[208:211], a[56:59], v[0:3]
 ds_read_b128 a[232:235], v252 offset:43008
 v_fma_mix_f32 v239, v231, v207, v239 op_sel:[1,0,0] op_sel_hi:[1,0,0]
 CB v240, v232, v233
 MM v[4:7], a[212:215], a[56:59], v[4:7]
 ds_read_b128 a[236:239], v251 offset:43008
 ds_read_b128 v[228:231], v250 offset:14336
 ds_read_b128 a[240:243], v252 offset:45056
 MM v[8:11], a[216:219], a[56:59], v[8:11]
 buffer_load_dwordx4 a[4:7], v245, s[8:11], s7 offen offset:1024
 ds_read_b128 a[244:247], v251 offset:45056
 MM v[12:15], a[220:223], a[56:59], v[12:15]
 ds_read_b128 a[248:251], v252 offset:47104
 CB v241, v234, v235
 CB v242, v236, v237
 MM v[16:19], a[224:227], a[56:59], v[16:19]
 ds_read_b128 a[252:255], v251 offset:47104
 CB v243, v238, v239
 MM v[20:23], a[228:231], a[56:59], v[20:23]
 buffer_load_dwordx4 a[8:11], v245, s[8:11], s7 offen offset:2048
 ds_write_b128 v255, v[240:243] offset:3072
 MM v[44:47], a[228:231], a[60:63], v[44:47]
 s_waitcnt lgkmcnt(9)
 v_fma_mix_f32 v232, v216, v208, 0 op_sel:[0,0,0] op_sel_hi:[1,0,0]
 v_fma_mix_f32 v233, v216, v208, 0 op_sel:[1,0,0] op_sel_hi:[1,0,0]
 MM v[40:43], a[224:227], a[60:63], v[40:43]
 v_fma_mix_f32 v234, v217, v208, 0 op_sel:[0,0,0] op_sel_hi:[1,0,0]
 v_fma_mix_f32 v235, v217, v208, 0 op_sel:[1,0,0] op_sel_hi:[1,0,0]
 v_fma_mix_f32 v236, v218, v208, 0 op_sel:[0,0,0] op_sel_hi:[1,0,0]
 MM v[36:39], a[220:223], a[60:63], v[36:39]
 buffer_load_dwordx4 a[12:15], v245, s[8:11], s7 offen offset:3072
 MM v[32:35], a[216:219], a[60:63], v[32:35]
 v_fma_mix_f32 v237, v218, v208, 0 op_sel:[1,0,0] op_sel_hi:[1,0,0]
 v_fma_mix_f32 v238, v219, v208, 0 op_sel:[0,0,0] op_sel_hi:[1,0,0]
 v_fma_mix_f32 v239, v219, v208, 0 op_sel:[1,0,0] op_sel_hi:[1,0,0]
 MM v[28:31], a[212:215], a[60:63], v[28:31]
 s_add_u32 s7, s7, 0x1000
 s_waitcnt vmcnt(24)
 MM v[24:27], a[208:211], a[60:63], v[24:27]
 ds_read_b128 v[216:219], v249 offset:5120
 MM v[48:51], a[208:211], a[64:67], v[48:51]
 buffer_load_dwordx4 a[16:19], v245, s[8:11], s7 offen offset:0
 v_fma_mix_f32 v232, v220, v209, v232 op_sel:[0,0,0] op_sel_hi:[1,0,0]
 MM v[52:55], a[212:215], a[64:67], v[52:55]
 v_fma_mix_f32 v233, v220, v209, v233 op_sel:[1,0,0] op_sel_hi:[1,0,0]
 v_fma_mix_f32 v234, v221, v209, v234 op_sel:[0,0,0] op_sel_hi:[1,0,0]
 v_fma_mix_f32 v235, v221, v209, v235 op_sel:[1,0,0] op_sel_hi:[1,0,0]
 MM v[56:59], a[216:219], a[64:67], v[56:59]
 v_fma_mix_f32 v236, v222, v209, v236 op_sel:[0,0,0] op_sel_hi:[1,0,0]
 v_fma_mix_f32 v237, v222, v209, v237 op_sel:[1,0,0] op_sel_hi:[1,0,0]
 MM v[60:63], a[220:223], a[64:67], v[60:63]
 buffer_load_dwordx4 a[20:23], v245, s[8:11], s7 offen offset:1024
 MM v[64:67], a[224:227], a[64:67], v[64:67]
 v_fma_mix_f32 v238, v223, v209, v238 op_sel:[0,0,0] op_sel_hi:[1,0,0]
 v_fma_mix_f32 v239, v223, v209, v239 op_sel:[1,0,0] op_sel_hi:[1,0,0]
 MM v[68:71], a[228:231], a[64:67], v[68:71]
 ds_read_b128 v[220:223], v250 offset:0
 s_waitcnt lgkmcnt(7)
 MM v[92:95], a[228:231], a[68:71], v[92:95]
 v_fma_mix_f32 v232, v224, v210, v232 op_sel:[0,0,0] op_sel_hi:[1,0,0]
 v_fma_mix_f32 v233, v224, v210, v233 op_sel:[1,0,0] op_sel_hi:[1,0,0]
 MM v[88:91], a[224:227], a[68:71], v[88:91]
 buffer_load_dwordx4 a[24:27], v245, s[8:11], s7 offen offset:2048
 MM v[84:87], a[220:223], a[68:71], v[84:87]
 v_fma_mix_f32 v234, v225, v210, v234 op_sel:[0,0,0] op_sel_hi:[1,0,0]
 v_fma_mix_f32 v235, v225, v210, v235 op_sel:[1,0,0] op_sel_hi:[1,0,0]
 MM v[80:83], a[216:219], a[68:71], v[80:83]
 v_fma_mix_f32 v236, v226, v210, v236 op_sel:[0,0,0] op_sel_hi:[1,0,0]
 s_add_u32 m0, s36, 11264
 MM v[76:79], a[212:215], a[68:71], v[76:79]
 s_add_u32 s34, s40, 360448
 v_fma_mix_f32 v237, v226, v210, v237 op_sel:[1,0,0] op_sel_hi:[1,0,0]
 MM v[72:75], a[208:211], a[68:71], v[72:75]
 buffer_load_dwordx4 v245, s[16:19], s34 offen offset:1024 sc1 lds
 MM v[96:99], a[208:211], a[72:75], v[96:99]
 v_fma_mix_f32 v238, v227, v210, v238 op_sel:[0,0,0] op_sel_hi:[1,0,0]
 v_fma_mix_f32 v239, v227, v210, v239 op_sel:[1,0,0] op_sel_hi:[1,0,0]
 v_fma_mix_f32 v232, v228, v211, v232 op_sel:[0,0,0] op_sel_hi:[1,0,0]
 MM v[100:103], a[212:215], a[72:75], v[100:103]
 ds_read_b128 v[224:227], v250 offset:1024
 v_fma_mix_f32 v233, v228, v211, v233 op_sel:[1,0,0] op_sel_hi:[1,0,0]
 MM v[104:107], a[216:219], a[72:75], v[104:107]
 v_fma_mix_f32 v234, v229, v211, v234 op_sel:[0,0,0] op_sel_hi:[1,0,0]
 v_fma_mix_f32 v235, v229, v211, v235 op_sel:[1,0,0] op_sel_hi:[1,0,0]
 MM v[108:111], a[220:223], a[72:75], v[108:111]
 buffer_load_dwordx4 v245, s[16:19], s34 offen offset:2048 sc1 lds
 MM v[112:115], a[224:227], a[72:75], v[112:115]
 v_fma_mix_f32 v236, v230, v211, v236 op_sel:[0,0,0] op_sel_hi:[1,0,0]
 v_fma_mix_f32 v237, v230, v211, v237 op_sel:[1,0,0] op_sel_hi:[1,0,0]
 v_fma_mix_f32 v238, v231, v211, v238 op_sel:[0,0,0] op_sel_hi:[1,0,0]
 MM v[116:119], a[228:231], a[72:75], v[116:119]
 v_fma_mix_f32 v239, v231, v211, v239 op_sel:[1,0,0] op_sel_hi:[1,0,0]
 CB v240, v232, v233
 MM v[140:143], a[228:231], a[76:79], v[140:143]
 ds_read_b128 v[228:231], v250 offset:2048
 CB v241, v234, v235
 MM v[136:139], a[224:227], a[76:79], v[136:139]
 buffer_load_dwordx4 v245, s[16:19], s34 offen offset:3072 sc1 lds
 MM v[132:135], a[220:223], a[76:79], v[132:135]
 CB v242, v236, v237
 CB v243, v238, v239
 MM v[128:131], a[216:219], a[76:79], v[128:131]
 ds_write_b128 v255, v[240:243] offset:4096
 s_waitcnt lgkmcnt(3)
 MM v[124:127], a[212:215], a[76:79], v[124:127]
 v_fma_mix_f32 v232, v216, v212, 0 op_sel:[0,0,0] op_sel_hi:[1,0,0]
 v_fma_mix_f32 v233, v216, v212, 0 op_sel:[1,0,0] op_sel_hi:[1,0,0]
 MM v[120:123], a[208:211], a[76:79], v[120:123]
 v_fma_mix_f32 v234, v217, v212, 0 op_sel:[0,0,0] op_sel_hi:[1,0,0]
 MM v[144:147], a[208:211], a[80:83], v[144:147]
 buffer_load_dwordx4 a[28:31], v245, s[8:11], s7 offen offset:3072
 MM v[148:151], a[212:215], a[80:83], v[148:151]
 s_add_u32 s7, s7, 0x1000
 v_fma_mix_f32 v235, v217, v212, 0 op_sel:[1,0,0] op_sel_hi:[1,0,0]
 MM v[152:155], a[216:219], a[80:83], v[152:155]
 v_fma_mix_f32 v236, v218, v212, 0 op_sel:[0,0,0] op_sel_hi:[1,0,0]
 v_fma_mix_f32 v237, v218, v212, 0 op_sel:[1,0,0] op_sel_hi:[1,0,0]
 MM v[156:159], a[220:223], a[80:83], v[156:159]
 buffer_load_dwordx4 a[32:35], v245, s[8:11], s7 offen offset:0
 MM v[160:163], a[224:227], a[80:83], v[160:163]
 v_fma_mix_f32 v238, v219, v212, 0 op_sel:[0,0,0] op_sel_hi:[1,0,0]
 v_fma_mix_f32 v239, v219, v212, 0 op_sel:[1,0,0] op_sel_hi:[1,0,0]
 s_waitcnt vmcnt(25)
 MM v[164:167], a[228:231], a[80:83], v[164:167]
 ds_read_b128 v[216:219], v249 offset:24576
 v_fma_mix_f32 v232, v220, v213, v232 op_sel:[0,0,0] op_sel_hi:[1,0,0]
 MM v[188:191], a[228:231], a[84:87], v[188:191]
 v_fma_mix_f32 v233, v220, v213, v233 op_sel:[1,0,0] op_sel_hi:[1,0,0]
 v_fma_mix_f32 v234, v221, v213, v234 op_sel:[0,0,0] op_sel_hi:[1,0,0]
 MM v[184:187], a[224:227], a[84:87], v[184:187]
 buffer_load_dwordx4 a[36:39], v245, s[8:11], s7 offen offset:1024
 MM v[180:183], a[220:223], a[84:87], v[180:183]
 v_fma_mix_f32 v235, v221, v213, v235 op_sel:[1,0,0] op_sel_hi:[1,0,0]
 v_fma_mix_f32 v236, v222, v213, v236 op_sel:[0,0,0] op_sel_hi:[1,0,0]
 MM v[176:179], a[216:219], a[84:87], v[176:179]
 v_fma_mix_f32 v237, v222, v213, v237 op_sel:[1,0,0] op_sel_hi:[1,0,0]
 v_fma_mix_f32 v238, v223, v213, v238 op_sel:[0,0,0] op_sel_hi:[1,0,0]
 MM v[172:175], a[212:215], a[84:87], v[172:175]
 v_fma_mix_f32 v239, v223, v213, v239 op_sel:[1,0,0] op_sel_hi:[1,0,0]
 MM v[168:171], a[208:211], a[84:87], v[168:171]
 MM v[0:3], a[232:235], a[88:91], v[0:3]
 buffer_load_dwordx4 a[40:43], v245, s[8:11], s7 offen offset:2048
 ds_read_b128 v[220:223], v250 offset:3072
 MM v[4:7], a[236:239], a[88:91], v[4:7]
 s_waitcnt lgkmcnt(3)
 v_fma_mix_f32 v232, v224, v214, v232 op_sel:[0,0,0] op_sel_hi:[1,0,0]
 v_fma_mix_f32 v233, v224, v214, v233 op_sel:[1,0,0] op_sel_hi:[1,0,0]
 MM v[8:11], a[240:243], a[88:91], v[8:11]
 buffer_load_dwordx4 a[44:47], v245, s[8:11], s7 offen offset:3072
 MM v[12:15], a[244:247], a[88:91], v[12:15]
 v_fma_mix_f32 v234, v225, v214, v234 op_sel:[0,0,0] op_sel_hi:[1,0,0]
 v_fma_mix_f32 v235, v225, v214, v235 op_sel:[1,0,0] op_sel_hi:[1,0,0]
 v_fma_mix_f32 v236, v226, v214, v236 op_sel:[0,0,0] op_sel_hi:[1,0,0]
 MM v[16:19], a[248:251], a[88:91], v[16:19]
 s_add_u32 m0, s36, -1024
 s_add_u32 s34, s40, 364544
 MM v[20:23], a[252:255], a[88:91], v[20:23]
 v_fma_mix_f32 v237, v226, v214, v237 op_sel:[1,0,0] op_sel_hi:[1,0,0]
 v_fma_mix_f32 v238, v227, v214, v238 op_sel:[0,0,0] op_sel_hi:[1,0,0]
 v_fma_mix_f32 v239, v227, v214, v239 op_sel:[1,0,0] op_sel_hi:[1,0,0]
 MM v[44:47], a[252:255], a[92:95], v[44:47]
 buffer_load_dwordx4 v245, s[16:19], s34 offen offset:1024 sc1 lds
 MM v[40:43], a[248:251], a[92:95], v[40:43]
 ds_read_b128 v[224:227], v250 offset:4096
 v_fma_mix_f32 v232, v228, v215, v232 op_sel:[0,0,0] op_sel_hi:[1,0,0]
 v_fma_mix_f32 v233, v228, v215, v233 op_sel:[1,0,0] op_sel_hi:[1,0,0]
 MM v[36:39], a[244:247], a[92:95], v[36:39]
 v_fma_mix_f32 v234, v229, v215, v234 op_sel:[0,0,0] op_sel_hi:[1,0,0]
 v_fma_mix_f32 v235, v229, v215, v235 op_sel:[1,0,0] op_sel_hi:[1,0,0]
 MM v[32:35], a[240:243], a[92:95], v[32:35]
 buffer_load_dwordx4 v245, s[16:19], s34 offen offset:2048 sc1 lds
 MM v[28:31], a[236:239], a[92:95], v[28:31]
 v_fma_mix_f32 v236, v230, v215, v236 op_sel:[0,0,0] op_sel_hi:[1,0,0]
 v_fma_mix_f32 v237, v230, v215, v237 op_sel:[1,0,0] op_sel_hi:[1,0,0]
 MM v[24:27], a[232:235], a[92:95], v[24:27]
 v_fma_mix_f32 v238, v231, v215, v238 op_sel:[0,0,0] op_sel_hi:[1,0,0]
 MM v[48:51], a[232:235], a[96:99], v[48:51]
 v_fma_mix_f32 v239, v231, v215, v239 op_sel:[1,0,0] op_sel_hi:[1,0,0]
 CB v240, v232, v233
 MM v[52:55], a[236:239], a[96:99], v[52:55]
 buffer_load_dwordx4 v245, s[16:19], s34 offen offset:3072 sc1 lds
 MM v[56:59], a[240:243], a[96:99], v[56:59]
 ds_read_b128 v[228:231], v250 offset:5120
 CB v241, v234, v235
 CB v242, v236, v237
 MM v[60:63], a[244:247], a[96:99], v[60:63]
 s_add_u32 s7, s7, 0x1000
 CB v243, v238, v239
 MM v[64:67], a[248:251], a[96:99], v[64:67]
 ds_write_b128 v255, v[240:243] offset:5120
 MM v[68:71], a[252:255], a[96:99], v[68:71]
 buffer_load_dwordx4 a[48:51], v245, s[8:11], s7 offen offset:0
 s_waitcnt lgkmcnt(0)
 s_barrier
 MM v[92:95], a[252:255], a[100:103], v[92:95]
 ds_read_b128 a[208:211], v253 offset:0
 MM v[88:91], a[248:251], a[100:103], v[88:91]
 ds_read_b128 a[212:215], v254 offset:0
 MM v[84:87], a[244:247], a[100:103], v[84:87]
 ds_read_b128 a[216:219], v253 offset:2048
 MM v[80:83], a[240:243], a[100:103], v[80:83]
 buffer_load_dwordx4 a[52:55], v245, s[8:11], s7 offen offset:1024
 MM v[76:79], a[236:239], a[100:103], v[76:79]
 ds_read_b128 a[220:223], v254 offset:2048
 MM v[72:75], a[232:235], a[100:103], v[72:75]
 ds_read_b128 a[224:227], v253 offset:4096
 MM v[96:99], a[232:235], a[104:107], v[96:99]
 ds_read_b128 a[228:231], v254 offset:4096
 MM v[100:103], a[236:239], a[104:107], v[100:103]
 buffer_load_dwordx4 a[56:59], v245, s[8:11], s7 offen offset:2048
 MM v[104:107], a[240:243], a[104:107], v[104:107]
 MM v[108:111], a[244:247], a[104:107], v[108:111]
 MM v[112:115], a[248:251], a[104:107], v[112:115]
 MM v[116:119], a[252:255], a[104:107], v[116:119]
 buffer_load_dwordx4 a[60:63], v245, s[8:11], s7 offen offset:3072
 MM v[140:143], a[252:255], a[108:111], v[140:143]
 MM v[136:139], a[248:251], a[108:111], v[136:139]
 s_add_u32 s7, s7, 0x1000
 MM v[132:135], a[244:247], a[108:111], v[132:135]
 MM v[128:131], a[240:243], a[108:111], v[128:131]
 buffer_load_dwordx4 a[64:67], v245, s[8:11], s7 offen offset:0
 MM v[124:127], a[236:239], a[108:111], v[124:127]
 MM v[120:123], a[232:235], a[108:111], v[120:123]
 s_waitcnt vmcnt(34)
 MM v[144:147], a[232:235], a[112:115], v[144:147]
 MM v[148:151], a[236:239], a[112:115], v[148:151]
 buffer_load_dwordx4 a[68:71], v245, s[8:11], s7 offen offset:1024
 MM v[152:155], a[240:243], a[112:115], v[152:155]
 MM v[156:159], a[244:247], a[112:115], v[156:159]
 MM v[160:163], a[248:251], a[112:115], v[160:163]
 MM v[164:167], a[252:255], a[112:115], v[164:167]
 buffer_load_dwordx4 a[72:75], v245, s[8:11], s7 offen offset:2048
 MM v[188:191], a[252:255], a[116:119], v[188:191]
 MM v[184:187], a[248:251], a[116:119], v[184:187]
 MM v[180:183], a[244:247], a[116:119], v[180:183]
 MM v[176:179], a[240:243], a[116:119], v[176:179]
 buffer_load_dwordx4 a[76:79], v245, s[8:11], s7 offen offset:3072
 MM v[172:175], a[236:239], a[116:119], v[172:175]
 MM v[168:171], a[232:235], a[116:119], v[168:171]
 s_waitcnt lgkmcnt(0)
 s_waitcnt vmcnt(31)
 MM v[0:3], a[208:211], a[120:123], v[0:3]
 ds_read_b128 a[232:235], v254 offset:6144
 s_add_u32 s7, s7, 0x1000
 ds_read_b128 a[236:239], v253 offset:6144
 MM v[4:7], a[212:215], a[120:123], v[4:7]
 buffer_load_dwordx4 a[80:83], v245, s[8:11], s7 offen offset:0
 v_fma_mix_f32 v232, v216, v192, 0 op_sel:[0,0,0] op_sel_hi:[1,0,0]
 MM v[8:11], a[216:219], a[120:123], v[8:11]
 ds_read_b128 a[240:243], v254 offset:8192
 v_fma_mix_f32 v233, v216, v192, 0 op_sel:[1,0,0] op_sel_hi:[1,0,0]
 v_fma_mix_f32 v234, v217, v192, 0 op_sel:[0,0,0] op_sel_hi:[1,0,0]
 MM v[12:15], a[220:223], a[120:123], v[12:15]
 ds_read_b128 a[244:247], v253 offset:8192
 ds_read_b128 a[248:251], v254 offset:10240
 v_fma_mix_f32 v235, v217, v192, 0 op_sel:[1,0,0] op_sel_hi:[1,0,0]
 MM v[16:19], a[224:227], a[120:123], v[16:19]
 buffer_load_dwordx4 a[84:87], v245, s[8:11], s7 offen offset:1024
 ds_read_b128 a[252:255], v253 offset:10240
 MM v[20:23], a[228:231], a[120:123], v[20:23]
 v_fma_mix_f32 v236, v218, v192, 0 op_sel:[0,0,0] op_sel_hi:[1,0,0]
 v_fma_mix_f32 v237, v218, v192, 0 op_sel:[1,0,0] op_sel_hi:[1,0,0]
 v_fma_mix_f32 v238, v219, v192, 0 op_sel:[0,0,0] op_sel_hi:[1,0,0]
 MM v[44:47], a[228:231], a[124:127], v[44:47]
 v_fma_mix_f32 v239, v219, v192, 0 op_sel:[1,0,0] op_sel_hi:[1,0,0]
 v_fma_mix_f32 v232, v220, v193, v232 op_sel:[0,0,0] op_sel_hi:[1,0,0]
 v_fma_mix_f32 v233, v220, v193, v233 op_sel:[1,0,0] op_sel_hi:[1,0,0]
 MM v[40:43], a[224:227], a[124:127], v[40:43]
 buffer_load_dwordx4 a[88:91], v245, s[8:11], s7 offen offset:2048
 ds_read_b128 v[216:219], v249 offset:25600
 MM v[36:39], a[220:223], a[124:127], v[36:39]
 v_fma_mix_f32 v234, v221, v193, v234 op_sel:[0,0,0] op_sel_hi:[1,0,0]
 v_fma_mix_f32 v235, v221, v193, v235 op_sel:[1,0,0] op_sel_hi:[1,0,0]
 v_fma_mix_f32 v236, v222, v193, v236 op_sel:[0,0,0] op_sel_hi:[1,0,0]
 MM v[32:35], a[216:219], a[124:127], v[32:35]
 v_fma_mix_f32 v237, v222, v193, v237 op_sel:[1,0,0] op_sel_hi:[1,0,0]
 v_fma_mix_f32 v238, v223, v193, v238 op_sel:[0,0,0] op_sel_hi:[1,0,0]
 v_fma_mix_f32 v239, v223, v193, v239 op_sel:[1,0,0] op_sel_hi:[1,0,0]
 MM v[28:31], a[212:215], a[124:127], v[28:31]
 buffer_load_dwordx4 a[92:95], v245, s[8:11], s7 offen offset:3072
 ds_read_b128 v[220:223], v250 offset:6144
 MM v[24:27], a[208:211], a[124:127], v[24:27]
 v_fma_mix_f32 v232, v224, v194, v232 op_sel:[0,0,0] op_sel_hi:[1,0,0]
 v_fma_mix_f32 v233, v224, v194, v233 op_sel:[1,0,0] op_sel_hi:[1,0,0]
 s_waitcnt vmcnt(33)
 MM v[48:51], a[208:211], a[128:131], v[48:51]
 s_add_u32 m0, s36, 2048
 s_add_u32 s34, s40, 491520
 v_fma_mix_f32 v234, v225, v194, v234 op_sel:[0,0,0] op_sel_hi:[1,0,0]
 MM v[52:55], a[212:215], a[128:131], v[52:55]
 buffer_load_dwordx4 v245, s[16:19], s34 offen offset:1024 sc1 lds
 v_fma_mix_f32 v235, v225, v194, v235 op_sel:[1,0,0] op_sel_hi:[1,0,0]
 MM v[56:59], a[216:219], a[128:131], v[56:59]
 v_fma_mix_f32 v236, v226, v194, v236 op_sel:[0,0,0] op_sel_hi:[1,0,0]
 v_fma_mix_f32 v237, v226, v194, v237 op_sel:[1,0,0] op_sel_hi:[1,0,0]
 v_fma_mix_f32 v238, v227, v194, v238 op_sel:[0,0,0] op_sel_hi:[1,0,0]
 MM v[60:63], a[220:223], a[128:131], v[60:63]
 v_fma_mix_f32 v239, v227, v194, v239 op_sel:[1,0,0] op_sel_hi:[1,0,0]
 v_fma_mix_f32 v232, v228, v195, v232 op_sel:[0,0,0] op_sel_hi:[1,0,0]
 v_fma_mix_f32 v233, v228, v195, v233 op_sel:[1,0,0] op_sel_hi:[1,0,0]
 MM v[64:67], a[224:227], a[128:131], v[64:67]
 ds_read_b128 v[224:227], v250 offset:7168
 v_fma_mix_f32 v234, v229, v195, v234 op_sel:[0,0,0] op_sel_hi:[1,0,0]
 v_fma_mix_f32 v235, v229, v195, v235 op_sel:[1,0,0] op_sel_hi:[1,0,0]
 MM v[68:71], a[228:231], a[128:131], v[68:71]
 buffer_load_dwordx4 v245, s[16:19], s34 offen offset:2048 sc1 lds
 v_fma_mix_f32 v236, v230, v195, v236 op_sel:[0,0,0] op_sel_hi:[1,0,0]
 MM v[92:95], a[228:231], a[132:135], v[92:95]
 v_fma_mix_f32 v237, v230, v195, v237 op_sel:[1,0,0] op_sel_hi:[1,0,0]
 v_fma_mix_f32 v238, v231, v195, v238 op_sel:[0,0,0] op_sel_hi:[1,0,0]
 v_fma_mix_f32 v239, v231, v195, v239 op_sel:[1,0,0] op_sel_hi:[1,0,0]
 MM v[88:91], a[224:227], a[132:135], v[88:91]
 ds_read_b128 v[228:231], v250 offset:8192
 CB v240, v232, v233
 CB v241, v234, v235
 MM v[84:87], a[220:223], a[132:135], v[84:87]
 buffer_load_dwordx4 v245, s[16:19], s34 offen offset:3072 sc1 lds
 CB v242, v236, v237
 MM v[80:83], a[216:219], a[132:135], v[80:83]
 CB v243, v238, v239
 s_add_u32 s7, s7, 0x1000
 ds_write_b128 v255, v[240:243] offset:24576
 MM v[76:79], a[212:215], a[132:135], v[76:79]
 s_waitcnt lgkmcnt(3)
 v_fma_mix_f32 v232, v216, v196, 0 op_sel:[0,0,0] op_sel_hi:[1,0,0]
 v_fma_mix_f32 v233, v216, v196, 0 op_sel:[1,0,0] op_sel_hi:[1,0,0]
 MM v[72:75], a[208:211], a[132:135], v[72:75]
 buffer_load_dwordx4 a[96:99], v245, s[8:11], s7 offen offset:0
 s_waitcnt vmcnt(32)
 MM v[96:99], a[208:211], a[0:3], v[96:99]
 v_fma_mix_f32 v234, v217, v196, 0 op_sel:[0,0,0] op_sel_hi:[1,0,0]
 v_fma_mix_f32 v235, v217, v196, 0 op_sel:[1,0,0] op_sel_hi:[1,0,0]
 v_fma_mix_f32 v236, v218, v196, 0 op_sel:[0,0,0] op_sel_hi:[1,0,0]
 MM v[100:103], a[212:215], a[0:3], v[100:103]
 v_fma_mix_f32 v237, v218, v196, 0 op_sel:[1,0,0] op_sel_hi:[1,0,0]
 v_fma_mix_f32 v238, v219, v196, 0 op_sel:[0,0,0] op_sel_hi:[1,0,0]
 v_fma_mix_f32 v239, v219, v196, 0 op_sel:[1,0,0] op_sel_hi:[1,0,0]
 MM v[104:107], a[216:219], a[0:3], v[104:107]
 buffer_load_dwordx4 a[100:103], v245, s[8:11], s7 offen offset:1024
 ds_read_b128 v[216:219], v249 offset:26624
 MM v[108:111], a[220:223], a[0:3], v[108:111]
 v_fma_mix_f32 v232, v220, v197, v232 op_sel:[0,0,0] op_sel_hi:[1,0,0]
 v_fma_mix_f32 v233, v220, v197, v233 op_sel:[1,0,0] op_sel_hi:[1,0,0]
 v_fma_mix_f32 v234, v221, v197, v234 op_sel:[0,0,0] op_sel_hi:[1,0,0]
 MM v[112:115], a[224:227], a[0:3], v[112:115]
 v_fma_mix_f32 v235, v221, v197, v235 op_sel:[1,0,0] op_sel_hi:[1,0,0]
 v_fma_mix_f32 v236, v222, v197, v236 op_sel:[0,0,0] op_sel_hi:[1,0,0]
 v_fma_mix_f32 v237, v222, v197, v237 op_sel:[1,0,0] op_sel_hi:[1,0,0]
 MM v[116:119], a[228:231], a[0:3], v[116:119]
 buffer_load_dwordx4 a[104:107], v245, s[8:11], s7 offen offset:2048
 v_fma_mix_f32 v238, v223, v197, v238 op_sel:[0,0,0] op_sel_hi:[1,0,0]
 MM v[140:143], a[228:231], a[4:7], v[140:143]
 v_fma_mix_f32 v239, v223, v197, v239 op_sel:[1,0,0] op_sel_hi:[1,0,0]
 MM v[136:139], a[224:227], a[4:7], v[136:139]
 ds_read_b128 v[220:223], v250 offset:9216
 s_waitcnt lgkmcnt(3)
 v_fma_mix_f32 v232, v224, v198, v232 op_sel:[0,0,0] op_sel_hi:[1,0,0]
 MM v[132:135], a[220:223], a[4:7], v[132:135]
 v_fma_mix_f32 v233, v224, v198, v233 op_sel:[1,0,0] op_sel_hi:[1,0,0]
 v_fma_mix_f32 v234, v225, v198, v234 op_sel:[0,0,0] op_sel_hi:[1,0,0]
 v_fma_mix_f32 v235, v225, v198, v235 op_sel:[1,0,0] op_sel_hi:[1,0,0]
 MM v[128:131], a[216:219], a[4:7], v[128:131]
 buffer_load_dwordx4 a[108:111], v245, s[8:11], s7 offen offset:3072
 v_fma_mix_f32 v236, v226, v198, v236 op_sel:[0,0,0] op_sel_hi:[1,0,0]
 MM v[124:127], a[212:215], a[4:7], v[124:127]
 v_fma_mix_f32 v237, v226, v198, v237 op_sel:[1,0,0] op_sel_hi:[1,0,0]
 s_add_u32 s7, s7, 0x1000
 v_fma_mix_f32 v238, v227, v198, v238 op_sel:[0,0,0] op_sel_hi:[1,0,0]
 MM v[120:123], a[208:211], a[4:7], v[120:123]
 v_fma_mix_f32 v239, v227, v198, v239 op_sel:[1,0,0] op_sel_hi:[1,0,0]
 v_fma_mix_f32 v232, v228, v199, v232 op_sel:[0,0,0] op_sel_hi:[1,0,0]
 s_waitcnt vmcnt(33)
 MM v[144:147], a[208:211], a[8:11], v[144:147]
 buffer_load_dwordx4 a[112:115], v245, s[8:11], s7 offen offset:0
 ds_read_b128 v[224:227], v250 offset:10240
 MM v[148:151], a[212:215], a[8:11], v[148:151]
 v_fma_mix_f32 v233, v228, v199, v233 op_sel:[1,0,0] op_sel_hi:[1,0,0]
 v_fma_mix_f32 v234, v229, v199, v234 op_sel:[0,0,0] op_sel_hi:[1,0,0]
 v_fma_mix_f32 v235, v229, v199, v235 op_sel:[1,0,0] op_sel_hi:[1,0,0]
 MM v[152:155], a[216:219], a[8:11], v[152:155]
 v_fma_mix_f32 v236, v230, v199, v236 op_sel:[0,0,0] op_sel_hi:[1,0,0]
 v_fma_mix_f32 v237, v230, v199, v237 op_sel:[1,0,0] op_sel_hi:[1,0,0]
 v_fma_mix_f32 v238, v231, v199, v238 op_sel:[0,0,0] op_sel_hi:[1,0,0]
 MM v[156:159], a[220:223], a[8:11], v[156:159]
 buffer_load_dwordx4 a[116:119], v245, s[8:11], s7 offen offset:1024
 v_fma_mix_f32 v239, v231, v199, v239 op_sel:[1,0,0] op_sel_hi:[1,0,0]
 MM v[160:163], a[224:227], a[8:11], v[160:163]
 ds_read_b128 v[228:231], v250 offset:11264
 CB v240, v232, v233
 CB v241, v234, v235
 MM v[164:167], a[228:231], a[8:11], v[164:167]
 CB v242, v236, v237
 CB v243, v238, v239
 MM v[188:191], a[228:231], a[12:15], v[188:191]
 ds_write_b128 v255, v[240:243] offset:25600
 s_waitcnt lgkmcnt(3)
 MM v[184:187], a[224:227], a[12:15], v[184:187]
 buffer_load_dwordx4 a[120:123], v245, s[8:11], s7 offen offset:2048
 MM v[180:183], a[220:223], a[12:15], v[180:183]
 v_fma_mix_f32 v232, v216, v200, 0 op_sel:[0,0,0] op_sel_hi:[1,0,0]
 v_fma_mix_f32 v233, v216, v200, 0 op_sel:[1,0,0] op_sel_hi:[1,0,0]
 v_fma_mix_f32 v234, v217, v200, 0 op_sel:[0,0,0] op_sel_hi:[1,0,0]
 MM v[176:179], a[216:219], a[12:15], v[176:179]
 v_fma_mix_f32 v235, v217, v200, 0 op_sel:[1,0,0] op_sel_hi:[1,0,0]
 v_fma_mix_f32 v236, v218, v200, 0 op_sel:[0,0,0] op_sel_hi:[1,0,0]
 MM v[172:175], a[212:215], a[12:15], v[172:175]
 buffer_load_dwordx4 a[124:127], v245, s[8:11], s7 offen offset:3072
 MM v[168:171], a[208:211], a[12:15], v[168:171]
 s_waitcnt vmcnt(35)
 MM v[0:3], a[232:235], a[16:19], v[0:3]
 ds_read_b128 a[208:211], v253 offset:12288
 s_add_u32 s7, s7, 0x1000
 v_fma_mix_f32 v237, v218, v200, 0 op_sel:[1,0,0] op_sel_hi:[1,0,0]
 MM v[4:7], a[236:239], a[16:19], v[4:7]
 ds_read_b128 a[212:215], v254 offset:12288
 v_fma_mix_f32 v238, v219, v200, 0 op_sel:[0,0,0] op_sel_hi:[1,0,0]
 v_fma_mix_f32 v239, v219, v200, 0 op_sel:[1,0,0] op_sel_hi:[1,0,0]
 MM v[8:11], a[240:243], a[16:19], v[8:11]
 buffer_load_dwordx4 a[128:131], v245, s[8:11], s7 offen offset:0
 ds_read_b128 a[216:219], v253 offset:14336
 MM v[12:15], a[244:247], a[16:19], v[12:15]
 ds_read_b128 a[220:223], v254 offset:14336
 s_waitcnt vmcnt(32)
 ds_read_b128 a[224:227], v253 offset:16384
 MM v[16:19], a[248:251], a[16:19], v[16:19]
 ds_read_b128 v[216:219], v249 offset:27648
 ds_read_b128 a[228:231], v254 offset:16384
 v_fma_mix_f32 v232, v220, v201, v232 op_sel:[0,0,0] op_sel_hi:[1,0,0]
 MM v[20:23], a[252:255], a[16:19], v[20:23]
 buffer_load_dwordx4 a[132:135], v245, s[8:11], s7 offen offset:1024
 v_fma_mix_f32 v233, v220, v201, v233 op_sel:[1,0,0] op_sel_hi:[1,0,0]
 MM v[44:47], a[252:255], a[20:23], v[44:47]
 v_fma_mix_f32 v234, v221, v201, v234 op_sel:[0,0,0] op_sel_hi:[1,0,0]
 v_fma_mix_f32 v235, v221, v201, v235 op_sel:[1,0,0] op_sel_hi:[1,0,0]
 v_fma_mix_f32 v236, v222, v201, v236 op_sel:[0,0,0] op_sel_hi:[1,0,0]
 MM v[40:43], a[248:251], a[20:23], v[40:43]
 v_fma_mix_f32 v237, v222, v201, v237 op_sel:[1,0,0] op_sel_hi:[1,0,0]
 v_fma_mix_f32 v238, v223, v201, v238 op_sel:[0,0,0] op_sel_hi:[1,0,0]
 v_fma_mix_f32 v239, v223, v201, v239 op_sel:[1,0,0] op_sel_hi:[1,0,0]
 MM v[36:39], a[244:247], a[20:23], v[36:39]
 buffer_load_dwordx4 a[0:3], v245, s[8:11], s7 offen offset:2048
 MM v[32:35], a[240:243], a[20:23], v[32:35]
 ds_read_b128 v[220:223], v250 offset:12288
 s_waitcnt lgkmcnt(9)
 v_fma_mix_f32 v232, v224, v202, v232 op_sel:[0,0,0] op_sel_hi:[1,0,0]
 MM v[28:31], a[236:239], a[20:23], v[28:31]
 v_fma_mix_f32 v233, v224, v202, v233 op_sel:[1,0,0] op_sel_hi:[1,0,0]
 v_fma_mix_f32 v234, v225, v202, v234 op_sel:[0,0,0] op_sel_hi:[1,0,0]
 MM v[24:27], a[232:235], a[20:23], v[24:27]
 v_fma_mix_f32 v235, v225, v202, v235 op_sel:[1,0,0] op_sel_hi:[1,0,0]
 s_waitcnt vmcnt(33)
 MM v[48:51], a[232:235], a[24:27], v[48:51]
 buffer_load_dwordx4 a[4:7], v245, s[8:11], s7 offen offset:3072
 MM v[52:55], a[236:239], a[24:27], v[52:55]
 v_fma_mix_f32 v236, v226, v202, v236 op_sel:[0,0,0] op_sel_hi:[1,0,0]
 v_fma_mix_f32 v237, v226, v202, v237 op_sel:[1,0,0] op_sel_hi:[1,0,0]
 v_fma_mix_f32 v238, v227, v202, v238 op_sel:[0,0,0] op_sel_hi:[1,0,0]
 MM v[56:59], a[240:243], a[24:27], v[56:59]
 s_add_u32 s7, s7, 0x1000
 v_fma_mix_f32 v239, v227, v202, v239 op_sel:[1,0,0] op_sel_hi:[1,0,0]
 MM v[60:63], a[244:247], a[24:27], v[60:63]
 ds_read_b128 v[224:227], v250 offset:13312
 v_fma_mix_f32 v232, v228, v203, v232 op_sel:[0,0,0] op_sel_hi:[1,0,0]
 MM v[64:67], a[248:251], a[24:27], v[64:67]
 buffer_load_dwordx4 a[8:11], v245, s[8:11], s7 offen offset:0
 MM v[68:71], a[252:255], a[24:27], v[68:71]
 v_fma_mix_f32 v233, v228, v203, v233 op_sel:[1,0,0] op_sel_hi:[1,0,0]
 v_fma_mix_f32 v234, v229, v203, v234 op_sel:[0,0,0] op_sel_hi:[1,0,0]
 v_fma_mix_f32 v235, v229, v203, v235 op_sel:[1,0,0] op_sel_hi:[1,0,0]
 MM v[92:95], a[252:255], a[28:31], v[92:95]
 v_fma_mix_f32 v236, v230, v203, v236 op_sel:[0,0,0] op_sel_hi:[1,0,0]
 v_fma_mix_f32 v237, v230, v203, v237 op_sel:[1,0,0] op_sel_hi:[1,0,0]
 MM v[88:91], a[248:251], a[28:31], v[88:91]
 v_fma_mix_f32 v238, v231, v203, v238 op_sel:[0,0,0] op_sel_hi:[1,0,0]
 v_fma_mix_f32 v239, v231, v203, v239 op_sel:[1,0,0] op_sel_hi:[1,0,0]
 MM v[84:87], a[244:247], a[28:31], v[84:87]
 buffer_load_dwordx4 a[12:15], v245, s[8:11], s7 offen offset:1024
 MM v[80:83], a[240:243], a[28:31], v[80:83]
 ds_read_b128 v[228:231], v250 offset:14336
 CB v240, v232, v233
 MM v[76:79], a[236:239], a[28:31], v[76:79]
 CB v241, v234, v235
 CB v242, v236, v237
 MM v[72:75], a[232:235], a[28:31], v[72:75]
 CB v243, v238, v239
 s_waitcnt vmcnt(34)
 MM v[96:99], a[232:235], a[32:35], v[96:99]
 buffer_load_dwordx4 a[16:19], v245, s[8:11], s7 offen offset:2048
 MM v[100:103], a[236:239], a[32:35], v[100:103]
 ds_write_b128 v255, v[240:243] offset:26624
 s_waitcnt lgkmcnt(3)
 v_fma_mix_f32 v232, v216, v204, 0 op_sel:[0,0,0] op_sel_hi:[1,0,0]
 MM v[104:107], a[240:243], a[32:35], v[104:107]
 v_fma_mix_f32 v233, v216, v204, 0 op_sel:[1,0,0] op_sel_hi:[1,0,0]
 v_fma_mix_f32 v234, v217, v204, 0 op_sel:[0,0,0] op_sel_hi:[1,0,0]
 MM v[108:111], a[244:247], a[32:35], v[108:111]
 buffer_load_dwordx4 a[20:23], v245, s[8:11], s7 offen offset:3072
 MM v[112:115], a[248:251], a[32:35], v[112:115]
 v_fma_mix_f32 v235, v217, v204, 0 op_sel:[1,0,0] op_sel_hi:[1,0,0]
 v_fma_mix_f32 v236, v218, v204, 0 op_sel:[0,0,0] op_sel_hi:[1,0,0]
 MM v[116:119], a[252:255], a[32:35], v[116:119]
 v_fma_mix_f32 v237, v218, v204, 0 op_sel:[1,0,0] op_sel_hi:[1,0,0]
 s_add_u32 s7, s7, 0x1000
 MM v[140:143], a[252:255], a[36:39], v[140:143]
 v_fma_mix_f32 v238, v219, v204, 0 op_sel:[0,0,0] op_sel_hi:[1,0,0]
 v_fma_mix_f32 v239, v219, v204, 0 op_sel:[1,0,0] op_sel_hi:[1,0,0]
 MM v[136:139], a[248:251], a[36:39], v[136:139]
 buffer_load_dwordx4 a[24:27], v245, s[8:11], s7 offen offset:0
 MM v[132:135], a[244:247], a[36:39], v[132:135]
 s_waitcnt vmcnt(32)
 ds_read_b128 v[216:219], v249 offset:28672
 v_fma_mix_f32 v232, v220, v205, v232 op_sel:[0,0,0] op_sel_hi:[1,0,0]
 MM v[128:131], a[240:243], a[36:39], v[128:131]
 v_fma_mix_f32 v233, v220, v205, v233 op_sel:[1,0,0] op_sel_hi:[1,0,0]
 v_fma_mix_f32 v234, v221, v205, v234 op_sel:[0,0,0] op_sel_hi:[1,0,0]
 MM v[124:127], a[236:239], a[36:39], v[124:127]
 v_fma_mix_f32 v235, v221, v205, v235 op_sel:[1,0,0] op_sel_hi:[1,0,0]
 v_fma_mix_f32 v236, v222, v205, v236 op_sel:[0,0,0] op_sel_hi:[1,0,0]
 MM v[120:123], a[232:235], a[36:39], v[120:123]
 v_fma_mix_f32 v237, v222, v205, v237 op_sel:[1,0,0] op_sel_hi:[1,0,0]
 MM v[144:147], a[232:235], a[40:43], v[144:147]
 buffer_load_dwordx4 a[28:31], v245, s[8:11], s7 offen offset:1024
 MM v[148:151], a[236:239], a[40:43], v[148:151]
 v_fma_mix_f32 v238, v223, v205, v238 op_sel:[0,0,0] op_sel_hi:[1,0,0]
 v_fma_mix_f32 v239, v223, v205, v239 op_sel:[1,0,0] op_sel_hi:[1,0,0]
 MM v[152:155], a[240:243], a[40:43], v[152:155]
 ds_read_b128 v[220:223], v250 offset:0
 s_waitcnt lgkmcnt(3)
 MM v[156:159], a[244:247], a[40:43], v[156:159]
 buffer_load_dwordx4 a[32:35], v245, s[8:11], s7 offen offset:2048
 MM v[160:163], a[248:251], a[40:43], v[160:163]
 v_fma_mix_f32 v232, v224, v206, v232 op_sel:[0,0,0] op_sel_hi:[1,0,0]
 v_fma_mix_f32 v233, v224, v206, v233 op_sel:[1,0,0] op_sel_hi:[1,0,0]
 v_fma_mix_f32 v234, v225, v206, v234 op_sel:[0,0,0] op_sel_hi:[1,0,0]
 MM v[164:167], a[252:255], a[40:43], v[164:167]
 v_fma_mix_f32 v235, v225, v206, v235 op_sel:[1,0,0] op_sel_hi:[1,0,0]
 v_fma_mix_f32 v236, v226, v206, v236 op_sel:[0,0,0] op_sel_hi:[1,0,0]
 MM v[188:191], a[252:255], a[44:47], v[188:191]
 v_fma_mix_f32 v237, v226, v206, v237 op_sel:[1,0,0] op_sel_hi:[1,0,0]
 v_fma_mix_f32 v238, v227, v206, v238 op_sel:[0,0,0] op_sel_hi:[1,0,0]
 MM v[184:187], a[248:251], a[44:47], v[184:187]
 buffer_load_dwordx4 a[36:39], v245, s[8:11], s7 offen offset:3072
 MM v[180:183], a[244:247], a[44:47], v[180:183]
 v_fma_mix_f32 v239, v227, v206, v239 op_sel:[1,0,0] op_sel_hi:[1,0,0]
 v_fma_mix_f32 v232, v228, v207, v232 op_sel:[0,0,0] op_sel_hi:[1,0,0]
 MM v[176:179], a[240:243], a[44:47], v[176:179]
 ds_read_b128 v[224:227], v250 offset:1024
 s_add_u32 s7, s7, 0x1000
 MM v[172:175], a[236:239], a[44:47], v[172:175]
 v_fma_mix_f32 v233, v228, v207, v233 op_sel:[1,0,0] op_sel_hi:[1,0,0]
 v_fma_mix_f32 v234, v229, v207, v234 op_sel:[0,0,0] op_sel_hi:[1,0,0]
 MM v[168:171], a[232:235], a[44:47], v[168:171]
 s_waitcnt vmcnt(33)
 MM v[0:3], a[208:211], a[48:51], v[0:3]
 buffer_load_dwordx4 a[40:43], v245, s[8:11], s7 offen offset:0
 ds_read_b128 a[232:235], v254 offset:18432
 MM v[4:7], a[212:215], a[48:51], v[4:7]
 ds_read_b128 a[236:239], v253 offset:18432
 v_fma_mix_f32 v235, v229, v207, v235 op_sel:[1,0,0] op_sel_hi:[1,0,0]
 v_fma_mix_f32 v236, v230, v207, v236 op_sel:[0,0,0] op_sel_hi:[1,0,0]
 MM v[8:11], a[216:219], a[48:51], v[8:11]
 buffer_load_dwordx4 a[44:47], v245, s[8:11], s7 offen offset:1024
 ds_read_b128 a[240:243], v254 offset:20480
 MM v[12:15], a[220:223], a[48:51], v[12:15]
 ds_read_b128 a[244:247], v253 offset:20480
 v_fma_mix_f32 v237, v230, v207, v237 op_sel:[1,0,0] op_sel_hi:[1,0,0]
 v_fma_mix_f32 v238, v231, v207, v238 op_sel:[0,0,0] op_sel_hi:[1,0,0]
 MM v[16:19], a[224:227], a[48:51], v[16:19]
 ds_read_b128 a[248:251], v254 offset:22528
 v_fma_mix_f32 v239, v231, v207, v239 op_sel:[1,0,0] op_sel_hi:[1,0,0]
 CB v240, v232, v233
 MM v[20:23], a[228:231], a[48:51], v[20:23]
 ds_read_b128 a[252:255], v253 offset:22528
 ds_read_b128 v[228:231], v250 offset:2048
 CB v241, v234, v235
 MM v[44:47], a[228:231], a[52:55], v[44:47]
 buffer_load_dwordx4 a[48:51], v245, s[8:11], s7 offen offset:2048
 CB v242, v236, v237
 MM v[40:43], a[224:227], a[52:55], v[40:43]
 CB v243, v238, v239
 MM v[36:39], a[220:223], a[52:55], v[36:39]
 ds_write_b128 v255, v[240:243] offset:27648
 s_waitcnt lgkmcnt(9)
 v_fma_mix_f32 v232, v216, v208, 0 op_sel:[0,0,0] op_sel_hi:[1,0,0]
 MM v[32:35], a[216:219], a[52:55], v[32:35]
 v_fma_mix_f32 v233, v216, v208, 0 op_sel:[1,0,0] op_sel_hi:[1,0,0]
 v_fma_mix_f32 v234, v217, v208, 0 op_sel:[0,0,0] op_sel_hi:[1,0,0]
 MM v[28:31], a[212:215], a[52:55], v[28:31]
 v_fma_mix_f32 v235, v217, v208, 0 op_sel:[1,0,0] op_sel_hi:[1,0,0]
 v_fma_mix_f32 v236, v218, v208, 0 op_sel:[0,0,0] op_sel_hi:[1,0,0]
 MM v[24:27], a[208:211], a[52:55], v[24:27]
 v_fma_mix_f32 v237, v218, v208, 0 op_sel:[1,0,0] op_sel_hi:[1,0,0]
 s_waitcnt vmcnt(34)
 MM v[48:51], a[208:211], a[56:59], v[48:51]
 buffer_load_dwordx4 a[52:55], v245, s[8:11], s7 offen offset:3072
 MM v[52:55], a[212:215], a[56:59], v[52:55]
 v_fma_mix_f32 v238, v219, v208, 0 op_sel:[0,0,0] op_sel_hi:[1,0,0]
 v_fma_mix_f32 v239, v219, v208, 0 op_sel:[1,0,0] op_sel_hi:[1,0,0]
 s_waitcnt vmcnt(24)
 MM v[56:59], a[216:219], a[56:59], v[56:59]
 ds_read_b128 v[216:219], v249 offset:29696
 v_fma_mix_f32 v232, v220, v209, v232 op_sel:[0,0,0] op_sel_hi:[1,0,0]
 MM v[60:63], a[220:223], a[56:59], v[60:63]
 v_fma_mix_f32 v233, v220, v209, v233 op_sel:[1,0,0] op_sel_hi:[1,0,0]
 v_fma_mix_f32 v234, v221, v209, v234 op_sel:[0,0,0] op_sel_hi:[1,0,0]
 MM v[64:67], a[224:227], a[56:59], v[64:67]
 v_fma_mix_f32 v235, v221, v209, v235 op_sel:[1,0,0] op_sel_hi:[1,0,0]
 v_fma_mix_f32 v236, v222, v209, v236 op_sel:[0,0,0] op_sel_hi:[1,0,0]
 MM v[68:71], a[228:231], a[56:59], v[68:71]
 s_add_u32 s7, s7, 0x1000
 v_fma_mix_f32 v237, v222, v209, v237 op_sel:[1,0,0] op_sel_hi:[1,0,0]
 MM v[92:95], a[228:231], a[60:63], v[92:95]
 buffer_load_dwordx4 a[56:59], v245, s[8:11], s7 offen offset:0
 MM v[88:91], a[224:227], a[60:63], v[88:91]
 v_fma_mix_f32 v238, v223, v209, v238 op_sel:[0,0,0] op_sel_hi:[1,0,0]
 v_fma_mix_f32 v239, v223, v209, v239 op_sel:[1,0,0] op_sel_hi:[1,0,0]
 MM v[84:87], a[220:223], a[60:63], v[84:87]
 ds_read_b128 v[220:223], v250 offset:3072
 s_waitcnt lgkmcnt(3)
 MM v[80:83], a[216:219], a[60:63], v[80:83]
 v_fma_mix_f32 v232, v224, v210, v232 op_sel:[0,0,0] op_sel_hi:[1,0,0]
 v_fma_mix_f32 v233, v224, v210, v233 op_sel:[1,0,0] op_sel_hi:[1,0,0]
 MM v[76:79], a[212:215], a[60:63], v[76:79]
 v_fma_mix_f32 v234, v225, v210, v234 op_sel:[0,0,0] op_sel_hi:[1,0,0]
 v_fma_mix_f32 v235, v225, v210, v235 op_sel:[1,0,0] op_sel_hi:[1,0,0]
 MM v[72:75], a[208:211], a[60:63], v[72:75]
 v_fma_mix_f32 v236, v226, v210, v236 op_sel:[0,0,0] op_sel_hi:[1,0,0]
 MM v[96:99], a[208:211], a[64:67], v[96:99]
 buffer_load_dwordx4 a[60:63], v245, s[8:11], s7 offen offset:1024
 MM v[100:103], a[212:215], a[64:67], v[100:103]
 v_fma_mix_f32 v237, v226, v210, v237 op_sel:[1,0,0] op_sel_hi:[1,0,0]
 v_fma_mix_f32 v238, v227, v210, v238 op_sel:[0,0,0] op_sel_hi:[1,0,0]
 MM v[104:107], a[216:219], a[64:67], v[104:107]
 v_fma_mix_f32 v239, v227, v210, v239 op_sel:[1,0,0] op_sel_hi:[1,0,0]
 v_fma_mix_f32 v232, v228, v211, v232 op_sel:[0,0,0] op_sel_hi:[1,0,0]
 MM v[108:111], a[220:223], a[64:67], v[108:111]
 ds_read_b128 v[224:227], v250 offset:4096
 v_fma_mix_f32 v233, v228, v211, v233 op_sel:[1,0,0] op_sel_hi:[1,0,0]
 MM v[112:115], a[224:227], a[64:67], v[112:115]
 v_fma_mix_f32 v234, v229, v211, v234 op_sel:[0,0,0] op_sel_hi:[1,0,0]
 v_fma_mix_f32 v235, v229, v211, v235 op_sel:[1,0,0] op_sel_hi:[1,0,0]
 MM v[116:119], a[228:231], a[64:67], v[116:119]
 buffer_load_dwordx4 a[64:67], v245, s[8:11], s7 offen offset:2048
 MM v[140:143], a[228:231], a[68:71], v[140:143]
 v_fma_mix_f32 v236, v230, v211, v236 op_sel:[0,0,0] op_sel_hi:[1,0,0]
 v_fma_mix_f32 v237, v230, v211, v237 op_sel:[1,0,0] op_sel_hi:[1,0,0]
 MM v[136:139], a[224:227], a[68:71], v[136:139]
 v_fma_mix_f32 v238, v231, v211, v238 op_sel:[0,0,0] op_sel_hi:[1,0,0]
 v_fma_mix_f32 v239, v231, v211, v239 op_sel:[1,0,0] op_sel_hi:[1,0,0]
 MM v[132:135], a[220:223], a[68:71], v[132:135]
 ds_read_b128 v[228:231], v250 offset:5120
 CB v240, v232, v233
 MM v[128:131], a[216:219], a[68:71], v[128:131]
 CB v241, v234, v235
 CB v242, v236, v237
 MM v[124:127], a[212:215], a[68:71], v[124:127]
 CB v243, v238, v239
 MM v[120:123], a[208:211], a[68:71], v[120:123]
 ds_write_b128 v255, v[240:243] offset:28672
 MM v[144:147], a[208:211], a[72:75], v[144:147]
 buffer_load_dwordx4 a[68:71], v245, s[8:11], s7 offen offset:3072
 MM v[148:151], a[212:215], a[72:75], v[148:151]
 s_waitcnt lgkmcnt(3)
 v_fma_mix_f32 v232, v216, v212, 0 op_sel:[0,0,0] op_sel_hi:[1,0,0]
 MM v[152:155], a[216:219], a[72:75], v[152:155]
 v_fma_mix_f32 v233, v216, v212, 0 op_sel:[1,0,0] op_sel_hi:[1,0,0]
 v_fma_mix_f32 v234, v217, v212, 0 op_sel:[0,0,0] op_sel_hi:[1,0,0]
 MM v[156:159], a[220:223], a[72:75], v[156:159]
 v_fma_mix_f32 v235, v217, v212, 0 op_sel:[1,0,0] op_sel_hi:[1,0,0]
 v_fma_mix_f32 v236, v218, v212, 0 op_sel:[0,0,0] op_sel_hi:[1,0,0]
 MM v[160:163], a[224:227], a[72:75], v[160:163]
 v_fma_mix_f32 v237, v218, v212, 0 op_sel:[1,0,0] op_sel_hi:[1,0,0]
 v_fma_mix_f32 v238, v219, v212, 0 op_sel:[0,0,0] op_sel_hi:[1,0,0]
 MM v[164:167], a[228:231], a[72:75], v[164:167]
 s_add_u32 s7, s7, 0x1000
 v_fma_mix_f32 v239, v219, v212, 0 op_sel:[1,0,0] op_sel_hi:[1,0,0]
 MM v[188:191], a[228:231], a[76:79], v[188:191]
 buffer_load_dwordx4 a[72:75], v245, s[8:11], s7 offen offset:0
 MM v[184:187], a[224:227], a[76:79], v[184:187]
 v_fma_mix_f32 v232, v220, v213, v232 op_sel:[0,0,0] op_sel_hi:[1,0,0]
 v_fma_mix_f32 v233, v220, v213, v233 op_sel:[1,0,0] op_sel_hi:[1,0,0]
 MM v[180:183], a[220:223], a[76:79], v[180:183]
 v_fma_mix_f32 v234, v221, v213, v234 op_sel:[0,0,0] op_sel_hi:[1,0,0]
 v_fma_mix_f32 v235, v221, v213, v235 op_sel:[1,0,0] op_sel_hi:[1,0,0]
 MM v[176:179], a[216:219], a[76:79], v[176:179]
 v_fma_mix_f32 v236, v222, v213, v236 op_sel:[0,0,0] op_sel_hi:[1,0,0]
 v_fma_mix_f32 v237, v222, v213, v237 op_sel:[1,0,0] op_sel_hi:[1,0,0]
 MM v[172:175], a[212:215], a[76:79], v[172:175]
 v_fma_mix_f32 v238, v223, v213, v238 op_sel:[0,0,0] op_sel_hi:[1,0,0]
 v_fma_mix_f32 v239, v223, v213, v239 op_sel:[1,0,0] op_sel_hi:[1,0,0]
 MM v[168:171], a[208:211], a[76:79], v[168:171]
 MM v[0:3], a[232:235], a[80:83], v[0:3]
 buffer_load_dwordx4 a[76:79], v245, s[8:11], s7 offen offset:1024
 MM v[4:7], a[236:239], a[80:83], v[4:7]
 s_waitcnt lgkmcnt(1)
 v_fma_mix_f32 v232, v224, v214, v232 op_sel:[0,0,0] op_sel_hi:[1,0,0]
 MM v[8:11], a[240:243], a[80:83], v[8:11]
 v_fma_mix_f32 v233, v224, v214, v233 op_sel:[1,0,0] op_sel_hi:[1,0,0]
 v_fma_mix_f32 v234, v225, v214, v234 op_sel:[0,0,0] op_sel_hi:[1,0,0]
 MM v[12:15], a[244:247], a[80:83], v[12:15]
 v_fma_mix_f32 v235, v225, v214, v235 op_sel:[1,0,0] op_sel_hi:[1,0,0]
 v_fma_mix_f32 v236, v226, v214, v236 op_sel:[0,0,0] op_sel_hi:[1,0,0]
 MM v[16:19], a[248:251], a[80:83], v[16:19]
 v_fma_mix_f32 v237, v226, v214, v237 op_sel:[1,0,0] op_sel_hi:[1,0,0]
 v_fma_mix_f32 v238, v227, v214, v238 op_sel:[0,0,0] op_sel_hi:[1,0,0]
 MM v[20:23], a[252:255], a[80:83], v[20:23]
 buffer_load_dwordx4 a[80:83], v245, s[8:11], s7 offen offset:2048
 MM v[44:47], a[252:255], a[84:87], v[44:47]
 v_fma_mix_f32 v239, v227, v214, v239 op_sel:[1,0,0] op_sel_hi:[1,0,0]
 v_fma_mix_f32 v232, v228, v215, v232 op_sel:[0,0,0] op_sel_hi:[1,0,0]
 MM v[40:43], a[248:251], a[84:87], v[40:43]
 v_fma_mix_f32 v233, v228, v215, v233 op_sel:[1,0,0] op_sel_hi:[1,0,0]
 v_fma_mix_f32 v234, v229, v215, v234 op_sel:[0,0,0] op_sel_hi:[1,0,0]
 MM v[36:39], a[244:247], a[84:87], v[36:39]
 v_fma_mix_f32 v235, v229, v215, v235 op_sel:[1,0,0] op_sel_hi:[1,0,0]
 v_fma_mix_f32 v236, v230, v215, v236 op_sel:[0,0,0] op_sel_hi:[1,0,0]
 MM v[32:35], a[240:243], a[84:87], v[32:35]
 v_fma_mix_f32 v237, v230, v215, v237 op_sel:[1,0,0] op_sel_hi:[1,0,0]
 v_fma_mix_f32 v238, v231, v215, v238 op_sel:[0,0,0] op_sel_hi:[1,0,0]
 MM v[28:31], a[236:239], a[84:87], v[28:31]
 v_fma_mix_f32 v239, v231, v215, v239 op_sel:[1,0,0] op_sel_hi:[1,0,0]
 CB v240, v232, v233
 MM v[24:27], a[232:235], a[84:87], v[24:27]
 CB v241, v234, v235
 MM v[48:51], a[232:235], a[88:91], v[48:51]
 buffer_load_dwordx4 a[84:87], v245, s[8:11], s7 offen offset:3072
 MM v[52:55], a[236:239], a[88:91], v[52:55]
 CB v242, v236, v237
 CB v243, v238, v239
 MM v[56:59], a[240:243], a[88:91], v[56:59]
 ds_write_b128 v255, v[240:243] offset:29696
 MM v[60:63], a[244:247], a[88:91], v[60:63]
 MM v[64:67], a[248:251], a[88:91], v[64:67]
 MM v[68:71], a[252:255], a[88:91], v[68:71]
 s_add_u32 s7, s7, 0x1000
 buffer_load_dwordx4 a[88:91], v245, s[8:11], s7 offen offset:0
 s_waitcnt lgkmcnt(0)
 s_barrier
 MM v[92:95], a[252:255], a[92:95], v[92:95]
 ds_read_b128 a[208:211], v253 offset:24576
 MM v[88:91], a[248:251], a[92:95], v[88:91]
 ds_read_b128 a[212:215], v254 offset:24576
 MM v[84:87], a[244:247], a[92:95], v[84:87]
 ds_read_b128 a[216:219], v253 offset:26624
 MM v[80:83], a[240:243], a[92:95], v[80:83]
 ds_read_b128 a[220:223], v254 offset:26624
 MM v[76:79], a[236:239], a[92:95], v[76:79]
 ds_read_b128 a[224:227], v253 offset:28672
 MM v[72:75], a[232:235], a[92:95], v[72:75]
 ds_read_b128 a[228:231], v254 offset:28672
 s_waitcnt vmcnt(31)
 MM v[96:99], a[232:235], a[96:99], v[96:99]
 buffer_load_dwordx4 a[92:95], v245, s[8:11], s7 offen offset:1024
 MM v[100:103], a[236:239], a[96:99], v[100:103]
 MM v[104:107], a[240:243], a[96:99], v[104:107]
 MM v[108:111], a[244:247], a[96:99], v[108:111]
 MM v[112:115], a[248:251], a[96:99], v[112:115]
 MM v[116:119], a[252:255], a[96:99], v[116:119]
 buffer_load_dwordx4 a[96:99], v245, s[8:11], s7 offen offset:2048
 MM v[140:143], a[252:255], a[100:103], v[140:143]
 MM v[136:139], a[248:251], a[100:103], v[136:139]
 MM v[132:135], a[244:247], a[100:103], v[132:135]
 MM v[128:131], a[240:243], a[100:103], v[128:131]
 MM v[124:127], a[236:239], a[100:103], v[124:127]
 MM v[120:123], a[232:235], a[100:103], v[120:123]
 s_waitcnt vmcnt(31)
 MM v[144:147], a[232:235], a[104:107], v[144:147]
 buffer_load_dwordx4 a[100:103], v245, s[8:11], s7 offen offset:3072
 MM v[148:151], a[236:239], a[104:107], v[148:151]
 MM v[152:155], a[240:243], a[104:107], v[152:155]
 MM v[156:159], a[244:247], a[104:107], v[156:159]
 MM v[160:163], a[248:251], a[104:107], v[160:163]
 MM v[164:167], a[252:255], a[104:107], v[164:167]
 MM v[188:191], a[252:255], a[108:111], v[188:191]
 MM v[184:187], a[248:251], a[108:111], v[184:187]
 MM v[180:183], a[244:247], a[108:111], v[180:183]
 MM v[176:179], a[240:243], a[108:111], v[176:179]
 MM v[172:175], a[236:239], a[108:111], v[172:175]
 MM v[168:171], a[232:235], a[108:111], v[168:171]
 s_waitcnt lgkmcnt(0)
 s_waitcnt vmcnt(30)
 MM v[0:3], a[208:211], a[112:115], v[0:3]
 ds_read_b128 a[232:235], v254 offset:30720
 s_add_u32 m0, s36, 0
 MM v[4:7], a[212:215], a[112:115], v[4:7]
 ds_read_b128 a[236:239], v253 offset:30720
 s_add_u32 s50, s49, 0
 MM v[8:11], a[216:219], a[112:115], v[8:11]
 buffer_load_dwordx4 v248, s[24:27], s50 offen lds
 MM v[12:15], a[220:223], a[112:115], v[12:15]
 ds_read_b128 a[240:243], v254 offset:32768
 s_add_u32 m0, s36, 1024
 MM v[16:19], a[224:227], a[112:115], v[16:19]
 ds_read_b128 a[244:247], v253 offset:32768
 s_add_u32 s50, s49, 64
 MM v[20:23], a[228:231], a[112:115], v[20:23]
 buffer_load_dwordx4 v248, s[24:27], s50 offen lds
 MM v[44:47], a[228:231], a[116:119], v[44:47]
 ds_read_b128 a[248:251], v254 offset:34816
 s_add_u32 m0, s36, 2048
 MM v[40:43], a[224:227], a[116:119], v[40:43]
 ds_read_b128 a[252:255], v253 offset:34816
 s_add_u32 s50, s49, 16384
 MM v[36:39], a[220:223], a[116:119], v[36:39]
 buffer_load_dwordx4 v248, s[24:27], s50 offen lds
 MM v[32:35], a[216:219], a[116:119], v[32:35]
 s_add_u32 m0, s36, 3072
 s_add_u32 s50, s49, 16448
 MM v[28:31], a[212:215], a[116:119], v[28:31]
 MM v[24:27], a[208:211], a[116:119], v[24:27]
 s_waitcnt vmcnt(31)
 MM v[48:51], a[208:211], a[120:123], v[48:51]
 buffer_load_dwordx4 v248, s[24:27], s50 offen lds
 MM v[52:55], a[212:215], a[120:123], v[52:55]
 s_add_u32 m0, s36, 4096
 s_add_u32 s50, s49, 32768
 MM v[56:59], a[216:219], a[120:123], v[56:59]
 MM v[60:63], a[220:223], a[120:123], v[60:63]
 buffer_load_dwordx4 v248, s[24:27], s50 offen lds
 MM v[64:67], a[224:227], a[120:123], v[64:67]
 MM v[68:71], a[228:231], a[120:123], v[68:71]
 s_add_u32 m0, s36, 5120
 s_add_u32 s50, s49, 32832
 MM v[92:95], a[228:231], a[124:127], v[92:95]
 MM v[88:91], a[224:227], a[124:127], v[88:91]
 buffer_load_dwordx4 v248, s[24:27], s50 offen lds
 MM v[84:87], a[220:223], a[124:127], v[84:87]
 MM v[80:83], a[216:219], a[124:127], v[80:83]
 s_add_u32 m0, s36, 6144
 s_add_u32 s50, s49, 49152
 MM v[76:79], a[212:215], a[124:127], v[76:79]
 MM v[72:75], a[208:211], a[124:127], v[72:75]
 s_waitcnt vmcnt(32)
 MM v[96:99], a[208:211], a[128:131], v[96:99]
 buffer_load_dwordx4 v248, s[24:27], s50 offen lds
 MM v[100:103], a[212:215], a[128:131], v[100:103]
 s_add_u32 m0, s36, 7168
 s_add_u32 s50, s49, 49216
 MM v[104:107], a[216:219], a[128:131], v[104:107]
 MM v[108:111], a[220:223], a[128:131], v[108:111]
 buffer_load_dwordx4 v248, s[24:27], s50 offen lds
 MM v[112:115], a[224:227], a[128:131], v[112:115]
 MM v[116:119], a[228:231], a[128:131], v[116:119]
 s_add_u32 s43, s46, 0
 MM v[140:143], a[228:231], a[132:135], v[140:143]
 MM v[136:139], a[224:227], a[132:135], v[136:139]
 buffer_load_dwordx4 a[136:139], v245, s[8:11], s43 offen offset:0
 MM v[132:135], a[220:223], a[132:135], v[132:135]
 MM v[128:131], a[216:219], a[132:135], v[128:131]
 MM v[124:127], a[212:215], a[132:135], v[124:127]
 MM v[120:123], a[208:211], a[132:135], v[120:123]
 s_waitcnt vmcnt(33)
 MM v[144:147], a[208:211], a[0:3], v[144:147]
 buffer_load_dwordx4 a[140:143], v245, s[8:11], s43 offen offset:1024
 MM v[148:151], a[212:215], a[0:3], v[148:151]
 MM v[152:155], a[216:219], a[0:3], v[152:155]
 MM v[156:159], a[220:223], a[0:3], v[156:159]
 buffer_load_dwordx4 a[144:147], v245, s[8:11], s43 offen offset:2048
 MM v[160:163], a[224:227], a[0:3], v[160:163]
 MM v[164:167], a[228:231], a[0:3], v[164:167]
 MM v[188:191], a[228:231], a[4:7], v[188:191]
 MM v[184:187], a[224:227], a[4:7], v[184:187]
 buffer_load_dwordx4 a[148:151], v245, s[8:11], s43 offen offset:3072
 MM v[180:183], a[220:223], a[4:7], v[180:183]
 MM v[176:179], a[216:219], a[4:7], v[176:179]
 s_add_u32 s43, s46, 4096
 MM v[172:175], a[212:215], a[4:7], v[172:175]
 MM v[168:171], a[208:211], a[4:7], v[168:171]
 s_waitcnt lgkmcnt(0)
 s_waitcnt vmcnt(34)
 MM v[0:3], a[232:235], a[8:11], v[0:3]
 buffer_load_dwordx4 a[152:155], v245, s[8:11], s43 offen offset:0
 MM v[4:7], a[236:239], a[8:11], v[4:7]
 ds_read_b128 a[208:211], v253 offset:36864
 MM v[8:11], a[240:243], a[8:11], v[8:11]
 ds_read_b128 a[212:215], v254 offset:36864
 MM v[12:15], a[244:247], a[8:11], v[12:15]
 buffer_load_dwordx4 a[156:159], v245, s[8:11], s43 offen offset:1024
 MM v[16:19], a[248:251], a[8:11], v[16:19]
 ds_read_b128 a[216:219], v253 offset:38912
 MM v[20:23], a[252:255], a[8:11], v[20:23]
 ds_read_b128 a[220:223], v254 offset:38912
 MM v[44:47], a[252:255], a[12:15], v[44:47]
 ds_read_b128 a[224:227], v253 offset:40960
 MM v[40:43], a[248:251], a[12:15], v[40:43]
 buffer_load_dwordx4 a[160:163], v245, s[8:11], s43 offen offset:2048
 MM v[36:39], a[244:247], a[12:15], v[36:39]
 ds_read_b128 a[228:231], v254 offset:40960
 MM v[32:35], a[240:243], a[12:15], v[32:35]
 MM v[28:31], a[236:239], a[12:15], v[28:31]
 MM v[24:27], a[232:235], a[12:15], v[24:27]
 s_waitcnt vmcnt(35)
 MM v[48:51], a[232:235], a[16:19], v[48:51]
 buffer_load_dwordx4 a[164:167], v245, s[8:11], s43 offen offset:3072
 MM v[52:55], a[236:239], a[16:19], v[52:55]
 s_add_u32 s43, s46, 8192
 MM v[56:59], a[240:243], a[16:19], v[56:59]
 MM v[60:63], a[244:247], a[16:19], v[60:63]
 buffer_load_dwordx4 a[168:171], v245, s[8:11], s43 offen offset:0
 MM v[64:67], a[248:251], a[16:19], v[64:67]
 MM v[68:71], a[252:255], a[16:19], v[68:71]
 s_add_u32 s43, s46, 9216
 MM v[92:95], a[252:255], a[20:23], v[92:95]
 MM v[88:91], a[248:251], a[20:23], v[88:91]
 buffer_load_dwordx4 a[172:175], v245, s[8:11], s43 offen offset:0
 MM v[84:87], a[244:247], a[20:23], v[84:87]
 MM v[80:83], a[240:243], a[20:23], v[80:83]
 MM v[76:79], a[236:239], a[20:23], v[76:79]
 MM v[72:75], a[232:235], a[20:23], v[72:75]
 s_waitcnt vmcnt(36)
 MM v[96:99], a[232:235], a[24:27], v[96:99]
 buffer_load_dwordx4 a[176:179], v245, s[8:11], s43 offen offset:1024
 MM v[100:103], a[236:239], a[24:27], v[100:103]
 MM v[104:107], a[240:243], a[24:27], v[104:107]
 MM v[108:111], a[244:247], a[24:27], v[108:111]
 buffer_load_dwordx4 a[180:183], v245, s[8:11], s43 offen offset:2048
 MM v[112:115], a[248:251], a[24:27], v[112:115]
 MM v[116:119], a[252:255], a[24:27], v[116:119]
 MM v[140:143], a[252:255], a[28:31], v[140:143]
 MM v[136:139], a[248:251], a[28:31], v[136:139]
 buffer_load_dwordx4 a[184:187], v245, s[8:11], s43 offen offset:3072
 MM v[132:135], a[244:247], a[28:31], v[132:135]
 MM v[128:131], a[240:243], a[28:31], v[128:131]
 s_add_u32 s43, s46, 13312
 MM v[124:127], a[236:239], a[28:31], v[124:127]
 MM v[120:123], a[232:235], a[28:31], v[120:123]
 s_waitcnt vmcnt(37)
 MM v[144:147], a[232:235], a[32:35], v[144:147]
 buffer_load_dwordx4 a[188:191], v245, s[8:11], s43 offen offset:0
 MM v[148:151], a[236:239], a[32:35], v[148:151]
 MM v[152:155], a[240:243], a[32:35], v[152:155]
 MM v[156:159], a[244:247], a[32:35], v[156:159]
 buffer_load_dwordx4 a[192:195], v245, s[8:11], s43 offen offset:1024
 MM v[160:163], a[248:251], a[32:35], v[160:163]
 MM v[164:167], a[252:255], a[32:35], v[164:167]
 MM v[188:191], a[252:255], a[36:39], v[188:191]
 MM v[184:187], a[248:251], a[36:39], v[184:187]
 buffer_load_dwordx4 a[196:199], v245, s[8:11], s43 offen offset:2048
 MM v[180:183], a[244:247], a[36:39], v[180:183]
 MM v[176:179], a[240:243], a[36:39], v[176:179]
 MM v[172:175], a[236:239], a[36:39], v[172:175]
 MM v[168:171], a[232:235], a[36:39], v[168:171]
 s_waitcnt lgkmcnt(0)
 s_waitcnt vmcnt(38)
 MM v[0:3], a[208:211], a[40:43], v[0:3]
 buffer_load_dwordx4 a[200:203], v245, s[8:11], s43 offen offset:3072
 MM v[4:7], a[212:215], a[40:43], v[4:7]
 ds_read_b128 a[232:235], v254 offset:43008
 s_add_u32 s43, s46, 17408
 MM v[8:11], a[216:219], a[40:43], v[8:11]
 ds_read_b128 a[236:239], v253 offset:43008
 MM v[12:15], a[220:223], a[40:43], v[12:15]
 buffer_load_dwordx4 a[204:207], v245, s[8:11], s43 offen offset:0
 MM v[16:19], a[224:227], a[40:43], v[16:19]
 ds_read_b128 a[240:243], v254 offset:45056
 MM v[20:23], a[228:231], a[40:43], v[20:23]
 ds_read_b128 a[244:247], v253 offset:45056
 MM v[44:47], a[228:231], a[44:47], v[44:47]
 ds_read_b128 a[248:251], v254 offset:47104
 MM v[40:43], a[224:227], a[44:47], v[40:43]
 ds_read_b128 a[252:255], v253 offset:47104
 MM v[36:39], a[220:223], a[44:47], v[36:39]
 MM v[32:35], a[216:219], a[44:47], v[32:35]
 MM v[28:31], a[212:215], a[44:47], v[28:31]
 MM v[24:27], a[208:211], a[44:47], v[24:27]
 s_waitcnt vmcnt(38)
 MM v[48:51], a[208:211], a[48:51], v[48:51]
 MM v[52:55], a[212:215], a[48:51], v[52:55]
 MM v[56:59], a[216:219], a[48:51], v[56:59]
 MM v[60:63], a[220:223], a[48:51], v[60:63]
 MM v[64:67], a[224:227], a[48:51], v[64:67]
 MM v[68:71], a[228:231], a[48:51], v[68:71]
 MM v[92:95], a[228:231], a[52:55], v[92:95]
 MM v[88:91], a[224:227], a[52:55], v[88:91]
 MM v[84:87], a[220:223], a[52:55], v[84:87]
 MM v[80:83], a[216:219], a[52:55], v[80:83]
 MM v[76:79], a[212:215], a[52:55], v[76:79]
 MM v[72:75], a[208:211], a[52:55], v[72:75]
 s_waitcnt vmcnt(36)
 MM v[96:99], a[208:211], a[56:59], v[96:99]
 MM v[100:103], a[212:215], a[56:59], v[100:103]
 MM v[104:107], a[216:219], a[56:59], v[104:107]
 MM v[108:111], a[220:223], a[56:59], v[108:111]
 MM v[112:115], a[224:227], a[56:59], v[112:115]
 MM v[116:119], a[228:231], a[56:59], v[116:119]
 MM v[140:143], a[228:231], a[60:63], v[140:143]
 MM v[136:139], a[224:227], a[60:63], v[136:139]
 MM v[132:135], a[220:223], a[60:63], v[132:135]
 MM v[128:131], a[216:219], a[60:63], v[128:131]
 MM v[124:127], a[212:215], a[60:63], v[124:127]
 MM v[120:123], a[208:211], a[60:63], v[120:123]
 s_waitcnt vmcnt(34)
 MM v[144:147], a[208:211], a[64:67], v[144:147]
 MM v[148:151], a[212:215], a[64:67], v[148:151]
 MM v[152:155], a[216:219], a[64:67], v[152:155]
 MM v[156:159], a[220:223], a[64:67], v[156:159]
 MM v[160:163], a[224:227], a[64:67], v[160:163]
 MM v[164:167], a[228:231], a[64:67], v[164:167]
 MM v[188:191], a[228:231], a[68:71], v[188:191]
 MM v[184:187], a[224:227], a[68:71], v[184:187]
 MM v[180:183], a[220:223], a[68:71], v[180:183]
 MM v[176:179], a[216:219], a[68:71], v[176:179]
 MM v[172:175], a[212:215], a[68:71], v[172:175]
 MM v[168:171], a[208:211], a[68:71], v[168:171]
 s_waitcnt lgkmcnt(0)
 s_waitcnt vmcnt(32)
 MM v[0:3], a[232:235], a[72:75], v[0:3]
 MM v[4:7], a[236:239], a[72:75], v[4:7]
 MM v[8:11], a[240:243], a[72:75], v[8:11]
 MM v[12:15], a[244:247], a[72:75], v[12:15]
 MM v[16:19], a[248:251], a[72:75], v[16:19]
 MM v[20:23], a[252:255], a[72:75], v[20:23]
 MM v[44:47], a[252:255], a[76:79], v[44:47]
 MM v[40:43], a[248:251], a[76:79], v[40:43]
 MM v[36:39], a[244:247], a[76:79], v[36:39]
 MM v[32:35], a[240:243], a[76:79], v[32:35]
 MM v[28:31], a[236:239], a[76:79], v[28:31]
 MM v[24:27], a[232:235], a[76:79], v[24:27]
 s_waitcnt vmcnt(30)
 MM v[48:51], a[232:235], a[80:83], v[48:51]
 MM v[52:55], a[236:239], a[80:83], v[52:55]
 MM v[56:59], a[240:243], a[80:83], v[56:59]
 MM v[60:63], a[244:247], a[80:83], v[60:63]
 MM v[64:67], a[248:251], a[80:83], v[64:67]
 MM v[68:71], a[252:255], a[80:83], v[68:71]
 s_add_u32 s7, s7, 921600
 MM v[92:95], a[252:255], a[84:87], v[92:95]
 buffer_load_dwordx4 a[80:83], v245, s[8:11], s7 offen offset:0
 MM v[88:91], a[248:251], a[84:87], v[88:91]
 MM v[84:87], a[244:247], a[84:87], v[84:87]
 MM v[80:83], a[240:243], a[84:87], v[80:83]
 MM v[76:79], a[236:239], a[84:87], v[76:79]
 MM v[72:75], a[232:235], a[84:87], v[72:75]
 s_waitcnt vmcnt(29)
 MM v[96:99], a[232:235], a[88:91], v[96:99]
 buffer_load_dwordx4 a[84:87], v245, s[8:11], s7 offen offset:1024
 MM v[100:103], a[236:239], a[88:91], v[100:103]
 MM v[104:107], a[240:243], a[88:91], v[104:107]
 MM v[108:111], a[244:247], a[88:91], v[108:111]
 MM v[112:115], a[248:251], a[88:91], v[112:115]
 MM v[116:119], a[252:255], a[88:91], v[116:119]
 buffer_load_dwordx4 a[88:91], v245, s[8:11], s7 offen offset:2048
 MM v[140:143], a[252:255], a[92:95], v[140:143]
 MM v[136:139], a[248:251], a[92:95], v[136:139]
 MM v[132:135], a[244:247], a[92:95], v[132:135]
 MM v[128:131], a[240:243], a[92:95], v[128:131]
 MM v[124:127], a[236:239], a[92:95], v[124:127]
 MM v[120:123], a[232:235], a[92:95], v[120:123]
 s_waitcnt vmcnt(29)
 MM v[144:147], a[232:235], a[96:99], v[144:147]
 buffer_load_dwordx4 a[92:95], v245, s[8:11], s7 offen offset:3072
 MM v[148:151], a[236:239], a[96:99], v[148:151]
 MM v[152:155], a[240:243], a[96:99], v[152:155]
 MM v[156:159], a[244:247], a[96:99], v[156:159]
 MM v[160:163], a[248:251], a[96:99], v[160:163]
 MM v[164:167], a[252:255], a[96:99], v[164:167]
 s_add_u32 s7, s7, 0x1000
 MM v[188:191], a[252:255], a[100:103], v[188:191]
 buffer_load_dwordx4 a[96:99], v245, s[8:11], s7 offen offset:0
 MM v[184:187], a[248:251], a[100:103], v[184:187]
 MM v[180:183], a[244:247], a[100:103], v[180:183]
 MM v[176:179], a[240:243], a[100:103], v[176:179]
 MM v[172:175], a[236:239], a[100:103], v[172:175]
 MM v[168:171], a[232:235], a[100:103], v[168:171]
 buffer_load_dwordx4 a[100:103], v245, s[8:11], s7 offen offset:1024
 buffer_load_dwordx4 a[104:107], v245, s[8:11], s7 offen offset:2048
 buffer_load_dwordx4 a[108:111], v245, s[8:11], s7 offen offset:3072
 s_add_u32 s7, s7, 0x1000
 buffer_load_dwordx4 a[112:115], v245, s[8:11], s7 offen offset:0
 buffer_load_dwordx4 a[116:119], v245, s[8:11], s7 offen offset:1024
 buffer_load_dwordx4 a[120:123], v245, s[8:11], s7 offen offset:2048
 buffer_load_dwordx4 a[124:127], v245, s[8:11], s7 offen offset:3072
 s_add_u32 s7, s7, 0x1000
 buffer_load_dwordx4 a[128:131], v245, s[8:11], s7 offen offset:0
 buffer_load_dwordx4 a[132:135], v245, s[8:11], s7 offen offset:1024
tail_kernel_s2:
 s_add_u32 s28, s54, s47
 s_addc_u32 s29, s55, 0
 s_and_b32 s29, s29, 0xffff
 s_mov_b32 s30, 4096000
 s_mov_b32 s31, 0x00020000
 v_mov_b32_e64 v195, v248
 s_mul_i32 s33, s3, 24576
 v_mul_u32_u24 v192, 192, v246
 v_bfe_u32 v248, v246, 1, 2
 v_xor_b32_e64 v248, v248, v247
 v_lshl_add_u32 v192, v248, 4, v192
 v_add_u32 v192, s33, v192
 v_lshrrev_b32 v248, 2, v244
 v_mul_u32_u24 v193, 192, v248
 v_add_u32_e64 v193, s33, v193
 v_bfe_u32 v249, v244, 3, 2
 v_and_b32 v248, 3, v244
 v_lshlrev_b32 v248, 1, v248
 v_add_u32 v250, 0, v248
 v_xor_b32 v250, v250, v249
 v_lshl_add_u32 v220, v250, 4, v193
 v_add_u32 v250, 1, v248
 v_xor_b32 v250, v250, v249
 v_lshl_add_u32 v221, v250, 4, v193
 v_add_u32 v250, 2, v248
 v_xor_b32 v250, v250, v249
 v_lshl_add_u32 v222, v250, 4, v193
 v_add_u32 v250, 3, v248
 v_xor_b32 v250, v250, v249
 v_lshl_add_u32 v223, v250, 4, v193
 v_add_u32 v250, 4, v248
 v_xor_b32 v250, v250, v249
 v_lshl_add_u32 v224, v250, 4, v193
 v_add_u32 v250, 5, v248
 v_xor_b32 v250, v250, v249
 v_lshl_add_u32 v225, v250, 4, v193
 buffer_load_dwordx4 a[0:3], v245, s[8:11], s7 offen offset:2048
 buffer_load_dwordx4 a[4:7], v245, s[8:11], s7 offen offset:3072
 s_add_u32 s7, s7, 0x1000
 buffer_load_dwordx4 a[8:11], v245, s[8:11], s7 offen offset:0
 buffer_load_dwordx4 a[12:15], v245, s[8:11], s7 offen offset:1024
 s_barrier
 s_nop 0
 CB v0, v0, v1
 CB v1, v2, v3
 CB v2, v4, v5
 CB v3, v6, v7
 CB v8, v8, v9
 CB v9, v10, v11
 CB v10, v12, v13
 CB v11, v14, v15
 CB v16, v16, v17
 CB v17, v18, v19
 CB v18, v20, v21
 CB v19, v22, v23
 CB v24, v24, v25
 CB v25, v26, v27
 CB v26, v28, v29
 CB v27, v30, v31
 CB v32, v32, v33
 CB v33, v34, v35
 CB v34, v36, v37
 CB v35, v38, v39
 CB v40, v40, v41
 CB v41, v42, v43
 CB v42, v44, v45
 CB v43, v46, v47
 ds_write_b128 v192, v[0:3] offset:0
 ds_write_b128 v192, v[8:11] offset:64
 ds_write_b128 v192, v[16:19] offset:128
 ds_write_b128 v192, v[24:27] offset:3072
 ds_write_b128 v192, v[32:35] offset:3136
 ds_write_b128 v192, v[40:43] offset:3200
 buffer_load_dwordx4 a[16:19], v245, s[8:11], s7 offen offset:2048
 buffer_load_dwordx4 a[20:23], v245, s[8:11], s7 offen offset:3072
 s_add_u32 s7, s7, 0x1000
 buffer_load_dwordx4 a[24:27], v245, s[8:11], s7 offen offset:0
 CB v48, v48, v49
 CB v49, v50, v51
 CB v50, v52, v53
 CB v51, v54, v55
 CB v56, v56, v57
 CB v57, v58, v59
 CB v58, v60, v61
 CB v59, v62, v63
 CB v64, v64, v65
 CB v65, v66, v67
 CB v66, v68, v69
 CB v67, v70, v71
 CB v72, v72, v73
 CB v73, v74, v75
 CB v74, v76, v77
 CB v75, v78, v79
 CB v80, v80, v81
 CB v81, v82, v83
 CB v82, v84, v85
 CB v83, v86, v87
 CB v88, v88, v89
 CB v89, v90, v91
 CB v90, v92, v93
 CB v91, v94, v95
 ds_write_b128 v192, v[48:51] offset:6144
 ds_write_b128 v192, v[56:59] offset:6208
 ds_write_b128 v192, v[64:67] offset:6272
 ds_write_b128 v192, v[72:75] offset:9216
 ds_write_b128 v192, v[80:83] offset:9280
 ds_write_b128 v192, v[88:91] offset:9344
 s_add_u32 s43, s46, 18432
 buffer_load_dwordx4 v[0:3], v245, s[8:11], s43 offen offset:0
 buffer_load_dwordx4 v[4:7], v245, s[8:11], s43 offen offset:1024
 buffer_load_dwordx4 v[8:11], v245, s[8:11], s43 offen offset:2048
 CB v96, v96, v97
 CB v97, v98, v99
 CB v98, v100, v101
 CB v99, v102, v103
 CB v104, v104, v105
 CB v105, v106, v107
 CB v106, v108, v109
 CB v107, v110, v111
 CB v112, v112, v113
 CB v113, v114, v115
 CB v114, v116, v117
 CB v115, v118, v119
 CB v120, v120, v121
 CB v121, v122, v123
 CB v122, v124, v125
 CB v123, v126, v127
 CB v128, v128, v129
 CB v129, v130, v131
 CB v130, v132, v133
 CB v131, v134, v135
 CB v136, v136, v137
 CB v137, v138, v139
 CB v138, v140, v141
 CB v139, v142, v143
 ds_write_b128 v192, v[96:99] offset:12288
 ds_write_b128 v192, v[104:107] offset:12352
 ds_write_b128 v192, v[112:115] offset:12416
 ds_write_b128 v192, v[120:123] offset:15360
 ds_write_b128 v192, v[128:131] offset:15424
 ds_write_b128 v192, v[136:139] offset:15488
 buffer_load_dwordx4 v[12:15], v245, s[8:11], s43 offen offset:3072
 s_add_u32 s43, s46, 22528
 buffer_load_dwordx4 v[16:19], v245, s[8:11], s43 offen offset:0
 buffer_load_dwordx4 v[20:23], v245, s[8:11], s43 offen offset:1024
 CB v144, v144, v145
 CB v145, v146, v147
 CB v146, v148, v149
 CB v147, v150, v151
 CB v152, v152, v153
 CB v153, v154, v155
 CB v154, v156, v157
 CB v155, v158, v159
 CB v160, v160, v161
 CB v161, v162, v163
 CB v162, v164, v165
 CB v163, v166, v167
 CB v168, v168, v169
 CB v169, v170, v171
 CB v170, v172, v173
 CB v171, v174, v175
 CB v176, v176, v177
 CB v177, v178, v179
 CB v178, v180, v181
 CB v179, v182, v183
 CB v184, v184, v185
 CB v185, v186, v187
 CB v186, v188, v189
 CB v187, v190, v191
 ds_write_b128 v192, v[144:147] offset:18432
 ds_write_b128 v192, v[152:155] offset:18496
 ds_write_b128 v192, v[160:163] offset:18560
 ds_write_b128 v192, v[168:171] offset:21504
 ds_write_b128 v192, v[176:179] offset:21568
 ds_write_b128 v192, v[184:187] offset:21632
 buffer_load_dwordx4 v[24:27], v245, s[8:11], s43 offen offset:2048
 buffer_load_dwordx4 v[28:31], v245, s[8:11], s43 offen offset:3072
 s_add_u32 s43, s46, 26624
 buffer_load_dwordx4 v[32:35], v245, s[8:11], s43 offen offset:0
 v_bfe_u32 v248, v244, 3, 1
 v_bfe_u32 v249, v244, 5, 1
 v_lshl_add_u32 v248, v249, 1, v248
 v_and_b32 v249, 3, v244
 v_xor_b32 v248, v248, v249
 v_lshrrev_b32 v249, 2, v244
 v_lshlrev_b32 v194, 7, v249
 v_lshl_add_u32 v194, v248, 5, v194
 s_lshl_b32 s33, s3, 14
 s_add_u32 s33, s33, 98304
 v_add_u32 v194, s33, v194
 v_bfe_u32 v248, v244, 3, 1
 v_bfe_u32 v249, v244, 4, 1
 v_lshl_add_u32 v248, v249, 1, v248
 v_lshrrev_b32 v249, 4, v244
 v_lshlrev_b32 v250, 10, v249
 v_bfe_u32 v249, v244, 2, 2
 v_lshl_add_u32 v250, v249, 7, v250
 v_and_b32_e64 v249, 3, v244
 v_lshl_add_u32 v250, v249, 3, v250
 v_xor_b32_e64 v249, 0, v248
 v_lshl_add_u32 v198, v249, 5, v250
 v_xor_b32_e64 v249, 1, v248
 v_lshl_add_u32 v199, v249, 5, v250
 v_xor_b32_e64 v249, 2, v248
 v_lshl_add_u32 v200, v249, 5, v250
 v_xor_b32_e64 v249, 3, v248
 v_lshl_add_u32 v201, v249, 5, v250
 v_add_u32 v198, 98304, v198
 v_add_u32 v199, 98304, v199
 v_add_u32 v200, 98304, v200
 v_add_u32 v201, 98304, v201
 v_and_b32 v248, 1, v244
 v_lshlrev_b32 v248, 4, v248
 v_mov_b32 v249, 0x3f80
 v_lshlrev_b32 v249, v248, v249
 v_and_b32 v248, 2, v244
 v_cmp_eq_u32_e64 vcc, 0, v248
 s_nop 1
 v_cndmask_b32 v196, 0, v249, vcc
 v_cndmask_b32 v197, v249, 0, vcc
 s_waitcnt vmcnt(47)
 v_add_u32 v248, s36, v245
 ds_read_b128 v[176:179], v248 offset:0
 ds_read_b128 v[180:183], v248 offset:1024
 ds_read_b128 v[184:187], v248 offset:2048
 ds_read_b128 v[188:191], v248 offset:3072
 ds_read_b128 v[226:229], v248 offset:4096
 ds_read_b128 v[230:233], v248 offset:5120
 ds_read_b128 v[234:237], v248 offset:6144
 ds_read_b128 v[238:241], v248 offset:7168
 s_lshl_b32 s51, s38, 6
 s_add_u32 s51, s51, s6
 s_lshl_b32 s56, s51, 8
 s_add_u32 s56, s56, 92291072
 ds_read_b128 a[208:211], v220 offset:0
 ds_read_b128 a[212:215], v221 offset:0
 ds_read_b128 a[216:219], v222 offset:0
 ds_read_b128 a[220:223], v223 offset:0
 ds_read_b128 a[224:227], v224 offset:0
 ds_read_b128 a[228:231], v225 offset:0
 s_waitcnt vmcnt(43)
 s_waitcnt lgkmcnt(0)
 M4 v[128:131], a[136:137], a[208:209], 0
 ds_read_b128 a[232:235], v220 offset:3072
 M4 v[132:135], a[136:137], a[210:211], 0
 ds_read_b128 a[236:239], v221 offset:3072
 M4 v[136:139], a[136:137], a[212:213], 0
 ds_read_b128 a[240:243], v222 offset:3072
 M4 v[140:143], a[136:137], a[214:215], 0
 ds_read_b128 a[244:247], v223 offset:3072
 M4 v[128:131], a[138:139], a[210:211], v[128:131]
 ds_read_b128 a[248:251], v224 offset:3072
 M4 v[132:135], a[138:139], a[212:213], v[132:135]
 ds_read_b128 a[252:255], v225 offset:3072
 M4 v[136:139], a[138:139], a[214:215], v[136:139]
 s_add_u32 s43, s46, 27648
 M4 v[140:143], a[138:139], a[216:217], v[140:143]
 buffer_load_dwordx4 v[36:39], v245, s[8:11], s43 offen offset:0
 M4 v[128:131], a[140:141], a[212:213], v[128:131]
 buffer_load_dwordx4 v[40:43], v245, s[8:11], s43 offen offset:1024
 M4 v[132:135], a[140:141], a[214:215], v[132:135]
 M4 v[136:139], a[140:141], a[216:217], v[136:139]
 M4 v[140:143], a[140:141], a[218:219], v[140:143]
 M4 v[128:131], a[142:143], a[214:215], v[128:131]
 M4 v[132:135], a[142:143], a[216:217], v[132:135]
 buffer_load_dwordx4 v[44:47], v245, s[8:11], s43 offen offset:2048
 M4 v[136:139], a[142:143], a[218:219], v[136:139]
 M4 v[140:143], a[142:143], a[220:221], v[140:143]
 M4 v[128:131], a[144:145], a[216:217], v[128:131]
 M4 v[132:135], a[144:145], a[218:219], v[132:135]
 M4 v[136:139], a[144:145], a[220:221], v[136:139]
 buffer_load_dwordx4 v[48:51], v245, s[8:11], s43 offen offset:3072
 M4 v[140:143], a[144:145], a[222:223], v[140:143]
 M4 v[128:131], a[146:147], a[218:219], v[128:131]
 s_add_u32 s43, s46, 31744
 M4 v[132:135], a[146:147], a[220:221], v[132:135]
 M4 v[136:139], a[146:147], a[222:223], v[136:139]
 M4 v[140:143], a[146:147], a[224:225], v[140:143]
 M4 v[128:131], a[148:149], a[220:221], v[128:131]
 buffer_load_dwordx4 v[52:55], v245, s[8:11], s43 offen offset:0
 M4 v[132:135], a[148:149], a[222:223], v[132:135]
 M4 v[136:139], a[148:149], a[224:225], v[136:139]
 M4 v[140:143], a[148:149], a[226:227], v[140:143]
 M4 v[128:131], a[150:151], a[222:223], v[128:131]
 M4 v[132:135], a[150:151], a[224:225], v[132:135]
 buffer_load_dwordx4 v[56:59], v245, s[8:11], s43 offen offset:1024
 M4 v[136:139], a[150:151], a[226:227], v[136:139]
 M4 v[140:143], a[150:151], a[228:229], v[140:143]
 M4 v[128:131], a[152:153], a[224:225], v[128:131]
 M4 v[132:135], a[152:153], a[226:227], v[132:135]
 M4 v[136:139], a[152:153], a[228:229], v[136:139]
 M4 v[140:143], a[152:153], a[230:231], v[140:143]
 buffer_load_dwordx4 v[60:63], v245, s[8:11], s43 offen offset:2048
 M4 v[128:131], v[196:197], a[216:217], v[128:131]
 M4 v[132:135], v[196:197], a[218:219], v[132:135]
 M4 v[136:139], v[196:197], a[220:221], v[136:139]
 M4 v[140:143], v[196:197], a[222:223], v[140:143]
 s_waitcnt vmcnt(46)
 s_waitcnt lgkmcnt(0)
 M4 v[144:147], a[154:155], a[232:233], 0
 buffer_load_dwordx4 v[64:67], v245, s[8:11], s43 offen offset:3072
 M4 v[148:151], a[154:155], a[234:235], 0
 ds_read_b128 a[208:211], v220 offset:6144
 M4 v[152:155], a[154:155], a[236:237], 0
 ds_read_b128 a[212:215], v221 offset:6144
 M4 v[156:159], a[154:155], a[238:239], 0
 ds_read_b128 a[216:219], v222 offset:6144
 M4 v[144:147], a[156:157], a[234:235], v[144:147]
 ds_read_b128 a[220:223], v223 offset:6144
 M4 v[148:151], a[156:157], a[236:237], v[148:151]
 ds_read_b128 a[224:227], v224 offset:6144
 M4 v[152:155], a[156:157], a[238:239], v[152:155]
 ds_read_b128 a[228:231], v225 offset:6144
 M4 v[156:159], a[156:157], a[240:241], v[156:159]
 s_add_u32 s43, s46, 35840
 M4 v[144:147], a[158:159], a[236:237], v[144:147]
 buffer_load_dwordx4 v[68:71], v245, s[8:11], s43 offen offset:0
 M4 v[148:151], a[158:159], a[238:239], v[148:151]
 CB v160, v128, v129
 M4 v[152:155], a[158:159], a[240:241], v[152:155]
 CB v161, v130, v131
 M4 v[156:159], a[158:159], a[242:243], v[156:159]
 buffer_load_dwordx4 a[28:31], v245, s[8:11], s7 offen offset:1024
 M4 v[144:147], a[160:161], a[238:239], v[144:147]
 CB v162, v132, v133
 M4 v[148:151], a[160:161], a[240:241], v[148:151]
 CB v163, v134, v135
 M4 v[152:155], a[160:161], a[242:243], v[152:155]
 ds_write_b128 v194, v[160:163] offset:0
 M4 v[156:159], a[160:161], a[244:245], v[156:159]
 CB v164, v136, v137
 M4 v[144:147], a[162:163], a[240:241], v[144:147]
 buffer_load_dwordx4 a[32:35], v245, s[8:11], s7 offen offset:2048
 M4 v[148:151], a[162:163], a[242:243], v[148:151]
 CB v165, v138, v139
 M4 v[152:155], a[162:163], a[244:245], v[152:155]
 CB v166, v140, v141
 M4 v[156:159], a[162:163], a[246:247], v[156:159]
 CB v167, v142, v143
 M4 v[144:147], a[164:165], a[242:243], v[144:147]
 ds_write_b128 v194, v[164:167] offset:16
 M4 v[148:151], a[164:165], a[244:245], v[148:151]
 M4 v[152:155], a[164:165], a[246:247], v[152:155]
 buffer_load_dwordx4 a[36:39], v245, s[8:11], s7 offen offset:3072
 M4 v[156:159], a[164:165], a[248:249], v[156:159]
 M4 v[144:147], a[166:167], a[244:245], v[144:147]
 s_add_u32 s7, s7, 0x1000
 M4 v[148:151], a[166:167], a[246:247], v[148:151]
 M4 v[152:155], a[166:167], a[248:249], v[152:155]
 M4 v[156:159], a[166:167], a[250:251], v[156:159]
 buffer_load_dwordx4 a[40:43], v245, s[8:11], s7 offen offset:0
 M4 v[144:147], a[168:169], a[246:247], v[144:147]
 M4 v[148:151], a[168:169], a[248:249], v[148:151]
 M4 v[152:155], a[168:169], a[250:251], v[152:155]
 M4 v[156:159], a[168:169], a[252:253], v[156:159]
 M4 v[144:147], a[170:171], a[248:249], v[144:147]
 M4 v[148:151], a[170:171], a[250:251], v[148:151]
 buffer_load_dwordx4 a[44:47], v245, s[8:11], s7 offen offset:1024
 M4 v[152:155], a[170:171], a[252:253], v[152:155]
 M4 v[156:159], a[170:171], a[254:255], v[156:159]
 M4 v[144:147], v[196:197], a[240:241], v[144:147]
 M4 v[148:151], v[196:197], a[242:243], v[148:151]
 M4 v[152:155], v[196:197], a[244:245], v[152:155]
 buffer_load_dwordx4 a[48:51], v245, s[8:11], s7 offen offset:2048
 M4 v[156:159], v[196:197], a[246:247], v[156:159]
 s_waitcnt vmcnt(49)
 s_waitcnt lgkmcnt(2)
 M4 v[128:131], a[172:173], a[208:209], 0
 ds_read_b128 a[232:235], v220 offset:9216
 M4 v[132:135], a[172:173], a[210:211], 0
 ds_read_b128 a[236:239], v221 offset:9216
 M4 v[136:139], a[172:173], a[212:213], 0
 ds_read_b128 a[240:243], v222 offset:9216
 M4 v[140:143], a[172:173], a[214:215], 0
 buffer_load_dwordx4 a[52:55], v245, s[8:11], s7 offen offset:3072
 M4 v[128:131], a[174:175], a[210:211], v[128:131]
 ds_read_b128 a[244:247], v223 offset:9216
 M4 v[132:135], a[174:175], a[212:213], v[132:135]
 ds_read_b128 a[248:251], v224 offset:9216
 M4 v[136:139], a[174:175], a[214:215], v[136:139]
 ds_read_b128 a[252:255], v225 offset:9216
 M4 v[140:143], a[174:175], a[216:217], v[140:143]
 s_add_u32 s7, s7, 0x1000
 M4 v[128:131], a[176:177], a[212:213], v[128:131]
 CB v168, v144, v145
 M4 v[132:135], a[176:177], a[214:215], v[132:135]
 buffer_load_dwordx4 a[56:59], v245, s[8:11], s7 offen offset:0
 M4 v[136:139], a[176:177], a[216:217], v[136:139]
 CB v169, v146, v147
 M4 v[140:143], a[176:177], a[218:219], v[140:143]
 CB v170, v148, v149
 M4 v[128:131], a[178:179], a[214:215], v[128:131]
 CB v171, v150, v151
 M4 v[132:135], a[178:179], a[216:217], v[132:135]
 ds_write_b128 v194, v[168:171] offset:2048
 M4 v[136:139], a[178:179], a[218:219], v[136:139]
 buffer_load_dwordx4 a[60:63], v245, s[8:11], s7 offen offset:1024
 M4 v[140:143], a[178:179], a[220:221], v[140:143]
 CB v172, v152, v153
 M4 v[128:131], a[180:181], a[216:217], v[128:131]
 CB v173, v154, v155
 M4 v[132:135], a[180:181], a[218:219], v[132:135]
 CB v174, v156, v157
 M4 v[136:139], a[180:181], a[220:221], v[136:139]
 CB v175, v158, v159
 M4 v[140:143], a[180:181], a[222:223], v[140:143]
 ds_write_b128 v194, v[172:175] offset:2064
 M4 v[128:131], a[182:183], a[218:219], v[128:131]
 buffer_load_dwordx4 a[64:67], v245, s[8:11], s7 offen offset:2048
 M4 v[132:135], a[182:183], a[220:221], v[132:135]
 M4 v[136:139], a[182:183], a[222:223], v[136:139]
 M4 v[140:143], a[182:183], a[224:225], v[140:143]
 M4 v[128:131], a[184:185], a[220:221], v[128:131]
 M4 v[132:135], a[184:185], a[222:223], v[132:135]
 buffer_load_dwordx4 a[68:71], v245, s[8:11], s7 offen offset:3072
 M4 v[136:139], a[184:185], a[224:225], v[136:139]
 M4 v[140:143], a[184:185], a[226:227], v[140:143]
 s_add_u32 s7, s7, 0x1000
 M4 v[128:131], a[186:187], a[222:223], v[128:131]
 M4 v[132:135], a[186:187], a[224:225], v[132:135]
 M4 v[136:139], a[186:187], a[226:227], v[136:139]
 M4 v[140:143], a[186:187], a[228:229], v[140:143]
 buffer_load_dwordx4 a[72:75], v245, s[8:11], s7 offen offset:0
 M4 v[128:131], a[188:189], a[224:225], v[128:131]
 M4 v[132:135], a[188:189], a[226:227], v[132:135]
 M4 v[136:139], a[188:189], a[228:229], v[136:139]
 M4 v[140:143], a[188:189], a[230:231], v[140:143]
 M4 v[128:131], v[196:197], a[216:217], v[128:131]
 buffer_load_dwordx4 a[76:79], v245, s[8:11], s7 offen offset:1024
 M4 v[132:135], v[196:197], a[218:219], v[132:135]
 M4 v[136:139], v[196:197], a[220:221], v[136:139]
 M4 v[140:143], v[196:197], a[222:223], v[140:143]
 s_waitcnt vmcnt(52)
 s_waitcnt lgkmcnt(2)
 M4 v[144:147], a[190:191], a[232:233], 0
 ds_read_b128 a[208:211], v220 offset:12288
 M4 v[148:151], a[190:191], a[234:235], 0
 buffer_load_dwordx4 a[136:139], v245, s[8:11], s7 offen offset:2048
 M4 v[152:155], a[190:191], a[236:237], 0
 ds_read_b128 a[212:215], v221 offset:12288
 M4 v[156:159], a[190:191], a[238:239], 0
 ds_read_b128 a[216:219], v222 offset:12288
 M4 v[144:147], a[192:193], a[234:235], v[144:147]
 ds_read_b128 a[220:223], v223 offset:12288
 M4 v[148:151], a[192:193], a[236:237], v[148:151]
 ds_read_b128 a[224:227], v224 offset:12288
 M4 v[152:155], a[192:193], a[238:239], v[152:155]
 ds_read_b128 a[228:231], v225 offset:12288
 M4 v[156:159], a[192:193], a[240:241], v[156:159]
 buffer_load_dwordx4 a[140:143], v245, s[8:11], s7 offen offset:3072
 M4 v[144:147], a[194:195], a[236:237], v[144:147]
 CB v160, v128, v129
 M4 v[148:151], a[194:195], a[238:239], v[148:151]
 s_add_u32 s7, s7, 0x1000
 M4 v[152:155], a[194:195], a[240:241], v[152:155]
 CB v161, v130, v131
 M4 v[156:159], a[194:195], a[242:243], v[156:159]
 CB v162, v132, v133
 M4 v[144:147], a[196:197], a[238:239], v[144:147]
 buffer_load_dwordx4 a[144:147], v245, s[8:11], s7 offen offset:0
 M4 v[148:151], a[196:197], a[240:241], v[148:151]
 CB v163, v134, v135
 M4 v[152:155], a[196:197], a[242:243], v[152:155]
 ds_write_b128 v194, v[160:163] offset:4096
 M4 v[156:159], a[196:197], a[244:245], v[156:159]
 CB v164, v136, v137
 M4 v[144:147], a[198:199], a[240:241], v[144:147]
 CB v165, v138, v139
 M4 v[148:151], a[198:199], a[242:243], v[148:151]
 CB v166, v140, v141
 M4 v[152:155], a[198:199], a[244:245], v[152:155]
 buffer_load_dwordx4 a[148:151], v245, s[8:11], s7 offen offset:1024
 M4 v[156:159], a[198:199], a[246:247], v[156:159]
 CB v167, v142, v143
 M4 v[144:147], a[200:201], a[242:243], v[144:147]
 ds_write_b128 v194, v[164:167] offset:4112
 M4 v[148:151], a[200:201], a[244:245], v[148:151]
 M4 v[152:155], a[200:201], a[246:247], v[152:155]
 M4 v[156:159], a[200:201], a[248:249], v[156:159]
 buffer_load_dwordx4 a[152:155], v245, s[8:11], s7 offen offset:2048
 M4 v[144:147], a[202:203], a[244:245], v[144:147]
 M4 v[148:151], a[202:203], a[246:247], v[148:151]
 M4 v[152:155], a[202:203], a[248:249], v[152:155]
 M4 v[156:159], a[202:203], a[250:251], v[156:159]
 M4 v[144:147], a[204:205], a[246:247], v[144:147]
 M4 v[148:151], a[204:205], a[248:249], v[148:151]
 buffer_load_dwordx4 a[156:159], v245, s[8:11], s7 offen offset:3072
 M4 v[152:155], a[204:205], a[250:251], v[152:155]
 M4 v[156:159], a[204:205], a[252:253], v[156:159]
 s_add_u32 s7, s7, 0x1000
 M4 v[144:147], a[206:207], a[248:249], v[144:147]
 M4 v[148:151], a[206:207], a[250:251], v[148:151]
 M4 v[152:155], a[206:207], a[252:253], v[152:155]
 buffer_load_dwordx4 a[160:163], v245, s[8:11], s7 offen offset:0
 M4 v[156:159], a[206:207], a[254:255], v[156:159]
 M4 v[144:147], v[196:197], a[240:241], v[144:147]
 M4 v[148:151], v[196:197], a[242:243], v[148:151]
 M4 v[152:155], v[196:197], a[244:245], v[152:155]
 M4 v[156:159], v[196:197], a[246:247], v[156:159]
 s_waitcnt vmcnt(33)
 s_waitcnt lgkmcnt(2)
 M4 v[128:131], v[0:1], a[208:209], 0
 buffer_load_dwordx4 a[164:167], v245, s[8:11], s7 offen offset:1024
 M4 v[132:135], v[0:1], a[210:211], 0
 ds_read_b128 a[232:235], v220 offset:15360
 M4 v[136:139], v[0:1], a[212:213], 0
 ds_read_b128 a[236:239], v221 offset:15360
 M4 v[140:143], v[0:1], a[214:215], 0
 ds_read_b128 a[240:243], v222 offset:15360
 M4 v[128:131], v[2:3], a[210:211], v[128:131]
 ds_read_b128 a[244:247], v223 offset:15360
 M4 v[132:135], v[2:3], a[212:213], v[132:135]
 buffer_load_dwordx4 a[168:171], v245, s[8:11], s7 offen offset:2048
 M4 v[136:139], v[2:3], a[214:215], v[136:139]
 ds_read_b128 a[248:251], v224 offset:15360
 M4 v[140:143], v[2:3], a[216:217], v[140:143]
 ds_read_b128 a[252:255], v225 offset:15360
 M4 v[128:131], v[4:5], a[212:213], v[128:131]
 CB v168, v144, v145
 M4 v[132:135], v[4:5], a[214:215], v[132:135]
 CB v169, v146, v147
 M4 v[136:139], v[4:5], a[216:217], v[136:139]
 buffer_load_dwordx4 a[172:175], v245, s[8:11], s7 offen offset:3072
 M4 v[140:143], v[4:5], a[218:219], v[140:143]
 CB v170, v148, v149
 M4 v[128:131], v[6:7], a[214:215], v[128:131]
 s_add_u32 s7, s7, 0x1000
 M4 v[132:135], v[6:7], a[216:217], v[132:135]
 CB v171, v150, v151
 M4 v[136:139], v[6:7], a[218:219], v[136:139]
 ds_write_b128 v194, v[168:171] offset:6144
 M4 v[140:143], v[6:7], a[220:221], v[140:143]
 CB v172, v152, v153
 M4 v[128:131], v[8:9], a[216:217], v[128:131]
 buffer_load_dwordx4 a[176:179], v245, s[8:11], s7 offen offset:0
 M4 v[132:135], v[8:9], a[218:219], v[132:135]
 CB v173, v154, v155
 M4 v[136:139], v[8:9], a[220:221], v[136:139]
 CB v174, v156, v157
 M4 v[140:143], v[8:9], a[222:223], v[140:143]
 CB v175, v158, v159
 M4 v[128:131], v[10:11], a[218:219], v[128:131]
 ds_write_b128 v194, v[172:175] offset:6160
 M4 v[132:135], v[10:11], a[220:221], v[132:135]
 buffer_load_dwordx4 a[180:183], v245, s[8:11], s7 offen offset:1024
 M4 v[136:139], v[10:11], a[222:223], v[136:139]
 M4 v[140:143], v[10:11], a[224:225], v[140:143]
 M4 v[128:131], v[12:13], a[220:221], v[128:131]
 M4 v[132:135], v[12:13], a[222:223], v[132:135]
 M4 v[136:139], v[12:13], a[224:225], v[136:139]
 M4 v[140:143], v[12:13], a[226:227], v[140:143]
 buffer_load_dwordx4 a[184:187], v245, s[8:11], s7 offen offset:2048
 M4 v[128:131], v[14:15], a[222:223], v[128:131]
 M4 v[132:135], v[14:15], a[224:225], v[132:135]
 M4 v[136:139], v[14:15], a[226:227], v[136:139]
 M4 v[140:143], v[14:15], a[228:229], v[140:143]
 M4 v[128:131], v[16:17], a[224:225], v[128:131]
 buffer_load_dwordx4 a[188:191], v245, s[8:11], s7 offen offset:3072
 M4 v[132:135], v[16:17], a[226:227], v[132:135]
 M4 v[136:139], v[16:17], a[228:229], v[136:139]
 s_add_u32 s7, s7, 0x1000
 M4 v[140:143], v[16:17], a[230:231], v[140:143]
 M4 v[128:131], v[196:197], a[216:217], v[128:131]
 M4 v[132:135], v[196:197], a[218:219], v[132:135]
 M4 v[136:139], v[196:197], a[220:221], v[136:139]
 buffer_load_dwordx4 a[192:195], v245, s[8:11], s7 offen offset:0
 M4 v[140:143], v[196:197], a[222:223], v[140:143]
 s_waitcnt vmcnt(37)
 s_waitcnt lgkmcnt(2)
 M4 v[144:147], v[18:19], a[232:233], 0
 ds_read_b128 a[208:211], v220 offset:18432
 M4 v[148:151], v[18:19], a[234:235], 0
 ds_read_b128 a[212:215], v221 offset:18432
 M4 v[152:155], v[18:19], a[236:237], 0
 ds_read_b128 a[216:219], v222 offset:18432
 M4 v[156:159], v[18:19], a[238:239], 0
 buffer_load_dwordx4 a[196:199], v245, s[8:11], s7 offen offset:1024
 M4 v[144:147], v[20:21], a[234:235], v[144:147]
 ds_read_b128 a[220:223], v223 offset:18432
 M4 v[148:151], v[20:21], a[236:237], v[148:151]
 ds_read_b128 a[224:227], v224 offset:18432
 M4 v[152:155], v[20:21], a[238:239], v[152:155]
 ds_read_b128 a[228:231], v225 offset:18432
 M4 v[156:159], v[20:21], a[240:241], v[156:159]
 CB v160, v128, v129
 M4 v[144:147], v[22:23], a[236:237], v[144:147]
 buffer_load_dwordx4 a[200:203], v245, s[8:11], s7 offen offset:2048
 M4 v[148:151], v[22:23], a[238:239], v[148:151]
 CB v161, v130, v131
 M4 v[152:155], v[22:23], a[240:241], v[152:155]
 CB v162, v132, v133
 M4 v[156:159], v[22:23], a[242:243], v[156:159]
 CB v163, v134, v135
 M4 v[144:147], v[24:25], a[238:239], v[144:147]
 ds_write_b128 v194, v[160:163] offset:8192
 M4 v[148:151], v[24:25], a[240:241], v[148:151]
 CB v164, v136, v137
 M4 v[152:155], v[24:25], a[242:243], v[152:155]
 buffer_load_dwordx4 a[204:207], v245, s[8:11], s7 offen offset:3072
 M4 v[156:159], v[24:25], a[244:245], v[156:159]
 CB v165, v138, v139
 M4 v[144:147], v[26:27], a[240:241], v[144:147]
 CB v166, v140, v141
 M4 v[148:151], v[26:27], a[242:243], v[148:151]
 CB v167, v142, v143
 M4 v[152:155], v[26:27], a[244:245], v[152:155]
 ds_write_b128 v194, v[164:167] offset:8208
 M4 v[156:159], v[26:27], a[246:247], v[156:159]
 M4 v[144:147], v[28:29], a[242:243], v[144:147]
 M4 v[148:151], v[28:29], a[244:245], v[148:151]
 M4 v[152:155], v[28:29], a[246:247], v[152:155]
 M4 v[156:159], v[28:29], a[248:249], v[156:159]
 M4 v[144:147], v[30:31], a[244:245], v[144:147]
 M4 v[148:151], v[30:31], a[246:247], v[148:151]
 M4 v[152:155], v[30:31], a[248:249], v[152:155]
 M4 v[156:159], v[30:31], a[250:251], v[156:159]
 M4 v[144:147], v[32:33], a[246:247], v[144:147]
 M4 v[148:151], v[32:33], a[248:249], v[148:151]
 M4 v[152:155], v[32:33], a[250:251], v[152:155]
 M4 v[156:159], v[32:33], a[252:253], v[156:159]
 M4 v[144:147], v[34:35], a[248:249], v[144:147]
 M4 v[148:151], v[34:35], a[250:251], v[148:151]
 M4 v[152:155], v[34:35], a[252:253], v[152:155]
 M4 v[156:159], v[34:35], a[254:255], v[156:159]
 M4 v[144:147], v[196:197], a[240:241], v[144:147]
 M4 v[148:151], v[196:197], a[242:243], v[148:151]
 M4 v[152:155], v[196:197], a[244:245], v[152:155]
 M4 v[156:159], v[196:197], a[246:247], v[156:159]
 s_waitcnt vmcnt(35)
 s_waitcnt lgkmcnt(2)
 M4 v[128:131], v[36:37], a[208:209], 0
 ds_read_b128 a[232:235], v220 offset:21504
 M4 v[132:135], v[36:37], a[210:211], 0
 ds_read_b128 a[236:239], v221 offset:21504
 M4 v[136:139], v[36:37], a[212:213], 0
 ds_read_b128 a[240:243], v222 offset:21504
 M4 v[140:143], v[36:37], a[214:215], 0
 ds_read_b128 a[244:247], v223 offset:21504
 M4 v[128:131], v[38:39], a[210:211], v[128:131]
 ds_read_b128 a[248:251], v224 offset:21504
 M4 v[132:135], v[38:39], a[212:213], v[132:135]
 ds_read_b128 a[252:255], v225 offset:21504
 M4 v[136:139], v[38:39], a[214:215], v[136:139]
 CB v168, v144, v145
 M4 v[140:143], v[38:39], a[216:217], v[140:143]
 CB v169, v146, v147
 M4 v[128:131], v[40:41], a[212:213], v[128:131]
 CB v170, v148, v149
 M4 v[132:135], v[40:41], a[214:215], v[132:135]
 CB v171, v150, v151
 M4 v[136:139], v[40:41], a[216:217], v[136:139]
 ds_write_b128 v194, v[168:171] offset:10240
 M4 v[140:143], v[40:41], a[218:219], v[140:143]
 CB v172, v152, v153
 M4 v[128:131], v[42:43], a[214:215], v[128:131]
 CB v173, v154, v155
 M4 v[132:135], v[42:43], a[216:217], v[132:135]
 CB v174, v156, v157
 M4 v[136:139], v[42:43], a[218:219], v[136:139]
 CB v175, v158, v159
 M4 v[140:143], v[42:43], a[220:221], v[140:143]
 ds_write_b128 v194, v[172:175] offset:10256
 M4 v[128:131], v[44:45], a[216:217], v[128:131]
 M4 v[132:135], v[44:45], a[218:219], v[132:135]
 M4 v[136:139], v[44:45], a[220:221], v[136:139]
 M4 v[140:143], v[44:45], a[222:223], v[140:143]
 M4 v[128:131], v[46:47], a[218:219], v[128:131]
 M4 v[132:135], v[46:47], a[220:221], v[132:135]
 M4 v[136:139], v[46:47], a[222:223], v[136:139]
 M4 v[140:143], v[46:47], a[224:225], v[140:143]
 M4 v[128:131], v[48:49], a[220:221], v[128:131]
 M4 v[132:135], v[48:49], a[222:223], v[132:135]
 M4 v[136:139], v[48:49], a[224:225], v[136:139]
 M4 v[140:143], v[48:49], a[226:227], v[140:143]
 M4 v[128:131], v[50:51], a[222:223], v[128:131]
 M4 v[132:135], v[50:51], a[224:225], v[132:135]
 M4 v[136:139], v[50:51], a[226:227], v[136:139]
 M4 v[140:143], v[50:51], a[228:229], v[140:143]
 M4 v[128:131], v[52:53], a[224:225], v[128:131]
 M4 v[132:135], v[52:53], a[226:227], v[132:135]
 M4 v[136:139], v[52:53], a[228:229], v[136:139]
 M4 v[140:143], v[52:53], a[230:231], v[140:143]
 M4 v[128:131], v[196:197], a[216:217], v[128:131]
 M4 v[132:135], v[196:197], a[218:219], v[132:135]
 M4 v[136:139], v[196:197], a[220:221], v[136:139]
 M4 v[140:143], v[196:197], a[222:223], v[140:143]
 s_waitcnt vmcnt(31)
 s_waitcnt lgkmcnt(2)
 M4 v[144:147], v[54:55], a[232:233], 0
 M4 v[148:151], v[54:55], a[234:235], 0
 M4 v[152:155], v[54:55], a[236:237], 0
 M4 v[156:159], v[54:55], a[238:239], 0
 CB v160, v128, v129
 M4 v[144:147], v[56:57], a[234:235], v[144:147]
 CB v161, v130, v131
 M4 v[148:151], v[56:57], a[236:237], v[148:151]
 CB v162, v132, v133
 M4 v[152:155], v[56:57], a[238:239], v[152:155]
 CB v163, v134, v135
 M4 v[156:159], v[56:57], a[240:241], v[156:159]
 ds_write_b128 v194, v[160:163] offset:12288
 M4 v[144:147], v[58:59], a[236:237], v[144:147]
 CB v164, v136, v137
 M4 v[148:151], v[58:59], a[238:239], v[148:151]
 CB v165, v138, v139
 M4 v[152:155], v[58:59], a[240:241], v[152:155]
 CB v166, v140, v141
 M4 v[156:159], v[58:59], a[242:243], v[156:159]
 CB v167, v142, v143
 M4 v[144:147], v[60:61], a[238:239], v[144:147]
 ds_write_b128 v194, v[164:167] offset:12304
 M4 v[148:151], v[60:61], a[240:241], v[148:151]
 M4 v[152:155], v[60:61], a[242:243], v[152:155]
 M4 v[156:159], v[60:61], a[244:245], v[156:159]
 M4 v[144:147], v[62:63], a[240:241], v[144:147]
 M4 v[148:151], v[62:63], a[242:243], v[148:151]
 M4 v[152:155], v[62:63], a[244:245], v[152:155]
 M4 v[156:159], v[62:63], a[246:247], v[156:159]
 M4 v[144:147], v[64:65], a[242:243], v[144:147]
 M4 v[148:151], v[64:65], a[244:245], v[148:151]
 M4 v[152:155], v[64:65], a[246:247], v[152:155]
 M4 v[156:159], v[64:65], a[248:249], v[156:159]
 M4 v[144:147], v[66:67], a[244:245], v[144:147]
 M4 v[148:151], v[66:67], a[246:247], v[148:151]
 M4 v[152:155], v[66:67], a[248:249], v[152:155]
 M4 v[156:159], v[66:67], a[250:251], v[156:159]
 M4 v[144:147], v[68:69], a[246:247], v[144:147]
 M4 v[148:151], v[68:69], a[248:249], v[148:151]
 M4 v[152:155], v[68:69], a[250:251], v[152:155]
 M4 v[156:159], v[68:69], a[252:253], v[156:159]
 M4 v[144:147], v[70:71], a[248:249], v[144:147]
 M4 v[148:151], v[70:71], a[250:251], v[148:151]
 M4 v[152:155], v[70:71], a[252:253], v[152:155]
 M4 v[156:159], v[70:71], a[254:255], v[156:159]
 M4 v[144:147], v[196:197], a[240:241], v[144:147]
 M4 v[148:151], v[196:197], a[242:243], v[148:151]
 M4 v[152:155], v[196:197], a[244:245], v[152:155]
 M4 v[156:159], v[196:197], a[246:247], v[156:159]
 s_nop 1
 CB v168, v144, v145
 CB v169, v146, v147
 CB v170, v148, v149
 CB v171, v150, v151
 ds_write_b128 v194, v[168:171] offset:14336
 CB v172, v152, v153
 CB v173, v154, v155
 CB v174, v156, v157
 CB v175, v158, v159
 ds_write_b128 v194, v[172:175] offset:14352
 s_waitcnt lgkmcnt(0)
 s_barrier
 ds_read_b64_tr_b16 a[208:209], v198 offset:0
 ds_read_b64_tr_b16 a[210:211], v198 offset:512
 ds_read_b64_tr_b16 a[212:213], v199 offset:0
 ds_read_b64_tr_b16 a[214:215], v199 offset:512
 ds_read_b64_tr_b16 a[216:217], v200 offset:0
 ds_read_b64_tr_b16 a[218:219], v200 offset:512
 ds_read_b64_tr_b16 a[220:221], v201 offset:0
 ds_read_b64_tr_b16 a[222:223], v201 offset:512
 ds_read_b64_tr_b16 a[224:225], v198 offset:4096
 ds_read_b64_tr_b16 a[226:227], v198 offset:4608
 ds_read_b64_tr_b16 a[228:229], v199 offset:4096
 ds_read_b64_tr_b16 a[230:231], v199 offset:4608
 ds_read_b64_tr_b16 a[232:233], v200 offset:4096
 ds_read_b64_tr_b16 a[234:235], v200 offset:4608
 ds_read_b64_tr_b16 a[236:237], v201 offset:4096
 ds_read_b64_tr_b16 a[238:239], v201 offset:4608
 s_lshl_b32 s57, s51, 16
 s_lshl_b32 s33, s3, 13
 s_add_u32 s57, s57, s33
 s_add_u32 s57, s57, 69206016
 s_lshl_b32 s33, s37, 15
 s_add_u32 s48, s57, s33
 s_xor_b32 s33, s33, 0x8000
 s_add_u32 s57, s57, s33
 s_add_u32 s58, s57, 0x1000
 s_waitcnt lgkmcnt(8)
 MM v[0:3], a[80:83], a[208:211], 0
 ds_read_b64_tr_b16 a[240:241], v198 offset:8192
 MM v[4:7], a[80:83], a[212:215], 0
 ds_read_b64_tr_b16 a[242:243], v198 offset:8704
 MM v[8:11], a[80:83], a[216:219], 0
 ds_read_b64_tr_b16 a[244:245], v199 offset:8192
 MM v[12:15], a[80:83], a[220:223], 0
 ds_read_b64_tr_b16 a[246:247], v199 offset:8704
 s_add_u32 s7, s7, 0x1000
 MM v[28:31], a[84:87], a[220:223], 0
 buffer_load_dwordx4 a[80:83], v245, s[8:11], s7 offen offset:0
 MM v[24:27], a[84:87], a[216:219], 0
 ds_read_b64_tr_b16 a[248:249], v200 offset:8192
 MM v[20:23], a[84:87], a[212:215], 0
 ds_read_b64_tr_b16 a[250:251], v200 offset:8704
 MM v[16:19], a[84:87], a[208:211], 0
 buffer_load_dwordx4 a[84:87], v245, s[8:11], s7 offen offset:1024
 MM v[32:35], a[88:91], a[208:211], 0
 ds_read_b64_tr_b16 a[252:253], v201 offset:8192
 MM v[36:39], a[88:91], a[212:215], 0
 ds_read_b64_tr_b16 a[254:255], v201 offset:8704
 MM v[40:43], a[88:91], a[216:219], 0
 MM v[44:47], a[88:91], a[220:223], 0
 buffer_load_dwordx4 a[88:91], v245, s[8:11], s7 offen offset:2048
 MM v[60:63], a[92:95], a[220:223], 0
 MM v[56:59], a[92:95], a[216:219], 0
 MM v[52:55], a[92:95], a[212:215], 0
 MM v[48:51], a[92:95], a[208:211], 0
 s_waitcnt lgkmcnt(8)
 MM v[0:3], a[96:99], a[224:227], v[0:3]
 buffer_load_dwordx4 a[92:95], v245, s[8:11], s7 offen offset:3072
 MM v[4:7], a[96:99], a[228:231], v[4:7]
 ds_read_b64_tr_b16 a[208:209], v198 offset:12288
 MM v[8:11], a[96:99], a[232:235], v[8:11]
 ds_read_b64_tr_b16 a[210:211], v198 offset:12800
 MM v[12:15], a[96:99], a[236:239], v[12:15]
 ds_read_b64_tr_b16 a[212:213], v199 offset:12288
 s_add_u32 s7, s7, 0x1000
 MM v[28:31], a[100:103], a[236:239], v[28:31]
 buffer_load_dwordx4 a[96:99], v245, s[8:11], s7 offen offset:0
 MM v[24:27], a[100:103], a[232:235], v[24:27]
 ds_read_b64_tr_b16 a[214:215], v199 offset:12800
 MM v[20:23], a[100:103], a[228:231], v[20:23]
 ds_read_b64_tr_b16 a[216:217], v200 offset:12288
 MM v[16:19], a[100:103], a[224:227], v[16:19]
 buffer_load_dwordx4 a[100:103], v245, s[8:11], s7 offen offset:1024
 MM v[32:35], a[104:107], a[224:227], v[32:35]
 ds_read_b64_tr_b16 a[218:219], v200 offset:12800
 MM v[36:39], a[104:107], a[228:231], v[36:39]
 ds_read_b64_tr_b16 a[220:221], v201 offset:12288
 MM v[40:43], a[104:107], a[232:235], v[40:43]
 ds_read_b64_tr_b16 a[222:223], v201 offset:12800
 MM v[44:47], a[104:107], a[236:239], v[44:47]
 buffer_load_dwordx4 a[104:107], v245, s[8:11], s7 offen offset:2048
 MM v[60:63], a[108:111], a[236:239], v[60:63]
 MM v[56:59], a[108:111], a[232:235], v[56:59]
 MM v[52:55], a[108:111], a[228:231], v[52:55]
 MM v[48:51], a[108:111], a[224:227], v[48:51]
 s_waitcnt lgkmcnt(8)
 MM v[0:3], a[112:115], a[240:243], v[0:3]
 buffer_load_dwordx4 a[108:111], v245, s[8:11], s7 offen offset:3072
 MM v[4:7], a[112:115], a[244:247], v[4:7]
 ds_read_b64_tr_b16 a[224:225], v198 offset:16384
 MM v[8:11], a[112:115], a[248:251], v[8:11]
 ds_read_b64_tr_b16 a[226:227], v198 offset:16896
 MM v[12:15], a[112:115], a[252:255], v[12:15]
 ds_read_b64_tr_b16 a[228:229], v199 offset:16384
 s_add_u32 s7, s7, 0x1000
 MM v[28:31], a[116:119], a[252:255], v[28:31]
 buffer_load_dwordx4 a[112:115], v245, s[8:11], s7 offen offset:0
 MM v[24:27], a[116:119], a[248:251], v[24:27]
 ds_read_b64_tr_b16 a[230:231], v199 offset:16896
 MM v[20:23], a[116:119], a[244:247], v[20:23]
 ds_read_b64_tr_b16 a[232:233], v200 offset:16384
 MM v[16:19], a[116:119], a[240:243], v[16:19]
 buffer_load_dwordx4 a[116:119], v245, s[8:11], s7 offen offset:1024
 MM v[32:35], a[120:123], a[240:243], v[32:35]
 ds_read_b64_tr_b16 a[234:235], v200 offset:16896
 MM v[36:39], a[120:123], a[244:247], v[36:39]
 ds_read_b64_tr_b16 a[236:237], v201 offset:16384
 MM v[40:43], a[120:123], a[248:251], v[40:43]
 ds_read_b64_tr_b16 a[238:239], v201 offset:16896
 MM v[44:47], a[120:123], a[252:255], v[44:47]
 buffer_load_dwordx4 a[120:123], v245, s[8:11], s7 offen offset:2048
 MM v[60:63], a[124:127], a[252:255], v[60:63]
 MM v[56:59], a[124:127], a[248:251], v[56:59]
 MM v[52:55], a[124:127], a[244:247], v[52:55]
 MM v[48:51], a[124:127], a[240:243], v[48:51]
 s_waitcnt lgkmcnt(8)
 MM v[0:3], a[128:131], a[208:211], v[0:3]
 buffer_load_dwordx4 a[124:127], v245, s[8:11], s7 offen offset:3072
 MM v[4:7], a[128:131], a[212:215], v[4:7]
 ds_read_b64_tr_b16 a[240:241], v198 offset:20480
 MM v[8:11], a[128:131], a[216:219], v[8:11]
 ds_read_b64_tr_b16 a[242:243], v198 offset:20992
 MM v[12:15], a[128:131], a[220:223], v[12:15]
 ds_read_b64_tr_b16 a[244:245], v199 offset:20480
 s_add_u32 s7, s7, 0x1000
 MM v[28:31], a[132:135], a[220:223], v[28:31]
 buffer_load_dwordx4 a[128:131], v245, s[8:11], s7 offen offset:0
 MM v[24:27], a[132:135], a[216:219], v[24:27]
 ds_read_b64_tr_b16 a[246:247], v199 offset:20992
 MM v[20:23], a[132:135], a[212:215], v[20:23]
 ds_read_b64_tr_b16 a[248:249], v200 offset:20480
 MM v[16:19], a[132:135], a[208:211], v[16:19]
 buffer_load_dwordx4 a[132:135], v245, s[8:11], s7 offen offset:1024
 MM v[32:35], a[0:3], a[208:211], v[32:35]
 ds_read_b64_tr_b16 a[250:251], v200 offset:20992
 MM v[36:39], a[0:3], a[212:215], v[36:39]
 ds_read_b64_tr_b16 a[252:253], v201 offset:20480
 MM v[40:43], a[0:3], a[216:219], v[40:43]
 ds_read_b64_tr_b16 a[254:255], v201 offset:20992
 MM v[44:47], a[0:3], a[220:223], v[44:47]
 buffer_load_dwordx4 a[0:3], v245, s[8:11], s7 offen offset:2048
 MM v[60:63], a[4:7], a[220:223], v[60:63]
 MM v[56:59], a[4:7], a[216:219], v[56:59]
 MM v[52:55], a[4:7], a[212:215], v[52:55]
 MM v[48:51], a[4:7], a[208:211], v[48:51]
 s_waitcnt lgkmcnt(8)
 MM v[0:3], a[8:11], a[224:227], v[0:3]
 buffer_load_dwordx4 a[4:7], v245, s[8:11], s7 offen offset:3072
 MM v[4:7], a[8:11], a[228:231], v[4:7]
 ds_read_b64_tr_b16 a[208:209], v198 offset:24576
 MM v[8:11], a[8:11], a[232:235], v[8:11]
 ds_read_b64_tr_b16 a[210:211], v198 offset:25088
 MM v[12:15], a[8:11], a[236:239], v[12:15]
 ds_read_b64_tr_b16 a[212:213], v199 offset:24576
 s_add_u32 s7, s7, 0x1000
 MM v[28:31], a[12:15], a[236:239], v[28:31]
 buffer_load_dwordx4 a[8:11], v245, s[8:11], s7 offen offset:0
 MM v[24:27], a[12:15], a[232:235], v[24:27]
 ds_read_b64_tr_b16 a[214:215], v199 offset:25088
 MM v[20:23], a[12:15], a[228:231], v[20:23]
 ds_read_b64_tr_b16 a[216:217], v200 offset:24576
 MM v[16:19], a[12:15], a[224:227], v[16:19]
 buffer_load_dwordx4 a[12:15], v245, s[8:11], s7 offen offset:1024
 MM v[32:35], a[16:19], a[224:227], v[32:35]
 ds_read_b64_tr_b16 a[218:219], v200 offset:25088
 MM v[36:39], a[16:19], a[228:231], v[36:39]
 ds_read_b64_tr_b16 a[220:221], v201 offset:24576
 MM v[40:43], a[16:19], a[232:235], v[40:43]
 ds_read_b64_tr_b16 a[222:223], v201 offset:25088
 MM v[44:47], a[16:19], a[236:239], v[44:47]
 buffer_load_dwordx4 a[16:19], v245, s[8:11], s7 offen offset:2048
 MM v[60:63], a[20:23], a[236:239], v[60:63]
 MM v[56:59], a[20:23], a[232:235], v[56:59]
 MM v[52:55], a[20:23], a[228:231], v[52:55]
 MM v[48:51], a[20:23], a[224:227], v[48:51]
 s_waitcnt lgkmcnt(8)
 s_waitcnt vmcnt(47)
 MM v[0:3], a[24:27], a[240:243], v[0:3]
 buffer_load_dwordx4 a[20:23], v245, s[8:11], s7 offen offset:3072
 MM v[4:7], a[24:27], a[244:247], v[4:7]
 ds_read_b64_tr_b16 a[224:225], v198 offset:28672
 MM v[8:11], a[24:27], a[248:251], v[8:11]
 ds_read_b64_tr_b16 a[226:227], v198 offset:29184
 MM v[12:15], a[24:27], a[252:255], v[12:15]
 ds_read_b64_tr_b16 a[228:229], v199 offset:28672
 s_add_u32 s7, s7, 0x1000
 MM v[28:31], a[28:31], a[252:255], v[28:31]
 buffer_load_dwordx4 a[24:27], v245, s[8:11], s7 offen offset:0
 MM v[24:27], a[28:31], a[248:251], v[24:27]
 ds_read_b64_tr_b16 a[230:231], v199 offset:29184
 MM v[20:23], a[28:31], a[244:247], v[20:23]
 ds_read_b64_tr_b16 a[232:233], v200 offset:28672
 MM v[16:19], a[28:31], a[240:243], v[16:19]
 buffer_load_dwordx4 a[28:31], v245, s[8:11], s7 offen offset:1024
 MM v[32:35], a[32:35], a[240:243], v[32:35]
 ds_read_b64_tr_b16 a[234:235], v200 offset:29184
 MM v[36:39], a[32:35], a[244:247], v[36:39]
 ds_read_b64_tr_b16 a[236:237], v201 offset:28672
 MM v[40:43], a[32:35], a[248:251], v[40:43]
 ds_read_b64_tr_b16 a[238:239], v201 offset:29184
 MM v[44:47], a[32:35], a[252:255], v[44:47]
 buffer_load_dwordx4 a[32:35], v245, s[8:11], s7 offen offset:2048
 MM v[60:63], a[36:39], a[252:255], v[60:63]
 MM v[56:59], a[36:39], a[248:251], v[56:59]
 MM v[52:55], a[36:39], a[244:247], v[52:55]
 MM v[48:51], a[36:39], a[240:243], v[48:51]
 s_waitcnt lgkmcnt(8)
 s_waitcnt vmcnt(47)
 MM v[0:3], a[40:43], a[208:211], v[0:3]
 buffer_load_dwordx4 a[36:39], v245, s[8:11], s7 offen offset:3072
 MM v[4:7], a[40:43], a[212:215], v[4:7]
 ds_read_b64_tr_b16 a[240:241], v198 offset:32768
 MM v[8:11], a[40:43], a[216:219], v[8:11]
 ds_read_b64_tr_b16 a[242:243], v198 offset:33280
 MM v[12:15], a[40:43], a[220:223], v[12:15]
 ds_read_b64_tr_b16 a[244:245], v199 offset:32768
 s_add_u32 s7, s7, 0x1000
 MM v[28:31], a[44:47], a[220:223], v[28:31]
 buffer_load_dwordx4 a[40:43], v245, s[8:11], s7 offen offset:0
 MM v[24:27], a[44:47], a[216:219], v[24:27]
 ds_read_b64_tr_b16 a[246:247], v199 offset:33280
 MM v[20:23], a[44:47], a[212:215], v[20:23]
 ds_read_b64_tr_b16 a[248:249], v200 offset:32768
 MM v[16:19], a[44:47], a[208:211], v[16:19]
 buffer_load_dwordx4 a[44:47], v245, s[8:11], s7 offen offset:1024
 MM v[32:35], a[48:51], a[208:211], v[32:35]
 ds_read_b64_tr_b16 a[250:251], v200 offset:33280
 MM v[36:39], a[48:51], a[212:215], v[36:39]
 ds_read_b64_tr_b16 a[252:253], v201 offset:32768
 MM v[40:43], a[48:51], a[216:219], v[40:43]
 ds_read_b64_tr_b16 a[254:255], v201 offset:33280
 MM v[44:47], a[48:51], a[220:223], v[44:47]
 buffer_load_dwordx4 a[48:51], v245, s[8:11], s7 offen offset:2048
 MM v[60:63], a[52:55], a[220:223], v[60:63]
 MM v[56:59], a[52:55], a[216:219], v[56:59]
 MM v[52:55], a[52:55], a[212:215], v[52:55]
 MM v[48:51], a[52:55], a[208:211], v[48:51]
 s_waitcnt lgkmcnt(8)
 s_waitcnt vmcnt(47)
 MM v[0:3], a[56:59], a[224:227], v[0:3]
 buffer_load_dwordx4 a[52:55], v245, s[8:11], s7 offen offset:3072
 MM v[4:7], a[56:59], a[228:231], v[4:7]
 ds_read_b64_tr_b16 a[208:209], v198 offset:36864
 MM v[8:11], a[56:59], a[232:235], v[8:11]
 ds_read_b64_tr_b16 a[210:211], v198 offset:37376
 MM v[12:15], a[56:59], a[236:239], v[12:15]
 ds_read_b64_tr_b16 a[212:213], v199 offset:36864
 s_add_u32 s7, s7, 0x1000
 MM v[28:31], a[60:63], a[236:239], v[28:31]
 buffer_load_dwordx4 a[56:59], v245, s[8:11], s7 offen offset:0
 MM v[24:27], a[60:63], a[232:235], v[24:27]
 ds_read_b64_tr_b16 a[214:215], v199 offset:37376
 MM v[20:23], a[60:63], a[228:231], v[20:23]
 ds_read_b64_tr_b16 a[216:217], v200 offset:36864
 MM v[16:19], a[60:63], a[224:227], v[16:19]
 buffer_load_dwordx4 a[60:63], v245, s[8:11], s7 offen offset:1024
 MM v[32:35], a[64:67], a[224:227], v[32:35]
 ds_read_b64_tr_b16 a[218:219], v200 offset:37376
 MM v[36:39], a[64:67], a[228:231], v[36:39]
 ds_read_b64_tr_b16 a[220:221], v201 offset:36864
 MM v[40:43], a[64:67], a[232:235], v[40:43]
 ds_read_b64_tr_b16 a[222:223], v201 offset:37376
 MM v[44:47], a[64:67], a[236:239], v[44:47]
 buffer_load_dwordx4 a[64:67], v245, s[8:11], s7 offen offset:2048
 MM v[60:63], a[68:71], a[236:239], v[60:63]
 MM v[56:59], a[68:71], a[232:235], v[56:59]
 MM v[52:55], a[68:71], a[228:231], v[52:55]
 MM v[48:51], a[68:71], a[224:227], v[48:51]
 s_waitcnt lgkmcnt(8)
 s_waitcnt vmcnt(47)
 MM v[0:3], a[72:75], a[240:243], v[0:3]
 buffer_load_dwordx4 a[68:71], v245, s[8:11], s7 offen offset:3072
 MM v[4:7], a[72:75], a[244:247], v[4:7]
 ds_read_b64_tr_b16 a[224:225], v198 offset:40960
 MM v[8:11], a[72:75], a[248:251], v[8:11]
 ds_read_b64_tr_b16 a[226:227], v198 offset:41472
 MM v[12:15], a[72:75], a[252:255], v[12:15]
 ds_read_b64_tr_b16 a[228:229], v199 offset:40960
 s_add_u32 s7, s7, 0x1000
 MM v[28:31], a[76:79], a[252:255], v[28:31]
 buffer_load_dwordx4 a[72:75], v245, s[8:11], s7 offen offset:0
 MM v[24:27], a[76:79], a[248:251], v[24:27]
 ds_read_b64_tr_b16 a[230:231], v199 offset:41472
 MM v[20:23], a[76:79], a[244:247], v[20:23]
 ds_read_b64_tr_b16 a[232:233], v200 offset:40960
 MM v[16:19], a[76:79], a[240:243], v[16:19]
 buffer_load_dwordx4 a[76:79], v245, s[8:11], s7 offen offset:1024
 MM v[32:35], a[136:139], a[240:243], v[32:35]
 ds_read_b64_tr_b16 a[234:235], v200 offset:41472
 MM v[36:39], a[136:139], a[244:247], v[36:39]
 ds_read_b64_tr_b16 a[236:237], v201 offset:40960
 MM v[40:43], a[136:139], a[248:251], v[40:43]
 ds_read_b64_tr_b16 a[238:239], v201 offset:41472
 MM v[44:47], a[136:139], a[252:255], v[44:47]
 buffer_load_dwordx4 a[136:139], v245, s[8:11], s7 offen offset:2048
 MM v[60:63], a[140:143], a[252:255], v[60:63]
 MM v[56:59], a[140:143], a[248:251], v[56:59]
 MM v[52:55], a[140:143], a[244:247], v[52:55]
 MM v[48:51], a[140:143], a[240:243], v[48:51]
 s_waitcnt lgkmcnt(8)
 s_waitcnt vmcnt(47)
 MM v[0:3], a[144:147], a[208:211], v[0:3]
 buffer_load_dwordx4 a[140:143], v245, s[8:11], s7 offen offset:3072
 MM v[4:7], a[144:147], a[212:215], v[4:7]
 ds_read_b64_tr_b16 a[240:241], v198 offset:45056
 MM v[8:11], a[144:147], a[216:219], v[8:11]
 ds_read_b64_tr_b16 a[242:243], v198 offset:45568
 MM v[12:15], a[144:147], a[220:223], v[12:15]
 ds_read_b64_tr_b16 a[244:245], v199 offset:45056
 s_add_u32 s7, s7, 0x1000
 MM v[28:31], a[148:151], a[220:223], v[28:31]
 buffer_load_dwordx4 a[144:147], v245, s[8:11], s7 offen offset:0
 MM v[24:27], a[148:151], a[216:219], v[24:27]
 ds_read_b64_tr_b16 a[246:247], v199 offset:45568
 MM v[20:23], a[148:151], a[212:215], v[20:23]
 ds_read_b64_tr_b16 a[248:249], v200 offset:45056
 MM v[16:19], a[148:151], a[208:211], v[16:19]
 buffer_load_dwordx4 a[148:151], v245, s[8:11], s7 offen offset:1024
 MM v[32:35], a[152:155], a[208:211], v[32:35]
 ds_read_b64_tr_b16 a[250:251], v200 offset:45568
 MM v[36:39], a[152:155], a[212:215], v[36:39]
 ds_read_b64_tr_b16 a[252:253], v201 offset:45056
 MM v[40:43], a[152:155], a[216:219], v[40:43]
 ds_read_b64_tr_b16 a[254:255], v201 offset:45568
 MM v[44:47], a[152:155], a[220:223], v[44:47]
 buffer_load_dwordx4 a[152:155], v245, s[8:11], s7 offen offset:2048
 MM v[60:63], a[156:159], a[220:223], v[60:63]
 MM v[56:59], a[156:159], a[216:219], v[56:59]
 MM v[52:55], a[156:159], a[212:215], v[52:55]
 MM v[48:51], a[156:159], a[208:211], v[48:51]
 s_waitcnt lgkmcnt(8)
 s_waitcnt vmcnt(47)
 MM v[0:3], a[160:163], a[224:227], v[0:3]
 buffer_load_dwordx4 a[156:159], v245, s[8:11], s7 offen offset:3072
 MM v[4:7], a[160:163], a[228:231], v[4:7]
 ds_read_b64_tr_b16 a[208:209], v198 offset:49152
 MM v[8:11], a[160:163], a[232:235], v[8:11]
 ds_read_b64_tr_b16 a[210:211], v198 offset:49664
 MM v[12:15], a[160:163], a[236:239], v[12:15]
 ds_read_b64_tr_b16 a[212:213], v199 offset:49152
 s_add_u32 s7, s7, 0x1000
 MM v[28:31], a[164:167], a[236:239], v[28:31]
 buffer_load_dwordx4 a[160:163], v245, s[8:11], s7 offen offset:0
 MM v[24:27], a[164:167], a[232:235], v[24:27]
 ds_read_b64_tr_b16 a[214:215], v199 offset:49664
 MM v[20:23], a[164:167], a[228:231], v[20:23]
 ds_read_b64_tr_b16 a[216:217], v200 offset:49152
 MM v[16:19], a[164:167], a[224:227], v[16:19]
 buffer_load_dwordx4 a[164:167], v245, s[8:11], s7 offen offset:1024
 MM v[32:35], a[168:171], a[224:227], v[32:35]
 ds_read_b64_tr_b16 a[218:219], v200 offset:49664
 MM v[36:39], a[168:171], a[228:231], v[36:39]
 ds_read_b64_tr_b16 a[220:221], v201 offset:49152
 MM v[40:43], a[168:171], a[232:235], v[40:43]
 ds_read_b64_tr_b16 a[222:223], v201 offset:49664
 MM v[44:47], a[168:171], a[236:239], v[44:47]
 buffer_load_dwordx4 a[168:171], v245, s[8:11], s7 offen offset:2048
 MM v[60:63], a[172:175], a[236:239], v[60:63]
 MM v[56:59], a[172:175], a[232:235], v[56:59]
 MM v[52:55], a[172:175], a[228:231], v[52:55]
 MM v[48:51], a[172:175], a[224:227], v[48:51]
 s_waitcnt lgkmcnt(8)
 s_waitcnt vmcnt(47)
 MM v[0:3], a[176:179], a[240:243], v[0:3]
 buffer_load_dwordx4 a[172:175], v245, s[8:11], s7 offen offset:3072
 MM v[4:7], a[176:179], a[244:247], v[4:7]
 ds_read_b64_tr_b16 a[224:225], v198 offset:53248
 MM v[8:11], a[176:179], a[248:251], v[8:11]
 ds_read_b64_tr_b16 a[226:227], v198 offset:53760
 MM v[12:15], a[176:179], a[252:255], v[12:15]
 ds_read_b64_tr_b16 a[228:229], v199 offset:53248
 s_add_u32 s7, s7, 0x1000
 MM v[28:31], a[180:183], a[252:255], v[28:31]
 buffer_load_dwordx4 a[176:179], v245, s[8:11], s7 offen offset:0
 MM v[24:27], a[180:183], a[248:251], v[24:27]
 ds_read_b64_tr_b16 a[230:231], v199 offset:53760
 MM v[20:23], a[180:183], a[244:247], v[20:23]
 ds_read_b64_tr_b16 a[232:233], v200 offset:53248
 MM v[16:19], a[180:183], a[240:243], v[16:19]
 buffer_load_dwordx4 a[180:183], v245, s[8:11], s7 offen offset:1024
 MM v[32:35], a[184:187], a[240:243], v[32:35]
 ds_read_b64_tr_b16 a[234:235], v200 offset:53760
 MM v[36:39], a[184:187], a[244:247], v[36:39]
 ds_read_b64_tr_b16 a[236:237], v201 offset:53248
 MM v[40:43], a[184:187], a[248:251], v[40:43]
 ds_read_b64_tr_b16 a[238:239], v201 offset:53760
 MM v[44:47], a[184:187], a[252:255], v[44:47]
 buffer_load_dwordx4 a[184:187], v245, s[8:11], s7 offen offset:2048
 MM v[60:63], a[188:191], a[252:255], v[60:63]
 MM v[56:59], a[188:191], a[248:251], v[56:59]
 MM v[52:55], a[188:191], a[244:247], v[52:55]
 MM v[48:51], a[188:191], a[240:243], v[48:51]
 s_waitcnt lgkmcnt(8)
 s_waitcnt vmcnt(47)
 MM v[0:3], a[192:195], a[208:211], v[0:3]
 buffer_load_dwordx4 a[188:191], v245, s[8:11], s7 offen offset:3072
 MM v[4:7], a[192:195], a[212:215], v[4:7]
 ds_read_b64_tr_b16 a[240:241], v198 offset:57344
 MM v[8:11], a[192:195], a[216:219], v[8:11]
 ds_read_b64_tr_b16 a[242:243], v198 offset:57856
 MM v[12:15], a[192:195], a[220:223], v[12:15]
 ds_read_b64_tr_b16 a[244:245], v199 offset:57344
 s_add_u32 s7, s7, 0x1000
 MM v[28:31], a[196:199], a[220:223], v[28:31]
 buffer_load_dwordx4 a[192:195], v245, s[8:11], s7 offen offset:0
 MM v[24:27], a[196:199], a[216:219], v[24:27]
 ds_read_b64_tr_b16 a[246:247], v199 offset:57856
 MM v[20:23], a[196:199], a[212:215], v[20:23]
 ds_read_b64_tr_b16 a[248:249], v200 offset:57344
 MM v[16:19], a[196:199], a[208:211], v[16:19]
 buffer_load_dwordx4 a[196:199], v245, s[8:11], s7 offen offset:1024
 MM v[32:35], a[200:203], a[208:211], v[32:35]
 ds_read_b64_tr_b16 a[250:251], v200 offset:57856
 MM v[36:39], a[200:203], a[212:215], v[36:39]
 ds_read_b64_tr_b16 a[252:253], v201 offset:57344
 MM v[40:43], a[200:203], a[216:219], v[40:43]
 ds_read_b64_tr_b16 a[254:255], v201 offset:57856
 MM v[44:47], a[200:203], a[220:223], v[44:47]
 buffer_load_dwordx4 a[200:203], v245, s[8:11], s7 offen offset:2048
 MM v[60:63], a[204:207], a[220:223], v[60:63]
 MM v[56:59], a[204:207], a[216:219], v[56:59]
 MM v[52:55], a[204:207], a[212:215], v[52:55]
 MM v[48:51], a[204:207], a[208:211], v[48:51]
 s_waitcnt lgkmcnt(8)
 s_waitcnt vmcnt(47)
 MM v[0:3], a[80:83], a[224:227], v[0:3]
 buffer_load_dwordx4 a[204:207], v245, s[8:11], s7 offen offset:3072
 MM v[4:7], a[80:83], a[228:231], v[4:7]
 ds_read_b64_tr_b16 a[208:209], v198 offset:61440
 MM v[8:11], a[80:83], a[232:235], v[8:11]
 ds_read_b64_tr_b16 a[210:211], v198 offset:61952
 MM v[12:15], a[80:83], a[236:239], v[12:15]
 ds_read_b64_tr_b16 a[212:213], v199 offset:61440
 s_add_u32 s7, s7, 0x1000
 MM v[28:31], a[84:87], a[236:239], v[28:31]
 buffer_load_dwordx4 a[80:83], v245, s[8:11], s7 offen offset:0
 MM v[24:27], a[84:87], a[232:235], v[24:27]
 ds_read_b64_tr_b16 a[214:215], v199 offset:61952
 MM v[20:23], a[84:87], a[228:231], v[20:23]
 ds_read_b64_tr_b16 a[216:217], v200 offset:61440
 MM v[16:19], a[84:87], a[224:227], v[16:19]
 buffer_load_dwordx4 a[84:87], v245, s[8:11], s7 offen offset:1024
 MM v[32:35], a[88:91], a[224:227], v[32:35]
 ds_read_b64_tr_b16 a[218:219], v200 offset:61952
 MM v[36:39], a[88:91], a[228:231], v[36:39]
 ds_read_b64_tr_b16 a[220:221], v201 offset:61440
 MM v[40:43], a[88:91], a[232:235], v[40:43]
 ds_read_b64_tr_b16 a[222:223], v201 offset:61952
 MM v[44:47], a[88:91], a[236:239], v[44:47]
 buffer_load_dwordx4 a[88:91], v245, s[8:11], s7 offen offset:2048
 MM v[60:63], a[92:95], a[236:239], v[60:63]
 MM v[56:59], a[92:95], a[232:235], v[56:59]
 MM v[52:55], a[92:95], a[228:231], v[52:55]
 MM v[48:51], a[92:95], a[224:227], v[48:51]
 s_waitcnt lgkmcnt(8)
 s_waitcnt vmcnt(47)
 MM v[0:3], a[96:99], a[240:243], v[0:3]
 buffer_load_dwordx4 a[92:95], v245, s[8:11], s7 offen offset:3072
 MM v[4:7], a[96:99], a[244:247], v[4:7]
 ds_read_b64_tr_b16 a[224:225], v198 offset:0
 MM v[8:11], a[96:99], a[248:251], v[8:11]
 ds_read_b64_tr_b16 a[226:227], v198 offset:512
 MM v[12:15], a[96:99], a[252:255], v[12:15]
 ds_read_b64_tr_b16 a[228:229], v199 offset:0
 s_add_u32 s7, s7, 0x1000
 MM v[28:31], a[100:103], a[252:255], v[28:31]
 buffer_load_dwordx4 a[96:99], v245, s[8:11], s7 offen offset:0
 MM v[24:27], a[100:103], a[248:251], v[24:27]
 ds_read_b64_tr_b16 a[230:231], v199 offset:512
 MM v[20:23], a[100:103], a[244:247], v[20:23]
 ds_read_b64_tr_b16 a[232:233], v200 offset:0
 MM v[16:19], a[100:103], a[240:243], v[16:19]
 buffer_load_dwordx4 a[100:103], v245, s[8:11], s7 offen offset:1024
 MM v[32:35], a[104:107], a[240:243], v[32:35]
 ds_read_b64_tr_b16 a[234:235], v200 offset:512
 MM v[36:39], a[104:107], a[244:247], v[36:39]
 ds_read_b64_tr_b16 a[236:237], v201 offset:0
 MM v[40:43], a[104:107], a[248:251], v[40:43]
 ds_read_b64_tr_b16 a[238:239], v201 offset:512
 MM v[44:47], a[104:107], a[252:255], v[44:47]
 buffer_load_dwordx4 a[104:107], v245, s[8:11], s7 offen offset:2048
 MM v[60:63], a[108:111], a[252:255], v[60:63]
 MM v[56:59], a[108:111], a[248:251], v[56:59]
 MM v[52:55], a[108:111], a[244:247], v[52:55]
 MM v[48:51], a[108:111], a[240:243], v[48:51]
 s_waitcnt lgkmcnt(8)
 s_waitcnt vmcnt(47)
 MM v[0:3], a[112:115], a[208:211], v[0:3]
 buffer_load_dwordx4 a[108:111], v245, s[8:11], s7 offen offset:3072
 MM v[4:7], a[112:115], a[212:215], v[4:7]
 ds_read_b64_tr_b16 a[240:241], v198 offset:4096
 MM v[8:11], a[112:115], a[216:219], v[8:11]
 ds_read_b64_tr_b16 a[242:243], v198 offset:4608
 MM v[12:15], a[112:115], a[220:223], v[12:15]
 ds_read_b64_tr_b16 a[244:245], v199 offset:4096
 s_add_u32 s7, s7, 0x1000
 MM v[28:31], a[116:119], a[220:223], v[28:31]
 buffer_load_dwordx4 a[112:115], v245, s[8:11], s7 offen offset:0
 MM v[24:27], a[116:119], a[216:219], v[24:27]
 ds_read_b64_tr_b16 a[246:247], v199 offset:4608
 MM v[20:23], a[116:119], a[212:215], v[20:23]
 ds_read_b64_tr_b16 a[248:249], v200 offset:4096
 MM v[16:19], a[116:119], a[208:211], v[16:19]
 buffer_load_dwordx4 a[116:119], v245, s[8:11], s7 offen offset:1024
 MM v[32:35], a[120:123], a[208:211], v[32:35]
 ds_read_b64_tr_b16 a[250:251], v200 offset:4608
 MM v[36:39], a[120:123], a[212:215], v[36:39]
 ds_read_b64_tr_b16 a[252:253], v201 offset:4096
 MM v[40:43], a[120:123], a[216:219], v[40:43]
 ds_read_b64_tr_b16 a[254:255], v201 offset:4608
 MM v[44:47], a[120:123], a[220:223], v[44:47]
 buffer_load_dwordx4 a[120:123], v245, s[8:11], s7 offen offset:2048
 MM v[60:63], a[124:127], a[220:223], v[60:63]
 MM v[56:59], a[124:127], a[216:219], v[56:59]
 MM v[52:55], a[124:127], a[212:215], v[52:55]
 MM v[48:51], a[124:127], a[208:211], v[48:51]
 s_waitcnt lgkmcnt(8)
 s_waitcnt vmcnt(47)
 MM v[64:67], a[128:131], a[224:227], 0
 buffer_load_dwordx4 a[124:127], v245, s[8:11], s7 offen offset:3072
 MM v[68:71], a[128:131], a[228:231], 0
 ds_read_b64_tr_b16 a[208:209], v198 offset:8192
 MM v[72:75], a[128:131], a[232:235], 0
 ds_read_b64_tr_b16 a[210:211], v198 offset:8704
 MM v[76:79], a[128:131], a[236:239], 0
 ds_read_b64_tr_b16 a[212:213], v199 offset:8192
 s_add_u32 s7, s7, 0x1000
 MM v[92:95], a[132:135], a[236:239], 0
 buffer_load_dwordx4 a[128:131], v245, s[8:11], s7 offen offset:0
 MM v[88:91], a[132:135], a[232:235], 0
 ds_read_b64_tr_b16 a[214:215], v199 offset:8704
 MM v[84:87], a[132:135], a[228:231], 0
 ds_read_b64_tr_b16 a[216:217], v200 offset:8192
 MM v[80:83], a[132:135], a[224:227], 0
 buffer_load_dwordx4 a[132:135], v245, s[8:11], s7 offen offset:1024
 MM v[96:99], a[0:3], a[224:227], 0
 ds_read_b64_tr_b16 a[218:219], v200 offset:8704
 MM v[100:103], a[0:3], a[228:231], 0
 ds_read_b64_tr_b16 a[220:221], v201 offset:8192
 MM v[104:107], a[0:3], a[232:235], 0
 ds_read_b64_tr_b16 a[222:223], v201 offset:8704
 MM v[108:111], a[0:3], a[236:239], 0
 buffer_load_dwordx4 a[0:3], v245, s[8:11], s7 offen offset:2048
 MM v[124:127], a[4:7], a[236:239], 0
 MM v[120:123], a[4:7], a[232:235], 0
 MM v[116:119], a[4:7], a[228:231], 0
 MM v[112:115], a[4:7], a[224:227], 0
 s_waitcnt lgkmcnt(8)
 s_waitcnt vmcnt(47)
 MM v[64:67], a[8:11], a[240:243], v[64:67]
 buffer_load_dwordx4 a[4:7], v245, s[8:11], s7 offen offset:3072
 MM v[68:71], a[8:11], a[244:247], v[68:71]
 ds_read_b64_tr_b16 a[224:225], v198 offset:12288
 MM v[72:75], a[8:11], a[248:251], v[72:75]
 ds_read_b64_tr_b16 a[226:227], v198 offset:12800
 MM v[76:79], a[8:11], a[252:255], v[76:79]
 ds_read_b64_tr_b16 a[228:229], v199 offset:12288
 s_add_u32 s7, s7, 0x1000
 MM v[92:95], a[12:15], a[252:255], v[92:95]
 buffer_load_dwordx4 a[8:11], v245, s[8:11], s7 offen offset:0
 MM v[88:91], a[12:15], a[248:251], v[88:91]
 ds_read_b64_tr_b16 a[230:231], v199 offset:12800
 MM v[84:87], a[12:15], a[244:247], v[84:87]
 ds_read_b64_tr_b16 a[232:233], v200 offset:12288
 MM v[80:83], a[12:15], a[240:243], v[80:83]
 buffer_load_dwordx4 a[12:15], v245, s[8:11], s7 offen offset:1024
 MM v[96:99], a[16:19], a[240:243], v[96:99]
 ds_read_b64_tr_b16 a[234:235], v200 offset:12800
 MM v[100:103], a[16:19], a[244:247], v[100:103]
 ds_read_b64_tr_b16 a[236:237], v201 offset:12288
 MM v[104:107], a[16:19], a[248:251], v[104:107]
 ds_read_b64_tr_b16 a[238:239], v201 offset:12800
 MM v[108:111], a[16:19], a[252:255], v[108:111]
 buffer_load_dwordx4 a[16:19], v245, s[8:11], s7 offen offset:2048
 MM v[124:127], a[20:23], a[252:255], v[124:127]
 MM v[120:123], a[20:23], a[248:251], v[120:123]
 MM v[116:119], a[20:23], a[244:247], v[116:119]
 MM v[112:115], a[20:23], a[240:243], v[112:115]
 s_waitcnt lgkmcnt(8)
 s_waitcnt vmcnt(47)
 MM v[64:67], a[24:27], a[208:211], v[64:67]
 buffer_load_dwordx4 a[20:23], v245, s[8:11], s7 offen offset:3072
 MM v[68:71], a[24:27], a[212:215], v[68:71]
 ds_read_b64_tr_b16 a[240:241], v198 offset:16384
 MM v[72:75], a[24:27], a[216:219], v[72:75]
 ds_read_b64_tr_b16 a[242:243], v198 offset:16896
 MM v[76:79], a[24:27], a[220:223], v[76:79]
 ds_read_b64_tr_b16 a[244:245], v199 offset:16384
 s_add_u32 s7, s7, 0x1000
 MM v[92:95], a[28:31], a[220:223], v[92:95]
 buffer_load_dwordx4 a[24:27], v245, s[8:11], s7 offen offset:0
 MM v[88:91], a[28:31], a[216:219], v[88:91]
 ds_read_b64_tr_b16 a[246:247], v199 offset:16896
 MM v[84:87], a[28:31], a[212:215], v[84:87]
 ds_read_b64_tr_b16 a[248:249], v200 offset:16384
 MM v[80:83], a[28:31], a[208:211], v[80:83]
 buffer_load_dwordx4 a[28:31], v245, s[8:11], s7 offen offset:1024
 MM v[96:99], a[32:35], a[208:211], v[96:99]
 ds_read_b64_tr_b16 a[250:251], v200 offset:16896
 MM v[100:103], a[32:35], a[212:215], v[100:103]
 ds_read_b64_tr_b16 a[252:253], v201 offset:16384
 MM v[104:107], a[32:35], a[216:219], v[104:107]
 ds_read_b64_tr_b16 a[254:255], v201 offset:16896
 MM v[108:111], a[32:35], a[220:223], v[108:111]
 buffer_load_dwordx4 a[32:35], v245, s[8:11], s7 offen offset:2048
 MM v[124:127], a[36:39], a[220:223], v[124:127]
 MM v[120:123], a[36:39], a[216:219], v[120:123]
 MM v[116:119], a[36:39], a[212:215], v[116:119]
 MM v[112:115], a[36:39], a[208:211], v[112:115]
 s_waitcnt lgkmcnt(8)
 s_waitcnt vmcnt(47)
 MM v[64:67], a[40:43], a[224:227], v[64:67]
 buffer_load_dwordx4 a[36:39], v245, s[8:11], s7 offen offset:3072
 MM v[68:71], a[40:43], a[228:231], v[68:71]
 ds_read_b64_tr_b16 a[208:209], v198 offset:20480
 MM v[72:75], a[40:43], a[232:235], v[72:75]
 ds_read_b64_tr_b16 a[210:211], v198 offset:20992
 MM v[76:79], a[40:43], a[236:239], v[76:79]
 ds_read_b64_tr_b16 a[212:213], v199 offset:20480
 MM v[92:95], a[44:47], a[236:239], v[92:95]
 ds_read_b64_tr_b16 a[214:215], v199 offset:20992
 MM v[88:91], a[44:47], a[232:235], v[88:91]
 ds_read_b64_tr_b16 a[216:217], v200 offset:20480
 MM v[84:87], a[44:47], a[228:231], v[84:87]
 ds_read_b64_tr_b16 a[218:219], v200 offset:20992
 MM v[80:83], a[44:47], a[224:227], v[80:83]
 ds_read_b64_tr_b16 a[220:221], v201 offset:20480
 MM v[96:99], a[48:51], a[224:227], v[96:99]
 ds_read_b64_tr_b16 a[222:223], v201 offset:20992
 MM v[100:103], a[48:51], a[228:231], v[100:103]
 MM v[104:107], a[48:51], a[232:235], v[104:107]
 MM v[108:111], a[48:51], a[236:239], v[108:111]
 MM v[124:127], a[52:55], a[236:239], v[124:127]
 MM v[120:123], a[52:55], a[232:235], v[120:123]
 MM v[116:119], a[52:55], a[228:231], v[116:119]
 MM v[112:115], a[52:55], a[224:227], v[112:115]
 s_waitcnt lgkmcnt(8)
 s_waitcnt vmcnt(44)
 MM v[64:67], a[56:59], a[240:243], v[64:67]
 ds_read_b64_tr_b16 a[224:225], v198 offset:24576
 CB v160, v0, v1
 MM v[68:71], a[56:59], a[244:247], v[68:71]
 ds_read_b64_tr_b16 a[226:227], v198 offset:25088
 v_min_u32 v160, -2, v160
 MM v[72:75], a[56:59], a[248:251], v[72:75]
 ds_read_b64_tr_b16 a[228:229], v199 offset:24576
 CB v161, v2, v3
 MM v[76:79], a[56:59], a[252:255], v[76:79]
 ds_read_b64_tr_b16 a[230:231], v199 offset:25088
 v_min_u32_e64 v161, -2, v161
 MM v[92:95], a[60:63], a[252:255], v[92:95]
 ds_read_b64_tr_b16 a[232:233], v200 offset:24576
 CB v162, v16, v17
 MM v[88:91], a[60:63], a[248:251], v[88:91]
 ds_read_b64_tr_b16 a[234:235], v200 offset:25088
 v_min_u32_e64 v162, -2, v162
 MM v[84:87], a[60:63], a[244:247], v[84:87]
 ds_read_b64_tr_b16 a[236:237], v201 offset:24576
 CB v163, v18, v19
 MM v[80:83], a[60:63], a[240:243], v[80:83]
 ds_read_b64_tr_b16 a[238:239], v201 offset:25088
 v_min_u32_e64 v163, -2, v163
 MM v[96:99], a[64:67], a[240:243], v[96:99]
 buffer_store_dwordx4 v[160:163], v245, s[8:11], s48 offen offset:0 sc1
 MM v[100:103], a[64:67], a[244:247], v[100:103]
 CB v164, v32, v33
 v_min_u32_e64 v164, -2, v164
 MM v[104:107], a[64:67], a[248:251], v[104:107]
 CB v165, v34, v35
 v_min_u32_e64 v165, -2, v165
 MM v[108:111], a[64:67], a[252:255], v[108:111]
 CB v166, v48, v49
 v_min_u32_e64 v166, -2, v166
 MM v[124:127], a[68:71], a[252:255], v[124:127]
 CB v167, v50, v51
 v_min_u32_e64 v167, -2, v167
 MM v[120:123], a[68:71], a[248:251], v[120:123]
 buffer_store_dwordx4 v[164:167], v245, s[8:11], s48 offen offset:1024 sc1
 MM v[116:119], a[68:71], a[244:247], v[116:119]
 CB v168, v4, v5
 v_min_u32_e64 v168, -2, v168
 MM v[112:115], a[68:71], a[240:243], v[112:115]
 s_waitcnt lgkmcnt(8)
 s_waitcnt vmcnt(42)
 MM v[64:67], a[72:75], a[208:211], v[64:67]
 ds_read_b64_tr_b16 a[240:241], v198 offset:28672
 CB v169, v6, v7
 MM v[68:71], a[72:75], a[212:215], v[68:71]
 ds_read_b64_tr_b16 a[242:243], v198 offset:29184
 v_min_u32_e64 v169, -2, v169
 MM v[72:75], a[72:75], a[216:219], v[72:75]
 ds_read_b64_tr_b16 a[244:245], v199 offset:28672
 CB v170, v20, v21
 MM v[76:79], a[72:75], a[220:223], v[76:79]
 ds_read_b64_tr_b16 a[246:247], v199 offset:29184
 v_min_u32_e64 v170, -2, v170
 MM v[92:95], a[76:79], a[220:223], v[92:95]
 ds_read_b64_tr_b16 a[248:249], v200 offset:28672
 CB v171, v22, v23
 MM v[88:91], a[76:79], a[216:219], v[88:91]
 ds_read_b64_tr_b16 a[250:251], v200 offset:29184
 v_min_u32_e64 v171, -2, v171
 MM v[84:87], a[76:79], a[212:215], v[84:87]
 ds_read_b64_tr_b16 a[252:253], v201 offset:28672
 CB v172, v36, v37
 MM v[80:83], a[76:79], a[208:211], v[80:83]
 ds_read_b64_tr_b16 a[254:255], v201 offset:29184
 v_min_u32_e64 v172, -2, v172
 MM v[96:99], a[136:139], a[208:211], v[96:99]
 buffer_store_dwordx4 v[168:171], v245, s[8:11], s48 offen offset:2048 sc1
 MM v[100:103], a[136:139], a[212:215], v[100:103]
 CB v173, v38, v39
 v_min_u32_e64 v173, -2, v173
 MM v[104:107], a[136:139], a[216:219], v[104:107]
 CB v174, v52, v53
 v_min_u32_e64 v174, -2, v174
 MM v[108:111], a[136:139], a[220:223], v[108:111]
 CB v175, v54, v55
 v_min_u32_e64 v175, -2, v175
 MM v[124:127], a[140:143], a[220:223], v[124:127]
 buffer_store_dwordx4 v[172:175], v245, s[8:11], s48 offen offset:3072 sc1
 MM v[120:123], a[140:143], a[216:219], v[120:123]
 CB v160, v8, v9
 v_min_u32_e64 v160, -2, v160
 MM v[116:119], a[140:143], a[212:215], v[116:119]
 CB v161, v10, v11
 v_min_u32_e64 v161, -2, v161
 MM v[112:115], a[140:143], a[208:211], v[112:115]
 s_waitcnt lgkmcnt(8)
 s_waitcnt vmcnt(40)
 MM v[64:67], a[144:147], a[224:227], v[64:67]
 ds_read_b64_tr_b16 a[208:209], v198 offset:32768
 CB v162, v24, v25
 MM v[68:71], a[144:147], a[228:231], v[68:71]
 ds_read_b64_tr_b16 a[210:211], v198 offset:33280
 v_min_u32_e64 v162, -2, v162
 MM v[72:75], a[144:147], a[232:235], v[72:75]
 ds_read_b64_tr_b16 a[212:213], v199 offset:32768
 CB v163, v26, v27
 MM v[76:79], a[144:147], a[236:239], v[76:79]
 ds_read_b64_tr_b16 a[214:215], v199 offset:33280
 v_min_u32_e64 v163, -2, v163
 MM v[92:95], a[148:151], a[236:239], v[92:95]
 ds_read_b64_tr_b16 a[216:217], v200 offset:32768
 MM v[88:91], a[148:151], a[232:235], v[88:91]
 ds_read_b64_tr_b16 a[218:219], v200 offset:33280
 MM v[84:87], a[148:151], a[228:231], v[84:87]
 ds_read_b64_tr_b16 a[220:221], v201 offset:32768
 MM v[80:83], a[148:151], a[224:227], v[80:83]
 ds_read_b64_tr_b16 a[222:223], v201 offset:33280
 s_add_u32 s48, s48, 0x1000
 MM v[96:99], a[152:155], a[224:227], v[96:99]
 buffer_store_dwordx4 v[160:163], v245, s[8:11], s48 offen offset:0 sc1
 MM v[100:103], a[152:155], a[228:231], v[100:103]
 CB v164, v40, v41
 v_min_u32_e64 v164, -2, v164
 MM v[104:107], a[152:155], a[232:235], v[104:107]
 CB v165, v42, v43
 v_min_u32_e64 v165, -2, v165
 MM v[108:111], a[152:155], a[236:239], v[108:111]
 CB v166, v56, v57
 v_min_u32_e64 v166, -2, v166
 MM v[124:127], a[156:159], a[236:239], v[124:127]
 CB v167, v58, v59
 v_min_u32_e64 v167, -2, v167
 MM v[120:123], a[156:159], a[232:235], v[120:123]
 buffer_store_dwordx4 v[164:167], v245, s[8:11], s48 offen offset:1024 sc1
 MM v[116:119], a[156:159], a[228:231], v[116:119]
 CB v168, v12, v13
 v_min_u32_e64 v168, -2, v168
 MM v[112:115], a[156:159], a[224:227], v[112:115]
 s_waitcnt lgkmcnt(8)
 s_waitcnt vmcnt(38)
 MM v[64:67], a[160:163], a[240:243], v[64:67]
 ds_read_b64_tr_b16 a[224:225], v198 offset:36864
 CB v169, v14, v15
 MM v[68:71], a[160:163], a[244:247], v[68:71]
 ds_read_b64_tr_b16 a[226:227], v198 offset:37376
 v_min_u32_e64 v169, -2, v169
 MM v[72:75], a[160:163], a[248:251], v[72:75]
 ds_read_b64_tr_b16 a[228:229], v199 offset:36864
 CB v170, v28, v29
 MM v[76:79], a[160:163], a[252:255], v[76:79]
 ds_read_b64_tr_b16 a[230:231], v199 offset:37376
 v_min_u32_e64 v170, -2, v170
 MM v[92:95], a[164:167], a[252:255], v[92:95]
 ds_read_b64_tr_b16 a[232:233], v200 offset:36864
 CB v171, v30, v31
 MM v[88:91], a[164:167], a[248:251], v[88:91]
 ds_read_b64_tr_b16 a[234:235], v200 offset:37376
 v_min_u32_e64 v171, -2, v171
 MM v[84:87], a[164:167], a[244:247], v[84:87]
 ds_read_b64_tr_b16 a[236:237], v201 offset:36864
 CB v172, v44, v45
 MM v[80:83], a[164:167], a[240:243], v[80:83]
 ds_read_b64_tr_b16 a[238:239], v201 offset:37376
 v_min_u32_e64 v172, -2, v172
 MM v[96:99], a[168:171], a[240:243], v[96:99]
 buffer_store_dwordx4 v[168:171], v245, s[8:11], s48 offen offset:2048 sc1
 MM v[100:103], a[168:171], a[244:247], v[100:103]
 CB v173, v46, v47
 v_min_u32_e64 v173, -2, v173
 MM v[104:107], a[168:171], a[248:251], v[104:107]
 CB v174, v60, v61
 v_min_u32_e64 v174, -2, v174
 MM v[108:111], a[168:171], a[252:255], v[108:111]
 CB v175, v62, v63
 v_min_u32_e64 v175, -2, v175
 MM v[124:127], a[172:175], a[252:255], v[124:127]
 buffer_store_dwordx4 v[172:175], v245, s[8:11], s48 offen offset:3072 sc1
 MM v[120:123], a[172:175], a[248:251], v[120:123]
 MM v[116:119], a[172:175], a[244:247], v[116:119]
 MM v[112:115], a[172:175], a[240:243], v[112:115]
 s_waitcnt lgkmcnt(8)
 s_waitcnt vmcnt(36)
 MM v[64:67], a[176:179], a[208:211], v[64:67]
 ds_read_b64_tr_b16 a[240:241], v198 offset:40960
 MM v[68:71], a[176:179], a[212:215], v[68:71]
 ds_read_b64_tr_b16 a[242:243], v198 offset:41472
 MM v[72:75], a[176:179], a[216:219], v[72:75]
 ds_read_b64_tr_b16 a[244:245], v199 offset:40960
 MM v[76:79], a[176:179], a[220:223], v[76:79]
 ds_read_b64_tr_b16 a[246:247], v199 offset:41472
 MM v[92:95], a[180:183], a[220:223], v[92:95]
 ds_read_b64_tr_b16 a[248:249], v200 offset:40960
 MM v[88:91], a[180:183], a[216:219], v[88:91]
 ds_read_b64_tr_b16 a[250:251], v200 offset:41472
 MM v[84:87], a[180:183], a[212:215], v[84:87]
 ds_read_b64_tr_b16 a[252:253], v201 offset:40960
 MM v[80:83], a[180:183], a[208:211], v[80:83]
 ds_read_b64_tr_b16 a[254:255], v201 offset:41472
 MM v[96:99], a[184:187], a[208:211], v[96:99]
 MM v[100:103], a[184:187], a[212:215], v[100:103]
 MM v[104:107], a[184:187], a[216:219], v[104:107]
 MM v[108:111], a[184:187], a[220:223], v[108:111]
 MM v[124:127], a[188:191], a[220:223], v[124:127]
 MM v[120:123], a[188:191], a[216:219], v[120:123]
 MM v[116:119], a[188:191], a[212:215], v[116:119]
 MM v[112:115], a[188:191], a[208:211], v[112:115]
 s_waitcnt lgkmcnt(8)
 s_waitcnt vmcnt(32)
 MM v[64:67], a[192:195], a[224:227], v[64:67]
 ds_read_b64_tr_b16 a[208:209], v198 offset:45056
 MM v[68:71], a[192:195], a[228:231], v[68:71]
 ds_read_b64_tr_b16 a[210:211], v198 offset:45568
 MM v[72:75], a[192:195], a[232:235], v[72:75]
 ds_read_b64_tr_b16 a[212:213], v199 offset:45056
 MM v[76:79], a[192:195], a[236:239], v[76:79]
 ds_read_b64_tr_b16 a[214:215], v199 offset:45568
 MM v[92:95], a[196:199], a[236:239], v[92:95]
 ds_read_b64_tr_b16 a[216:217], v200 offset:45056
 MM v[88:91], a[196:199], a[232:235], v[88:91]
 ds_read_b64_tr_b16 a[218:219], v200 offset:45568
 MM v[84:87], a[196:199], a[228:231], v[84:87]
 ds_read_b64_tr_b16 a[220:221], v201 offset:45056
 MM v[80:83], a[196:199], a[224:227], v[80:83]
 ds_read_b64_tr_b16 a[222:223], v201 offset:45568
 MM v[96:99], a[200:203], a[224:227], v[96:99]
 MM v[100:103], a[200:203], a[228:231], v[100:103]
 MM v[104:107], a[200:203], a[232:235], v[104:107]
 MM v[108:111], a[200:203], a[236:239], v[108:111]
 MM v[124:127], a[204:207], a[236:239], v[124:127]
 MM v[120:123], a[204:207], a[232:235], v[120:123]
 MM v[116:119], a[204:207], a[228:231], v[116:119]
 MM v[112:115], a[204:207], a[224:227], v[112:115]
 s_waitcnt lgkmcnt(8)
 s_waitcnt vmcnt(28)
 MM v[64:67], a[80:83], a[240:243], v[64:67]
 ds_read_b64_tr_b16 a[224:225], v198 offset:49152
 MM v[68:71], a[80:83], a[244:247], v[68:71]
 ds_read_b64_tr_b16 a[226:227], v198 offset:49664
 MM v[72:75], a[80:83], a[248:251], v[72:75]
 ds_read_b64_tr_b16 a[228:229], v199 offset:49152
 MM v[76:79], a[80:83], a[252:255], v[76:79]
 ds_read_b64_tr_b16 a[230:231], v199 offset:49664
 MM v[92:95], a[84:87], a[252:255], v[92:95]
 ds_read_b64_tr_b16 a[232:233], v200 offset:49152
 MM v[88:91], a[84:87], a[248:251], v[88:91]
 ds_read_b64_tr_b16 a[234:235], v200 offset:49664
 MM v[84:87], a[84:87], a[244:247], v[84:87]
 ds_read_b64_tr_b16 a[236:237], v201 offset:49152
 MM v[80:83], a[84:87], a[240:243], v[80:83]
 ds_read_b64_tr_b16 a[238:239], v201 offset:49664
 MM v[96:99], a[88:91], a[240:243], v[96:99]
 MM v[100:103], a[88:91], a[244:247], v[100:103]
 MM v[104:107], a[88:91], a[248:251], v[104:107]
 MM v[108:111], a[88:91], a[252:255], v[108:111]
 MM v[124:127], a[92:95], a[252:255], v[124:127]
 MM v[120:123], a[92:95], a[248:251], v[120:123]
 MM v[116:119], a[92:95], a[244:247], v[116:119]
 MM v[112:115], a[92:95], a[240:243], v[112:115]
 s_waitcnt lgkmcnt(8)
 s_waitcnt vmcnt(24)
 MM v[64:67], a[96:99], a[208:211], v[64:67]
 ds_read_b64_tr_b16 a[240:241], v198 offset:53248
 MM v[68:71], a[96:99], a[212:215], v[68:71]
 ds_read_b64_tr_b16 a[242:243], v198 offset:53760
 MM v[72:75], a[96:99], a[216:219], v[72:75]
 ds_read_b64_tr_b16 a[244:245], v199 offset:53248
 MM v[76:79], a[96:99], a[220:223], v[76:79]
 ds_read_b64_tr_b16 a[246:247], v199 offset:53760
 MM v[92:95], a[100:103], a[220:223], v[92:95]
 ds_read_b64_tr_b16 a[248:249], v200 offset:53248
 MM v[88:91], a[100:103], a[216:219], v[88:91]
 ds_read_b64_tr_b16 a[250:251], v200 offset:53760
 MM v[84:87], a[100:103], a[212:215], v[84:87]
 ds_read_b64_tr_b16 a[252:253], v201 offset:53248
 MM v[80:83], a[100:103], a[208:211], v[80:83]
 ds_read_b64_tr_b16 a[254:255], v201 offset:53760
 MM v[96:99], a[104:107], a[208:211], v[96:99]
 MM v[100:103], a[104:107], a[212:215], v[100:103]
 MM v[104:107], a[104:107], a[216:219], v[104:107]
 MM v[108:111], a[104:107], a[220:223], v[108:111]
 MM v[124:127], a[108:111], a[220:223], v[124:127]
 MM v[120:123], a[108:111], a[216:219], v[120:123]
 MM v[116:119], a[108:111], a[212:215], v[116:119]
 MM v[112:115], a[108:111], a[208:211], v[112:115]
 s_waitcnt lgkmcnt(8)
 s_waitcnt vmcnt(20)
 MM v[64:67], a[112:115], a[224:227], v[64:67]
 ds_read_b64_tr_b16 a[208:209], v198 offset:57344
 MM v[68:71], a[112:115], a[228:231], v[68:71]
 ds_read_b64_tr_b16 a[210:211], v198 offset:57856
 MM v[72:75], a[112:115], a[232:235], v[72:75]
 ds_read_b64_tr_b16 a[212:213], v199 offset:57344
 MM v[76:79], a[112:115], a[236:239], v[76:79]
 ds_read_b64_tr_b16 a[214:215], v199 offset:57856
 MM v[92:95], a[116:119], a[236:239], v[92:95]
 ds_read_b64_tr_b16 a[216:217], v200 offset:57344
 MM v[88:91], a[116:119], a[232:235], v[88:91]
 ds_read_b64_tr_b16 a[218:219], v200 offset:57856
 MM v[84:87], a[116:119], a[228:231], v[84:87]
 ds_read_b64_tr_b16 a[220:221], v201 offset:57344
 MM v[80:83], a[116:119], a[224:227], v[80:83]
 ds_read_b64_tr_b16 a[222:223], v201 offset:57856
 MM v[96:99], a[120:123], a[224:227], v[96:99]
 MM v[100:103], a[120:123], a[228:231], v[100:103]
 MM v[104:107], a[120:123], a[232:235], v[104:107]
 MM v[108:111], a[120:123], a[236:239], v[108:111]
 MM v[124:127], a[124:127], a[236:239], v[124:127]
 MM v[120:123], a[124:127], a[232:235], v[120:123]
 MM v[116:119], a[124:127], a[228:231], v[116:119]
 MM v[112:115], a[124:127], a[224:227], v[112:115]
 s_waitcnt lgkmcnt(8)
 s_waitcnt vmcnt(16)
 MM v[64:67], a[128:131], a[240:243], v[64:67]
 ds_read_b64_tr_b16 a[224:225], v198 offset:61440
 MM v[68:71], a[128:131], a[244:247], v[68:71]
 ds_read_b64_tr_b16 a[226:227], v198 offset:61952
 MM v[72:75], a[128:131], a[248:251], v[72:75]
 ds_read_b64_tr_b16 a[228:229], v199 offset:61440
 MM v[76:79], a[128:131], a[252:255], v[76:79]
 ds_read_b64_tr_b16 a[230:231], v199 offset:61952
 MM v[92:95], a[132:135], a[252:255], v[92:95]
 ds_read_b64_tr_b16 a[232:233], v200 offset:61440
 MM v[88:91], a[132:135], a[248:251], v[88:91]
 ds_read_b64_tr_b16 a[234:235], v200 offset:61952
 MM v[84:87], a[132:135], a[244:247], v[84:87]
 ds_read_b64_tr_b16 a[236:237], v201 offset:61440
 MM v[80:83], a[132:135], a[240:243], v[80:83]
 ds_read_b64_tr_b16 a[238:239], v201 offset:61952
 MM v[96:99], a[0:3], a[240:243], v[96:99]
 MM v[100:103], a[0:3], a[244:247], v[100:103]
 MM v[104:107], a[0:3], a[248:251], v[104:107]
 MM v[108:111], a[0:3], a[252:255], v[108:111]
 MM v[124:127], a[4:7], a[252:255], v[124:127]
 MM v[120:123], a[4:7], a[248:251], v[120:123]
 MM v[116:119], a[4:7], a[244:247], v[116:119]
 MM v[112:115], a[4:7], a[240:243], v[112:115]
 s_waitcnt lgkmcnt(8)
 s_waitcnt vmcnt(12)
 MM v[64:67], a[8:11], a[208:211], v[64:67]
 buffer_load_dwordx4 v[128:131], v245, s[8:11], s57 offen offset:0 sc1
 MM v[68:71], a[8:11], a[212:215], v[68:71]
 buffer_load_dwordx4 v[132:135], v245, s[8:11], s57 offen offset:1024 sc1
 MM v[72:75], a[8:11], a[216:219], v[72:75]
 buffer_load_dwordx4 v[136:139], v245, s[8:11], s57 offen offset:2048 sc1
 MM v[76:79], a[8:11], a[220:223], v[76:79]
 buffer_load_dwordx4 v[140:143], v245, s[8:11], s57 offen offset:3072 sc1
 MM v[92:95], a[12:15], a[220:223], v[92:95]
 buffer_load_dwordx4 v[144:147], v245, s[8:11], s58 offen offset:0 sc1
 MM v[88:91], a[12:15], a[216:219], v[88:91]
 buffer_load_dwordx4 v[148:151], v245, s[8:11], s58 offen offset:1024 sc1
 MM v[84:87], a[12:15], a[212:215], v[84:87]
 buffer_load_dwordx4 v[152:155], v245, s[8:11], s58 offen offset:2048 sc1
 MM v[80:83], a[12:15], a[208:211], v[80:83]
 buffer_load_dwordx4 v[156:159], v245, s[8:11], s58 offen offset:3072 sc1
 MM v[96:99], a[16:19], a[208:211], v[96:99]
 MM v[100:103], a[16:19], a[212:215], v[100:103]
 MM v[104:107], a[16:19], a[216:219], v[104:107]
 MM v[108:111], a[16:19], a[220:223], v[108:111]
 MM v[124:127], a[20:23], a[220:223], v[124:127]
 MM v[120:123], a[20:23], a[216:219], v[120:123]
 MM v[116:119], a[20:23], a[212:215], v[116:119]
 MM v[112:115], a[20:23], a[208:211], v[112:115]
 s_waitcnt lgkmcnt(0)
 s_waitcnt vmcnt(16)
 MM v[64:67], a[24:27], a[224:227], v[64:67]
 MM v[68:71], a[24:27], a[228:231], v[68:71]
 MM v[72:75], a[24:27], a[232:235], v[72:75]
 MM v[76:79], a[24:27], a[236:239], v[76:79]
 MM v[92:95], a[28:31], a[236:239], v[92:95]
 MM v[88:91], a[28:31], a[232:235], v[88:91]
 MM v[84:87], a[28:31], a[228:231], v[84:87]
 MM v[80:83], a[28:31], a[224:227], v[80:83]
 MM v[96:99], a[32:35], a[224:227], v[96:99]
 MM v[100:103], a[32:35], a[228:231], v[100:103]
 MM v[104:107], a[32:35], a[232:235], v[104:107]
 MM v[108:111], a[32:35], a[236:239], v[108:111]
 MM v[124:127], a[36:39], a[236:239], v[124:127]
 MM v[120:123], a[36:39], a[232:235], v[120:123]
 MM v[116:119], a[36:39], a[228:231], v[116:119]
 MM v[112:115], a[36:39], a[224:227], v[112:115]
 v_lshlrev_b32 v208, 16, v176
 v_and_b32 v209, s90, v176
 v_pk_add_f32 v[64:65], v[64:65], v[208:209]
 v_lshlrev_b32 v210, 16, v177
 v_and_b32 v211, s90, v177
 v_pk_add_f32 v[66:67], v[66:67], v[210:211]
 v_lshlrev_b32 v212, 16, v178
 v_and_b32 v213, s90, v178
 v_pk_add_f32 v[80:81], v[80:81], v[212:213]
 v_lshlrev_b32 v214, 16, v179
 v_and_b32 v215, s90, v179
 v_pk_add_f32 v[82:83], v[82:83], v[214:215]
 v_lshlrev_b32 v208, 16, v180
 v_and_b32 v209, s90, v180
 v_pk_add_f32 v[96:97], v[96:97], v[208:209]
 v_lshlrev_b32 v210, 16, v181
 v_and_b32 v211, s90, v181
 v_pk_add_f32 v[98:99], v[98:99], v[210:211]
 v_lshlrev_b32 v212, 16, v182
 v_and_b32 v213, s90, v182
 v_pk_add_f32 v[112:113], v[112:113], v[212:213]
 v_lshlrev_b32 v214, 16, v183
 v_and_b32 v215, s90, v183
 v_pk_add_f32 v[114:115], v[114:115], v[214:215]
 v_lshlrev_b32 v208, 16, v184
 v_and_b32 v209, s90, v184
 v_pk_add_f32 v[68:69], v[68:69], v[208:209]
 v_lshlrev_b32 v210, 16, v185
 v_and_b32 v211, s90, v185
 v_pk_add_f32 v[70:71], v[70:71], v[210:211]
 v_lshlrev_b32 v212, 16, v186
 v_and_b32 v213, s90, v186
 v_pk_add_f32 v[84:85], v[84:85], v[212:213]
 v_lshlrev_b32 v214, 16, v187
 v_and_b32 v215, s90, v187
 v_pk_add_f32 v[86:87], v[86:87], v[214:215]
 v_lshlrev_b32 v208, 16, v188
 v_and_b32 v209, s90, v188
 v_pk_add_f32 v[100:101], v[100:101], v[208:209]
 v_lshlrev_b32 v210, 16, v189
 v_and_b32 v211, s90, v189
 v_pk_add_f32 v[102:103], v[102:103], v[210:211]
 v_lshlrev_b32 v212, 16, v190
 v_and_b32 v213, s90, v190
 v_pk_add_f32 v[116:117], v[116:117], v[212:213]
 v_lshlrev_b32 v214, 16, v191
 v_and_b32 v215, s90, v191
 v_pk_add_f32 v[118:119], v[118:119], v[214:215]
 v_lshlrev_b32 v208, 16, v226
 v_and_b32 v209, s90, v226
 v_pk_add_f32 v[72:73], v[72:73], v[208:209]
 v_lshlrev_b32 v210, 16, v227
 v_and_b32 v211, s90, v227
 v_pk_add_f32 v[74:75], v[74:75], v[210:211]
 v_lshlrev_b32 v212, 16, v228
 v_and_b32 v213, s90, v228
 v_pk_add_f32 v[88:89], v[88:89], v[212:213]
 v_lshlrev_b32 v214, 16, v229
 v_and_b32 v215, s90, v229
 v_pk_add_f32 v[90:91], v[90:91], v[214:215]
 v_lshlrev_b32 v208, 16, v230
 v_and_b32 v209, s90, v230
 v_pk_add_f32 v[104:105], v[104:105], v[208:209]
 v_lshlrev_b32 v210, 16, v231
 v_and_b32 v211, s90, v231
 v_pk_add_f32 v[106:107], v[106:107], v[210:211]
 v_lshlrev_b32 v212, 16, v232
 v_and_b32 v213, s90, v232
 v_pk_add_f32 v[120:121], v[120:121], v[212:213]
 v_lshlrev_b32 v214, 16, v233
 v_and_b32 v215, s90, v233
 v_pk_add_f32 v[122:123], v[122:123], v[214:215]
 v_lshlrev_b32 v208, 16, v234
 v_and_b32 v209, s90, v234
 v_pk_add_f32 v[76:77], v[76:77], v[208:209]
 v_lshlrev_b32 v210, 16, v235
 v_and_b32 v211, s90, v235
 v_pk_add_f32 v[78:79], v[78:79], v[210:211]
 v_lshlrev_b32 v212, 16, v236
 v_and_b32 v213, s90, v236
 v_pk_add_f32 v[92:93], v[92:93], v[212:213]
 v_lshlrev_b32 v214, 16, v237
 v_and_b32 v215, s90, v237
 v_pk_add_f32 v[94:95], v[94:95], v[214:215]
 v_lshlrev_b32 v208, 16, v238
 v_and_b32 v209, s90, v238
 v_pk_add_f32 v[108:109], v[108:109], v[208:209]
 v_lshlrev_b32 v210, 16, v239
 v_and_b32 v211, s90, v239
 v_pk_add_f32 v[110:111], v[110:111], v[210:211]
 v_lshlrev_b32 v212, 16, v240
 v_and_b32 v213, s90, v240
 v_pk_add_f32 v[124:125], v[124:125], v[212:213]
 v_lshlrev_b32 v214, 16, v241
 v_and_b32 v215, s90, v241
 v_pk_add_f32 v[126:127], v[126:127], v[214:215]
 s_mov_b32 s59, 0
tail_kernel_poll:
 s_waitcnt vmcnt(0)
 v_max3_u32 v206, v128, v129, v130
 v_max3_u32 v207, v131, v132, v133
 v_max3_u32 v206, v206, v134, v135
 v_max3_u32 v207, v207, v136, v137
 v_max3_u32 v206, v206, v138, v139
 v_max3_u32 v207, v207, v140, v141
 v_max3_u32 v206, v206, v142, v143
 v_max3_u32 v207, v207, v144, v145
 v_max3_u32 v206, v206, v146, v147
 v_max3_u32 v207, v207, v148, v149
 v_max3_u32 v206, v206, v150, v151
 v_max3_u32 v207, v207, v152, v153
 v_max3_u32 v206, v206, v154, v155
 v_max3_u32 v207, v207, v156, v157
 v_max3_u32 v206, v206, v158, v159
 v_max_u32 v206, v206, v207
 v_cmp_eq_u32_e64 vcc, -1, v206
 s_cbranch_vccz tail_kernel_go
 buffer_load_dwordx4 v[128:131], v245, s[8:11], s57 offen offset:0 sc1
 buffer_load_dwordx4 v[132:135], v245, s[8:11], s57 offen offset:1024 sc1
 buffer_load_dwordx4 v[136:139], v245, s[8:11], s57 offen offset:2048 sc1
 buffer_load_dwordx4 v[140:143], v245, s[8:11], s57 offen offset:3072 sc1
 buffer_load_dwordx4 v[144:147], v245, s[8:11], s58 offen offset:0 sc1
 buffer_load_dwordx4 v[148:151], v245, s[8:11], s58 offen offset:1024 sc1
 buffer_load_dwordx4 v[152:155], v245, s[8:11], s58 offen offset:2048 sc1
 buffer_load_dwordx4 v[156:159], v245, s[8:11], s58 offen offset:3072 sc1
 s_add_u32 s59, s59, 1
 s_nop 0
 s_cmp_lt_u32 s59, 0x40000
 s_cbranch_scc1 tail_kernel_poll
 s_waitcnt vmcnt(0)
tail_kernel_go:
 s_add_u32 s50, s49, 0
 v_lshlrev_b32 v208, 16, v128
 v_and_b32_e64 v209, s90, v128
 v_pk_add_f32 v[64:65], v[64:65], v[208:209]
 CB v128, v64, v65
 v_lshlrev_b32 v210, 16, v129
 v_and_b32 v211, s90, v129
 v_pk_add_f32 v[66:67], v[66:67], v[210:211]
 CB v129, v66, v67
 v_lshlrev_b32 v212, 16, v130
 v_and_b32 v213, s90, v130
 v_pk_add_f32 v[80:81], v[80:81], v[212:213]
 CB v130, v80, v81
 v_lshlrev_b32 v214, 16, v131
 v_and_b32 v215, s90, v131
 v_pk_add_f32 v[82:83], v[82:83], v[214:215]
 CB v131, v82, v83
 buffer_store_dwordx4 v[128:131], v195, s[28:31], s50 offen offset:0 sc1
 v_lshlrev_b32 v208, 16, v132
 v_and_b32 v209, s90, v132
 v_pk_add_f32 v[96:97], v[96:97], v[208:209]
 CB v132, v96, v97
 v_lshlrev_b32 v210, 16, v133
 v_and_b32 v211, s90, v133
 v_pk_add_f32 v[98:99], v[98:99], v[210:211]
 CB v133, v98, v99
 v_lshlrev_b32 v212, 16, v134
 v_and_b32 v213, s90, v134
 v_pk_add_f32 v[112:113], v[112:113], v[212:213]
 CB v134, v112, v113
 v_lshlrev_b32 v214, 16, v135
 v_and_b32 v215, s90, v135
 v_pk_add_f32 v[114:115], v[114:115], v[214:215]
 CB v135, v114, v115
 buffer_store_dwordx4 v[132:135], v195, s[28:31], s50 offen offset:64 sc1
 s_add_u32 s50, s49, 16384
 v_lshlrev_b32 v208, 16, v136
 v_and_b32 v209, s90, v136
 v_pk_add_f32 v[68:69], v[68:69], v[208:209]
 CB v136, v68, v69
 v_lshlrev_b32 v210, 16, v137
 v_and_b32 v211, s90, v137
 v_pk_add_f32 v[70:71], v[70:71], v[210:211]
 CB v137, v70, v71
 v_lshlrev_b32 v212, 16, v138
 v_and_b32 v213, s90, v138
 v_pk_add_f32 v[84:85], v[84:85], v[212:213]
 CB v138, v84, v85
 v_lshlrev_b32 v214, 16, v139
 v_and_b32 v215, s90, v139
 v_pk_add_f32 v[86:87], v[86:87], v[214:215]
 CB v139, v86, v87
 buffer_store_dwordx4 v[136:139], v195, s[28:31], s50 offen offset:0 sc1
 v_lshlrev_b32 v208, 16, v140
 v_and_b32 v209, s90, v140
 v_pk_add_f32 v[100:101], v[100:101], v[208:209]
 CB v140, v100, v101
 v_lshlrev_b32 v210, 16, v141
 v_and_b32 v211, s90, v141
 v_pk_add_f32 v[102:103], v[102:103], v[210:211]
 CB v141, v102, v103
 v_lshlrev_b32 v212, 16, v142
 v_and_b32 v213, s90, v142
 v_pk_add_f32 v[116:117], v[116:117], v[212:213]
 CB v142, v116, v117
 v_lshlrev_b32 v214, 16, v143
 v_and_b32 v215, s90, v143
 v_pk_add_f32 v[118:119], v[118:119], v[214:215]
 CB v143, v118, v119
 buffer_store_dwordx4 v[140:143], v195, s[28:31], s50 offen offset:64 sc1
 s_add_u32 s50, s49, 32768
 v_lshlrev_b32 v208, 16, v144
 v_and_b32 v209, s90, v144
 v_pk_add_f32 v[72:73], v[72:73], v[208:209]
 CB v144, v72, v73
 v_lshlrev_b32 v210, 16, v145
 v_and_b32 v211, s90, v145
 v_pk_add_f32 v[74:75], v[74:75], v[210:211]
 CB v145, v74, v75
 v_lshlrev_b32 v212, 16, v146
 v_and_b32 v213, s90, v146
 v_pk_add_f32 v[88:89], v[88:89], v[212:213]
 CB v146, v88, v89
 v_lshlrev_b32 v214, 16, v147
 v_and_b32 v215, s90, v147
 v_pk_add_f32 v[90:91], v[90:91], v[214:215]
 CB v147, v90, v91
 buffer_store_dwordx4 v[144:147], v195, s[28:31], s50 offen offset:0 sc1
 v_lshlrev_b32 v208, 16, v148
 v_and_b32 v209, s90, v148
 v_pk_add_f32 v[104:105], v[104:105], v[208:209]
 CB v148, v104, v105
 v_lshlrev_b32 v210, 16, v149
 v_and_b32 v211, s90, v149
 v_pk_add_f32 v[106:107], v[106:107], v[210:211]
 CB v149, v106, v107
 v_lshlrev_b32 v212, 16, v150
 v_and_b32 v213, s90, v150
 v_pk_add_f32 v[120:121], v[120:121], v[212:213]
 CB v150, v120, v121
 v_lshlrev_b32 v214, 16, v151
 v_and_b32 v215, s90, v151
 v_pk_add_f32 v[122:123], v[122:123], v[214:215]
 CB v151, v122, v123
 buffer_store_dwordx4 v[148:151], v195, s[28:31], s50 offen offset:64 sc1
 s_add_u32 s50, s49, 49152
 v_lshlrev_b32 v208, 16, v152
 v_and_b32 v209, s90, v152
 v_pk_add_f32 v[76:77], v[76:77], v[208:209]
 CB v152, v76, v77
 v_lshlrev_b32 v210, 16, v153
 v_and_b32 v211, s90, v153
 v_pk_add_f32 v[78:79], v[78:79], v[210:211]
 CB v153, v78, v79
 v_lshlrev_b32 v212, 16, v154
 v_and_b32 v213, s90, v154
 v_pk_add_f32 v[92:93], v[92:93], v[212:213]
 CB v154, v92, v93
 v_lshlrev_b32 v214, 16, v155
 v_and_b32 v215, s90, v155
 v_pk_add_f32 v[94:95], v[94:95], v[214:215]
 CB v155, v94, v95
 buffer_store_dwordx4 v[152:155], v195, s[28:31], s50 offen offset:0 sc1
 v_lshlrev_b32 v208, 16, v156
 v_and_b32 v209, s90, v156
 v_pk_add_f32 v[108:109], v[108:109], v[208:209]
 CB v156, v108, v109
 v_lshlrev_b32 v210, 16, v157
 v_and_b32 v211, s90, v157
 v_pk_add_f32 v[110:111], v[110:111], v[210:211]
 CB v157, v110, v111
 v_lshlrev_b32 v212, 16, v158
 v_and_b32 v213, s90, v158
 v_pk_add_f32 v[124:125], v[124:125], v[212:213]
 CB v158, v124, v125
 v_lshlrev_b32 v214, 16, v159
 v_and_b32 v215, s90, v159
 v_pk_add_f32 v[126:127], v[126:127], v[214:215]
 CB v159, v126, v127
 buffer_store_dwordx4 v[156:159], v195, s[28:31], s50 offen offset:64 sc1
tail_kernel_fin:
 s_endpgm
tail_kernel_out:
 v_mov_b32 v70, 1
 v_mov_b32_e64 v71, 0
 s_waitcnt vmcnt(0)
 s_mov_b64 exec, 1
 buffer_atomic_add v70, v71, s[8:11], s87 offen sc1
 s_mov_b64 exec, -1
tail_kernel_end:
 s_endpgm
.section .rodata,"a"
.p2align 6
.amdhsa_kernel prep_kernel
  .amdhsa_next_free_vgpr 208
  .amdhsa_next_free_sgpr 96
  .amdhsa_accum_offset 208
  .amdhsa_group_segment_fixed_size 0
  .amdhsa_kernarg_size 88
  .amdhsa_user_sgpr_count 2
  .amdhsa_user_sgpr_kernarg_segment_ptr 1
  .amdhsa_system_sgpr_workgroup_id_x 1
.end_amdhsa_kernel
.p2align 6
.amdhsa_kernel in_kernel
  .amdhsa_next_free_vgpr 512
  .amdhsa_next_free_sgpr 96
  .amdhsa_accum_offset 256
  .amdhsa_group_segment_fixed_size 0
  .amdhsa_kernarg_size 88
  .amdhsa_user_sgpr_count 2
  .amdhsa_user_sgpr_kernarg_segment_ptr 1
  .amdhsa_system_sgpr_workgroup_id_x 1
.end_amdhsa_kernel
```
